```python
import torch

def _softmax(x, axis=-1):
    return torch.softmax(x, dim=axis)
def _gelu(x):
    return torch.nn.functional.gelu(x, approximate="tanh")
def _silu(x):
    return torch.nn.functional.silu(x)
def _sigmoid(x):
    return torch.sigmoid(x)
def _layernorm(x, axis=-1, eps=1e-5):
    m = x.mean(dim=axis, keepdim=True)
    v = x.var(dim=axis, keepdim=True, unbiased=False)
    return (x - m) / torch.sqrt(v + eps)
def _scatter_add(tgt, idx, src, axis=0):
    return tgt.clone().index_add_(axis, idx, src)
def _segment_sum(src, seg, n):
    out = torch.zeros((n,) + src.shape[1:], dtype=src.dtype)
    return out.index_add_(0, seg, src)
def _pad(x, pw):
    flat = tuple(v for pair in reversed(pw) for v in pair)
    return torch.nn.functional.pad(x, flat)

kernel_name = 'recurrent_scan__linear_attn_block__glu_gated_swiglu__prompt'

def setup_inputs():

    _w = (lambda a: (lambda t: t.to(torch.bfloat16) if t.is_floating_point() else t)(torch.as_tensor(a)))
    def _A_setup():
        B, S, D = 1, 2048, 640
        return {
            "x": _w((lambda *s: torch.randn(*s, dtype=torch.bfloat16) * 0.05)(B, S, D)),
            "wqkv": _w((lambda *s: torch.randn(*s, dtype=torch.bfloat16) * 0.8)(D, 3 * D)),
            "wo": _w((lambda *s: torch.randn(*s, dtype=torch.bfloat16) * 0.8)(D, D)),
        }
    _A_in = _A_setup()

    def _B_setup():
        B, S, D, F = 1, 2048, 640, 1728
        return {
            "x": _w((lambda *s: torch.randn(*s, dtype=torch.bfloat16) * 0.05)(B, S, D)),
            "w1": _w((lambda *s: torch.randn(*s, dtype=torch.bfloat16) * 0.2)(D, F) * (2.0 / D) ** 0.5),
            "w3": _w((lambda *s: torch.randn(*s, dtype=torch.bfloat16) * 0.2)(D, F) * (2.0 / D) ** 0.5),
            "w2": _w((lambda *s: torch.randn(*s, dtype=torch.bfloat16) * 0.2)(F, D) * (2.0 / F) ** 0.5),
        }
    _B_in = _B_setup()

    return {
        "A_x": _A_in["x"],
        "A_wqkv": _A_in["wqkv"],
        "A_wo": _A_in["wo"],
        "B_x": _B_in["x"],
        "B_w1": _B_in["w1"],
        "B_w3": _B_in["w3"],
        "B_w2": _B_in["w2"],
    }

def reference(A_x, A_wqkv, A_wo, B_x, B_w1, B_w3, B_w2):
    def _A_ref(x, wqkv, wo):
        B, S, D = x.shape
        H = 32; Dh = D // H
        qkv = (lambda x, *d: x.permute(*d))((x @ wqkv).reshape(B, S, 3, H, Dh), 2, 0, 3, 1, 4)
        q, k, v = qkv[0], qkv[1], qkv[2]
        phi = lambda t: torch.where(t > 0, t + 1, torch.exp(t)) + 1e-6
        pq, pk = phi(q), phi(k)
        kv = torch.einsum("bhsd,bhse->bhde", pk, v)
        z = torch.einsum("bhsd->bhd", pk)
        num = torch.einsum("bhqd,bhde->bhqe", pq, kv)
        den = torch.einsum("bhqd,bhd->bhq", pq, z)[..., None] + 1e-6
        o = num / den
        return (lambda x, *d: x.permute(*d))(o, 0, 2, 1, 3).reshape(B, S, D) @ wo

    def _B_ref(x, w1, w3, w2):
        gate = torch.einsum("bsd,df->bsf", x, w1)
        up = torch.einsum("bsd,df->bsf", x, w3)
        h = _silu(gate) * up
        out = torch.einsum("bsf,fd->bsd", h, w2)
        return out

    x = A_x
    xn = _layernorm(x, axis=-1)
    s = _A_ref(xn, A_wqkv, A_wo)
    g = _silu(_B_ref(xn, B_w1, B_w3, B_w2))
    return x + s * g
```

```asm
; @launch grid=(256,1,1) block=(512,1,1) lds=163840
.amdgcn_target "amdgcn-amd-amdhsa--gfx950"
.text
.globl recurrent_scan__linear_attn_block__glu_gated_swiglu__prompt_kernel
.p2align 8
.type recurrent_scan__linear_attn_block__glu_gated_swiglu__prompt_kernel,@function
recurrent_scan__linear_attn_block__glu_gated_swiglu__prompt_kernel:
    s_cmp_ge_u32 s2, 256
    s_cbranch_scc1 L_k1_exit
    s_load_dwordx2 s[4:5], s[0:1], 0
    s_load_dwordx4 s[64:67], s[0:1], 64
    s_load_dwordx2 s[36:37], s[0:1], 8
    s_load_dwordx4 s[40:43], s[0:1], 32
    s_load_dwordx2 s[80:81], s[0:1], 56
    v_and_b32 v1, 63, v0
    v_lshrrev_b32 v44, 6, v0
    s_and_b32 s32, s2, 7
    v_readfirstlane_b32 s20, v44
    s_lshr_b32 s33, s2, 3
    s_and_b32 s21, s32, 1
    s_lshl_b32 s21, s21, 2
    s_and_b32 s34, s33, 3
    s_add_u32 s21, s21, s34
    s_lshr_b32 s35, s32, 1
    s_lshl_b32 s35, s35, 3
    s_lshr_b32 s34, s33, 2
    s_add_u32 s35, s35, s34
    s_lshr_b32 s34, s35, 2
    s_mov_b32 s38, 0x3020100
    s_cmp_eq_u32 s34, 1
    s_cselect_b32 s38, 0x1a060504, s38
    s_cmp_eq_u32 s34, 2
    s_cselect_b32 s38, 0xa090807, s38
    s_cmp_eq_u32 s34, 3
    s_cselect_b32 s38, 0x1b0d0c0b, s38
    s_cmp_eq_u32 s34, 4
    s_cselect_b32 s38, 0x15141312, s38
    s_cmp_eq_u32 s34, 5
    s_cselect_b32 s38, 0x1c0f0e1e, s38
    s_cmp_eq_u32 s34, 6
    s_cselect_b32 s38, 0x19181716, s38
    s_cmp_eq_u32 s34, 7
    s_cselect_b32 s38, 0x1d11101f, s38
    s_and_b32 s34, s35, 3
    s_lshl_b32 s34, s34, 3
    s_lshr_b32 s35, s38, s34
    s_and_b32 s35, s35, 0xff
    s_add_u32 s25, s21, s35
    s_mov_b32 s25, s21
    s_and_b32 s25, s25, 1
    s_mov_b32 s89, 1
    s_and_b32 s31, s20, 3
    s_lshr_b32 s27, s20, 2
    s_lshl_b32 s32, s21, 3
    s_add_u32 s32, s32, s20
    s_mul_i32 s32, s32, 40960
    s_lshl_b32 s26, s20, 12
    s_add_u32 s26, s26, 98304
    v_lshrrev_b32 v44, 3, v1
    v_mul_u32_u24 v44, 1280, v44
    v_add_u32 v44, s32, v44
    v_lshrrev_b32 v45, 4, v1
    v_and_b32 v46, 7, v1
    v_xor_b32 v45, v45, v46
    v_lshl_add_u32 v2, v45, 4, v44
    v_xor_b32 v45, 4, v45
    v_lshl_add_u32 v3, v45, 4, v44
    v_add_u32 v3, 10240, v3
    v_add_u32 v4, 20480, v2
    v_add_u32 v5, 20480, v3
    v_and_b32 v46, 3, v1
    v_lshlrev_b32 v15, 4, v1
    s_waitcnt lgkmcnt(0)
    s_mov_b32 s8, s4
    s_and_b32 s9, s5, 0xffff
    s_mov_b32 s10, 2621440
    s_mov_b32 s11, 0x20000
    s_mov_b32 s16, s66
    s_and_b32 s17, s67, 0xffff
    s_mov_b32 s18, 14697472
    s_mov_b32 s19, 0x20000
    s_mov_b32 s44, s64
    s_and_b32 s45, s65, 0xffff
    s_mov_b32 s46, 256
    s_mov_b32 s47, 0x20000
    s_lshl_b32 s23, s25, 7
    s_cmp_ge_u32 s35, 30
    s_cbranch_scc1 L_k1_sp0
    s_add_u32 m0, s26, 0
    s_nop 0
    buffer_load_dwordx4 v2, s[8:11], s23 offen lds
    s_add_u32 m0, s26, 1024
    s_nop 0
    buffer_load_dwordx4 v3, s[8:11], s23 offen lds
    s_add_u32 m0, s26, 2048
    s_nop 0
    buffer_load_dwordx4 v4, s[8:11], s23 offen lds
    s_add_u32 m0, s26, 3072
    s_nop 0
    buffer_load_dwordx4 v5, s[8:11], s23 offen lds
L_k1_sp0:
    s_cmp_lt_u32 s35, 18
    s_cbranch_scc1 L_k1_ffn
    s_cmp_lt_u32 s35, 26
    s_cbranch_scc1 L_k1_kv
    s_cmp_lt_u32 s35, 30
    s_cbranch_scc1 L_k1_q
    s_sub_u32 s22, s35, 30
    s_and_b32 s32, s2, 7
    s_lshr_b32 s33, s2, 3
    s_lshr_b32 s82, s32, 1
    s_lshl_b32 s82, s82, 3
    s_and_b32 s34, s33, 7
    s_add_u32 s82, s82, s34
    s_and_b32 s83, s32, 1
    s_lshl_b32 s83, s83, 2
    s_lshr_b32 s34, s33, 3
    s_add_u32 s83, s83, s34
    s_lshl_b32 s79, s82, 3
    s_add_u32 s79, s79, s83
    s_lshl_b32 s79, s79, 9
    s_add_u32 s79, s79, 14560256
    s_lshl_b32 s68, s21, 14
    s_lshl_b32 s69, s35, 2
    s_sub_u32 s34, s69, 32
    s_cmp_ge_u32 s35, 26
    s_cselect_b32 s69, s34, s69
    s_add_u32 s68, s68, s69
    s_sub_u32 s69, s35, 18
    s_lshl_b32 s34, s69, 8
    s_lshl_b32 s38, s21, 2
    s_add_u32 s34, s34, s38
    s_add_u32 s34, s34, 131072
    s_cmp_lt_u32 s69, 8
    s_cselect_b32 s68, s34, s68
    s_cselect_b32 s69, 2, 32
    s_cselect_b32 s85, 7, 9
    s_lshl_b32 s34, s21, 1
    s_add_u32 s34, s34, s35
    s_add_u32 s34, s34, 18
    s_lshl_b32 s34, s34, 2
    s_cmp_ge_u32 s35, 30
    s_cselect_b32 s68, s34, s68
    s_cselect_b32 s69, 256, s69
    s_add_u32 s68, s68, 14560256
    s_lshl_b32 s32, s21, 1
    s_add_u32 s32, s32, s22
    s_lshl_b32 s52, s32, 3
    s_add_u32 s52, s52, s20
    s_load_dwordx2 s[40:41], s[0:1], 48
    s_load_dwordx2 s[42:43], s[0:1], 16
    s_mul_i32 s33, s52, 20480
    v_lshrrev_b32 v28, 3, v1
    v_mul_u32_u24 v29, 1280, v28
    v_and_b32 v31, 7, v1
    v_lshl_add_u32 v29, v31, 4, v29
    v_add_u32 v30, 10240, v29
    buffer_load_dwordx4 v[160:163], v29, s[8:11], s33 offen offset:0
    buffer_load_dwordx4 v[164:167], v30, s[8:11], s33 offen offset:0
    buffer_load_dwordx4 v[168:171], v29, s[8:11], s33 offen offset:128
    buffer_load_dwordx4 v[172:175], v30, s[8:11], s33 offen offset:128
    buffer_load_dwordx4 v[176:179], v29, s[8:11], s33 offen offset:256
    buffer_load_dwordx4 v[180:183], v30, s[8:11], s33 offen offset:256
    buffer_load_dwordx4 v[184:187], v29, s[8:11], s33 offen offset:384
    buffer_load_dwordx4 v[188:191], v30, s[8:11], s33 offen offset:384
    buffer_load_dwordx4 v[192:195], v29, s[8:11], s33 offen offset:512
    buffer_load_dwordx4 v[196:199], v30, s[8:11], s33 offen offset:512
    buffer_load_dwordx4 v[200:203], v29, s[8:11], s33 offen offset:640
    buffer_load_dwordx4 v[204:207], v30, s[8:11], s33 offen offset:640
    buffer_load_dwordx4 v[208:211], v29, s[8:11], s33 offen offset:768
    buffer_load_dwordx4 v[212:215], v30, s[8:11], s33 offen offset:768
    buffer_load_dwordx4 v[216:219], v29, s[8:11], s33 offen offset:896
    buffer_load_dwordx4 v[220:223], v30, s[8:11], s33 offen offset:896
    buffer_load_dwordx4 v[224:227], v29, s[8:11], s33 offen offset:1024
    buffer_load_dwordx4 v[228:231], v30, s[8:11], s33 offen offset:1024
    buffer_load_dwordx4 v[232:235], v29, s[8:11], s33 offen offset:1152
    buffer_load_dwordx4 v[236:239], v30, s[8:11], s33 offen offset:1152
    v_mov_b32 v44, 0
    v_mov_b32 v45, 0
    v_mov_b32 v46, 0
    v_mov_b32 v47, 0
    s_lshl_b32 s34, s52, 10
    s_add_u32 s34, s34, 14560256
    buffer_store_dwordx4 v[44:47], v15, s[16:19], s34 offen sc1
    s_lshl_b32 s78, s32, 7
    s_add_u32 s78, s78, 14691328
    v_and_b32 v48, 31, v1
    v_lshlrev_b32 v48, 2, v48
    buffer_store_dword v44, v48, s[16:19], s78 offen sc1
    s_waitcnt lgkmcnt(0)
    s_mov_b32 s12, s40
    s_and_b32 s13, s41, 0xffff
    s_mov_b32 s14, 2211840
    s_mov_b32 s15, 0x20000
    s_mov_b32 s88, s42
    s_and_b32 s89, s43, 0xffff
    s_mov_b32 s90, 819200
    s_mov_b32 s91, 0x20000
    s_mul_i32 s53, s20, 5120
    s_mul_i32 s34, s32, 40960
    s_add_u32 s34, s34, s53
    s_add_u32 m0, s53, 0
    s_add_u32 s35, s34, 0
    buffer_load_dwordx4 v15, s[12:15], s35 offen lds
    s_add_u32 m0, s53, 1024
    s_add_u32 s35, s34, 1024
    buffer_load_dwordx4 v15, s[12:15], s35 offen lds
    s_add_u32 m0, s53, 2048
    s_add_u32 s35, s34, 2048
    buffer_load_dwordx4 v15, s[12:15], s35 offen lds
    s_add_u32 m0, s53, 3072
    s_add_u32 s35, s34, 3072
    buffer_load_dwordx4 v15, s[12:15], s35 offen lds
    s_add_u32 m0, s53, 4096
    s_add_u32 s35, s34, 4096
    buffer_load_dwordx4 v15, s[12:15], s35 offen lds
    s_add_u32 m0, s53, 40960
    s_add_u32 s35, s34, 655360
    buffer_load_dwordx4 v15, s[12:15], s35 offen lds
    s_add_u32 m0, s53, 41984
    s_add_u32 s35, s34, 656384
    buffer_load_dwordx4 v15, s[12:15], s35 offen lds
    s_add_u32 m0, s53, 43008
    s_add_u32 s35, s34, 657408
    buffer_load_dwordx4 v15, s[12:15], s35 offen lds
    s_add_u32 m0, s53, 44032
    s_add_u32 s35, s34, 658432
    buffer_load_dwordx4 v15, s[12:15], s35 offen lds
    s_add_u32 m0, s53, 45056
    s_add_u32 s35, s34, 659456
    buffer_load_dwordx4 v15, s[12:15], s35 offen lds
    s_add_u32 m0, s53, 81920
    s_add_u32 s35, s34, 1310720
    buffer_load_dwordx4 v15, s[12:15], s35 offen lds
    s_add_u32 m0, s53, 82944
    s_add_u32 s35, s34, 1311744
    buffer_load_dwordx4 v15, s[12:15], s35 offen lds
    s_add_u32 m0, s53, 83968
    s_add_u32 s35, s34, 1312768
    buffer_load_dwordx4 v15, s[12:15], s35 offen lds
    s_add_u32 m0, s53, 84992
    s_add_u32 s35, s34, 1313792
    buffer_load_dwordx4 v15, s[12:15], s35 offen lds
    s_add_u32 m0, s53, 86016
    s_add_u32 s35, s34, 1314816
    buffer_load_dwordx4 v15, s[12:15], s35 offen lds
    s_add_u32 m0, s53, 122880
    s_add_u32 s35, s34, 1966080
    buffer_load_dwordx4 v15, s[12:15], s35 offen lds
    s_add_u32 m0, s53, 123904
    s_add_u32 s35, s34, 1967104
    buffer_load_dwordx4 v15, s[12:15], s35 offen lds
    s_add_u32 m0, s53, 124928
    s_add_u32 s35, s34, 1968128
    buffer_load_dwordx4 v15, s[12:15], s35 offen lds
    s_add_u32 m0, s53, 125952
    s_add_u32 s35, s34, 1969152
    buffer_load_dwordx4 v15, s[12:15], s35 offen lds
    s_add_u32 m0, s53, 126976
    s_add_u32 s35, s34, 1970176
    buffer_load_dwordx4 v15, s[12:15], s35 offen lds
    s_mul_i32 s53, s20, 160
    v_lshrrev_b32 v32, 4, v1
    v_bfe_u32 v33, v1, 2, 2
    v_and_b32 v34, 3, v1
    v_lshlrev_b32 v34, 3, v34
    v_add_u32 v34, s53, v34
    v_lshl_add_u32 v35, v32, 2, v33
    v_mul_u32_u24 v35, 1280, v35
    v_add_u32 v56, v35, v34
    v_add_u32 v57, 81920, v56
    v_lshl_add_u32 v35, v32, 3, v33
    v_mul_u32_u24 v35, 1280, v35
    v_add_u32 v58, v35, v34
    v_add_u32 v59, 4096, v15
    s_mov_b32 s31, 0x3f803f80
    v_mov_b32 v36, 0
    v_mov_b32 v37, 0
    v_mov_b32 v38, 0
    v_mov_b32 v39, 0
    v_mov_b32 v40, 0
    v_mov_b32 v41, 0
    v_mov_b32 v42, 0
    v_mov_b32 v43, 0
    s_waitcnt vmcnt(40)
    v_dot2_f32_bf16 v36, v160, s31, v36
    v_dot2_f32_bf16 v40, v160, v160, v40
    v_dot2_f32_bf16 v37, v161, s31, v37
    v_dot2_f32_bf16 v41, v161, v161, v41
    v_dot2_f32_bf16 v36, v162, s31, v36
    v_dot2_f32_bf16 v40, v162, v162, v40
    v_dot2_f32_bf16 v37, v163, s31, v37
    v_dot2_f32_bf16 v41, v163, v163, v41
    v_dot2_f32_bf16 v38, v164, s31, v38
    v_dot2_f32_bf16 v42, v164, v164, v42
    v_dot2_f32_bf16 v39, v165, s31, v39
    v_dot2_f32_bf16 v43, v165, v165, v43
    v_dot2_f32_bf16 v38, v166, s31, v38
    v_dot2_f32_bf16 v42, v166, v166, v42
    v_dot2_f32_bf16 v39, v167, s31, v39
    v_dot2_f32_bf16 v43, v167, v167, v43
    s_waitcnt vmcnt(38)
    v_dot2_f32_bf16 v36, v168, s31, v36
    v_dot2_f32_bf16 v40, v168, v168, v40
    v_dot2_f32_bf16 v37, v169, s31, v37
    v_dot2_f32_bf16 v41, v169, v169, v41
    v_dot2_f32_bf16 v36, v170, s31, v36
    v_dot2_f32_bf16 v40, v170, v170, v40
    v_dot2_f32_bf16 v37, v171, s31, v37
    v_dot2_f32_bf16 v41, v171, v171, v41
    v_dot2_f32_bf16 v38, v172, s31, v38
    v_dot2_f32_bf16 v42, v172, v172, v42
    v_dot2_f32_bf16 v39, v173, s31, v39
    v_dot2_f32_bf16 v43, v173, v173, v43
    v_dot2_f32_bf16 v38, v174, s31, v38
    v_dot2_f32_bf16 v42, v174, v174, v42
    v_dot2_f32_bf16 v39, v175, s31, v39
    v_dot2_f32_bf16 v43, v175, v175, v43
    s_waitcnt vmcnt(36)
    v_dot2_f32_bf16 v36, v176, s31, v36
    v_dot2_f32_bf16 v40, v176, v176, v40
    v_dot2_f32_bf16 v37, v177, s31, v37
    v_dot2_f32_bf16 v41, v177, v177, v41
    v_dot2_f32_bf16 v36, v178, s31, v36
    v_dot2_f32_bf16 v40, v178, v178, v40
    v_dot2_f32_bf16 v37, v179, s31, v37
    v_dot2_f32_bf16 v41, v179, v179, v41
    v_dot2_f32_bf16 v38, v180, s31, v38
    v_dot2_f32_bf16 v42, v180, v180, v42
    v_dot2_f32_bf16 v39, v181, s31, v39
    v_dot2_f32_bf16 v43, v181, v181, v43
    v_dot2_f32_bf16 v38, v182, s31, v38
    v_dot2_f32_bf16 v42, v182, v182, v42
    v_dot2_f32_bf16 v39, v183, s31, v39
    v_dot2_f32_bf16 v43, v183, v183, v43
    s_waitcnt vmcnt(34)
    v_dot2_f32_bf16 v36, v184, s31, v36
    v_dot2_f32_bf16 v40, v184, v184, v40
    v_dot2_f32_bf16 v37, v185, s31, v37
    v_dot2_f32_bf16 v41, v185, v185, v41
    v_dot2_f32_bf16 v36, v186, s31, v36
    v_dot2_f32_bf16 v40, v186, v186, v40
    v_dot2_f32_bf16 v37, v187, s31, v37
    v_dot2_f32_bf16 v41, v187, v187, v41
    v_dot2_f32_bf16 v38, v188, s31, v38
    v_dot2_f32_bf16 v42, v188, v188, v42
    v_dot2_f32_bf16 v39, v189, s31, v39
    v_dot2_f32_bf16 v43, v189, v189, v43
    v_dot2_f32_bf16 v38, v190, s31, v38
    v_dot2_f32_bf16 v42, v190, v190, v42
    v_dot2_f32_bf16 v39, v191, s31, v39
    v_dot2_f32_bf16 v43, v191, v191, v43
    s_waitcnt vmcnt(32)
    v_dot2_f32_bf16 v36, v192, s31, v36
    v_dot2_f32_bf16 v40, v192, v192, v40
    v_dot2_f32_bf16 v37, v193, s31, v37
    v_dot2_f32_bf16 v41, v193, v193, v41
    v_dot2_f32_bf16 v36, v194, s31, v36
    v_dot2_f32_bf16 v40, v194, v194, v40
    v_dot2_f32_bf16 v37, v195, s31, v37
    v_dot2_f32_bf16 v41, v195, v195, v41
    v_dot2_f32_bf16 v38, v196, s31, v38
    v_dot2_f32_bf16 v42, v196, v196, v42
    v_dot2_f32_bf16 v39, v197, s31, v39
    v_dot2_f32_bf16 v43, v197, v197, v43
    v_dot2_f32_bf16 v38, v198, s31, v38
    v_dot2_f32_bf16 v42, v198, v198, v42
    v_dot2_f32_bf16 v39, v199, s31, v39
    v_dot2_f32_bf16 v43, v199, v199, v43
    s_waitcnt vmcnt(30)
    v_dot2_f32_bf16 v36, v200, s31, v36
    v_dot2_f32_bf16 v40, v200, v200, v40
    v_dot2_f32_bf16 v37, v201, s31, v37
    v_dot2_f32_bf16 v41, v201, v201, v41
    v_dot2_f32_bf16 v36, v202, s31, v36
    v_dot2_f32_bf16 v40, v202, v202, v40
    v_dot2_f32_bf16 v37, v203, s31, v37
    v_dot2_f32_bf16 v41, v203, v203, v41
    v_dot2_f32_bf16 v38, v204, s31, v38
    v_dot2_f32_bf16 v42, v204, v204, v42
    v_dot2_f32_bf16 v39, v205, s31, v39
    v_dot2_f32_bf16 v43, v205, v205, v43
    v_dot2_f32_bf16 v38, v206, s31, v38
    v_dot2_f32_bf16 v42, v206, v206, v42
    v_dot2_f32_bf16 v39, v207, s31, v39
    v_dot2_f32_bf16 v43, v207, v207, v43
    s_waitcnt vmcnt(28)
    v_dot2_f32_bf16 v36, v208, s31, v36
    v_dot2_f32_bf16 v40, v208, v208, v40
    v_dot2_f32_bf16 v37, v209, s31, v37
    v_dot2_f32_bf16 v41, v209, v209, v41
    v_dot2_f32_bf16 v36, v210, s31, v36
    v_dot2_f32_bf16 v40, v210, v210, v40
    v_dot2_f32_bf16 v37, v211, s31, v37
    v_dot2_f32_bf16 v41, v211, v211, v41
    v_dot2_f32_bf16 v38, v212, s31, v38
    v_dot2_f32_bf16 v42, v212, v212, v42
    v_dot2_f32_bf16 v39, v213, s31, v39
    v_dot2_f32_bf16 v43, v213, v213, v43
    v_dot2_f32_bf16 v38, v214, s31, v38
    v_dot2_f32_bf16 v42, v214, v214, v42
    v_dot2_f32_bf16 v39, v215, s31, v39
    v_dot2_f32_bf16 v43, v215, v215, v43
    s_waitcnt vmcnt(26)
    v_dot2_f32_bf16 v36, v216, s31, v36
    v_dot2_f32_bf16 v40, v216, v216, v40
    v_dot2_f32_bf16 v37, v217, s31, v37
    v_dot2_f32_bf16 v41, v217, v217, v41
    v_dot2_f32_bf16 v36, v218, s31, v36
    v_dot2_f32_bf16 v40, v218, v218, v40
    v_dot2_f32_bf16 v37, v219, s31, v37
    v_dot2_f32_bf16 v41, v219, v219, v41
    v_dot2_f32_bf16 v38, v220, s31, v38
    v_dot2_f32_bf16 v42, v220, v220, v42
    v_dot2_f32_bf16 v39, v221, s31, v39
    v_dot2_f32_bf16 v43, v221, v221, v43
    v_dot2_f32_bf16 v38, v222, s31, v38
    v_dot2_f32_bf16 v42, v222, v222, v42
    v_dot2_f32_bf16 v39, v223, s31, v39
    v_dot2_f32_bf16 v43, v223, v223, v43
    s_waitcnt vmcnt(24)
    v_dot2_f32_bf16 v36, v224, s31, v36
    v_dot2_f32_bf16 v40, v224, v224, v40
    v_dot2_f32_bf16 v37, v225, s31, v37
    v_dot2_f32_bf16 v41, v225, v225, v41
    v_dot2_f32_bf16 v36, v226, s31, v36
    v_dot2_f32_bf16 v40, v226, v226, v40
    v_dot2_f32_bf16 v37, v227, s31, v37
    v_dot2_f32_bf16 v41, v227, v227, v41
    v_dot2_f32_bf16 v38, v228, s31, v38
    v_dot2_f32_bf16 v42, v228, v228, v42
    v_dot2_f32_bf16 v39, v229, s31, v39
    v_dot2_f32_bf16 v43, v229, v229, v43
    v_dot2_f32_bf16 v38, v230, s31, v38
    v_dot2_f32_bf16 v42, v230, v230, v42
    v_dot2_f32_bf16 v39, v231, s31, v39
    v_dot2_f32_bf16 v43, v231, v231, v43
    s_waitcnt vmcnt(22)
    v_dot2_f32_bf16 v36, v232, s31, v36
    v_dot2_f32_bf16 v40, v232, v232, v40
    v_dot2_f32_bf16 v37, v233, s31, v37
    v_dot2_f32_bf16 v41, v233, v233, v41
    v_dot2_f32_bf16 v36, v234, s31, v36
    v_dot2_f32_bf16 v40, v234, v234, v40
    v_dot2_f32_bf16 v37, v235, s31, v37
    v_dot2_f32_bf16 v41, v235, v235, v41
    v_dot2_f32_bf16 v38, v236, s31, v38
    v_dot2_f32_bf16 v42, v236, v236, v42
    v_dot2_f32_bf16 v39, v237, s31, v39
    v_dot2_f32_bf16 v43, v237, v237, v43
    v_dot2_f32_bf16 v38, v238, s31, v38
    v_dot2_f32_bf16 v42, v238, v238, v42
    v_dot2_f32_bf16 v39, v239, s31, v39
    v_dot2_f32_bf16 v43, v239, v239, v43
    s_nop 2
    v_add_f32 v36, v36, v37
    v_add_f32 v38, v38, v39
    v_add_f32 v40, v40, v41
    v_add_f32 v42, v42, v43
    s_nop 1
    v_add_f32_dpp v44, v36, v36 quad_perm:[1,0,3,2] row_mask:0xf bank_mask:0xf
    s_nop 1
    v_add_f32_dpp v36, v44, v44 quad_perm:[2,3,0,1] row_mask:0xf bank_mask:0xf
    s_nop 1
    v_add_f32_dpp v36, v36, v36 row_half_mirror row_mask:0xf bank_mask:0xf
    s_nop 1
    v_add_f32_dpp v44, v38, v38 quad_perm:[1,0,3,2] row_mask:0xf bank_mask:0xf
    s_nop 1
    v_add_f32_dpp v38, v44, v44 quad_perm:[2,3,0,1] row_mask:0xf bank_mask:0xf
    s_nop 1
    v_add_f32_dpp v38, v38, v38 row_half_mirror row_mask:0xf bank_mask:0xf
    s_nop 1
    v_add_f32_dpp v44, v40, v40 quad_perm:[1,0,3,2] row_mask:0xf bank_mask:0xf
    s_nop 1
    v_add_f32_dpp v40, v44, v44 quad_perm:[2,3,0,1] row_mask:0xf bank_mask:0xf
    s_nop 1
    v_add_f32_dpp v40, v40, v40 row_half_mirror row_mask:0xf bank_mask:0xf
    s_nop 1
    v_add_f32_dpp v44, v42, v42 quad_perm:[1,0,3,2] row_mask:0xf bank_mask:0xf
    s_nop 1
    v_add_f32_dpp v42, v44, v44 quad_perm:[2,3,0,1] row_mask:0xf bank_mask:0xf
    s_nop 1
    v_add_f32_dpp v42, v42, v42 row_half_mirror row_mask:0xf bank_mask:0xf
    v_and_b32 v44, 1, v1
    v_cmp_eq_u32 vcc, 1, v44
    v_lshl_add_u32 v46, v44, 3, v28
    s_nop 0
    v_cndmask_b32 v36, v36, v38, vcc
    v_cndmask_b32 v40, v40, v42, vcc
    v_mul_f32 v36, 0xbacccccd, v36
    v_mul_f32 v40, 0x3acccccd, v40
    v_fma_f32 v40, -v36, v36, v40
    v_max_f32 v40, 0, v40
    v_cvt_pk_bf16_f32 v40, v40, v40
    v_and_b32 v40, 0xffff0000, v40
    v_add_f32 v40, 0x3727c5ac, v40
    v_cvt_pk_bf16_f32 v40, v40, v40
    v_and_b32 v40, 0xffff0000, v40
    v_sqrt_f32 v40, v40
    v_cvt_pk_bf16_f32 v36, v36, v36
    v_and_b32 v36, 0xffff0000, v36
    v_cvt_pk_bf16_f32 v40, v40, v40
    v_and_b32 v40, 0xffff0000, v40
    v_rcp_f32 v40, v40
    v_lshlrev_b32 v44, 2, v46
    v_mov_b32 v45, 0x40000000
    v_cmp_gt_u32 vcc, 2, v31
    s_lshl_b32 s33, s52, 6
    s_add_u32 s33, s33, 14543872
    v_cndmask_b32 v44, v45, v44, vcc
    s_add_u32 s34, s33, 8192
    buffer_store_dword v36, v44, s[16:19], s33 offen sc1
    buffer_store_dword v40, v44, s[16:19], s34 offen sc1
    s_waitcnt vmcnt(0)
    s_barrier
    s_cmp_lg_u32 s20, 0
    s_cbranch_scc1 L_k1_sp_nofl
    s_lshl_b32 s33, s32, 2
    v_mov_b32 v44, 1
    buffer_store_dword v44, off, s[44:47], s33 sc1
L_k1_sp_nofl:
    s_mul_i32 s34, s20, 54
    s_add_u32 s34, s34, s32
    s_mul_i32 s34, s34, 5120
    s_add_u32 s34, s34, 9699328
    ds_read_b64_tr_b16 v[160:161], v56 offset:0
    ds_read_b64_tr_b16 v[162:163], v56 offset:20480
    ds_read_b64_tr_b16 v[164:165], v56 offset:32
    ds_read_b64_tr_b16 v[166:167], v56 offset:20512
    ds_read_b64_tr_b16 v[168:169], v56 offset:64
    ds_read_b64_tr_b16 v[170:171], v56 offset:20544
    ds_read_b64_tr_b16 v[172:173], v56 offset:96
    ds_read_b64_tr_b16 v[174:175], v56 offset:20576
    ds_read_b64_tr_b16 v[176:177], v56 offset:128
    ds_read_b64_tr_b16 v[178:179], v56 offset:20608
    s_waitcnt lgkmcnt(0)
    buffer_store_dwordx4 v[160:163], v15, s[16:19], s34 offen offset:0 sc1
    buffer_store_dwordx4 v[164:167], v15, s[16:19], s34 offen offset:1024 sc1
    buffer_store_dwordx4 v[168:171], v15, s[16:19], s34 offen offset:2048 sc1
    buffer_store_dwordx4 v[172:175], v15, s[16:19], s34 offen offset:3072 sc1
    buffer_store_dwordx4 v[176:179], v59, s[16:19], s34 offen sc1
    s_add_u32 s34, s34, 81920
    ds_read_b64_tr_b16 v[180:181], v56 offset:40960
    ds_read_b64_tr_b16 v[182:183], v56 offset:61440
    ds_read_b64_tr_b16 v[184:185], v56 offset:40992
    ds_read_b64_tr_b16 v[186:187], v56 offset:61472
    ds_read_b64_tr_b16 v[188:189], v56 offset:41024
    ds_read_b64_tr_b16 v[190:191], v56 offset:61504
    ds_read_b64_tr_b16 v[192:193], v56 offset:41056
    ds_read_b64_tr_b16 v[194:195], v56 offset:61536
    ds_read_b64_tr_b16 v[196:197], v56 offset:41088
    ds_read_b64_tr_b16 v[198:199], v56 offset:61568
    s_waitcnt lgkmcnt(0)
    buffer_store_dwordx4 v[180:183], v15, s[16:19], s34 offen offset:0 sc1
    buffer_store_dwordx4 v[184:187], v15, s[16:19], s34 offen offset:1024 sc1
    buffer_store_dwordx4 v[188:191], v15, s[16:19], s34 offen offset:2048 sc1
    buffer_store_dwordx4 v[192:195], v15, s[16:19], s34 offen offset:3072 sc1
    buffer_store_dwordx4 v[196:199], v59, s[16:19], s34 offen sc1
    s_add_u32 s34, s34, 81920
    ds_read_b64_tr_b16 v[200:201], v57 offset:0
    ds_read_b64_tr_b16 v[202:203], v57 offset:20480
    ds_read_b64_tr_b16 v[204:205], v57 offset:32
    ds_read_b64_tr_b16 v[206:207], v57 offset:20512
    ds_read_b64_tr_b16 v[208:209], v57 offset:64
    ds_read_b64_tr_b16 v[210:211], v57 offset:20544
    ds_read_b64_tr_b16 v[212:213], v57 offset:96
    ds_read_b64_tr_b16 v[214:215], v57 offset:20576
    ds_read_b64_tr_b16 v[216:217], v57 offset:128
    ds_read_b64_tr_b16 v[218:219], v57 offset:20608
    s_waitcnt lgkmcnt(0)
    buffer_store_dwordx4 v[200:203], v15, s[16:19], s34 offen offset:0 sc1
    buffer_store_dwordx4 v[204:207], v15, s[16:19], s34 offen offset:1024 sc1
    buffer_store_dwordx4 v[208:211], v15, s[16:19], s34 offen offset:2048 sc1
    buffer_store_dwordx4 v[212:215], v15, s[16:19], s34 offen offset:3072 sc1
    buffer_store_dwordx4 v[216:219], v59, s[16:19], s34 offen sc1
    s_add_u32 s34, s34, 81920
    ds_read_b64_tr_b16 v[220:221], v57 offset:40960
    ds_read_b64_tr_b16 v[222:223], v57 offset:61440
    ds_read_b64_tr_b16 v[224:225], v57 offset:40992
    ds_read_b64_tr_b16 v[226:227], v57 offset:61472
    ds_read_b64_tr_b16 v[228:229], v57 offset:41024
    ds_read_b64_tr_b16 v[230:231], v57 offset:61504
    ds_read_b64_tr_b16 v[232:233], v57 offset:41056
    ds_read_b64_tr_b16 v[234:235], v57 offset:61536
    ds_read_b64_tr_b16 v[236:237], v57 offset:41088
    ds_read_b64_tr_b16 v[238:239], v57 offset:61568
    s_waitcnt lgkmcnt(0)
    s_cmp_lt_u32 s32, 6
    s_cselect_b32 s34, s34, 1073741824
    buffer_store_dwordx4 v[220:223], v15, s[16:19], s34 offen offset:0 sc1
    buffer_store_dwordx4 v[224:227], v15, s[16:19], s34 offen offset:1024 sc1
    buffer_store_dwordx4 v[228:231], v15, s[16:19], s34 offen offset:2048 sc1
    buffer_store_dwordx4 v[232:235], v15, s[16:19], s34 offen offset:3072 sc1
    buffer_store_dwordx4 v[236:239], v59, s[16:19], s34 offen sc1
    s_add_u32 s34, s34, 81920
    s_mov_b32 s86, s32
    v_lshlrev_b32 v24, 2, v1
    s_mov_b32 s40, 0xffff
    s_mov_b32 s41, 0x0
    s_mov_b32 s29, 0
L_gate_sz:
    buffer_load_dword v25, v24, s[44:47], 0 offen offset:0 sc1
    s_add_u32 s29, s29, 1
    s_cmp_ge_u32 s29, 1000000
    s_waitcnt vmcnt(0)
    s_cbranch_scc1 L_gate_sz_ok
    v_cmp_ne_u32 vcc, 1, v25
    s_nop 0
    s_and_b64 vcc, vcc, s[40:41]
    s_cbranch_scc0 L_gate_sz_ok
    s_sleep 2
    s_branch L_gate_sz
L_gate_sz_ok:
    v_mov_b32 v28, 1
    v_lshlrev_b32 v29, 9, v0
    v_mov_b32 v30, 163808
    v_mov_b32 v32, 0
    v_mov_b32 v33, 0
    v_mov_b32 v34, 0
    v_mov_b32 v35, 0
    s_waitcnt vmcnt(0) lgkmcnt(0)
    s_barrier
    ds_write_b128 v30, v[32:35]
    ds_write_b64 v30, v[32:33] offset:16
    s_cmp_ge_u32 s20, 4
    s_cbranch_scc1 L_sp_nom
    buffer_store_dword v28, v29, s[16:19], s68 offen sc1
L_sp_nom:
    s_mul_i32 s33, s20, 7168
    s_mul_i32 s34, s86, 51200
    s_add_u32 s34, s34, s33
    s_add_u32 m0, s33, 0
    s_add_u32 s35, s34, 0
    buffer_load_dwordx4 v15, s[88:91], s35 offen lds
    s_add_u32 m0, s33, 1024
    s_add_u32 s35, s34, 1024
    buffer_load_dwordx4 v15, s[88:91], s35 offen lds
    s_add_u32 m0, s33, 2048
    s_add_u32 s35, s34, 2048
    buffer_load_dwordx4 v15, s[88:91], s35 offen lds
    s_add_u32 m0, s33, 3072
    s_add_u32 s35, s34, 3072
    buffer_load_dwordx4 v15, s[88:91], s35 offen lds
    s_add_u32 m0, s33, 4096
    s_add_u32 s35, s34, 4096
    buffer_load_dwordx4 v15, s[88:91], s35 offen lds
    s_add_u32 m0, s33, 5120
    s_add_u32 s35, s34, 5120
    buffer_load_dwordx4 v15, s[88:91], s35 offen lds
    s_add_u32 m0, s33, 6144
    s_add_u32 s35, s34, 6144
    buffer_load_dwordx4 v15, s[88:91], s35 offen lds
    v_lshrrev_b32 v31, 4, v1
    v_cmp_gt_u32 vcc, 3, v31
    v_cmp_gt_u32 s[36:37], 2, v31
    s_waitcnt vmcnt(0)
    s_barrier
    ds_read_b64_tr_b16 v[60:61], v58 offset:0
    ds_read_b64_tr_b16 v[62:63], v58 offset:5120
    ds_read_b64_tr_b16 v[64:65], v58 offset:32
    ds_read_b64_tr_b16 v[66:67], v58 offset:5152
    ds_read_b64_tr_b16 v[68:69], v58 offset:64
    ds_read_b64_tr_b16 v[70:71], v58 offset:5184
    ds_read_b64_tr_b16 v[72:73], v58 offset:96
    ds_read_b64_tr_b16 v[74:75], v58 offset:5216
    ds_read_b64_tr_b16 v[76:77], v58 offset:128
    ds_read_b64_tr_b16 v[78:79], v58 offset:5248
    s_waitcnt lgkmcnt(0)
    ds_read_b64_tr_b16 v[80:81], v58 offset:25600
    ds_read_b64_tr_b16 v[82:83], v58 offset:30720
    ds_read_b64_tr_b16 v[84:85], v58 offset:25632
    ds_read_b64_tr_b16 v[86:87], v58 offset:30752
    ds_read_b64_tr_b16 v[88:89], v58 offset:25664
    ds_read_b64_tr_b16 v[90:91], v58 offset:30784
    ds_read_b64_tr_b16 v[92:93], v58 offset:25696
    ds_read_b64_tr_b16 v[94:95], v58 offset:30816
    ds_read_b64_tr_b16 v[96:97], v58 offset:25728
    ds_read_b64_tr_b16 v[98:99], v58 offset:30848
    s_waitcnt lgkmcnt(0)
    v_cndmask_b32 v60, 0, v60, vcc
    v_cndmask_b32 v61, 0, v61, vcc
    v_cndmask_b32 v62, 0, v62, s[36:37]
    v_cndmask_b32 v63, 0, v63, s[36:37]
    v_cndmask_b32 v64, 0, v64, vcc
    v_cndmask_b32 v65, 0, v65, vcc
    v_cndmask_b32 v66, 0, v66, s[36:37]
    v_cndmask_b32 v67, 0, v67, s[36:37]
    v_cndmask_b32 v68, 0, v68, vcc
    v_cndmask_b32 v69, 0, v69, vcc
    v_cndmask_b32 v70, 0, v70, s[36:37]
    v_cndmask_b32 v71, 0, v71, s[36:37]
    v_cndmask_b32 v72, 0, v72, vcc
    v_cndmask_b32 v73, 0, v73, vcc
    v_cndmask_b32 v74, 0, v74, s[36:37]
    v_cndmask_b32 v75, 0, v75, s[36:37]
    v_cndmask_b32 v76, 0, v76, vcc
    v_cndmask_b32 v77, 0, v77, vcc
    v_cndmask_b32 v78, 0, v78, s[36:37]
    v_cndmask_b32 v79, 0, v79, s[36:37]
    v_cndmask_b32 v80, 0, v80, vcc
    v_cndmask_b32 v81, 0, v81, vcc
    v_cndmask_b32 v82, 0, v82, s[36:37]
    v_cndmask_b32 v83, 0, v83, s[36:37]
    v_cndmask_b32 v84, 0, v84, vcc
    v_cndmask_b32 v85, 0, v85, vcc
    v_cndmask_b32 v86, 0, v86, s[36:37]
    v_cndmask_b32 v87, 0, v87, s[36:37]
    v_cndmask_b32 v88, 0, v88, vcc
    v_cndmask_b32 v89, 0, v89, vcc
    v_cndmask_b32 v90, 0, v90, s[36:37]
    v_cndmask_b32 v91, 0, v91, s[36:37]
    v_cndmask_b32 v92, 0, v92, vcc
    v_cndmask_b32 v93, 0, v93, vcc
    v_cndmask_b32 v94, 0, v94, s[36:37]
    v_cndmask_b32 v95, 0, v95, s[36:37]
    v_cndmask_b32 v96, 0, v96, vcc
    v_cndmask_b32 v97, 0, v97, vcc
    v_cndmask_b32 v98, 0, v98, s[36:37]
    v_cndmask_b32 v99, 0, v99, s[36:37]
    s_barrier
    s_cmp_ge_u32 s20, 4
    s_cbranch_scc1 L_sp_nob
    v_lshlrev_b32 v24, 2, v1
    s_mov_b32 s40, 0x0
    s_mov_b32 s41, 0xffff0000
    s_mov_b32 s29, 0
L_gate_sb:
    buffer_load_dword v25, v24, s[16:19], s79 offen offset:0 sc1
    s_add_u32 s29, s29, 1
    s_cmp_ge_u32 s29, 1000000
    s_waitcnt vmcnt(0)
    s_cbranch_scc1 L_gate_sb_ok
    v_cmp_ne_u32 vcc, 1, v25
    s_nop 0
    s_and_b64 vcc, vcc, s[40:41]
    s_cbranch_scc0 L_gate_sb_ok
    s_sleep 4
    s_branch L_gate_sb
L_gate_sb_ok:
    s_mov_b32 s22, s83
    s_and_b32 s27, s20, 3
    s_mul_i32 s32, s27, 14
    s_cmp_eq_u32 s27, 3
    s_cselect_b32 s32, 41, s32
    s_mul_i32 s24, s83, 54
    s_add_u32 s24, s24, s32
    s_mul_i32 s24, s24, 5120
    s_add_u32 s24, s24, 9699328
    s_mul_i32 s43, s27, 10240
    s_add_u32 s43, s43, 51200
    s_cmp_ge_u32 s27, 2
    s_cselect_b32 s39, 40960, 0
    s_mul_i32 s42, s27, 25600
    s_add_u32 s42, s42, s39
    s_add_u32 m0, s43, 0
    s_add_u32 s39, s24, 0
    buffer_load_dwordx4 v15, s[16:19], s39 offen sc1 lds
    s_add_u32 m0, s43, 1024
    s_add_u32 s39, s24, 1024
    buffer_load_dwordx4 v15, s[16:19], s39 offen sc1 lds
    s_add_u32 m0, s43, 2048
    s_add_u32 s39, s24, 2048
    buffer_load_dwordx4 v15, s[16:19], s39 offen sc1 lds
    s_add_u32 m0, s43, 3072
    s_add_u32 s39, s24, 3072
    buffer_load_dwordx4 v15, s[16:19], s39 offen sc1 lds
    s_add_u32 m0, s43, 4096
    s_add_u32 s39, s24, 4096
    buffer_load_dwordx4 v15, s[16:19], s39 offen sc1 lds
    s_add_u32 m0, s43, 5120
    s_add_u32 s39, s24, 5120
    buffer_load_dwordx4 v15, s[16:19], s39 offen sc1 lds
    s_add_u32 m0, s43, 6144
    s_add_u32 s39, s24, 6144
    buffer_load_dwordx4 v15, s[16:19], s39 offen sc1 lds
    s_add_u32 m0, s43, 7168
    s_add_u32 s39, s24, 7168
    buffer_load_dwordx4 v15, s[16:19], s39 offen sc1 lds
    s_add_u32 m0, s43, 8192
    s_add_u32 s39, s24, 8192
    buffer_load_dwordx4 v15, s[16:19], s39 offen sc1 lds
    s_add_u32 m0, s43, 9216
    s_add_u32 s39, s24, 9216
    buffer_load_dwordx4 v15, s[16:19], s39 offen sc1 lds
    s_add_u32 m0, s42, 0
    s_add_u32 s39, s24, 10240
    buffer_load_dwordx4 v15, s[16:19], s39 offen sc1 lds
    s_add_u32 m0, s42, 1024
    s_add_u32 s39, s24, 11264
    buffer_load_dwordx4 v15, s[16:19], s39 offen sc1 lds
    s_add_u32 m0, s42, 2048
    s_add_u32 s39, s24, 12288
    buffer_load_dwordx4 v15, s[16:19], s39 offen sc1 lds
    s_add_u32 m0, s42, 3072
    s_add_u32 s39, s24, 13312
    buffer_load_dwordx4 v15, s[16:19], s39 offen sc1 lds
    s_add_u32 m0, s42, 4096
    s_add_u32 s39, s24, 14336
    buffer_load_dwordx4 v15, s[16:19], s39 offen sc1 lds
    s_add_u32 m0, s42, 5120
    s_add_u32 s39, s24, 15360
    buffer_load_dwordx4 v15, s[16:19], s39 offen sc1 lds
    s_add_u32 m0, s42, 6144
    s_add_u32 s39, s24, 16384
    buffer_load_dwordx4 v15, s[16:19], s39 offen sc1 lds
    s_add_u32 m0, s42, 7168
    s_add_u32 s39, s24, 17408
    buffer_load_dwordx4 v15, s[16:19], s39 offen sc1 lds
    s_add_u32 m0, s42, 8192
    s_add_u32 s39, s24, 18432
    buffer_load_dwordx4 v15, s[16:19], s39 offen sc1 lds
    s_add_u32 m0, s42, 9216
    s_add_u32 s39, s24, 19456
    buffer_load_dwordx4 v15, s[16:19], s39 offen sc1 lds
    s_add_u32 m0, s42, 10240
    s_add_u32 s39, s24, 20480
    buffer_load_dwordx4 v15, s[16:19], s39 offen sc1 lds
    s_add_u32 m0, s42, 11264
    s_add_u32 s39, s24, 21504
    buffer_load_dwordx4 v15, s[16:19], s39 offen sc1 lds
    s_add_u32 m0, s42, 12288
    s_add_u32 s39, s24, 22528
    buffer_load_dwordx4 v15, s[16:19], s39 offen sc1 lds
    s_add_u32 m0, s42, 13312
    s_add_u32 s39, s24, 23552
    buffer_load_dwordx4 v15, s[16:19], s39 offen sc1 lds
    s_add_u32 m0, s42, 14336
    s_add_u32 s39, s24, 24576
    buffer_load_dwordx4 v15, s[16:19], s39 offen sc1 lds
    s_add_u32 m0, s42, 15360
    s_add_u32 s39, s24, 25600
    buffer_load_dwordx4 v15, s[16:19], s39 offen sc1 lds
    s_add_u32 m0, s42, 16384
    s_add_u32 s39, s24, 26624
    buffer_load_dwordx4 v15, s[16:19], s39 offen sc1 lds
    s_add_u32 m0, s42, 17408
    s_add_u32 s39, s24, 27648
    buffer_load_dwordx4 v15, s[16:19], s39 offen sc1 lds
    s_add_u32 m0, s42, 18432
    s_add_u32 s39, s24, 28672
    buffer_load_dwordx4 v15, s[16:19], s39 offen sc1 lds
    s_add_u32 m0, s42, 19456
    s_add_u32 s39, s24, 29696
    buffer_load_dwordx4 v15, s[16:19], s39 offen sc1 lds
    s_add_u32 m0, s42, 20480
    s_add_u32 s39, s24, 30720
    buffer_load_dwordx4 v15, s[16:19], s39 offen sc1 lds
    s_add_u32 m0, s42, 21504
    s_add_u32 s39, s24, 31744
    buffer_load_dwordx4 v15, s[16:19], s39 offen sc1 lds
    s_add_u32 m0, s42, 22528
    s_add_u32 s39, s24, 32768
    buffer_load_dwordx4 v15, s[16:19], s39 offen sc1 lds
    s_add_u32 m0, s42, 23552
    s_add_u32 s39, s24, 33792
    buffer_load_dwordx4 v15, s[16:19], s39 offen sc1 lds
    s_add_u32 m0, s42, 24576
    s_add_u32 s39, s24, 34816
    buffer_load_dwordx4 v15, s[16:19], s39 offen sc1 lds
    s_add_u32 s39, s24, 35840
    buffer_load_dwordx4 v[116:119], v15, s[16:19], s39 offen sc1
    s_add_u32 s39, s24, 36864
    buffer_load_dwordx4 v[120:123], v15, s[16:19], s39 offen sc1
    s_add_u32 s39, s24, 37888
    buffer_load_dwordx4 v[124:127], v15, s[16:19], s39 offen sc1
    s_add_u32 s39, s24, 38912
    buffer_load_dwordx4 v[128:131], v15, s[16:19], s39 offen sc1
    s_add_u32 s39, s24, 39936
    buffer_load_dwordx4 v[132:135], v15, s[16:19], s39 offen sc1
    s_add_u32 s39, s24, 40960
    buffer_load_dwordx4 v[136:139], v15, s[16:19], s39 offen sc1
    s_add_u32 s39, s24, 41984
    buffer_load_dwordx4 v[140:143], v15, s[16:19], s39 offen sc1
    s_add_u32 s39, s24, 43008
    buffer_load_dwordx4 v[144:147], v15, s[16:19], s39 offen sc1
    s_add_u32 s39, s24, 44032
    buffer_load_dwordx4 v[148:151], v15, s[16:19], s39 offen sc1
    s_add_u32 s39, s24, 45056
    buffer_load_dwordx4 v[152:155], v15, s[16:19], s39 offen sc1
    s_add_u32 s39, s24, 46080
    buffer_load_dwordx4 v[156:159], v15, s[16:19], s39 offen sc1
    s_add_u32 s39, s24, 47104
    buffer_load_dwordx4 v[160:163], v15, s[16:19], s39 offen sc1
    s_add_u32 s39, s24, 48128
    buffer_load_dwordx4 v[164:167], v15, s[16:19], s39 offen sc1
    s_add_u32 s39, s24, 49152
    buffer_load_dwordx4 v[168:171], v15, s[16:19], s39 offen sc1
    s_add_u32 s39, s24, 50176
    buffer_load_dwordx4 v[172:175], v15, s[16:19], s39 offen sc1
L_sp_nob:
    v_and_b32 v28, 15, v1
    v_lshrrev_b32 v29, 4, v1
    v_cmp_eq_u32 vcc, 2, v29
    v_mov_b32 v100, 0
    v_mov_b32 v101, 0
    v_mov_b32 v103, 0
    v_mov_b32 v33, 0x3f80
    v_cndmask_b32 v102, 0, v33, vcc
    v_mov_b32 v32, 0x40000000
    s_lshr_b32 s33, s86, 2
    s_and_b32 s34, s86, 3
    s_mul_i32 s38, s20, 20
    s_mul_i32 s39, s33, 5
    s_add_u32 s38, s38, s39
    s_mul_i32 s36, s38, 5120
    s_lshl_b32 s37, s34, 8
    s_add_u32 s36, s36, s37
    s_add_u32 s36, s36, 13221888
    s_lshl_b32 s38, s38, 6
    s_lshl_b32 s37, s34, 4
    s_add_u32 s38, s38, s37
    s_add_u32 s38, s38, 14532608
    v_lshrrev_b32 v34, 1, v29
    v_and_b32 v35, 1, v29
    v_mul_u32_u24 v36, 5120, v34
    v_lshl_add_u32 v36, v35, 10, v36
    v_lshl_add_u32 v36, v28, 4, v36
    v_add_u32 v36, s36, v36
    v_lshl_add_u32 v37, v34, 6, s38
    v_cmp_eq_u32 vcc, 0, v28
    v_cmp_eq_u32 s[40:41], 1, v35
    v_cmp_eq_u32 s[36:37], 0, v34
    v_cndmask_b32 v37, v32, v37, vcc
    v_add_u32 v44, 0, v36
    v_add_u32 v38, 4096, v44
    v_add_u32 v39, 0, v37
    v_cndmask_b32 v45, v38, v39, s[40:41]
    v_add_u32 v46, 10240, v36
    v_add_u32 v38, 4096, v46
    v_add_u32 v39, 128, v37
    v_cndmask_b32 v47, v38, v39, s[40:41]
    v_add_u32 v48, 20480, v36
    v_add_u32 v38, 4096, v48
    v_add_u32 v39, 256, v37
    v_cndmask_b32 v49, v38, v39, s[40:41]
    v_cndmask_b32 v48, v32, v48, s[36:37]
    v_cndmask_b32 v49, v32, v49, s[36:37]
    v_mul_u32_u24 v38, 40, v29
    v_add_u32 v38, v38, v28
    v_add_u32 v38, 0, v38
    v_subrev_u32 v39, 0, v28
    v_cmp_gt_u32 vcc, 16, v39
    v_cmp_gt_u32 s[40:41], 3, v29
    v_add_u32 v39, 20, v38
    v_mov_b32 v40, 120
    s_and_b64 vcc, vcc, s[40:41]
    v_cndmask_b32 v38, v40, v38, vcc
    v_cndmask_b32 v39, v40, v39, vcc
    v_lshlrev_b32 v50, 3, v38
    v_lshlrev_b32 v51, 3, v39
    v_add_u32 v50, 159744, v50
    v_add_u32 v51, 159744, v51
    v_mul_u32_u24 v38, 40, v29
    v_add_u32 v38, v38, v28
    v_add_u32 v38, 16, v38
    v_subrev_u32 v39, 0, v28
    v_cmp_gt_u32 vcc, 4, v39
    v_cmp_gt_u32 s[40:41], 3, v29
    v_add_u32 v39, 20, v38
    v_mov_b32 v40, 120
    s_and_b64 vcc, vcc, s[40:41]
    v_cndmask_b32 v38, v40, v38, vcc
    v_cndmask_b32 v39, v40, v39, vcc
    v_lshlrev_b32 v52, 3, v38
    v_lshlrev_b32 v53, 3, v39
    v_add_u32 v52, 159744, v52
    v_add_u32 v53, 159744, v53
    v_mul_u32_u24 v38, 40, v29
    v_add_u32 v38, v38, v28
    v_add_u32 v38, 124, v38
    v_subrev_u32 v39, 4, v28
    v_cmp_gt_u32 vcc, 12, v39
    v_cmp_gt_u32 s[40:41], 3, v29
    v_add_u32 v39, 20, v38
    v_mov_b32 v40, 120
    s_and_b64 vcc, vcc, s[40:41]
    v_cndmask_b32 v38, v40, v38, vcc
    v_cndmask_b32 v39, v40, v39, vcc
    v_lshlrev_b32 v54, 3, v38
    v_lshlrev_b32 v55, 3, v39
    v_add_u32 v54, 159744, v54
    v_add_u32 v55, 159744, v55
    v_mul_u32_u24 v38, 40, v29
    v_add_u32 v38, v38, v28
    v_add_u32 v38, 140, v38
    v_subrev_u32 v39, 0, v28
    v_cmp_gt_u32 vcc, 8, v39
    v_cmp_gt_u32 s[40:41], 3, v29
    v_add_u32 v39, 20, v38
    v_mov_b32 v40, 120
    s_and_b64 vcc, vcc, s[40:41]
    v_cndmask_b32 v38, v40, v38, vcc
    v_cndmask_b32 v39, v40, v39, vcc
    v_lshlrev_b32 v56, 3, v38
    v_lshlrev_b32 v57, 3, v39
    v_add_u32 v56, 159744, v56
    v_add_u32 v57, 159744, v57
    s_and_b32 s33, s20, 1
    s_lshl_b32 s33, s33, 6
    v_add_u32 v42, s33, v1
    v_cmp_gt_u32 vcc, 120, v42
    v_lshlrev_b32 v43, 4, v42
    s_bfe_u32 s33, s20, 0x10001
    s_lshl_b32 s34, s33, 10
    s_add_u32 s34, s34, 159744
    v_cndmask_b32 v43, v32, v43, vcc
    v_lshl_add_u32 v42, v42, 3, s34
    s_lshl_b32 s34, s86, 1
    s_add_u32 s33, s33, s34
    s_mul_i32 s33, s33, 1920
    s_add_u32 s33, s33, 14041088
    s_cmp_lt_u32 s20, 4
    s_cbranch_scc1 L_sp_red_done
    s_cmp_lg_u32 s20, 4
    s_cbranch_scc1 L_sp_pw
    v_lshlrev_b32 v24, 2, v1
    s_mov_b32 s40, 0xff
    s_mov_b32 s41, 0x0
    s_mov_b32 s29, 0
L_gate_p:
    buffer_load_dword v25, v24, s[16:19], s78 offen offset:0 sc1
    s_add_u32 s29, s29, 1
    s_cmp_ge_u32 s29, 1000000
    s_waitcnt vmcnt(0)
    s_cbranch_scc1 L_gate_p_ok
    v_cmp_ne_u32 vcc, 1, v25
    s_nop 0
    s_and_b64 vcc, vcc, s[40:41]
    s_cbranch_scc0 L_gate_p_ok
    s_sleep 0
    s_branch L_gate_p
L_gate_p_ok:
    v_mov_b32 v24, 1
    ds_write_b32 v30, v24 offset:20
    s_branch L_sp_pgo
L_sp_pw:
    s_mov_b32 s29, 0
L_lw_pw:
    ds_read_b32 v24, v30 offset:20
    s_add_u32 s29, s29, 1
    s_cmp_ge_u32 s29, 40000000
    s_waitcnt lgkmcnt(0)
    s_cbranch_scc1 L_lw_pw_ok
    v_cmp_gt_u32 vcc, 1, v24
    s_cbranch_vccz L_lw_pw_ok
    s_sleep 1
    s_branch L_lw_pw
L_lw_pw_ok:
L_sp_pgo:
    buffer_load_dwordx4 v[176:179], v43, s[16:19], s33 offen sc1
    s_add_u32 s33, s33, 61440
    buffer_load_dwordx4 v[180:183], v43, s[16:19], s33 offen sc1
    s_add_u32 s33, s33, 61440
    buffer_load_dwordx4 v[184:187], v43, s[16:19], s33 offen sc1
    s_add_u32 s33, s33, 61440
    buffer_load_dwordx4 v[188:191], v43, s[16:19], s33 offen sc1
    s_add_u32 s33, s33, 61440
    buffer_load_dwordx4 v[192:195], v43, s[16:19], s33 offen sc1
    s_add_u32 s33, s33, 61440
    buffer_load_dwordx4 v[196:199], v43, s[16:19], s33 offen sc1
    s_add_u32 s33, s33, 61440
    buffer_load_dwordx4 v[200:203], v43, s[16:19], s33 offen sc1
    s_add_u32 s33, s33, 61440
    buffer_load_dwordx4 v[204:207], v43, s[16:19], s33 offen sc1
    s_waitcnt vmcnt(6)
    v_pk_add_f32 v[176:177], v[176:177], v[180:181]
    v_pk_add_f32 v[178:179], v[178:179], v[182:183]
    s_waitcnt vmcnt(5)
    v_pk_add_f32 v[176:177], v[176:177], v[184:185]
    v_pk_add_f32 v[178:179], v[178:179], v[186:187]
    s_waitcnt vmcnt(4)
    v_pk_add_f32 v[176:177], v[176:177], v[188:189]
    v_pk_add_f32 v[178:179], v[178:179], v[190:191]
    s_waitcnt vmcnt(3)
    v_pk_add_f32 v[176:177], v[176:177], v[192:193]
    v_pk_add_f32 v[178:179], v[178:179], v[194:195]
    s_waitcnt vmcnt(2)
    v_pk_add_f32 v[176:177], v[176:177], v[196:197]
    v_pk_add_f32 v[178:179], v[178:179], v[198:199]
    s_waitcnt vmcnt(1)
    v_pk_add_f32 v[176:177], v[176:177], v[200:201]
    v_pk_add_f32 v[178:179], v[178:179], v[202:203]
    s_waitcnt vmcnt(0)
    v_pk_add_f32 v[176:177], v[176:177], v[204:205]
    v_pk_add_f32 v[178:179], v[178:179], v[206:207]
    v_cvt_pk_bf16_f32 v180, v176, v177
    v_cvt_pk_bf16_f32 v181, v178, v179
    ds_write_b64 v42, v[180:181]
L_sp_red_done:
    s_waitcnt lgkmcnt(0)
    s_barrier
    ds_read_b64 v[104:105], v50
    ds_read_b64 v[106:107], v51
    ds_read_b64 v[108:109], v52
    ds_read_b64 v[110:111], v53
    ds_read_b64 v[248:249], v54
    ds_read_b64 v[250:251], v55
    ds_read_b64 v[252:253], v56
    ds_read_b64 v[254:255], v57
    s_waitcnt lgkmcnt(6)
    v_mfma_f32_16x16x32_bf16 v[176:179], v[104:107], v[60:63], 0
    v_mfma_f32_16x16x32_bf16 v[180:183], v[104:107], v[64:67], 0
    v_mfma_f32_16x16x32_bf16 v[184:187], v[104:107], v[68:71], 0
    v_mfma_f32_16x16x32_bf16 v[188:191], v[104:107], v[72:75], 0
    v_mfma_f32_16x16x32_bf16 v[192:195], v[104:107], v[76:79], 0
    v_mfma_f32_16x16x32_bf16 v[196:199], v[104:107], v[100:103], 0
    s_waitcnt lgkmcnt(4)
    v_mfma_f32_16x16x32_bf16 v[200:203], v[108:111], v[60:63], 0
    v_mfma_f32_16x16x32_bf16 v[204:207], v[108:111], v[64:67], 0
    v_mfma_f32_16x16x32_bf16 v[208:211], v[108:111], v[68:71], 0
    v_mfma_f32_16x16x32_bf16 v[212:215], v[108:111], v[72:75], 0
    v_mfma_f32_16x16x32_bf16 v[216:219], v[108:111], v[76:79], 0
    v_mfma_f32_16x16x32_bf16 v[220:223], v[108:111], v[100:103], 0
    s_waitcnt lgkmcnt(0)
    v_mfma_f32_16x16x32_bf16 v[200:203], v[248:251], v[80:83], v[200:203]
    v_mfma_f32_16x16x32_bf16 v[204:207], v[248:251], v[84:87], v[204:207]
    v_mfma_f32_16x16x32_bf16 v[208:211], v[248:251], v[88:91], v[208:211]
    v_mfma_f32_16x16x32_bf16 v[212:215], v[248:251], v[92:95], v[212:215]
    v_mfma_f32_16x16x32_bf16 v[216:219], v[248:251], v[96:99], v[216:219]
    v_mfma_f32_16x16x32_bf16 v[220:223], v[248:251], v[100:103], v[220:223]
    v_mfma_f32_16x16x32_bf16 v[224:227], v[252:255], v[80:83], 0
    v_mfma_f32_16x16x32_bf16 v[228:231], v[252:255], v[84:87], 0
    v_mfma_f32_16x16x32_bf16 v[232:235], v[252:255], v[88:91], 0
    v_mfma_f32_16x16x32_bf16 v[236:239], v[252:255], v[92:95], 0
    v_mfma_f32_16x16x32_bf16 v[240:243], v[252:255], v[96:99], 0
    v_mfma_f32_16x16x32_bf16 v[244:247], v[252:255], v[100:103], 0
    v_cvt_pk_bf16_f32 v176, v176, v177
    v_cvt_pk_bf16_f32 v177, v178, v179
    v_cvt_pk_bf16_f32 v178, v180, v181
    v_cvt_pk_bf16_f32 v179, v182, v183
    v_cvt_pk_bf16_f32 v184, v184, v185
    v_cvt_pk_bf16_f32 v185, v186, v187
    v_cvt_pk_bf16_f32 v186, v188, v189
    v_cvt_pk_bf16_f32 v187, v190, v191
    v_cvt_pk_bf16_f32 v192, v192, v193
    v_cvt_pk_bf16_f32 v193, v194, v195
    v_cvt_pk_bf16_f32 v194, v196, v197
    v_cvt_pk_bf16_f32 v195, v198, v199
    v_permlane16_swap_b32 v176, v178
    v_permlane16_swap_b32 v177, v179
    v_permlane16_swap_b32 v184, v186
    v_permlane16_swap_b32 v185, v187
    v_permlane16_swap_b32 v192, v194
    v_permlane16_swap_b32 v193, v195
    buffer_store_dwordx4 v[176:179], v44, s[16:19], 0 offen offset:0 sc1
    buffer_store_dwordx4 v[184:187], v44, s[16:19], 0 offen offset:2048 sc1
    buffer_store_dwordx4 v[192:195], v45, s[16:19], 0 offen sc1
    v_cvt_pk_bf16_f32 v200, v200, v201
    v_cvt_pk_bf16_f32 v201, v202, v203
    v_cvt_pk_bf16_f32 v202, v204, v205
    v_cvt_pk_bf16_f32 v203, v206, v207
    v_cvt_pk_bf16_f32 v208, v208, v209
    v_cvt_pk_bf16_f32 v209, v210, v211
    v_cvt_pk_bf16_f32 v210, v212, v213
    v_cvt_pk_bf16_f32 v211, v214, v215
    v_cvt_pk_bf16_f32 v216, v216, v217
    v_cvt_pk_bf16_f32 v217, v218, v219
    v_cvt_pk_bf16_f32 v218, v220, v221
    v_cvt_pk_bf16_f32 v219, v222, v223
    v_permlane16_swap_b32 v200, v202
    v_permlane16_swap_b32 v201, v203
    v_permlane16_swap_b32 v208, v210
    v_permlane16_swap_b32 v209, v211
    v_permlane16_swap_b32 v216, v218
    v_permlane16_swap_b32 v217, v219
    buffer_store_dwordx4 v[200:203], v46, s[16:19], 0 offen offset:0 sc1
    buffer_store_dwordx4 v[208:211], v46, s[16:19], 0 offen offset:2048 sc1
    buffer_store_dwordx4 v[216:219], v47, s[16:19], 0 offen sc1
    v_cvt_pk_bf16_f32 v224, v224, v225
    v_cvt_pk_bf16_f32 v225, v226, v227
    v_cvt_pk_bf16_f32 v226, v228, v229
    v_cvt_pk_bf16_f32 v227, v230, v231
    v_cvt_pk_bf16_f32 v232, v232, v233
    v_cvt_pk_bf16_f32 v233, v234, v235
    v_cvt_pk_bf16_f32 v234, v236, v237
    v_cvt_pk_bf16_f32 v235, v238, v239
    v_cvt_pk_bf16_f32 v240, v240, v241
    v_cvt_pk_bf16_f32 v241, v242, v243
    v_cvt_pk_bf16_f32 v242, v244, v245
    v_cvt_pk_bf16_f32 v243, v246, v247
    v_permlane16_swap_b32 v224, v226
    v_permlane16_swap_b32 v225, v227
    v_permlane16_swap_b32 v232, v234
    v_permlane16_swap_b32 v233, v235
    v_permlane16_swap_b32 v240, v242
    v_permlane16_swap_b32 v241, v243
    buffer_store_dwordx4 v[224:227], v48, s[16:19], 0 offen offset:0 sc1
    buffer_store_dwordx4 v[232:235], v48, s[16:19], 0 offen offset:2048 sc1
    buffer_store_dwordx4 v[240:243], v49, s[16:19], 0 offen sc1
    v_mov_b32 v28, 1
    v_lshlrev_b32 v29, 9, v1
    s_add_u32 s68, s68, 64
    s_cmp_lt_u32 s20, 4
    s_cbranch_scc1 L_sp_h
    s_waitcnt vmcnt(0)
    s_branch L_sp_cnt
L_sp_h:
    s_branch L_p2_spare_h
L_sp_cnt:
    s_mov_b64 exec, 1
    ds_add_rtn_u32 v24, v30, v28 offset:12
    s_mov_b64 exec, -1
    s_waitcnt lgkmcnt(0)
    v_readfirstlane_b32 s33, v24
    s_nop 3
    s_cmp_lg_u32 s33, 7
    s_cbranch_scc1 L_sp_nolast_s
    buffer_store_dword v28, v29, s[16:19], s68 offen sc1
    s_add_u32 s68, s68, 32768
    buffer_store_dword v28, v29, s[16:19], s68 offen sc1
    s_add_u32 s68, s68, 32768
    buffer_store_dword v28, v29, s[16:19], s68 offen sc1
    s_add_u32 s68, s68, 32768
    buffer_store_dword v28, v29, s[16:19], s68 offen sc1
    s_add_u32 s68, s68, 32768
L_sp_nolast_s:
    s_branch L_p2_roles
L_k1_ffn:
    s_mov_b32 s22, s35
    s_cmp_lt_u32 s20, 4
    s_cselect_b32 s12, s40, s42
    s_cselect_b32 s13, s41, s43
    s_cselect_b32 s28, 0, 12288
    s_and_b32 s13, s13, 0xffff
    s_mov_b32 s14, 2211840
    s_mov_b32 s15, 0x20000
    s_lshl_b32 s33, s31, 10
    s_add_u32 s28, s28, s33
    s_add_u32 s29, s28, 4096
    s_add_u32 s30, s28, 8192
    s_lshl_b32 s33, s31, 6
    s_mul_i32 s34, s22, 192
    s_add_u32 s38, s33, 0
    v_add_u32 v44, s38, v1
    v_mul_u32_u24 v45, 43691, v44
    v_lshrrev_b32 v45, 19, v45
    v_mul_u32_u24 v47, 12, v45
    v_sub_u32 v47, v44, v47
    v_bfe_u32 v48, v45, 3, 1
    v_mul_u32_u24 v48, 10, v48
    v_add_u32 v47, v47, v48
    v_subrev_u32 v48, 12, v47
    v_min_u32 v47, v47, v48
    v_mul_u32_u24 v45, 3456, v45
    v_lshl_add_u32 v45, v47, 4, v45
    v_add_u32 v6, s34, v45
    s_add_u32 s38, s33, 256
    v_add_u32 v44, s38, v1
    v_mul_u32_u24 v45, 43691, v44
    v_lshrrev_b32 v45, 19, v45
    v_mul_u32_u24 v47, 12, v45
    v_sub_u32 v47, v44, v47
    v_bfe_u32 v48, v45, 3, 1
    v_mul_u32_u24 v48, 10, v48
    v_add_u32 v47, v47, v48
    v_subrev_u32 v48, 12, v47
    v_min_u32 v47, v47, v48
    v_mul_u32_u24 v45, 3456, v45
    v_lshl_add_u32 v45, v47, 4, v45
    v_add_u32 v7, s34, v45
    s_add_u32 s38, s33, 512
    v_add_u32 v44, s38, v1
    v_mul_u32_u24 v45, 43691, v44
    v_lshrrev_b32 v45, 19, v45
    v_mul_u32_u24 v47, 12, v45
    v_sub_u32 v47, v44, v47
    v_bfe_u32 v48, v45, 3, 1
    v_mul_u32_u24 v48, 10, v48
    v_add_u32 v47, v47, v48
    v_subrev_u32 v48, 12, v47
    v_min_u32 v47, v47, v48
    v_mul_u32_u24 v45, 3456, v45
    v_lshl_add_u32 v45, v47, 4, v45
    v_add_u32 v8, s34, v45
    s_mul_i32 s24, s25, 221184
    s_mov_b32 s62, s25
    s_and_b32 s63, s25, 1
    s_add_u32 s23, s23, 128
    s_cmp_eq_u32 s23, 1280
    s_cselect_b32 s23, 0, s23
    s_add_u32 m0, s28, 0
    s_xor_b32 s24, 0, s62
    s_mul_i32 s24, s24, 221184
    buffer_load_dwordx4 v6, s[12:15], s24 offen  lds
    s_add_u32 m0, s29, 0
    s_nop 0
    buffer_load_dwordx4 v7, s[12:15], s24 offen  lds
    s_add_u32 m0, s30, 0
    s_nop 0
    buffer_load_dwordx4 v8, s[12:15], s24 offen  lds
    s_and_b32 s32, s2, 7
    s_lshr_b32 s33, s2, 3
    s_lshr_b32 s82, s32, 1
    s_lshl_b32 s82, s82, 3
    s_and_b32 s34, s33, 7
    s_add_u32 s82, s82, s34
    s_and_b32 s83, s32, 1
    s_lshl_b32 s83, s83, 2
    s_lshr_b32 s34, s33, 3
    s_add_u32 s83, s83, s34
    s_lshl_b32 s79, s82, 3
    s_add_u32 s79, s79, s83
    s_lshl_b32 s79, s79, 9
    s_add_u32 s79, s79, 14560256
    s_lshl_b32 s68, s21, 14
    s_lshl_b32 s69, s35, 2
    s_sub_u32 s34, s69, 32
    s_cmp_ge_u32 s35, 26
    s_cselect_b32 s69, s34, s69
    s_add_u32 s68, s68, s69
    s_sub_u32 s69, s35, 18
    s_lshl_b32 s34, s69, 8
    s_lshl_b32 s38, s21, 2
    s_add_u32 s34, s34, s38
    s_add_u32 s34, s34, 131072
    s_cmp_lt_u32 s69, 8
    s_cselect_b32 s68, s34, s68
    s_cselect_b32 s69, 2, 32
    s_cselect_b32 s85, 7, 9
    s_lshl_b32 s34, s21, 1
    s_add_u32 s34, s34, s35
    s_add_u32 s34, s34, 18
    s_lshl_b32 s34, s34, 2
    s_cmp_ge_u32 s35, 30
    s_cselect_b32 s68, s34, s68
    s_cselect_b32 s69, 256, s69
    s_add_u32 s68, s68, 14560256
    v_lshrrev_b32 v47, 4, v1
    v_bfe_u32 v48, v1, 2, 2
    v_lshl_add_u32 v48, v47, 3, v48
    v_mul_u32_u24 v48, 192, v48
    v_and_b32 v49, 1, v47
    v_lshlrev_b32 v49, 5, v49
    v_bfe_u32 v50, v1, 1, 3
    v_xor_b32 v50, v50, v47
    v_and_b32 v51, 15, v1
    v_lshlrev_b32 v52, 7, v51
    v_lshl_add_u32 v52, v50, 4, v52
    s_lshl_b32 s32, s31, 13
    s_add_u32 s32, s32, 98304
    v_add_u32 v156, s32, v52
    v_xor_b32 v52, 64, v52
    v_add_u32 v157, s32, v52
    s_lshl_b32 s32, s21, 2
    s_add_u32 s32, s32, s31
    s_lshl_b32 s49, s32, 8
    s_add_u32 s49, s49, 14543872
    s_add_u32 s50, s49, 8192
    v_lshlrev_b32 v158, 2, v51
    s_cmp_eq_u32 s27, 0
    s_cselect_b32 s32, 0, 128
    v_add_u32 v53, s32, v49
    v_subrev_u32 v54, 192, v53
    v_min_u32 v53, v53, v54
    v_lshl_add_u32 v53, v46, 3, v53
    v_add_u32 v9, v53, v48
    s_lshl_b32 s32, s32, 2
    s_add_u32 s32, s32, 159744
    v_lshl_add_u32 v152, v47, 4, s32
    s_cmp_eq_u32 s27, 0
    s_cselect_b32 s32, 32, 160
    v_add_u32 v53, s32, v49
    v_subrev_u32 v54, 192, v53
    v_min_u32 v53, v53, v54
    v_lshl_add_u32 v53, v46, 3, v53
    v_add_u32 v10, v53, v48
    s_lshl_b32 s32, s32, 2
    s_add_u32 s32, s32, 159744
    v_lshl_add_u32 v153, v47, 4, s32
    s_cmp_eq_u32 s27, 0
    s_cselect_b32 s32, 64, 96
    v_add_u32 v53, s32, v49
    v_subrev_u32 v54, 192, v53
    v_min_u32 v53, v53, v54
    v_lshl_add_u32 v53, v46, 3, v53
    v_add_u32 v11, v53, v48
    s_lshl_b32 s32, s32, 2
    s_add_u32 s32, s32, 159744
    v_lshl_add_u32 v154, v47, 4, s32
    s_mul_i32 s32, s20, 3
    s_add_u32 s32, s32, 0
    s_and_b32 s33, s32, 1
    s_mul_i32 s33, s33, 768
    s_lshr_b32 s32, s32, 1
    s_cmp_ge_u32 s32, 6
    s_cselect_b32 s34, 12288, 0
    s_cselect_b32 s38, 6, 0
    s_add_u32 s33, s33, s34
    s_sub_u32 s32, s32, s38
    s_lshl_b32 s32, s32, 5
    v_add_u32 v53, s32, v49
    v_subrev_u32 v54, 192, v53
    v_min_u32 v53, v53, v54
    v_lshl_add_u32 v53, v46, 3, v53
    v_add3_u32 v12, v53, v48, s33
    s_mul_i32 s32, s20, 3
    s_add_u32 s32, s32, 1
    s_and_b32 s33, s32, 1
    s_mul_i32 s33, s33, 768
    s_lshr_b32 s32, s32, 1
    s_cmp_ge_u32 s32, 6
    s_cselect_b32 s34, 12288, 0
    s_cselect_b32 s38, 6, 0
    s_add_u32 s33, s33, s34
    s_sub_u32 s32, s32, s38
    s_lshl_b32 s32, s32, 5
    v_add_u32 v53, s32, v49
    v_subrev_u32 v54, 192, v53
    v_min_u32 v53, v53, v54
    v_lshl_add_u32 v53, v46, 3, v53
    v_add3_u32 v13, v53, v48, s33
    s_mul_i32 s32, s20, 3
    s_add_u32 s32, s32, 2
    s_and_b32 s33, s32, 1
    s_mul_i32 s33, s33, 768
    s_lshr_b32 s32, s32, 1
    s_cmp_ge_u32 s32, 6
    s_cselect_b32 s34, 12288, 0
    s_cselect_b32 s38, 6, 0
    s_add_u32 s33, s33, s34
    s_sub_u32 s32, s32, s38
    s_lshl_b32 s32, s32, 5
    v_add_u32 v53, s32, v49
    v_subrev_u32 v54, 192, v53
    v_min_u32 v53, v53, v54
    v_lshl_add_u32 v53, v46, 3, v53
    v_add3_u32 v14, v53, v48, s33
    v_lshlrev_b32 v155, 2, v51
    s_lshl_b32 s32, s21, 2
    s_add_u32 s32, s32, s31
    s_mul_i32 s32, s32, 54
    s_mul_i32 s33, s22, 3
    s_add_u32 s32, s32, s33
    s_lshl_b32 s32, s32, 12
    s_add_u32 s32, s32, 0
    s_mul_i32 s33, s27, 8192
    s_add_u32 s52, s32, s33
    s_add_u32 s53, s32, 4096
    v_mov_b32 v16, 0
    v_mov_b32 v17, 0
    v_mov_b32 v18, 0
    v_mov_b32 v19, 0
    v_mov_b32 v20, 0
    v_mov_b32 v21, 0
    s_add_u32 m0, s28, 24576
    s_xor_b32 s24, 1, s62
    s_mul_i32 s24, s24, 221184
    buffer_load_dwordx4 v6, s[12:15], s24 offen  lds
    s_add_u32 m0, s29, 24576
    s_nop 0
    buffer_load_dwordx4 v7, s[12:15], s24 offen  lds
    s_add_u32 m0, s30, 24576
    s_nop 0
    buffer_load_dwordx4 v8, s[12:15], s24 offen  lds
    s_add_u32 m0, s26, 32768
    s_xor_b32 s23, 1, s62
    s_lshl_b32 s23, s23, 7
    buffer_load_dwordx4 v2, s[8:11], s23 offen  lds
    s_add_u32 m0, s26, 33792
    s_nop 0
    buffer_load_dwordx4 v3, s[8:11], s23 offen  lds
    s_add_u32 m0, s26, 34816
    s_nop 0
    buffer_load_dwordx4 v4, s[8:11], s23 offen  lds
    s_add_u32 m0, s26, 35840
    s_nop 0
    buffer_load_dwordx4 v5, s[8:11], s23 offen  lds
    s_add_u32 m0, s28, 49152
    s_xor_b32 s24, 2, s62
    s_mul_i32 s24, s24, 221184
    buffer_load_dwordx4 v6, s[12:15], s24 offen  lds
    s_add_u32 m0, s29, 49152
    s_nop 0
    buffer_load_dwordx4 v7, s[12:15], s24 offen  lds
    s_add_u32 m0, s30, 49152
    s_nop 0
    buffer_load_dwordx4 v8, s[12:15], s24 offen  lds
    s_waitcnt vmcnt(10)
    s_barrier
    ds_read_b128 v[60:63], v156 offset:0
    ds_read_b64_tr_b16 v[92:93], v9 offset:0
    ds_read_b64_tr_b16 v[94:95], v9 offset:768
    ds_read_b128 v[64:67], v156 offset:2048
    ds_read_b128 v[68:71], v156 offset:4096
    ds_read_b128 v[72:75], v156 offset:6144
    ds_read_b64_tr_b16 v[116:117], v12 offset:0
    ds_read_b64_tr_b16 v[118:119], v13 offset:0
    ds_read_b64_tr_b16 v[120:121], v14 offset:0
    ds_read_b64_tr_b16 v[96:97], v9 offset:12288
    ds_read_b64_tr_b16 v[98:99], v9 offset:13056
    ds_read_b64_tr_b16 v[100:101], v10 offset:0
    ds_read_b64_tr_b16 v[102:103], v10 offset:768
    ds_read_b64_tr_b16 v[104:105], v10 offset:12288
    ds_read_b64_tr_b16 v[106:107], v10 offset:13056
    s_waitcnt lgkmcnt(14)
    ds_read_b64_tr_b16 v[108:109], v11 offset:0
    s_waitcnt lgkmcnt(14)
    ds_read_b64_tr_b16 v[110:111], v11 offset:768
    s_waitcnt lgkmcnt(14)
    ds_read_b64_tr_b16 v[112:113], v11 offset:12288
    s_waitcnt lgkmcnt(14)
    ds_read_b64_tr_b16 v[114:115], v11 offset:13056
    s_cmp_eq_u32 s27, 1
    s_cbranch_scc0 L_prio_ffn
    s_setprio 1
L_prio_ffn:
    v_mfma_f32_16x16x32_bf16 v[160:163], v[92:95], v[60:63], 0
    s_waitcnt lgkmcnt(14)
    ds_read_b128 v[76:79], v157 offset:0
    v_mfma_f32_16x16x32_bf16 v[164:167], v[92:95], v[64:67], 0
    s_waitcnt lgkmcnt(14)
    ds_read_b64_tr_b16 v[122:123], v9 offset:6144
    v_mfma_f32_16x16x32_bf16 v[168:171], v[92:95], v[68:71], 0
    s_waitcnt lgkmcnt(14)
    ds_read_b64_tr_b16 v[124:125], v9 offset:6912
    s_waitcnt lgkmcnt(13)
    v_lshlrev_b32 v24, 16, v116
    v_and_b32 v25, 0xffff0000, v116
    v_mfma_f32_16x16x32_bf16 v[172:175], v[92:95], v[72:75], 0
    ds_read_b128 v[80:83], v157 offset:2048
    v_add_f32 v16, v16, v24
    v_add_f32 v17, v17, v25
    s_waitcnt lgkmcnt(12)
    v_mfma_f32_16x16x32_bf16 v[188:191], v[96:99], v[72:75], 0
    ds_read_b128 v[84:87], v157 offset:4096
    v_lshlrev_b32 v26, 16, v117
    v_mfma_f32_16x16x32_bf16 v[184:187], v[96:99], v[68:71], 0
    ds_read_b128 v[88:91], v157 offset:6144
    v_and_b32 v27, 0xffff0000, v117
    v_mfma_f32_16x16x32_bf16 v[180:183], v[96:99], v[64:67], 0
    ds_read_b64_tr_b16 v[146:147], v12 offset:6144
    v_add_f32 v16, v16, v26
    v_mfma_f32_16x16x32_bf16 v[176:179], v[96:99], v[60:63], 0
    s_waitcnt lgkmcnt(14)
    ds_read_b64_tr_b16 v[148:149], v13 offset:6144
    v_add_f32 v17, v17, v27
    s_waitcnt lgkmcnt(14)
    v_mfma_f32_16x16x32_bf16 v[192:195], v[100:103], v[60:63], 0
    ds_read_b64_tr_b16 v[150:151], v14 offset:6144
    v_lshlrev_b32 v24, 16, v118
    v_mfma_f32_16x16x32_bf16 v[196:199], v[100:103], v[64:67], 0
    s_waitcnt lgkmcnt(14)
    ds_read_b64_tr_b16 v[126:127], v9 offset:18432
    v_and_b32 v25, 0xffff0000, v118
    v_mfma_f32_16x16x32_bf16 v[200:203], v[100:103], v[68:71], 0
    s_waitcnt lgkmcnt(14)
    ds_read_b64_tr_b16 v[128:129], v9 offset:19200
    v_add_f32 v18, v18, v24
    v_mfma_f32_16x16x32_bf16 v[204:207], v[100:103], v[72:75], 0
    s_waitcnt lgkmcnt(14)
    ds_read_b64_tr_b16 v[130:131], v10 offset:6144
    v_add_f32 v19, v19, v25
    v_mfma_f32_16x16x32_bf16 v[220:223], v[104:107], v[72:75], 0
    s_waitcnt lgkmcnt(14)
    ds_read_b64_tr_b16 v[132:133], v10 offset:6912
    v_lshlrev_b32 v26, 16, v119
    v_mfma_f32_16x16x32_bf16 v[216:219], v[104:107], v[68:71], 0
    s_waitcnt lgkmcnt(14)
    ds_read_b64_tr_b16 v[134:135], v10 offset:18432
    v_and_b32 v27, 0xffff0000, v119
    v_mfma_f32_16x16x32_bf16 v[212:215], v[104:107], v[64:67], 0
    s_waitcnt lgkmcnt(14)
    ds_read_b64_tr_b16 v[136:137], v10 offset:19200
    v_add_f32 v18, v18, v26
    v_mfma_f32_16x16x32_bf16 v[208:211], v[104:107], v[60:63], 0
    s_waitcnt lgkmcnt(14)
    ds_read_b64_tr_b16 v[138:139], v11 offset:6144
    v_add_f32 v19, v19, v27
    v_mfma_f32_16x16x32_bf16 v[224:227], v[108:111], v[60:63], 0
    s_waitcnt lgkmcnt(14)
    ds_read_b64_tr_b16 v[140:141], v11 offset:6912
    v_lshlrev_b32 v24, 16, v120
    v_mfma_f32_16x16x32_bf16 v[228:231], v[108:111], v[64:67], 0
    s_waitcnt lgkmcnt(14)
    ds_read_b64_tr_b16 v[142:143], v11 offset:18432
    v_and_b32 v25, 0xffff0000, v120
    v_mfma_f32_16x16x32_bf16 v[232:235], v[108:111], v[68:71], 0
    s_waitcnt lgkmcnt(14)
    ds_read_b64_tr_b16 v[144:145], v11 offset:19200
    v_add_f32 v20, v20, v24
    v_mfma_f32_16x16x32_bf16 v[236:239], v[108:111], v[72:75], 0
    v_add_f32 v21, v21, v25
    v_mfma_f32_16x16x32_bf16 v[252:255], v[112:115], v[72:75], 0
    v_lshlrev_b32 v26, 16, v121
    v_mfma_f32_16x16x32_bf16 v[248:251], v[112:115], v[68:71], 0
    v_and_b32 v27, 0xffff0000, v121
    v_mfma_f32_16x16x32_bf16 v[244:247], v[112:115], v[64:67], 0
    v_add_f32 v20, v20, v26
    v_mfma_f32_16x16x32_bf16 v[240:243], v[112:115], v[60:63], 0
    v_add_f32 v21, v21, v27
    s_waitcnt vmcnt(3) lgkmcnt(13)
    s_barrier
    v_mfma_f32_16x16x32_bf16 v[160:163], v[122:125], v[76:79], v[160:163]
    ds_read_b128 v[60:63], v156 offset:32768
    s_add_u32 m0, s26, 0
    s_xor_b32 s23, 2, s62
    s_lshl_b32 s23, s23, 7
    buffer_load_dwordx4 v2, s[8:11], s23 offen  lds
    v_mfma_f32_16x16x32_bf16 v[164:167], v[122:125], v[80:83], v[164:167]
    ds_read_b64_tr_b16 v[92:93], v9 offset:24576
    v_mfma_f32_16x16x32_bf16 v[168:171], v[122:125], v[84:87], v[168:171]
    s_waitcnt lgkmcnt(14)
    ds_read_b64_tr_b16 v[94:95], v9 offset:25344
    s_waitcnt lgkmcnt(13)
    v_lshlrev_b32 v24, 16, v146
    v_and_b32 v25, 0xffff0000, v146
    s_add_u32 m0, s26, 1024
    s_nop 0
    buffer_load_dwordx4 v3, s[8:11], s23 offen  lds
    v_mfma_f32_16x16x32_bf16 v[172:175], v[122:125], v[88:91], v[172:175]
    ds_read_b128 v[64:67], v156 offset:34816
    v_add_f32 v16, v16, v24
    v_add_f32 v17, v17, v25
    s_waitcnt lgkmcnt(12)
    v_mfma_f32_16x16x32_bf16 v[188:191], v[126:129], v[88:91], v[188:191]
    ds_read_b128 v[68:71], v156 offset:36864
    v_lshlrev_b32 v26, 16, v147
    s_add_u32 m0, s26, 2048
    s_nop 0
    buffer_load_dwordx4 v4, s[8:11], s23 offen  lds
    v_mfma_f32_16x16x32_bf16 v[184:187], v[126:129], v[84:87], v[184:187]
    ds_read_b128 v[72:75], v156 offset:38912
    v_and_b32 v27, 0xffff0000, v147
    v_mfma_f32_16x16x32_bf16 v[180:183], v[126:129], v[80:83], v[180:183]
    ds_read_b64_tr_b16 v[116:117], v12 offset:24576
    v_add_f32 v16, v16, v26
    s_add_u32 m0, s26, 3072
    s_nop 0
    buffer_load_dwordx4 v5, s[8:11], s23 offen  lds
    v_mfma_f32_16x16x32_bf16 v[176:179], v[126:129], v[76:79], v[176:179]
    s_waitcnt lgkmcnt(14)
    ds_read_b64_tr_b16 v[118:119], v13 offset:24576
    v_add_f32 v17, v17, v27
    s_waitcnt lgkmcnt(14)
    v_mfma_f32_16x16x32_bf16 v[192:195], v[130:133], v[76:79], v[192:195]
    ds_read_b64_tr_b16 v[120:121], v14 offset:24576
    v_lshlrev_b32 v24, 16, v148
    s_add_u32 m0, s28, 73728
    s_xor_b32 s24, 3, s62
    s_mul_i32 s24, s24, 221184
    buffer_load_dwordx4 v6, s[12:15], s24 offen  lds
    v_mfma_f32_16x16x32_bf16 v[196:199], v[130:133], v[80:83], v[196:199]
    s_waitcnt lgkmcnt(14)
    ds_read_b64_tr_b16 v[96:97], v9 offset:36864
    v_and_b32 v25, 0xffff0000, v148
    v_mfma_f32_16x16x32_bf16 v[200:203], v[130:133], v[84:87], v[200:203]
    s_waitcnt lgkmcnt(14)
    ds_read_b64_tr_b16 v[98:99], v9 offset:37632
    v_add_f32 v18, v18, v24
    s_add_u32 m0, s29, 73728
    s_nop 0
    buffer_load_dwordx4 v7, s[12:15], s24 offen  lds
    v_mfma_f32_16x16x32_bf16 v[204:207], v[130:133], v[88:91], v[204:207]
    s_waitcnt lgkmcnt(14)
    ds_read_b64_tr_b16 v[100:101], v10 offset:24576
    v_add_f32 v19, v19, v25
    v_mfma_f32_16x16x32_bf16 v[220:223], v[134:137], v[88:91], v[220:223]
    s_waitcnt lgkmcnt(14)
    ds_read_b64_tr_b16 v[102:103], v10 offset:25344
    v_lshlrev_b32 v26, 16, v149
    s_add_u32 m0, s30, 73728
    s_nop 0
    buffer_load_dwordx4 v8, s[12:15], s24 offen  lds
    v_mfma_f32_16x16x32_bf16 v[216:219], v[134:137], v[84:87], v[216:219]
    s_waitcnt lgkmcnt(14)
    ds_read_b64_tr_b16 v[104:105], v10 offset:36864
    v_and_b32 v27, 0xffff0000, v149
    v_mfma_f32_16x16x32_bf16 v[212:215], v[134:137], v[80:83], v[212:215]
    s_waitcnt lgkmcnt(14)
    ds_read_b64_tr_b16 v[106:107], v10 offset:37632
    v_add_f32 v18, v18, v26
    v_mfma_f32_16x16x32_bf16 v[208:211], v[134:137], v[76:79], v[208:211]
    s_waitcnt lgkmcnt(14)
    ds_read_b64_tr_b16 v[108:109], v11 offset:24576
    v_add_f32 v19, v19, v27
    v_mfma_f32_16x16x32_bf16 v[224:227], v[138:141], v[76:79], v[224:227]
    s_waitcnt lgkmcnt(14)
    ds_read_b64_tr_b16 v[110:111], v11 offset:25344
    v_lshlrev_b32 v24, 16, v150
    v_mfma_f32_16x16x32_bf16 v[228:231], v[138:141], v[80:83], v[228:231]
    s_waitcnt lgkmcnt(14)
    ds_read_b64_tr_b16 v[112:113], v11 offset:36864
    v_and_b32 v25, 0xffff0000, v150
    v_mfma_f32_16x16x32_bf16 v[232:235], v[138:141], v[84:87], v[232:235]
    s_waitcnt lgkmcnt(14)
    ds_read_b64_tr_b16 v[114:115], v11 offset:37632
    v_add_f32 v20, v20, v24
    v_mfma_f32_16x16x32_bf16 v[236:239], v[138:141], v[88:91], v[236:239]
    v_add_f32 v21, v21, v25
    v_mfma_f32_16x16x32_bf16 v[252:255], v[142:145], v[88:91], v[252:255]
    v_lshlrev_b32 v26, 16, v151
    v_mfma_f32_16x16x32_bf16 v[248:251], v[142:145], v[84:87], v[248:251]
    v_and_b32 v27, 0xffff0000, v151
    v_mfma_f32_16x16x32_bf16 v[244:247], v[142:145], v[80:83], v[244:247]
    v_add_f32 v20, v20, v26
    v_mfma_f32_16x16x32_bf16 v[240:243], v[142:145], v[76:79], v[240:243]
    v_add_f32 v21, v21, v27
    v_mfma_f32_16x16x32_bf16 v[160:163], v[92:95], v[60:63], v[160:163]
    s_waitcnt lgkmcnt(14)
    ds_read_b128 v[76:79], v157 offset:32768
    v_mfma_f32_16x16x32_bf16 v[164:167], v[92:95], v[64:67], v[164:167]
    s_waitcnt lgkmcnt(14)
    ds_read_b64_tr_b16 v[122:123], v9 offset:30720
    v_mfma_f32_16x16x32_bf16 v[168:171], v[92:95], v[68:71], v[168:171]
    s_waitcnt lgkmcnt(14)
    ds_read_b64_tr_b16 v[124:125], v9 offset:31488
    s_waitcnt lgkmcnt(13)
    v_lshlrev_b32 v24, 16, v116
    v_and_b32 v25, 0xffff0000, v116
    v_mfma_f32_16x16x32_bf16 v[172:175], v[92:95], v[72:75], v[172:175]
    ds_read_b128 v[80:83], v157 offset:34816
    v_add_f32 v16, v16, v24
    v_add_f32 v17, v17, v25
    s_waitcnt lgkmcnt(12)
    v_mfma_f32_16x16x32_bf16 v[188:191], v[96:99], v[72:75], v[188:191]
    ds_read_b128 v[84:87], v157 offset:36864
    v_lshlrev_b32 v26, 16, v117
    v_mfma_f32_16x16x32_bf16 v[184:187], v[96:99], v[68:71], v[184:187]
    ds_read_b128 v[88:91], v157 offset:38912
    v_and_b32 v27, 0xffff0000, v117
    v_mfma_f32_16x16x32_bf16 v[180:183], v[96:99], v[64:67], v[180:183]
    ds_read_b64_tr_b16 v[146:147], v12 offset:30720
    v_add_f32 v16, v16, v26
    v_mfma_f32_16x16x32_bf16 v[176:179], v[96:99], v[60:63], v[176:179]
    s_waitcnt lgkmcnt(14)
    ds_read_b64_tr_b16 v[148:149], v13 offset:30720
    v_add_f32 v17, v17, v27
    s_waitcnt lgkmcnt(14)
    v_mfma_f32_16x16x32_bf16 v[192:195], v[100:103], v[60:63], v[192:195]
    ds_read_b64_tr_b16 v[150:151], v14 offset:30720
    v_lshlrev_b32 v24, 16, v118
    v_mfma_f32_16x16x32_bf16 v[196:199], v[100:103], v[64:67], v[196:199]
    s_waitcnt lgkmcnt(14)
    ds_read_b64_tr_b16 v[126:127], v9 offset:43008
    v_and_b32 v25, 0xffff0000, v118
    v_mfma_f32_16x16x32_bf16 v[200:203], v[100:103], v[68:71], v[200:203]
    s_waitcnt lgkmcnt(14)
    ds_read_b64_tr_b16 v[128:129], v9 offset:43776
    v_add_f32 v18, v18, v24
    v_mfma_f32_16x16x32_bf16 v[204:207], v[100:103], v[72:75], v[204:207]
    s_waitcnt lgkmcnt(14)
    ds_read_b64_tr_b16 v[130:131], v10 offset:30720
    v_add_f32 v19, v19, v25
    v_mfma_f32_16x16x32_bf16 v[220:223], v[104:107], v[72:75], v[220:223]
    s_waitcnt lgkmcnt(14)
    ds_read_b64_tr_b16 v[132:133], v10 offset:31488
    v_lshlrev_b32 v26, 16, v119
    v_mfma_f32_16x16x32_bf16 v[216:219], v[104:107], v[68:71], v[216:219]
    s_waitcnt lgkmcnt(14)
    ds_read_b64_tr_b16 v[134:135], v10 offset:43008
    v_and_b32 v27, 0xffff0000, v119
    v_mfma_f32_16x16x32_bf16 v[212:215], v[104:107], v[64:67], v[212:215]
    s_waitcnt lgkmcnt(14)
    ds_read_b64_tr_b16 v[136:137], v10 offset:43776
    v_add_f32 v18, v18, v26
    v_mfma_f32_16x16x32_bf16 v[208:211], v[104:107], v[60:63], v[208:211]
    s_waitcnt lgkmcnt(14)
    ds_read_b64_tr_b16 v[138:139], v11 offset:30720
    v_add_f32 v19, v19, v27
    v_mfma_f32_16x16x32_bf16 v[224:227], v[108:111], v[60:63], v[224:227]
    s_waitcnt lgkmcnt(14)
    ds_read_b64_tr_b16 v[140:141], v11 offset:31488
    v_lshlrev_b32 v24, 16, v120
    v_mfma_f32_16x16x32_bf16 v[228:231], v[108:111], v[64:67], v[228:231]
    s_waitcnt lgkmcnt(14)
    ds_read_b64_tr_b16 v[142:143], v11 offset:43008
    v_and_b32 v25, 0xffff0000, v120
    v_mfma_f32_16x16x32_bf16 v[232:235], v[108:111], v[68:71], v[232:235]
    s_waitcnt lgkmcnt(14)
    ds_read_b64_tr_b16 v[144:145], v11 offset:43776
    v_add_f32 v20, v20, v24
    v_mfma_f32_16x16x32_bf16 v[236:239], v[108:111], v[72:75], v[236:239]
    v_add_f32 v21, v21, v25
    v_mfma_f32_16x16x32_bf16 v[252:255], v[112:115], v[72:75], v[252:255]
    v_lshlrev_b32 v26, 16, v121
    v_mfma_f32_16x16x32_bf16 v[248:251], v[112:115], v[68:71], v[248:251]
    v_and_b32 v27, 0xffff0000, v121
    v_mfma_f32_16x16x32_bf16 v[244:247], v[112:115], v[64:67], v[244:247]
    v_add_f32 v20, v20, v26
    v_mfma_f32_16x16x32_bf16 v[240:243], v[112:115], v[60:63], v[240:243]
    v_add_f32 v21, v21, v27
    s_waitcnt vmcnt(3) lgkmcnt(13)
    s_barrier
    v_add_u32 v9, 49152, v9
    v_add_u32 v10, 49152, v10
    v_add_u32 v11, 49152, v11
    v_add_u32 v12, 49152, v12
    v_add_u32 v13, 49152, v13
    v_add_u32 v14, 49152, v14
    v_mfma_f32_16x16x32_bf16 v[160:163], v[122:125], v[76:79], v[160:163]
    ds_read_b128 v[60:63], v156 offset:0
    s_add_u32 m0, s26, 32768
    s_xor_b32 s23, 3, s62
    s_lshl_b32 s23, s23, 7
    buffer_load_dwordx4 v2, s[8:11], s23 offen  lds
    v_mfma_f32_16x16x32_bf16 v[164:167], v[122:125], v[80:83], v[164:167]
    ds_read_b64_tr_b16 v[92:93], v9 offset:0
    v_mfma_f32_16x16x32_bf16 v[168:171], v[122:125], v[84:87], v[168:171]
    s_waitcnt lgkmcnt(14)
    ds_read_b64_tr_b16 v[94:95], v9 offset:768
    s_waitcnt lgkmcnt(13)
    v_lshlrev_b32 v24, 16, v146
    v_and_b32 v25, 0xffff0000, v146
    s_add_u32 m0, s26, 33792
    s_nop 0
    buffer_load_dwordx4 v3, s[8:11], s23 offen  lds
    v_mfma_f32_16x16x32_bf16 v[172:175], v[122:125], v[88:91], v[172:175]
    ds_read_b128 v[64:67], v156 offset:2048
    v_add_f32 v16, v16, v24
    v_add_f32 v17, v17, v25
    s_waitcnt lgkmcnt(12)
    v_mfma_f32_16x16x32_bf16 v[188:191], v[126:129], v[88:91], v[188:191]
    ds_read_b128 v[68:71], v156 offset:4096
    v_lshlrev_b32 v26, 16, v147
    s_add_u32 m0, s26, 34816
    s_nop 0
    buffer_load_dwordx4 v4, s[8:11], s23 offen  lds
    v_mfma_f32_16x16x32_bf16 v[184:187], v[126:129], v[84:87], v[184:187]
    ds_read_b128 v[72:75], v156 offset:6144
    v_and_b32 v27, 0xffff0000, v147
    v_mfma_f32_16x16x32_bf16 v[180:183], v[126:129], v[80:83], v[180:183]
    ds_read_b64_tr_b16 v[116:117], v12 offset:0
    v_add_f32 v16, v16, v26
    s_add_u32 m0, s26, 35840
    s_nop 0
    buffer_load_dwordx4 v5, s[8:11], s23 offen  lds
    v_mfma_f32_16x16x32_bf16 v[176:179], v[126:129], v[76:79], v[176:179]
    s_waitcnt lgkmcnt(14)
    ds_read_b64_tr_b16 v[118:119], v13 offset:0
    v_add_f32 v17, v17, v27
    s_waitcnt lgkmcnt(14)
    v_mfma_f32_16x16x32_bf16 v[192:195], v[130:133], v[76:79], v[192:195]
    ds_read_b64_tr_b16 v[120:121], v14 offset:0
    v_lshlrev_b32 v24, 16, v148
    s_add_u32 m0, s28, 0
    s_xor_b32 s24, 4, s62
    s_mul_i32 s24, s24, 221184
    buffer_load_dwordx4 v6, s[12:15], s24 offen  lds
    v_mfma_f32_16x16x32_bf16 v[196:199], v[130:133], v[80:83], v[196:199]
    s_waitcnt lgkmcnt(14)
    ds_read_b64_tr_b16 v[96:97], v9 offset:12288
    v_and_b32 v25, 0xffff0000, v148
    v_mfma_f32_16x16x32_bf16 v[200:203], v[130:133], v[84:87], v[200:203]
    s_waitcnt lgkmcnt(14)
    ds_read_b64_tr_b16 v[98:99], v9 offset:13056
    v_add_f32 v18, v18, v24
    s_add_u32 m0, s29, 0
    s_nop 0
    buffer_load_dwordx4 v7, s[12:15], s24 offen  lds
    v_mfma_f32_16x16x32_bf16 v[204:207], v[130:133], v[88:91], v[204:207]
    s_waitcnt lgkmcnt(14)
    ds_read_b64_tr_b16 v[100:101], v10 offset:0
    v_add_f32 v19, v19, v25
    v_mfma_f32_16x16x32_bf16 v[220:223], v[134:137], v[88:91], v[220:223]
    s_waitcnt lgkmcnt(14)
    ds_read_b64_tr_b16 v[102:103], v10 offset:768
    v_lshlrev_b32 v26, 16, v149
    s_add_u32 m0, s30, 0
    s_nop 0
    buffer_load_dwordx4 v8, s[12:15], s24 offen  lds
    v_mfma_f32_16x16x32_bf16 v[216:219], v[134:137], v[84:87], v[216:219]
    s_waitcnt lgkmcnt(14)
    ds_read_b64_tr_b16 v[104:105], v10 offset:12288
    v_and_b32 v27, 0xffff0000, v149
    v_mfma_f32_16x16x32_bf16 v[212:215], v[134:137], v[80:83], v[212:215]
    s_waitcnt lgkmcnt(14)
    ds_read_b64_tr_b16 v[106:107], v10 offset:13056
    v_add_f32 v18, v18, v26
    v_mfma_f32_16x16x32_bf16 v[208:211], v[134:137], v[76:79], v[208:211]
    s_waitcnt lgkmcnt(14)
    ds_read_b64_tr_b16 v[108:109], v11 offset:0
    v_add_f32 v19, v19, v27
    v_mfma_f32_16x16x32_bf16 v[224:227], v[138:141], v[76:79], v[224:227]
    s_waitcnt lgkmcnt(14)
    ds_read_b64_tr_b16 v[110:111], v11 offset:768
    v_lshlrev_b32 v24, 16, v150
    v_mfma_f32_16x16x32_bf16 v[228:231], v[138:141], v[80:83], v[228:231]
    s_waitcnt lgkmcnt(14)
    ds_read_b64_tr_b16 v[112:113], v11 offset:12288
    v_and_b32 v25, 0xffff0000, v150
    v_mfma_f32_16x16x32_bf16 v[232:235], v[138:141], v[84:87], v[232:235]
    s_waitcnt lgkmcnt(14)
    ds_read_b64_tr_b16 v[114:115], v11 offset:13056
    v_add_f32 v20, v20, v24
    v_mfma_f32_16x16x32_bf16 v[236:239], v[138:141], v[88:91], v[236:239]
    v_add_f32 v21, v21, v25
    v_mfma_f32_16x16x32_bf16 v[252:255], v[142:145], v[88:91], v[252:255]
    v_lshlrev_b32 v26, 16, v151
    v_mfma_f32_16x16x32_bf16 v[248:251], v[142:145], v[84:87], v[248:251]
    v_and_b32 v27, 0xffff0000, v151
    v_mfma_f32_16x16x32_bf16 v[244:247], v[142:145], v[80:83], v[244:247]
    v_add_f32 v20, v20, v26
    v_mfma_f32_16x16x32_bf16 v[240:243], v[142:145], v[76:79], v[240:243]
    v_add_f32 v21, v21, v27
    v_mfma_f32_16x16x32_bf16 v[160:163], v[92:95], v[60:63], v[160:163]
    s_waitcnt lgkmcnt(14)
    ds_read_b128 v[76:79], v157 offset:0
    v_mfma_f32_16x16x32_bf16 v[164:167], v[92:95], v[64:67], v[164:167]
    s_waitcnt lgkmcnt(14)
    ds_read_b64_tr_b16 v[122:123], v9 offset:6144
    v_mfma_f32_16x16x32_bf16 v[168:171], v[92:95], v[68:71], v[168:171]
    s_waitcnt lgkmcnt(14)
    ds_read_b64_tr_b16 v[124:125], v9 offset:6912
    s_waitcnt lgkmcnt(13)
    v_lshlrev_b32 v24, 16, v116
    v_and_b32 v25, 0xffff0000, v116
    v_mfma_f32_16x16x32_bf16 v[172:175], v[92:95], v[72:75], v[172:175]
    ds_read_b128 v[80:83], v157 offset:2048
    v_add_f32 v16, v16, v24
    v_add_f32 v17, v17, v25
    s_waitcnt lgkmcnt(12)
    v_mfma_f32_16x16x32_bf16 v[188:191], v[96:99], v[72:75], v[188:191]
    ds_read_b128 v[84:87], v157 offset:4096
    v_lshlrev_b32 v26, 16, v117
    v_mfma_f32_16x16x32_bf16 v[184:187], v[96:99], v[68:71], v[184:187]
    ds_read_b128 v[88:91], v157 offset:6144
    v_and_b32 v27, 0xffff0000, v117
    v_mfma_f32_16x16x32_bf16 v[180:183], v[96:99], v[64:67], v[180:183]
    ds_read_b64_tr_b16 v[146:147], v12 offset:6144
    v_add_f32 v16, v16, v26
    v_mfma_f32_16x16x32_bf16 v[176:179], v[96:99], v[60:63], v[176:179]
    s_waitcnt lgkmcnt(14)
    ds_read_b64_tr_b16 v[148:149], v13 offset:6144
    v_add_f32 v17, v17, v27
    s_waitcnt lgkmcnt(14)
    v_mfma_f32_16x16x32_bf16 v[192:195], v[100:103], v[60:63], v[192:195]
    ds_read_b64_tr_b16 v[150:151], v14 offset:6144
    v_lshlrev_b32 v24, 16, v118
    v_mfma_f32_16x16x32_bf16 v[196:199], v[100:103], v[64:67], v[196:199]
    s_waitcnt lgkmcnt(14)
    ds_read_b64_tr_b16 v[126:127], v9 offset:18432
    v_and_b32 v25, 0xffff0000, v118
    v_mfma_f32_16x16x32_bf16 v[200:203], v[100:103], v[68:71], v[200:203]
    s_waitcnt lgkmcnt(14)
    ds_read_b64_tr_b16 v[128:129], v9 offset:19200
    v_add_f32 v18, v18, v24
    v_mfma_f32_16x16x32_bf16 v[204:207], v[100:103], v[72:75], v[204:207]
    s_waitcnt lgkmcnt(14)
    ds_read_b64_tr_b16 v[130:131], v10 offset:6144
    v_add_f32 v19, v19, v25
    v_mfma_f32_16x16x32_bf16 v[220:223], v[104:107], v[72:75], v[220:223]
    s_waitcnt lgkmcnt(14)
    ds_read_b64_tr_b16 v[132:133], v10 offset:6912
    v_lshlrev_b32 v26, 16, v119
    v_mfma_f32_16x16x32_bf16 v[216:219], v[104:107], v[68:71], v[216:219]
    s_waitcnt lgkmcnt(14)
    ds_read_b64_tr_b16 v[134:135], v10 offset:18432
    v_and_b32 v27, 0xffff0000, v119
    v_mfma_f32_16x16x32_bf16 v[212:215], v[104:107], v[64:67], v[212:215]
    s_waitcnt lgkmcnt(14)
    ds_read_b64_tr_b16 v[136:137], v10 offset:19200
    v_add_f32 v18, v18, v26
    v_mfma_f32_16x16x32_bf16 v[208:211], v[104:107], v[60:63], v[208:211]
    s_waitcnt lgkmcnt(14)
    ds_read_b64_tr_b16 v[138:139], v11 offset:6144
    v_add_f32 v19, v19, v27
    v_mfma_f32_16x16x32_bf16 v[224:227], v[108:111], v[60:63], v[224:227]
    s_waitcnt lgkmcnt(14)
    ds_read_b64_tr_b16 v[140:141], v11 offset:6912
    v_lshlrev_b32 v24, 16, v120
    v_mfma_f32_16x16x32_bf16 v[228:231], v[108:111], v[64:67], v[228:231]
    s_waitcnt lgkmcnt(14)
    ds_read_b64_tr_b16 v[142:143], v11 offset:18432
    v_and_b32 v25, 0xffff0000, v120
    v_mfma_f32_16x16x32_bf16 v[232:235], v[108:111], v[68:71], v[232:235]
    s_waitcnt lgkmcnt(14)
    ds_read_b64_tr_b16 v[144:145], v11 offset:19200
    v_add_f32 v20, v20, v24
    v_mfma_f32_16x16x32_bf16 v[236:239], v[108:111], v[72:75], v[236:239]
    v_add_f32 v21, v21, v25
    v_mfma_f32_16x16x32_bf16 v[252:255], v[112:115], v[72:75], v[252:255]
    v_lshlrev_b32 v26, 16, v121
    v_mfma_f32_16x16x32_bf16 v[248:251], v[112:115], v[68:71], v[248:251]
    v_and_b32 v27, 0xffff0000, v121
    v_mfma_f32_16x16x32_bf16 v[244:247], v[112:115], v[64:67], v[244:247]
    v_add_f32 v20, v20, v26
    v_mfma_f32_16x16x32_bf16 v[240:243], v[112:115], v[60:63], v[240:243]
    v_add_f32 v21, v21, v27
    s_waitcnt vmcnt(3) lgkmcnt(13)
    s_barrier
    v_mfma_f32_16x16x32_bf16 v[160:163], v[122:125], v[76:79], v[160:163]
    ds_read_b128 v[60:63], v156 offset:32768
    s_add_u32 m0, s26, 0
    s_xor_b32 s23, 4, s62
    s_lshl_b32 s23, s23, 7
    buffer_load_dwordx4 v2, s[8:11], s23 offen  lds
    v_mfma_f32_16x16x32_bf16 v[164:167], v[122:125], v[80:83], v[164:167]
    ds_read_b64_tr_b16 v[92:93], v9 offset:24576
    v_mfma_f32_16x16x32_bf16 v[168:171], v[122:125], v[84:87], v[168:171]
    s_waitcnt lgkmcnt(14)
    ds_read_b64_tr_b16 v[94:95], v9 offset:25344
    s_waitcnt lgkmcnt(13)
    v_lshlrev_b32 v24, 16, v146
    v_and_b32 v25, 0xffff0000, v146
    s_add_u32 m0, s26, 1024
    s_nop 0
    buffer_load_dwordx4 v3, s[8:11], s23 offen  lds
    v_mfma_f32_16x16x32_bf16 v[172:175], v[122:125], v[88:91], v[172:175]
    ds_read_b128 v[64:67], v156 offset:34816
    v_add_f32 v16, v16, v24
    v_add_f32 v17, v17, v25
    s_waitcnt lgkmcnt(12)
    v_mfma_f32_16x16x32_bf16 v[188:191], v[126:129], v[88:91], v[188:191]
    ds_read_b128 v[68:71], v156 offset:36864
    v_lshlrev_b32 v26, 16, v147
    s_add_u32 m0, s26, 2048
    s_nop 0
    buffer_load_dwordx4 v4, s[8:11], s23 offen  lds
    v_mfma_f32_16x16x32_bf16 v[184:187], v[126:129], v[84:87], v[184:187]
    ds_read_b128 v[72:75], v156 offset:38912
    v_and_b32 v27, 0xffff0000, v147
    v_mfma_f32_16x16x32_bf16 v[180:183], v[126:129], v[80:83], v[180:183]
    ds_read_b64_tr_b16 v[116:117], v12 offset:24576
    v_add_f32 v16, v16, v26
    s_add_u32 m0, s26, 3072
    s_nop 0
    buffer_load_dwordx4 v5, s[8:11], s23 offen  lds
    v_mfma_f32_16x16x32_bf16 v[176:179], v[126:129], v[76:79], v[176:179]
    s_waitcnt lgkmcnt(14)
    ds_read_b64_tr_b16 v[118:119], v13 offset:24576
    v_add_f32 v17, v17, v27
    s_waitcnt lgkmcnt(14)
    v_mfma_f32_16x16x32_bf16 v[192:195], v[130:133], v[76:79], v[192:195]
    ds_read_b64_tr_b16 v[120:121], v14 offset:24576
    v_lshlrev_b32 v24, 16, v148
    s_add_u32 m0, s28, 24576
    s_xor_b32 s24, 5, s62
    s_mul_i32 s24, s24, 221184
    buffer_load_dwordx4 v6, s[12:15], s24 offen  lds
    v_mfma_f32_16x16x32_bf16 v[196:199], v[130:133], v[80:83], v[196:199]
    s_waitcnt lgkmcnt(14)
    ds_read_b64_tr_b16 v[96:97], v9 offset:36864
    v_and_b32 v25, 0xffff0000, v148
    v_mfma_f32_16x16x32_bf16 v[200:203], v[130:133], v[84:87], v[200:203]
    s_waitcnt lgkmcnt(14)
    ds_read_b64_tr_b16 v[98:99], v9 offset:37632
    v_add_f32 v18, v18, v24
    s_add_u32 m0, s29, 24576
    s_nop 0
    buffer_load_dwordx4 v7, s[12:15], s24 offen  lds
    v_mfma_f32_16x16x32_bf16 v[204:207], v[130:133], v[88:91], v[204:207]
    s_waitcnt lgkmcnt(14)
    ds_read_b64_tr_b16 v[100:101], v10 offset:24576
    v_add_f32 v19, v19, v25
    v_mfma_f32_16x16x32_bf16 v[220:223], v[134:137], v[88:91], v[220:223]
    s_waitcnt lgkmcnt(14)
    ds_read_b64_tr_b16 v[102:103], v10 offset:25344
    v_lshlrev_b32 v26, 16, v149
    s_add_u32 m0, s30, 24576
    s_nop 0
    buffer_load_dwordx4 v8, s[12:15], s24 offen  lds
    v_mfma_f32_16x16x32_bf16 v[216:219], v[134:137], v[84:87], v[216:219]
    s_waitcnt lgkmcnt(14)
    ds_read_b64_tr_b16 v[104:105], v10 offset:36864
    v_and_b32 v27, 0xffff0000, v149
    v_mfma_f32_16x16x32_bf16 v[212:215], v[134:137], v[80:83], v[212:215]
    s_waitcnt lgkmcnt(14)
    ds_read_b64_tr_b16 v[106:107], v10 offset:37632
    v_add_f32 v18, v18, v26
    v_mfma_f32_16x16x32_bf16 v[208:211], v[134:137], v[76:79], v[208:211]
    s_waitcnt lgkmcnt(14)
    ds_read_b64_tr_b16 v[108:109], v11 offset:24576
    v_add_f32 v19, v19, v27
    v_mfma_f32_16x16x32_bf16 v[224:227], v[138:141], v[76:79], v[224:227]
    s_waitcnt lgkmcnt(14)
    ds_read_b64_tr_b16 v[110:111], v11 offset:25344
    v_lshlrev_b32 v24, 16, v150
    v_mfma_f32_16x16x32_bf16 v[228:231], v[138:141], v[80:83], v[228:231]
    s_waitcnt lgkmcnt(14)
    ds_read_b64_tr_b16 v[112:113], v11 offset:36864
    v_and_b32 v25, 0xffff0000, v150
    v_mfma_f32_16x16x32_bf16 v[232:235], v[138:141], v[84:87], v[232:235]
    s_waitcnt lgkmcnt(14)
    ds_read_b64_tr_b16 v[114:115], v11 offset:37632
    v_add_f32 v20, v20, v24
    v_mfma_f32_16x16x32_bf16 v[236:239], v[138:141], v[88:91], v[236:239]
    v_add_f32 v21, v21, v25
    v_mfma_f32_16x16x32_bf16 v[252:255], v[142:145], v[88:91], v[252:255]
    v_lshlrev_b32 v26, 16, v151
    v_mfma_f32_16x16x32_bf16 v[248:251], v[142:145], v[84:87], v[248:251]
    v_and_b32 v27, 0xffff0000, v151
    v_mfma_f32_16x16x32_bf16 v[244:247], v[142:145], v[80:83], v[244:247]
    v_add_f32 v20, v20, v26
    v_mfma_f32_16x16x32_bf16 v[240:243], v[142:145], v[76:79], v[240:243]
    v_add_f32 v21, v21, v27
    v_mfma_f32_16x16x32_bf16 v[160:163], v[92:95], v[60:63], v[160:163]
    s_waitcnt lgkmcnt(14)
    ds_read_b128 v[76:79], v157 offset:32768
    v_mfma_f32_16x16x32_bf16 v[164:167], v[92:95], v[64:67], v[164:167]
    s_waitcnt lgkmcnt(14)
    ds_read_b64_tr_b16 v[122:123], v9 offset:30720
    v_mfma_f32_16x16x32_bf16 v[168:171], v[92:95], v[68:71], v[168:171]
    s_waitcnt lgkmcnt(14)
    ds_read_b64_tr_b16 v[124:125], v9 offset:31488
    s_waitcnt lgkmcnt(13)
    v_lshlrev_b32 v24, 16, v116
    v_and_b32 v25, 0xffff0000, v116
    v_mfma_f32_16x16x32_bf16 v[172:175], v[92:95], v[72:75], v[172:175]
    ds_read_b128 v[80:83], v157 offset:34816
    v_add_f32 v16, v16, v24
    v_add_f32 v17, v17, v25
    s_waitcnt lgkmcnt(12)
    v_mfma_f32_16x16x32_bf16 v[188:191], v[96:99], v[72:75], v[188:191]
    ds_read_b128 v[84:87], v157 offset:36864
    v_lshlrev_b32 v26, 16, v117
    v_mfma_f32_16x16x32_bf16 v[184:187], v[96:99], v[68:71], v[184:187]
    ds_read_b128 v[88:91], v157 offset:38912
    v_and_b32 v27, 0xffff0000, v117
    v_mfma_f32_16x16x32_bf16 v[180:183], v[96:99], v[64:67], v[180:183]
    ds_read_b64_tr_b16 v[146:147], v12 offset:30720
    v_add_f32 v16, v16, v26
    v_mfma_f32_16x16x32_bf16 v[176:179], v[96:99], v[60:63], v[176:179]
    s_waitcnt lgkmcnt(14)
    ds_read_b64_tr_b16 v[148:149], v13 offset:30720
    v_add_f32 v17, v17, v27
    s_waitcnt lgkmcnt(14)
    v_mfma_f32_16x16x32_bf16 v[192:195], v[100:103], v[60:63], v[192:195]
    ds_read_b64_tr_b16 v[150:151], v14 offset:30720
    v_lshlrev_b32 v24, 16, v118
    v_mfma_f32_16x16x32_bf16 v[196:199], v[100:103], v[64:67], v[196:199]
    s_waitcnt lgkmcnt(14)
    ds_read_b64_tr_b16 v[126:127], v9 offset:43008
    v_and_b32 v25, 0xffff0000, v118
    v_mfma_f32_16x16x32_bf16 v[200:203], v[100:103], v[68:71], v[200:203]
    s_waitcnt lgkmcnt(14)
    ds_read_b64_tr_b16 v[128:129], v9 offset:43776
    v_add_f32 v18, v18, v24
    v_mfma_f32_16x16x32_bf16 v[204:207], v[100:103], v[72:75], v[204:207]
    s_waitcnt lgkmcnt(14)
    ds_read_b64_tr_b16 v[130:131], v10 offset:30720
    v_add_f32 v19, v19, v25
    v_mfma_f32_16x16x32_bf16 v[220:223], v[104:107], v[72:75], v[220:223]
    s_waitcnt lgkmcnt(14)
    ds_read_b64_tr_b16 v[132:133], v10 offset:31488
    v_lshlrev_b32 v26, 16, v119
    v_mfma_f32_16x16x32_bf16 v[216:219], v[104:107], v[68:71], v[216:219]
    s_waitcnt lgkmcnt(14)
    ds_read_b64_tr_b16 v[134:135], v10 offset:43008
    v_and_b32 v27, 0xffff0000, v119
    v_mfma_f32_16x16x32_bf16 v[212:215], v[104:107], v[64:67], v[212:215]
    s_waitcnt lgkmcnt(14)
    ds_read_b64_tr_b16 v[136:137], v10 offset:43776
    v_add_f32 v18, v18, v26
    v_mfma_f32_16x16x32_bf16 v[208:211], v[104:107], v[60:63], v[208:211]
    s_waitcnt lgkmcnt(14)
    ds_read_b64_tr_b16 v[138:139], v11 offset:30720
    v_add_f32 v19, v19, v27
    v_mfma_f32_16x16x32_bf16 v[224:227], v[108:111], v[60:63], v[224:227]
    s_waitcnt lgkmcnt(14)
    ds_read_b64_tr_b16 v[140:141], v11 offset:31488
    v_lshlrev_b32 v24, 16, v120
    v_mfma_f32_16x16x32_bf16 v[228:231], v[108:111], v[64:67], v[228:231]
    s_waitcnt lgkmcnt(14)
    ds_read_b64_tr_b16 v[142:143], v11 offset:43008
    v_and_b32 v25, 0xffff0000, v120
    v_mfma_f32_16x16x32_bf16 v[232:235], v[108:111], v[68:71], v[232:235]
    s_waitcnt lgkmcnt(14)
    ds_read_b64_tr_b16 v[144:145], v11 offset:43776
    v_add_f32 v20, v20, v24
    v_mfma_f32_16x16x32_bf16 v[236:239], v[108:111], v[72:75], v[236:239]
    v_add_f32 v21, v21, v25
    v_mfma_f32_16x16x32_bf16 v[252:255], v[112:115], v[72:75], v[252:255]
    v_lshlrev_b32 v26, 16, v121
    v_mfma_f32_16x16x32_bf16 v[248:251], v[112:115], v[68:71], v[248:251]
    v_and_b32 v27, 0xffff0000, v121
    v_mfma_f32_16x16x32_bf16 v[244:247], v[112:115], v[64:67], v[244:247]
    v_add_f32 v20, v20, v26
    v_mfma_f32_16x16x32_bf16 v[240:243], v[112:115], v[60:63], v[240:243]
    v_add_f32 v21, v21, v27
    s_waitcnt vmcnt(3) lgkmcnt(13)
    s_barrier
    v_subrev_u32 v9, 49152, v9
    v_subrev_u32 v10, 49152, v10
    v_subrev_u32 v11, 49152, v11
    v_subrev_u32 v12, 49152, v12
    v_subrev_u32 v13, 49152, v13
    v_subrev_u32 v14, 49152, v14
    v_mfma_f32_16x16x32_bf16 v[160:163], v[122:125], v[76:79], v[160:163]
    ds_read_b128 v[60:63], v156 offset:0
    s_add_u32 m0, s26, 32768
    s_xor_b32 s23, 5, s62
    s_lshl_b32 s23, s23, 7
    buffer_load_dwordx4 v2, s[8:11], s23 offen  lds
    v_mfma_f32_16x16x32_bf16 v[164:167], v[122:125], v[80:83], v[164:167]
    ds_read_b64_tr_b16 v[92:93], v9 offset:0
    v_mfma_f32_16x16x32_bf16 v[168:171], v[122:125], v[84:87], v[168:171]
    s_waitcnt lgkmcnt(14)
    ds_read_b64_tr_b16 v[94:95], v9 offset:768
    s_waitcnt lgkmcnt(13)
    v_lshlrev_b32 v24, 16, v146
    v_and_b32 v25, 0xffff0000, v146
    s_add_u32 m0, s26, 33792
    s_nop 0
    buffer_load_dwordx4 v3, s[8:11], s23 offen  lds
    v_mfma_f32_16x16x32_bf16 v[172:175], v[122:125], v[88:91], v[172:175]
    ds_read_b128 v[64:67], v156 offset:2048
    v_add_f32 v16, v16, v24
    v_add_f32 v17, v17, v25
    s_waitcnt lgkmcnt(12)
    v_mfma_f32_16x16x32_bf16 v[188:191], v[126:129], v[88:91], v[188:191]
    ds_read_b128 v[68:71], v156 offset:4096
    v_lshlrev_b32 v26, 16, v147
    s_add_u32 m0, s26, 34816
    s_nop 0
    buffer_load_dwordx4 v4, s[8:11], s23 offen  lds
    v_mfma_f32_16x16x32_bf16 v[184:187], v[126:129], v[84:87], v[184:187]
    ds_read_b128 v[72:75], v156 offset:6144
    v_and_b32 v27, 0xffff0000, v147
    v_mfma_f32_16x16x32_bf16 v[180:183], v[126:129], v[80:83], v[180:183]
    ds_read_b64_tr_b16 v[116:117], v12 offset:0
    v_add_f32 v16, v16, v26
    s_add_u32 m0, s26, 35840
    s_nop 0
    buffer_load_dwordx4 v5, s[8:11], s23 offen  lds
    v_mfma_f32_16x16x32_bf16 v[176:179], v[126:129], v[76:79], v[176:179]
    s_waitcnt lgkmcnt(14)
    ds_read_b64_tr_b16 v[118:119], v13 offset:0
    v_add_f32 v17, v17, v27
    s_waitcnt lgkmcnt(14)
    v_mfma_f32_16x16x32_bf16 v[192:195], v[130:133], v[76:79], v[192:195]
    ds_read_b64_tr_b16 v[120:121], v14 offset:0
    v_lshlrev_b32 v24, 16, v148
    s_add_u32 m0, s28, 49152
    s_xor_b32 s24, 6, s62
    s_mul_i32 s24, s24, 221184
    buffer_load_dwordx4 v6, s[12:15], s24 offen  lds
    v_mfma_f32_16x16x32_bf16 v[196:199], v[130:133], v[80:83], v[196:199]
    s_waitcnt lgkmcnt(14)
    ds_read_b64_tr_b16 v[96:97], v9 offset:12288
    v_and_b32 v25, 0xffff0000, v148
    v_mfma_f32_16x16x32_bf16 v[200:203], v[130:133], v[84:87], v[200:203]
    s_waitcnt lgkmcnt(14)
    ds_read_b64_tr_b16 v[98:99], v9 offset:13056
    v_add_f32 v18, v18, v24
    s_add_u32 m0, s29, 49152
    s_nop 0
    buffer_load_dwordx4 v7, s[12:15], s24 offen  lds
    v_mfma_f32_16x16x32_bf16 v[204:207], v[130:133], v[88:91], v[204:207]
    s_waitcnt lgkmcnt(14)
    ds_read_b64_tr_b16 v[100:101], v10 offset:0
    v_add_f32 v19, v19, v25
    v_mfma_f32_16x16x32_bf16 v[220:223], v[134:137], v[88:91], v[220:223]
    s_waitcnt lgkmcnt(14)
    ds_read_b64_tr_b16 v[102:103], v10 offset:768
    v_lshlrev_b32 v26, 16, v149
    s_add_u32 m0, s30, 49152
    s_nop 0
    buffer_load_dwordx4 v8, s[12:15], s24 offen  lds
    v_mfma_f32_16x16x32_bf16 v[216:219], v[134:137], v[84:87], v[216:219]
    s_waitcnt lgkmcnt(14)
    ds_read_b64_tr_b16 v[104:105], v10 offset:12288
    v_and_b32 v27, 0xffff0000, v149
    v_mfma_f32_16x16x32_bf16 v[212:215], v[134:137], v[80:83], v[212:215]
    s_waitcnt lgkmcnt(14)
    ds_read_b64_tr_b16 v[106:107], v10 offset:13056
    v_add_f32 v18, v18, v26
    v_mfma_f32_16x16x32_bf16 v[208:211], v[134:137], v[76:79], v[208:211]
    s_waitcnt lgkmcnt(14)
    ds_read_b64_tr_b16 v[108:109], v11 offset:0
    v_add_f32 v19, v19, v27
    v_mfma_f32_16x16x32_bf16 v[224:227], v[138:141], v[76:79], v[224:227]
    s_waitcnt lgkmcnt(14)
    ds_read_b64_tr_b16 v[110:111], v11 offset:768
    v_lshlrev_b32 v24, 16, v150
    v_mfma_f32_16x16x32_bf16 v[228:231], v[138:141], v[80:83], v[228:231]
    s_waitcnt lgkmcnt(14)
    ds_read_b64_tr_b16 v[112:113], v11 offset:12288
    v_and_b32 v25, 0xffff0000, v150
    v_mfma_f32_16x16x32_bf16 v[232:235], v[138:141], v[84:87], v[232:235]
    s_waitcnt lgkmcnt(14)
    ds_read_b64_tr_b16 v[114:115], v11 offset:13056
    v_add_f32 v20, v20, v24
    v_mfma_f32_16x16x32_bf16 v[236:239], v[138:141], v[88:91], v[236:239]
    v_add_f32 v21, v21, v25
    v_mfma_f32_16x16x32_bf16 v[252:255], v[142:145], v[88:91], v[252:255]
    v_lshlrev_b32 v26, 16, v151
    v_mfma_f32_16x16x32_bf16 v[248:251], v[142:145], v[84:87], v[248:251]
    v_and_b32 v27, 0xffff0000, v151
    v_mfma_f32_16x16x32_bf16 v[244:247], v[142:145], v[80:83], v[244:247]
    v_add_f32 v20, v20, v26
    v_mfma_f32_16x16x32_bf16 v[240:243], v[142:145], v[76:79], v[240:243]
    v_add_f32 v21, v21, v27
    v_mfma_f32_16x16x32_bf16 v[160:163], v[92:95], v[60:63], v[160:163]
    s_waitcnt lgkmcnt(14)
    ds_read_b128 v[76:79], v157 offset:0
    v_mfma_f32_16x16x32_bf16 v[164:167], v[92:95], v[64:67], v[164:167]
    s_waitcnt lgkmcnt(14)
    ds_read_b64_tr_b16 v[122:123], v9 offset:6144
    v_mfma_f32_16x16x32_bf16 v[168:171], v[92:95], v[68:71], v[168:171]
    s_waitcnt lgkmcnt(14)
    ds_read_b64_tr_b16 v[124:125], v9 offset:6912
    s_waitcnt lgkmcnt(13)
    v_lshlrev_b32 v24, 16, v116
    v_and_b32 v25, 0xffff0000, v116
    v_mfma_f32_16x16x32_bf16 v[172:175], v[92:95], v[72:75], v[172:175]
    ds_read_b128 v[80:83], v157 offset:2048
    v_add_f32 v16, v16, v24
    v_add_f32 v17, v17, v25
    s_waitcnt lgkmcnt(12)
    v_mfma_f32_16x16x32_bf16 v[188:191], v[96:99], v[72:75], v[188:191]
    ds_read_b128 v[84:87], v157 offset:4096
    v_lshlrev_b32 v26, 16, v117
    v_mfma_f32_16x16x32_bf16 v[184:187], v[96:99], v[68:71], v[184:187]
    ds_read_b128 v[88:91], v157 offset:6144
    v_and_b32 v27, 0xffff0000, v117
    v_mfma_f32_16x16x32_bf16 v[180:183], v[96:99], v[64:67], v[180:183]
    ds_read_b64_tr_b16 v[146:147], v12 offset:6144
    v_add_f32 v16, v16, v26
    v_mfma_f32_16x16x32_bf16 v[176:179], v[96:99], v[60:63], v[176:179]
    s_waitcnt lgkmcnt(14)
    ds_read_b64_tr_b16 v[148:149], v13 offset:6144
    v_add_f32 v17, v17, v27
    s_waitcnt lgkmcnt(14)
    v_mfma_f32_16x16x32_bf16 v[192:195], v[100:103], v[60:63], v[192:195]
    ds_read_b64_tr_b16 v[150:151], v14 offset:6144
    v_lshlrev_b32 v24, 16, v118
    v_mfma_f32_16x16x32_bf16 v[196:199], v[100:103], v[64:67], v[196:199]
    s_waitcnt lgkmcnt(14)
    ds_read_b64_tr_b16 v[126:127], v9 offset:18432
    v_and_b32 v25, 0xffff0000, v118
    v_mfma_f32_16x16x32_bf16 v[200:203], v[100:103], v[68:71], v[200:203]
    s_waitcnt lgkmcnt(14)
    ds_read_b64_tr_b16 v[128:129], v9 offset:19200
    v_add_f32 v18, v18, v24
    v_mfma_f32_16x16x32_bf16 v[204:207], v[100:103], v[72:75], v[204:207]
    s_waitcnt lgkmcnt(14)
    ds_read_b64_tr_b16 v[130:131], v10 offset:6144
    v_add_f32 v19, v19, v25
    v_mfma_f32_16x16x32_bf16 v[220:223], v[104:107], v[72:75], v[220:223]
    s_waitcnt lgkmcnt(14)
    ds_read_b64_tr_b16 v[132:133], v10 offset:6912
    v_lshlrev_b32 v26, 16, v119
    v_mfma_f32_16x16x32_bf16 v[216:219], v[104:107], v[68:71], v[216:219]
    s_waitcnt lgkmcnt(14)
    ds_read_b64_tr_b16 v[134:135], v10 offset:18432
    v_and_b32 v27, 0xffff0000, v119
    v_mfma_f32_16x16x32_bf16 v[212:215], v[104:107], v[64:67], v[212:215]
    s_waitcnt lgkmcnt(14)
    ds_read_b64_tr_b16 v[136:137], v10 offset:19200
    v_add_f32 v18, v18, v26
    v_mfma_f32_16x16x32_bf16 v[208:211], v[104:107], v[60:63], v[208:211]
    s_waitcnt lgkmcnt(14)
    ds_read_b64_tr_b16 v[138:139], v11 offset:6144
    v_add_f32 v19, v19, v27
    v_mfma_f32_16x16x32_bf16 v[224:227], v[108:111], v[60:63], v[224:227]
    s_waitcnt lgkmcnt(14)
    ds_read_b64_tr_b16 v[140:141], v11 offset:6912
    v_lshlrev_b32 v24, 16, v120
    v_mfma_f32_16x16x32_bf16 v[228:231], v[108:111], v[64:67], v[228:231]
    s_waitcnt lgkmcnt(14)
    ds_read_b64_tr_b16 v[142:143], v11 offset:18432
    v_and_b32 v25, 0xffff0000, v120
    v_mfma_f32_16x16x32_bf16 v[232:235], v[108:111], v[68:71], v[232:235]
    s_waitcnt lgkmcnt(14)
    ds_read_b64_tr_b16 v[144:145], v11 offset:19200
    v_add_f32 v20, v20, v24
    v_mfma_f32_16x16x32_bf16 v[236:239], v[108:111], v[72:75], v[236:239]
    v_add_f32 v21, v21, v25
    v_mfma_f32_16x16x32_bf16 v[252:255], v[112:115], v[72:75], v[252:255]
    v_lshlrev_b32 v26, 16, v121
    v_mfma_f32_16x16x32_bf16 v[248:251], v[112:115], v[68:71], v[248:251]
    v_and_b32 v27, 0xffff0000, v121
    v_mfma_f32_16x16x32_bf16 v[244:247], v[112:115], v[64:67], v[244:247]
    v_add_f32 v20, v20, v26
    v_mfma_f32_16x16x32_bf16 v[240:243], v[112:115], v[60:63], v[240:243]
    v_add_f32 v21, v21, v27
    s_waitcnt vmcnt(3) lgkmcnt(13)
    s_barrier
    v_mfma_f32_16x16x32_bf16 v[160:163], v[122:125], v[76:79], v[160:163]
    ds_read_b128 v[60:63], v156 offset:32768
    s_add_u32 m0, s26, 0
    s_xor_b32 s23, 6, s62
    s_lshl_b32 s23, s23, 7
    buffer_load_dwordx4 v2, s[8:11], s23 offen  lds
    v_mfma_f32_16x16x32_bf16 v[164:167], v[122:125], v[80:83], v[164:167]
    ds_read_b64_tr_b16 v[92:93], v9 offset:24576
    v_mfma_f32_16x16x32_bf16 v[168:171], v[122:125], v[84:87], v[168:171]
    s_waitcnt lgkmcnt(14)
    ds_read_b64_tr_b16 v[94:95], v9 offset:25344
    s_waitcnt lgkmcnt(13)
    v_lshlrev_b32 v24, 16, v146
    v_and_b32 v25, 0xffff0000, v146
    s_add_u32 m0, s26, 1024
    s_nop 0
    buffer_load_dwordx4 v3, s[8:11], s23 offen  lds
    v_mfma_f32_16x16x32_bf16 v[172:175], v[122:125], v[88:91], v[172:175]
    ds_read_b128 v[64:67], v156 offset:34816
    v_add_f32 v16, v16, v24
    v_add_f32 v17, v17, v25
    s_waitcnt lgkmcnt(12)
    v_mfma_f32_16x16x32_bf16 v[188:191], v[126:129], v[88:91], v[188:191]
    ds_read_b128 v[68:71], v156 offset:36864
    v_lshlrev_b32 v26, 16, v147
    s_add_u32 m0, s26, 2048
    s_nop 0
    buffer_load_dwordx4 v4, s[8:11], s23 offen  lds
    v_mfma_f32_16x16x32_bf16 v[184:187], v[126:129], v[84:87], v[184:187]
    ds_read_b128 v[72:75], v156 offset:38912
    v_and_b32 v27, 0xffff0000, v147
    v_mfma_f32_16x16x32_bf16 v[180:183], v[126:129], v[80:83], v[180:183]
    ds_read_b64_tr_b16 v[116:117], v12 offset:24576
    v_add_f32 v16, v16, v26
    s_add_u32 m0, s26, 3072
    s_nop 0
    buffer_load_dwordx4 v5, s[8:11], s23 offen  lds
    v_mfma_f32_16x16x32_bf16 v[176:179], v[126:129], v[76:79], v[176:179]
    s_waitcnt lgkmcnt(14)
    ds_read_b64_tr_b16 v[118:119], v13 offset:24576
    v_add_f32 v17, v17, v27
    s_waitcnt lgkmcnt(14)
    v_mfma_f32_16x16x32_bf16 v[192:195], v[130:133], v[76:79], v[192:195]
    ds_read_b64_tr_b16 v[120:121], v14 offset:24576
    v_lshlrev_b32 v24, 16, v148
    s_add_u32 m0, s28, 73728
    s_xor_b32 s24, 7, s62
    s_mul_i32 s24, s24, 221184
    buffer_load_dwordx4 v6, s[12:15], s24 offen  lds
    v_mfma_f32_16x16x32_bf16 v[196:199], v[130:133], v[80:83], v[196:199]
    s_waitcnt lgkmcnt(14)
    ds_read_b64_tr_b16 v[96:97], v9 offset:36864
    v_and_b32 v25, 0xffff0000, v148
    v_mfma_f32_16x16x32_bf16 v[200:203], v[130:133], v[84:87], v[200:203]
    s_waitcnt lgkmcnt(14)
    ds_read_b64_tr_b16 v[98:99], v9 offset:37632
    v_add_f32 v18, v18, v24
    s_add_u32 m0, s29, 73728
    s_nop 0
    buffer_load_dwordx4 v7, s[12:15], s24 offen  lds
    v_mfma_f32_16x16x32_bf16 v[204:207], v[130:133], v[88:91], v[204:207]
    s_waitcnt lgkmcnt(14)
    ds_read_b64_tr_b16 v[100:101], v10 offset:24576
    v_add_f32 v19, v19, v25
    v_mfma_f32_16x16x32_bf16 v[220:223], v[134:137], v[88:91], v[220:223]
    s_waitcnt lgkmcnt(14)
    ds_read_b64_tr_b16 v[102:103], v10 offset:25344
    v_lshlrev_b32 v26, 16, v149
    s_add_u32 m0, s30, 73728
    s_nop 0
    buffer_load_dwordx4 v8, s[12:15], s24 offen  lds
    v_mfma_f32_16x16x32_bf16 v[216:219], v[134:137], v[84:87], v[216:219]
    s_waitcnt lgkmcnt(14)
    ds_read_b64_tr_b16 v[104:105], v10 offset:36864
    v_and_b32 v27, 0xffff0000, v149
    v_mfma_f32_16x16x32_bf16 v[212:215], v[134:137], v[80:83], v[212:215]
    s_waitcnt lgkmcnt(14)
    ds_read_b64_tr_b16 v[106:107], v10 offset:37632
    v_add_f32 v18, v18, v26
    v_mfma_f32_16x16x32_bf16 v[208:211], v[134:137], v[76:79], v[208:211]
    s_waitcnt lgkmcnt(14)
    ds_read_b64_tr_b16 v[108:109], v11 offset:24576
    v_add_f32 v19, v19, v27
    v_mfma_f32_16x16x32_bf16 v[224:227], v[138:141], v[76:79], v[224:227]
    s_waitcnt lgkmcnt(14)
    ds_read_b64_tr_b16 v[110:111], v11 offset:25344
    v_lshlrev_b32 v24, 16, v150
    v_mfma_f32_16x16x32_bf16 v[228:231], v[138:141], v[80:83], v[228:231]
    s_waitcnt lgkmcnt(14)
    ds_read_b64_tr_b16 v[112:113], v11 offset:36864
    v_and_b32 v25, 0xffff0000, v150
    v_mfma_f32_16x16x32_bf16 v[232:235], v[138:141], v[84:87], v[232:235]
    s_waitcnt lgkmcnt(14)
    ds_read_b64_tr_b16 v[114:115], v11 offset:37632
    v_add_f32 v20, v20, v24
    v_mfma_f32_16x16x32_bf16 v[236:239], v[138:141], v[88:91], v[236:239]
    v_add_f32 v21, v21, v25
    v_mfma_f32_16x16x32_bf16 v[252:255], v[142:145], v[88:91], v[252:255]
    v_lshlrev_b32 v26, 16, v151
    v_mfma_f32_16x16x32_bf16 v[248:251], v[142:145], v[84:87], v[248:251]
    v_and_b32 v27, 0xffff0000, v151
    v_mfma_f32_16x16x32_bf16 v[244:247], v[142:145], v[80:83], v[244:247]
    v_add_f32 v20, v20, v26
    v_mfma_f32_16x16x32_bf16 v[240:243], v[142:145], v[76:79], v[240:243]
    v_add_f32 v21, v21, v27
    v_mfma_f32_16x16x32_bf16 v[160:163], v[92:95], v[60:63], v[160:163]
    s_waitcnt lgkmcnt(14)
    ds_read_b128 v[76:79], v157 offset:32768
    v_mfma_f32_16x16x32_bf16 v[164:167], v[92:95], v[64:67], v[164:167]
    s_waitcnt lgkmcnt(14)
    ds_read_b64_tr_b16 v[122:123], v9 offset:30720
    v_mfma_f32_16x16x32_bf16 v[168:171], v[92:95], v[68:71], v[168:171]
    s_waitcnt lgkmcnt(14)
    ds_read_b64_tr_b16 v[124:125], v9 offset:31488
    s_waitcnt lgkmcnt(13)
    v_lshlrev_b32 v24, 16, v116
    v_and_b32 v25, 0xffff0000, v116
    v_mfma_f32_16x16x32_bf16 v[172:175], v[92:95], v[72:75], v[172:175]
    ds_read_b128 v[80:83], v157 offset:34816
    v_add_f32 v16, v16, v24
    v_add_f32 v17, v17, v25
    s_waitcnt lgkmcnt(12)
    v_mfma_f32_16x16x32_bf16 v[188:191], v[96:99], v[72:75], v[188:191]
    ds_read_b128 v[84:87], v157 offset:36864
    v_lshlrev_b32 v26, 16, v117
    v_mfma_f32_16x16x32_bf16 v[184:187], v[96:99], v[68:71], v[184:187]
    ds_read_b128 v[88:91], v157 offset:38912
    v_and_b32 v27, 0xffff0000, v117
    v_mfma_f32_16x16x32_bf16 v[180:183], v[96:99], v[64:67], v[180:183]
    ds_read_b64_tr_b16 v[146:147], v12 offset:30720
    v_add_f32 v16, v16, v26
    v_mfma_f32_16x16x32_bf16 v[176:179], v[96:99], v[60:63], v[176:179]
    s_waitcnt lgkmcnt(14)
    ds_read_b64_tr_b16 v[148:149], v13 offset:30720
    v_add_f32 v17, v17, v27
    s_waitcnt lgkmcnt(14)
    v_mfma_f32_16x16x32_bf16 v[192:195], v[100:103], v[60:63], v[192:195]
    ds_read_b64_tr_b16 v[150:151], v14 offset:30720
    v_lshlrev_b32 v24, 16, v118
    v_mfma_f32_16x16x32_bf16 v[196:199], v[100:103], v[64:67], v[196:199]
    s_waitcnt lgkmcnt(14)
    ds_read_b64_tr_b16 v[126:127], v9 offset:43008
    v_and_b32 v25, 0xffff0000, v118
    v_mfma_f32_16x16x32_bf16 v[200:203], v[100:103], v[68:71], v[200:203]
    s_waitcnt lgkmcnt(14)
    ds_read_b64_tr_b16 v[128:129], v9 offset:43776
    v_add_f32 v18, v18, v24
    v_mfma_f32_16x16x32_bf16 v[204:207], v[100:103], v[72:75], v[204:207]
    s_waitcnt lgkmcnt(14)
    ds_read_b64_tr_b16 v[130:131], v10 offset:30720
    v_add_f32 v19, v19, v25
    v_mfma_f32_16x16x32_bf16 v[220:223], v[104:107], v[72:75], v[220:223]
    s_waitcnt lgkmcnt(14)
    ds_read_b64_tr_b16 v[132:133], v10 offset:31488
    v_lshlrev_b32 v26, 16, v119
    v_mfma_f32_16x16x32_bf16 v[216:219], v[104:107], v[68:71], v[216:219]
    s_waitcnt lgkmcnt(14)
    ds_read_b64_tr_b16 v[134:135], v10 offset:43008
    v_and_b32 v27, 0xffff0000, v119
    v_mfma_f32_16x16x32_bf16 v[212:215], v[104:107], v[64:67], v[212:215]
    s_waitcnt lgkmcnt(14)
    ds_read_b64_tr_b16 v[136:137], v10 offset:43776
    v_add_f32 v18, v18, v26
    v_mfma_f32_16x16x32_bf16 v[208:211], v[104:107], v[60:63], v[208:211]
    s_waitcnt lgkmcnt(14)
    ds_read_b64_tr_b16 v[138:139], v11 offset:30720
    v_add_f32 v19, v19, v27
    v_mfma_f32_16x16x32_bf16 v[224:227], v[108:111], v[60:63], v[224:227]
    s_waitcnt lgkmcnt(14)
    ds_read_b64_tr_b16 v[140:141], v11 offset:31488
    v_lshlrev_b32 v24, 16, v120
    v_mfma_f32_16x16x32_bf16 v[228:231], v[108:111], v[64:67], v[228:231]
    s_waitcnt lgkmcnt(14)
    ds_read_b64_tr_b16 v[142:143], v11 offset:43008
    v_and_b32 v25, 0xffff0000, v120
    v_mfma_f32_16x16x32_bf16 v[232:235], v[108:111], v[68:71], v[232:235]
    s_waitcnt lgkmcnt(14)
    ds_read_b64_tr_b16 v[144:145], v11 offset:43776
    v_add_f32 v20, v20, v24
    v_mfma_f32_16x16x32_bf16 v[236:239], v[108:111], v[72:75], v[236:239]
    v_add_f32 v21, v21, v25
    v_mfma_f32_16x16x32_bf16 v[252:255], v[112:115], v[72:75], v[252:255]
    v_lshlrev_b32 v26, 16, v121
    v_mfma_f32_16x16x32_bf16 v[248:251], v[112:115], v[68:71], v[248:251]
    v_and_b32 v27, 0xffff0000, v121
    v_mfma_f32_16x16x32_bf16 v[244:247], v[112:115], v[64:67], v[244:247]
    v_add_f32 v20, v20, v26
    v_mfma_f32_16x16x32_bf16 v[240:243], v[112:115], v[60:63], v[240:243]
    v_add_f32 v21, v21, v27
    s_waitcnt vmcnt(3) lgkmcnt(13)
    s_barrier
    v_add_u32 v9, 49152, v9
    v_add_u32 v10, 49152, v10
    v_add_u32 v11, 49152, v11
    v_add_u32 v12, 49152, v12
    v_add_u32 v13, 49152, v13
    v_add_u32 v14, 49152, v14
    v_mfma_f32_16x16x32_bf16 v[160:163], v[122:125], v[76:79], v[160:163]
    ds_read_b128 v[60:63], v156 offset:0
    s_add_u32 m0, s26, 32768
    s_xor_b32 s23, 7, s62
    s_lshl_b32 s23, s23, 7
    buffer_load_dwordx4 v2, s[8:11], s23 offen  lds
    v_mfma_f32_16x16x32_bf16 v[164:167], v[122:125], v[80:83], v[164:167]
    ds_read_b64_tr_b16 v[92:93], v9 offset:0
    v_mfma_f32_16x16x32_bf16 v[168:171], v[122:125], v[84:87], v[168:171]
    s_waitcnt lgkmcnt(14)
    ds_read_b64_tr_b16 v[94:95], v9 offset:768
    s_waitcnt lgkmcnt(13)
    v_lshlrev_b32 v24, 16, v146
    v_and_b32 v25, 0xffff0000, v146
    s_add_u32 m0, s26, 33792
    s_nop 0
    buffer_load_dwordx4 v3, s[8:11], s23 offen  lds
    v_mfma_f32_16x16x32_bf16 v[172:175], v[122:125], v[88:91], v[172:175]
    ds_read_b128 v[64:67], v156 offset:2048
    v_add_f32 v16, v16, v24
    v_add_f32 v17, v17, v25
    s_waitcnt lgkmcnt(12)
    v_mfma_f32_16x16x32_bf16 v[188:191], v[126:129], v[88:91], v[188:191]
    ds_read_b128 v[68:71], v156 offset:4096
    v_lshlrev_b32 v26, 16, v147
    s_add_u32 m0, s26, 34816
    s_nop 0
    buffer_load_dwordx4 v4, s[8:11], s23 offen  lds
    v_mfma_f32_16x16x32_bf16 v[184:187], v[126:129], v[84:87], v[184:187]
    ds_read_b128 v[72:75], v156 offset:6144
    v_and_b32 v27, 0xffff0000, v147
    v_mfma_f32_16x16x32_bf16 v[180:183], v[126:129], v[80:83], v[180:183]
    ds_read_b64_tr_b16 v[116:117], v12 offset:0
    v_add_f32 v16, v16, v26
    s_add_u32 m0, s26, 35840
    s_nop 0
    buffer_load_dwordx4 v5, s[8:11], s23 offen  lds
    v_mfma_f32_16x16x32_bf16 v[176:179], v[126:129], v[76:79], v[176:179]
    s_waitcnt lgkmcnt(14)
    ds_read_b64_tr_b16 v[118:119], v13 offset:0
    v_add_f32 v17, v17, v27
    s_waitcnt lgkmcnt(14)
    v_mfma_f32_16x16x32_bf16 v[192:195], v[130:133], v[76:79], v[192:195]
    ds_read_b64_tr_b16 v[120:121], v14 offset:0
    v_lshlrev_b32 v24, 16, v148
    s_add_u32 m0, s28, 0
    s_xor_b32 s24, 8, s63
    s_mul_i32 s24, s24, 221184
    buffer_load_dwordx4 v6, s[12:15], s24 offen  lds
    v_mfma_f32_16x16x32_bf16 v[196:199], v[130:133], v[80:83], v[196:199]
    s_waitcnt lgkmcnt(14)
    ds_read_b64_tr_b16 v[96:97], v9 offset:12288
    v_and_b32 v25, 0xffff0000, v148
    v_mfma_f32_16x16x32_bf16 v[200:203], v[130:133], v[84:87], v[200:203]
    s_waitcnt lgkmcnt(14)
    ds_read_b64_tr_b16 v[98:99], v9 offset:13056
    v_add_f32 v18, v18, v24
    s_add_u32 m0, s29, 0
    s_nop 0
    buffer_load_dwordx4 v7, s[12:15], s24 offen  lds
    v_mfma_f32_16x16x32_bf16 v[204:207], v[130:133], v[88:91], v[204:207]
    s_waitcnt lgkmcnt(14)
    ds_read_b64_tr_b16 v[100:101], v10 offset:0
    v_add_f32 v19, v19, v25
    v_mfma_f32_16x16x32_bf16 v[220:223], v[134:137], v[88:91], v[220:223]
    s_waitcnt lgkmcnt(14)
    ds_read_b64_tr_b16 v[102:103], v10 offset:768
    v_lshlrev_b32 v26, 16, v149
    s_add_u32 m0, s30, 0
    s_nop 0
    buffer_load_dwordx4 v8, s[12:15], s24 offen  lds
    v_mfma_f32_16x16x32_bf16 v[216:219], v[134:137], v[84:87], v[216:219]
    s_waitcnt lgkmcnt(14)
    ds_read_b64_tr_b16 v[104:105], v10 offset:12288
    v_and_b32 v27, 0xffff0000, v149
    v_mfma_f32_16x16x32_bf16 v[212:215], v[134:137], v[80:83], v[212:215]
    s_waitcnt lgkmcnt(14)
    ds_read_b64_tr_b16 v[106:107], v10 offset:13056
    v_add_f32 v18, v18, v26
    v_mfma_f32_16x16x32_bf16 v[208:211], v[134:137], v[76:79], v[208:211]
    s_waitcnt lgkmcnt(14)
    ds_read_b64_tr_b16 v[108:109], v11 offset:0
    v_add_f32 v19, v19, v27
    v_mfma_f32_16x16x32_bf16 v[224:227], v[138:141], v[76:79], v[224:227]
    s_waitcnt lgkmcnt(14)
    ds_read_b64_tr_b16 v[110:111], v11 offset:768
    v_lshlrev_b32 v24, 16, v150
    v_mfma_f32_16x16x32_bf16 v[228:231], v[138:141], v[80:83], v[228:231]
    s_waitcnt lgkmcnt(14)
    ds_read_b64_tr_b16 v[112:113], v11 offset:12288
    v_and_b32 v25, 0xffff0000, v150
    v_mfma_f32_16x16x32_bf16 v[232:235], v[138:141], v[84:87], v[232:235]
    s_waitcnt lgkmcnt(14)
    ds_read_b64_tr_b16 v[114:115], v11 offset:13056
    v_add_f32 v20, v20, v24
    v_mfma_f32_16x16x32_bf16 v[236:239], v[138:141], v[88:91], v[236:239]
    v_add_f32 v21, v21, v25
    v_mfma_f32_16x16x32_bf16 v[252:255], v[142:145], v[88:91], v[252:255]
    v_lshlrev_b32 v26, 16, v151
    v_mfma_f32_16x16x32_bf16 v[248:251], v[142:145], v[84:87], v[248:251]
    v_and_b32 v27, 0xffff0000, v151
    v_mfma_f32_16x16x32_bf16 v[244:247], v[142:145], v[80:83], v[244:247]
    v_add_f32 v20, v20, v26
    v_mfma_f32_16x16x32_bf16 v[240:243], v[142:145], v[76:79], v[240:243]
    v_add_f32 v21, v21, v27
    v_mfma_f32_16x16x32_bf16 v[160:163], v[92:95], v[60:63], v[160:163]
    s_waitcnt lgkmcnt(14)
    ds_read_b128 v[76:79], v157 offset:0
    buffer_load_dword v159, v158, s[44:47], 0 offen sc1
    v_mfma_f32_16x16x32_bf16 v[164:167], v[92:95], v[64:67], v[164:167]
    s_waitcnt lgkmcnt(14)
    ds_read_b64_tr_b16 v[122:123], v9 offset:6144
    v_mfma_f32_16x16x32_bf16 v[168:171], v[92:95], v[68:71], v[168:171]
    s_waitcnt lgkmcnt(14)
    ds_read_b64_tr_b16 v[124:125], v9 offset:6912
    s_waitcnt lgkmcnt(13)
    v_lshlrev_b32 v24, 16, v116
    v_and_b32 v25, 0xffff0000, v116
    v_mfma_f32_16x16x32_bf16 v[172:175], v[92:95], v[72:75], v[172:175]
    ds_read_b128 v[80:83], v157 offset:2048
    v_add_f32 v16, v16, v24
    v_add_f32 v17, v17, v25
    s_waitcnt lgkmcnt(12)
    v_mfma_f32_16x16x32_bf16 v[188:191], v[96:99], v[72:75], v[188:191]
    ds_read_b128 v[84:87], v157 offset:4096
    v_lshlrev_b32 v26, 16, v117
    v_mfma_f32_16x16x32_bf16 v[184:187], v[96:99], v[68:71], v[184:187]
    ds_read_b128 v[88:91], v157 offset:6144
    v_and_b32 v27, 0xffff0000, v117
    v_mfma_f32_16x16x32_bf16 v[180:183], v[96:99], v[64:67], v[180:183]
    ds_read_b64_tr_b16 v[146:147], v12 offset:6144
    v_add_f32 v16, v16, v26
    v_mfma_f32_16x16x32_bf16 v[176:179], v[96:99], v[60:63], v[176:179]
    s_waitcnt lgkmcnt(14)
    ds_read_b64_tr_b16 v[148:149], v13 offset:6144
    v_add_f32 v17, v17, v27
    s_waitcnt lgkmcnt(14)
    v_mfma_f32_16x16x32_bf16 v[192:195], v[100:103], v[60:63], v[192:195]
    ds_read_b64_tr_b16 v[150:151], v14 offset:6144
    v_lshlrev_b32 v24, 16, v118
    v_mfma_f32_16x16x32_bf16 v[196:199], v[100:103], v[64:67], v[196:199]
    s_waitcnt lgkmcnt(14)
    ds_read_b64_tr_b16 v[126:127], v9 offset:18432
    v_and_b32 v25, 0xffff0000, v118
    v_mfma_f32_16x16x32_bf16 v[200:203], v[100:103], v[68:71], v[200:203]
    s_waitcnt lgkmcnt(14)
    ds_read_b64_tr_b16 v[128:129], v9 offset:19200
    v_add_f32 v18, v18, v24
    v_mfma_f32_16x16x32_bf16 v[204:207], v[100:103], v[72:75], v[204:207]
    s_waitcnt lgkmcnt(14)
    ds_read_b64_tr_b16 v[130:131], v10 offset:6144
    v_add_f32 v19, v19, v25
    v_mfma_f32_16x16x32_bf16 v[220:223], v[104:107], v[72:75], v[220:223]
    s_waitcnt lgkmcnt(14)
    ds_read_b64_tr_b16 v[132:133], v10 offset:6912
    v_lshlrev_b32 v26, 16, v119
    v_mfma_f32_16x16x32_bf16 v[216:219], v[104:107], v[68:71], v[216:219]
    s_waitcnt lgkmcnt(14)
    ds_read_b64_tr_b16 v[134:135], v10 offset:18432
    v_and_b32 v27, 0xffff0000, v119
    v_mfma_f32_16x16x32_bf16 v[212:215], v[104:107], v[64:67], v[212:215]
    s_waitcnt lgkmcnt(14)
    ds_read_b64_tr_b16 v[136:137], v10 offset:19200
    v_add_f32 v18, v18, v26
    v_mfma_f32_16x16x32_bf16 v[208:211], v[104:107], v[60:63], v[208:211]
    s_waitcnt lgkmcnt(14)
    ds_read_b64_tr_b16 v[138:139], v11 offset:6144
    v_add_f32 v19, v19, v27
    v_mfma_f32_16x16x32_bf16 v[224:227], v[108:111], v[60:63], v[224:227]
    s_waitcnt lgkmcnt(14)
    ds_read_b64_tr_b16 v[140:141], v11 offset:6912
    v_lshlrev_b32 v24, 16, v120
    v_mfma_f32_16x16x32_bf16 v[228:231], v[108:111], v[64:67], v[228:231]
    s_waitcnt lgkmcnt(14)
    ds_read_b64_tr_b16 v[142:143], v11 offset:18432
    v_and_b32 v25, 0xffff0000, v120
    v_mfma_f32_16x16x32_bf16 v[232:235], v[108:111], v[68:71], v[232:235]
    s_waitcnt lgkmcnt(14)
    ds_read_b64_tr_b16 v[144:145], v11 offset:19200
    v_add_f32 v20, v20, v24
    v_mfma_f32_16x16x32_bf16 v[236:239], v[108:111], v[72:75], v[236:239]
    v_add_f32 v21, v21, v25
    v_mfma_f32_16x16x32_bf16 v[252:255], v[112:115], v[72:75], v[252:255]
    v_lshlrev_b32 v26, 16, v121
    v_mfma_f32_16x16x32_bf16 v[248:251], v[112:115], v[68:71], v[248:251]
    v_and_b32 v27, 0xffff0000, v121
    v_mfma_f32_16x16x32_bf16 v[244:247], v[112:115], v[64:67], v[244:247]
    v_add_f32 v20, v20, v26
    v_mfma_f32_16x16x32_bf16 v[240:243], v[112:115], v[60:63], v[240:243]
    v_add_f32 v21, v21, v27
    s_waitcnt vmcnt(4) lgkmcnt(13)
    s_barrier
    v_mfma_f32_16x16x32_bf16 v[160:163], v[122:125], v[76:79], v[160:163]
    ds_read_b128 v[60:63], v156 offset:32768
    s_add_u32 m0, s26, 0
    s_xor_b32 s23, 8, s63
    s_lshl_b32 s23, s23, 7
    buffer_load_dwordx4 v2, s[8:11], s23 offen  lds
    v_mfma_f32_16x16x32_bf16 v[164:167], v[122:125], v[80:83], v[164:167]
    ds_read_b64_tr_b16 v[92:93], v9 offset:24576
    v_mfma_f32_16x16x32_bf16 v[168:171], v[122:125], v[84:87], v[168:171]
    s_waitcnt lgkmcnt(14)
    ds_read_b64_tr_b16 v[94:95], v9 offset:25344
    s_waitcnt lgkmcnt(13)
    v_lshlrev_b32 v24, 16, v146
    v_and_b32 v25, 0xffff0000, v146
    s_add_u32 m0, s26, 1024
    s_nop 0
    buffer_load_dwordx4 v3, s[8:11], s23 offen  lds
    v_mfma_f32_16x16x32_bf16 v[172:175], v[122:125], v[88:91], v[172:175]
    ds_read_b128 v[64:67], v156 offset:34816
    v_add_f32 v16, v16, v24
    v_add_f32 v17, v17, v25
    s_waitcnt lgkmcnt(12)
    v_mfma_f32_16x16x32_bf16 v[188:191], v[126:129], v[88:91], v[188:191]
    ds_read_b128 v[68:71], v156 offset:36864
    v_lshlrev_b32 v26, 16, v147
    s_add_u32 m0, s26, 2048
    s_nop 0
    buffer_load_dwordx4 v4, s[8:11], s23 offen  lds
    v_mfma_f32_16x16x32_bf16 v[184:187], v[126:129], v[84:87], v[184:187]
    ds_read_b128 v[72:75], v156 offset:38912
    v_and_b32 v27, 0xffff0000, v147
    v_mfma_f32_16x16x32_bf16 v[180:183], v[126:129], v[80:83], v[180:183]
    ds_read_b64_tr_b16 v[116:117], v12 offset:24576
    v_add_f32 v16, v16, v26
    s_add_u32 m0, s26, 3072
    s_nop 0
    buffer_load_dwordx4 v5, s[8:11], s23 offen  lds
    v_mfma_f32_16x16x32_bf16 v[176:179], v[126:129], v[76:79], v[176:179]
    s_waitcnt lgkmcnt(14)
    ds_read_b64_tr_b16 v[118:119], v13 offset:24576
    v_add_f32 v17, v17, v27
    s_waitcnt lgkmcnt(14)
    v_mfma_f32_16x16x32_bf16 v[192:195], v[130:133], v[76:79], v[192:195]
    ds_read_b64_tr_b16 v[120:121], v14 offset:24576
    v_lshlrev_b32 v24, 16, v148
    s_add_u32 m0, s28, 24576
    s_xor_b32 s24, 9, s63
    s_mul_i32 s24, s24, 221184
    buffer_load_dwordx4 v6, s[12:15], s24 offen  lds
    v_mfma_f32_16x16x32_bf16 v[196:199], v[130:133], v[80:83], v[196:199]
    s_waitcnt lgkmcnt(14)
    ds_read_b64_tr_b16 v[96:97], v9 offset:36864
    v_and_b32 v25, 0xffff0000, v148
    v_mfma_f32_16x16x32_bf16 v[200:203], v[130:133], v[84:87], v[200:203]
    s_waitcnt lgkmcnt(14)
    ds_read_b64_tr_b16 v[98:99], v9 offset:37632
    v_add_f32 v18, v18, v24
    s_add_u32 m0, s29, 24576
    s_nop 0
    buffer_load_dwordx4 v7, s[12:15], s24 offen  lds
    v_mfma_f32_16x16x32_bf16 v[204:207], v[130:133], v[88:91], v[204:207]
    s_waitcnt lgkmcnt(14)
    ds_read_b64_tr_b16 v[100:101], v10 offset:24576
    v_add_f32 v19, v19, v25
    v_mfma_f32_16x16x32_bf16 v[220:223], v[134:137], v[88:91], v[220:223]
    s_waitcnt lgkmcnt(14)
    ds_read_b64_tr_b16 v[102:103], v10 offset:25344
    v_lshlrev_b32 v26, 16, v149
    s_add_u32 m0, s30, 24576
    s_nop 0
    buffer_load_dwordx4 v8, s[12:15], s24 offen  lds
    v_mfma_f32_16x16x32_bf16 v[216:219], v[134:137], v[84:87], v[216:219]
    s_waitcnt lgkmcnt(14)
    ds_read_b64_tr_b16 v[104:105], v10 offset:36864
    v_and_b32 v27, 0xffff0000, v149
    v_mfma_f32_16x16x32_bf16 v[212:215], v[134:137], v[80:83], v[212:215]
    s_waitcnt lgkmcnt(14)
    ds_read_b64_tr_b16 v[106:107], v10 offset:37632
    v_add_f32 v18, v18, v26
    v_mfma_f32_16x16x32_bf16 v[208:211], v[134:137], v[76:79], v[208:211]
    s_waitcnt lgkmcnt(14)
    ds_read_b64_tr_b16 v[108:109], v11 offset:24576
    v_add_f32 v19, v19, v27
    v_mfma_f32_16x16x32_bf16 v[224:227], v[138:141], v[76:79], v[224:227]
    s_waitcnt lgkmcnt(14)
    ds_read_b64_tr_b16 v[110:111], v11 offset:25344
    v_lshlrev_b32 v24, 16, v150
    v_mfma_f32_16x16x32_bf16 v[228:231], v[138:141], v[80:83], v[228:231]
    s_waitcnt lgkmcnt(14)
    ds_read_b64_tr_b16 v[112:113], v11 offset:36864
    v_and_b32 v25, 0xffff0000, v150
    v_mfma_f32_16x16x32_bf16 v[232:235], v[138:141], v[84:87], v[232:235]
    s_waitcnt lgkmcnt(14)
    ds_read_b64_tr_b16 v[114:115], v11 offset:37632
    v_add_f32 v20, v20, v24
    v_mfma_f32_16x16x32_bf16 v[236:239], v[138:141], v[88:91], v[236:239]
    v_add_f32 v21, v21, v25
    v_mfma_f32_16x16x32_bf16 v[252:255], v[142:145], v[88:91], v[252:255]
    v_lshlrev_b32 v26, 16, v151
    v_mfma_f32_16x16x32_bf16 v[248:251], v[142:145], v[84:87], v[248:251]
    v_and_b32 v27, 0xffff0000, v151
    v_mfma_f32_16x16x32_bf16 v[244:247], v[142:145], v[80:83], v[244:247]
    v_add_f32 v20, v20, v26
    v_mfma_f32_16x16x32_bf16 v[240:243], v[142:145], v[76:79], v[240:243]
    v_add_f32 v21, v21, v27
    v_mfma_f32_16x16x32_bf16 v[160:163], v[92:95], v[60:63], v[160:163]
    s_waitcnt lgkmcnt(14)
    ds_read_b128 v[76:79], v157 offset:32768
    v_mfma_f32_16x16x32_bf16 v[164:167], v[92:95], v[64:67], v[164:167]
    s_waitcnt lgkmcnt(14)
    ds_read_b64_tr_b16 v[122:123], v9 offset:30720
    v_mfma_f32_16x16x32_bf16 v[168:171], v[92:95], v[68:71], v[168:171]
    s_waitcnt lgkmcnt(14)
    ds_read_b64_tr_b16 v[124:125], v9 offset:31488
    s_waitcnt lgkmcnt(13)
    v_lshlrev_b32 v24, 16, v116
    v_and_b32 v25, 0xffff0000, v116
    v_mfma_f32_16x16x32_bf16 v[172:175], v[92:95], v[72:75], v[172:175]
    ds_read_b128 v[80:83], v157 offset:34816
    v_add_f32 v16, v16, v24
    v_add_f32 v17, v17, v25
    s_waitcnt lgkmcnt(12)
    v_mfma_f32_16x16x32_bf16 v[188:191], v[96:99], v[72:75], v[188:191]
    ds_read_b128 v[84:87], v157 offset:36864
    v_lshlrev_b32 v26, 16, v117
    v_mfma_f32_16x16x32_bf16 v[184:187], v[96:99], v[68:71], v[184:187]
    ds_read_b128 v[88:91], v157 offset:38912
    v_and_b32 v27, 0xffff0000, v117
    v_mfma_f32_16x16x32_bf16 v[180:183], v[96:99], v[64:67], v[180:183]
    ds_read_b64_tr_b16 v[146:147], v12 offset:30720
    v_add_f32 v16, v16, v26
    v_mfma_f32_16x16x32_bf16 v[176:179], v[96:99], v[60:63], v[176:179]
    s_waitcnt lgkmcnt(14)
    ds_read_b64_tr_b16 v[148:149], v13 offset:30720
    v_add_f32 v17, v17, v27
    s_waitcnt lgkmcnt(14)
    v_mfma_f32_16x16x32_bf16 v[192:195], v[100:103], v[60:63], v[192:195]
    ds_read_b64_tr_b16 v[150:151], v14 offset:30720
    v_lshlrev_b32 v24, 16, v118
    v_mfma_f32_16x16x32_bf16 v[196:199], v[100:103], v[64:67], v[196:199]
    s_waitcnt lgkmcnt(14)
    ds_read_b64_tr_b16 v[126:127], v9 offset:43008
    v_and_b32 v25, 0xffff0000, v118
    v_mfma_f32_16x16x32_bf16 v[200:203], v[100:103], v[68:71], v[200:203]
    s_waitcnt lgkmcnt(14)
    ds_read_b64_tr_b16 v[128:129], v9 offset:43776
    v_add_f32 v18, v18, v24
    v_mfma_f32_16x16x32_bf16 v[204:207], v[100:103], v[72:75], v[204:207]
    s_waitcnt lgkmcnt(14)
    ds_read_b64_tr_b16 v[130:131], v10 offset:30720
    v_add_f32 v19, v19, v25
    v_mfma_f32_16x16x32_bf16 v[220:223], v[104:107], v[72:75], v[220:223]
    s_waitcnt lgkmcnt(14)
    ds_read_b64_tr_b16 v[132:133], v10 offset:31488
    v_lshlrev_b32 v26, 16, v119
    v_mfma_f32_16x16x32_bf16 v[216:219], v[104:107], v[68:71], v[216:219]
    s_waitcnt lgkmcnt(14)
    ds_read_b64_tr_b16 v[134:135], v10 offset:43008
    v_and_b32 v27, 0xffff0000, v119
    v_mfma_f32_16x16x32_bf16 v[212:215], v[104:107], v[64:67], v[212:215]
    s_waitcnt lgkmcnt(14)
    ds_read_b64_tr_b16 v[136:137], v10 offset:43776
    v_add_f32 v18, v18, v26
    v_mfma_f32_16x16x32_bf16 v[208:211], v[104:107], v[60:63], v[208:211]
    s_waitcnt lgkmcnt(14)
    ds_read_b64_tr_b16 v[138:139], v11 offset:30720
    v_add_f32 v19, v19, v27
    v_mfma_f32_16x16x32_bf16 v[224:227], v[108:111], v[60:63], v[224:227]
    s_waitcnt lgkmcnt(14)
    ds_read_b64_tr_b16 v[140:141], v11 offset:31488
    v_lshlrev_b32 v24, 16, v120
    v_mfma_f32_16x16x32_bf16 v[228:231], v[108:111], v[64:67], v[228:231]
    s_waitcnt lgkmcnt(14)
    ds_read_b64_tr_b16 v[142:143], v11 offset:43008
    v_and_b32 v25, 0xffff0000, v120
    v_mfma_f32_16x16x32_bf16 v[232:235], v[108:111], v[68:71], v[232:235]
    s_waitcnt lgkmcnt(14)
    ds_read_b64_tr_b16 v[144:145], v11 offset:43776
    v_add_f32 v20, v20, v24
    v_mfma_f32_16x16x32_bf16 v[236:239], v[108:111], v[72:75], v[236:239]
    v_add_f32 v21, v21, v25
    v_mfma_f32_16x16x32_bf16 v[252:255], v[112:115], v[72:75], v[252:255]
    v_lshlrev_b32 v26, 16, v121
    v_mfma_f32_16x16x32_bf16 v[248:251], v[112:115], v[68:71], v[248:251]
    v_and_b32 v27, 0xffff0000, v121
    v_mfma_f32_16x16x32_bf16 v[244:247], v[112:115], v[64:67], v[244:247]
    v_add_f32 v20, v20, v26
    v_mfma_f32_16x16x32_bf16 v[240:243], v[112:115], v[60:63], v[240:243]
    v_add_f32 v21, v21, v27
    s_waitcnt vmcnt(3) lgkmcnt(13)
    s_barrier
    v_subrev_u32 v9, 49152, v9
    v_subrev_u32 v10, 49152, v10
    v_subrev_u32 v11, 49152, v11
    v_subrev_u32 v12, 49152, v12
    v_subrev_u32 v13, 49152, v13
    v_subrev_u32 v14, 49152, v14
    v_mfma_f32_16x16x32_bf16 v[160:163], v[122:125], v[76:79], v[160:163]
    ds_read_b128 v[60:63], v156 offset:0
    s_add_u32 m0, s26, 32768
    s_xor_b32 s23, 9, s63
    s_lshl_b32 s23, s23, 7
    buffer_load_dwordx4 v2, s[8:11], s23 offen  lds
    v_mfma_f32_16x16x32_bf16 v[164:167], v[122:125], v[80:83], v[164:167]
    ds_read_b64_tr_b16 v[92:93], v9 offset:0
    v_mfma_f32_16x16x32_bf16 v[168:171], v[122:125], v[84:87], v[168:171]
    s_waitcnt lgkmcnt(14)
    ds_read_b64_tr_b16 v[94:95], v9 offset:768
    s_waitcnt lgkmcnt(13)
    v_lshlrev_b32 v24, 16, v146
    v_and_b32 v25, 0xffff0000, v146
    s_add_u32 m0, s26, 33792
    s_nop 0
    buffer_load_dwordx4 v3, s[8:11], s23 offen  lds
    v_mfma_f32_16x16x32_bf16 v[172:175], v[122:125], v[88:91], v[172:175]
    ds_read_b128 v[64:67], v156 offset:2048
    v_add_f32 v16, v16, v24
    v_add_f32 v17, v17, v25
    s_waitcnt lgkmcnt(12)
    v_mfma_f32_16x16x32_bf16 v[188:191], v[126:129], v[88:91], v[188:191]
    ds_read_b128 v[68:71], v156 offset:4096
    v_lshlrev_b32 v26, 16, v147
    s_add_u32 m0, s26, 34816
    s_nop 0
    buffer_load_dwordx4 v4, s[8:11], s23 offen  lds
    v_mfma_f32_16x16x32_bf16 v[184:187], v[126:129], v[84:87], v[184:187]
    ds_read_b128 v[72:75], v156 offset:6144
    v_and_b32 v27, 0xffff0000, v147
    v_mfma_f32_16x16x32_bf16 v[180:183], v[126:129], v[80:83], v[180:183]
    ds_read_b64_tr_b16 v[116:117], v12 offset:0
    v_add_f32 v16, v16, v26
    s_add_u32 m0, s26, 35840
    s_nop 0
    buffer_load_dwordx4 v5, s[8:11], s23 offen  lds
    v_mfma_f32_16x16x32_bf16 v[176:179], v[126:129], v[76:79], v[176:179]
    s_waitcnt lgkmcnt(14)
    ds_read_b64_tr_b16 v[118:119], v13 offset:0
    v_add_f32 v17, v17, v27
    s_waitcnt lgkmcnt(14)
    v_mfma_f32_16x16x32_bf16 v[192:195], v[130:133], v[76:79], v[192:195]
    ds_read_b64_tr_b16 v[120:121], v14 offset:0
    v_lshlrev_b32 v24, 16, v148
    v_mfma_f32_16x16x32_bf16 v[196:199], v[130:133], v[80:83], v[196:199]
    s_waitcnt lgkmcnt(14)
    ds_read_b64_tr_b16 v[96:97], v9 offset:12288
    v_and_b32 v25, 0xffff0000, v148
    v_mfma_f32_16x16x32_bf16 v[200:203], v[130:133], v[84:87], v[200:203]
    s_waitcnt lgkmcnt(14)
    ds_read_b64_tr_b16 v[98:99], v9 offset:13056
    v_add_f32 v18, v18, v24
    v_mfma_f32_16x16x32_bf16 v[204:207], v[130:133], v[88:91], v[204:207]
    s_waitcnt lgkmcnt(14)
    ds_read_b64_tr_b16 v[100:101], v10 offset:0
    v_add_f32 v19, v19, v25
    v_mfma_f32_16x16x32_bf16 v[220:223], v[134:137], v[88:91], v[220:223]
    s_waitcnt lgkmcnt(14)
    ds_read_b64_tr_b16 v[102:103], v10 offset:768
    v_lshlrev_b32 v26, 16, v149
    v_mfma_f32_16x16x32_bf16 v[216:219], v[134:137], v[84:87], v[216:219]
    s_waitcnt lgkmcnt(14)
    ds_read_b64_tr_b16 v[104:105], v10 offset:12288
    v_and_b32 v27, 0xffff0000, v149
    v_mfma_f32_16x16x32_bf16 v[212:215], v[134:137], v[80:83], v[212:215]
    s_waitcnt lgkmcnt(14)
    ds_read_b64_tr_b16 v[106:107], v10 offset:13056
    v_add_f32 v18, v18, v26
    v_mfma_f32_16x16x32_bf16 v[208:211], v[134:137], v[76:79], v[208:211]
    s_waitcnt lgkmcnt(14)
    ds_read_b64_tr_b16 v[108:109], v11 offset:0
    v_add_f32 v19, v19, v27
    v_mfma_f32_16x16x32_bf16 v[224:227], v[138:141], v[76:79], v[224:227]
    s_waitcnt lgkmcnt(14)
    ds_read_b64_tr_b16 v[110:111], v11 offset:768
    v_lshlrev_b32 v24, 16, v150
    v_mfma_f32_16x16x32_bf16 v[228:231], v[138:141], v[80:83], v[228:231]
    s_waitcnt lgkmcnt(14)
    ds_read_b64_tr_b16 v[112:113], v11 offset:12288
    v_and_b32 v25, 0xffff0000, v150
    v_mfma_f32_16x16x32_bf16 v[232:235], v[138:141], v[84:87], v[232:235]
    s_waitcnt lgkmcnt(14)
    ds_read_b64_tr_b16 v[114:115], v11 offset:13056
    v_add_f32 v20, v20, v24
    v_mfma_f32_16x16x32_bf16 v[236:239], v[138:141], v[88:91], v[236:239]
    v_add_f32 v21, v21, v25
    v_mfma_f32_16x16x32_bf16 v[252:255], v[142:145], v[88:91], v[252:255]
    v_lshlrev_b32 v26, 16, v151
    v_mfma_f32_16x16x32_bf16 v[248:251], v[142:145], v[84:87], v[248:251]
    v_and_b32 v27, 0xffff0000, v151
    v_mfma_f32_16x16x32_bf16 v[244:247], v[142:145], v[80:83], v[244:247]
    v_add_f32 v20, v20, v26
    v_mfma_f32_16x16x32_bf16 v[240:243], v[142:145], v[76:79], v[240:243]
    v_add_f32 v21, v21, v27
    v_cmp_eq_u32 vcc, 0, v159
    s_cbranch_vccnz L_k1_ffn_spin
L_k1_ffn_go:
    v_mfma_f32_16x16x32_bf16 v[160:163], v[92:95], v[60:63], v[160:163]
    s_waitcnt lgkmcnt(14)
    ds_read_b128 v[76:79], v157 offset:0
    buffer_load_dword v28, v155, s[16:19], s49 offen offset:0 sc1
    v_mfma_f32_16x16x32_bf16 v[164:167], v[92:95], v[64:67], v[164:167]
    s_waitcnt lgkmcnt(14)
    ds_read_b64_tr_b16 v[122:123], v9 offset:6144
    v_mfma_f32_16x16x32_bf16 v[168:171], v[92:95], v[68:71], v[168:171]
    s_waitcnt lgkmcnt(14)
    ds_read_b64_tr_b16 v[124:125], v9 offset:6912
    s_waitcnt lgkmcnt(13)
    v_lshlrev_b32 v24, 16, v116
    v_and_b32 v25, 0xffff0000, v116
    buffer_load_dword v36, v155, s[16:19], s50 offen offset:0 sc1
    v_mfma_f32_16x16x32_bf16 v[172:175], v[92:95], v[72:75], v[172:175]
    ds_read_b128 v[80:83], v157 offset:2048
    v_add_f32 v16, v16, v24
    v_add_f32 v17, v17, v25
    s_waitcnt lgkmcnt(12)
    v_mfma_f32_16x16x32_bf16 v[188:191], v[96:99], v[72:75], v[188:191]
    ds_read_b128 v[84:87], v157 offset:4096
    v_lshlrev_b32 v26, 16, v117
    buffer_load_dword v30, v155, s[16:19], s49 offen offset:64 sc1
    v_mfma_f32_16x16x32_bf16 v[184:187], v[96:99], v[68:71], v[184:187]
    ds_read_b128 v[88:91], v157 offset:6144
    v_and_b32 v27, 0xffff0000, v117
    v_mfma_f32_16x16x32_bf16 v[180:183], v[96:99], v[64:67], v[180:183]
    ds_read_b64_tr_b16 v[146:147], v12 offset:6144
    v_add_f32 v16, v16, v26
    buffer_load_dword v38, v155, s[16:19], s50 offen offset:64 sc1
    v_mfma_f32_16x16x32_bf16 v[176:179], v[96:99], v[60:63], v[176:179]
    s_waitcnt lgkmcnt(14)
    ds_read_b64_tr_b16 v[148:149], v13 offset:6144
    v_add_f32 v17, v17, v27
    s_waitcnt lgkmcnt(14)
    v_mfma_f32_16x16x32_bf16 v[192:195], v[100:103], v[60:63], v[192:195]
    ds_read_b64_tr_b16 v[150:151], v14 offset:6144
    v_lshlrev_b32 v24, 16, v118
    buffer_load_dword v32, v155, s[16:19], s49 offen offset:128 sc1
    v_mfma_f32_16x16x32_bf16 v[196:199], v[100:103], v[64:67], v[196:199]
    s_waitcnt lgkmcnt(14)
    ds_read_b64_tr_b16 v[126:127], v9 offset:18432
    v_and_b32 v25, 0xffff0000, v118
    v_mfma_f32_16x16x32_bf16 v[200:203], v[100:103], v[68:71], v[200:203]
    s_waitcnt lgkmcnt(14)
    ds_read_b64_tr_b16 v[128:129], v9 offset:19200
    v_add_f32 v18, v18, v24
    buffer_load_dword v40, v155, s[16:19], s50 offen offset:128 sc1
    v_mfma_f32_16x16x32_bf16 v[204:207], v[100:103], v[72:75], v[204:207]
    s_waitcnt lgkmcnt(14)
    ds_read_b64_tr_b16 v[130:131], v10 offset:6144
    v_add_f32 v19, v19, v25
    v_mfma_f32_16x16x32_bf16 v[220:223], v[104:107], v[72:75], v[220:223]
    s_waitcnt lgkmcnt(14)
    ds_read_b64_tr_b16 v[132:133], v10 offset:6912
    v_lshlrev_b32 v26, 16, v119
    buffer_load_dword v34, v155, s[16:19], s49 offen offset:192 sc1
    v_mfma_f32_16x16x32_bf16 v[216:219], v[104:107], v[68:71], v[216:219]
    s_waitcnt lgkmcnt(14)
    ds_read_b64_tr_b16 v[134:135], v10 offset:18432
    v_and_b32 v27, 0xffff0000, v119
    v_mfma_f32_16x16x32_bf16 v[212:215], v[104:107], v[64:67], v[212:215]
    s_waitcnt lgkmcnt(14)
    ds_read_b64_tr_b16 v[136:137], v10 offset:19200
    v_add_f32 v18, v18, v26
    buffer_load_dword v42, v155, s[16:19], s50 offen offset:192 sc1
    v_mfma_f32_16x16x32_bf16 v[208:211], v[104:107], v[60:63], v[208:211]
    s_waitcnt lgkmcnt(14)
    ds_read_b64_tr_b16 v[138:139], v11 offset:6144
    v_add_f32 v19, v19, v27
    v_mfma_f32_16x16x32_bf16 v[224:227], v[108:111], v[60:63], v[224:227]
    s_waitcnt lgkmcnt(14)
    ds_read_b64_tr_b16 v[140:141], v11 offset:6912
    v_lshlrev_b32 v24, 16, v120
    v_mfma_f32_16x16x32_bf16 v[228:231], v[108:111], v[64:67], v[228:231]
    s_waitcnt lgkmcnt(14)
    ds_read_b64_tr_b16 v[142:143], v11 offset:18432
    v_and_b32 v25, 0xffff0000, v120
    v_mfma_f32_16x16x32_bf16 v[232:235], v[108:111], v[68:71], v[232:235]
    s_waitcnt lgkmcnt(14)
    ds_read_b64_tr_b16 v[144:145], v11 offset:19200
    v_add_f32 v20, v20, v24
    v_mfma_f32_16x16x32_bf16 v[236:239], v[108:111], v[72:75], v[236:239]
    v_add_f32 v21, v21, v25
    v_mfma_f32_16x16x32_bf16 v[252:255], v[112:115], v[72:75], v[252:255]
    v_lshlrev_b32 v26, 16, v121
    v_mfma_f32_16x16x32_bf16 v[248:251], v[112:115], v[68:71], v[248:251]
    v_and_b32 v27, 0xffff0000, v121
    v_mfma_f32_16x16x32_bf16 v[244:247], v[112:115], v[64:67], v[244:247]
    v_add_f32 v20, v20, v26
    v_mfma_f32_16x16x32_bf16 v[240:243], v[112:115], v[60:63], v[240:243]
    v_add_f32 v21, v21, v27
    s_waitcnt vmcnt(8) lgkmcnt(13)
    s_barrier
    v_mfma_f32_16x16x32_bf16 v[160:163], v[122:125], v[76:79], v[160:163]
    ds_read_b128 v[60:63], v156 offset:32768
    v_mfma_f32_16x16x32_bf16 v[164:167], v[122:125], v[80:83], v[164:167]
    ds_read_b64_tr_b16 v[92:93], v9 offset:24576
    v_mfma_f32_16x16x32_bf16 v[168:171], v[122:125], v[84:87], v[168:171]
    s_waitcnt lgkmcnt(14)
    ds_read_b64_tr_b16 v[94:95], v9 offset:25344
    s_waitcnt lgkmcnt(13)
    v_lshlrev_b32 v24, 16, v146
    v_and_b32 v25, 0xffff0000, v146
    v_mfma_f32_16x16x32_bf16 v[172:175], v[122:125], v[88:91], v[172:175]
    ds_read_b128 v[64:67], v156 offset:34816
    v_add_f32 v16, v16, v24
    v_add_f32 v17, v17, v25
    s_waitcnt lgkmcnt(12)
    v_mfma_f32_16x16x32_bf16 v[188:191], v[126:129], v[88:91], v[188:191]
    ds_read_b128 v[68:71], v156 offset:36864
    v_lshlrev_b32 v26, 16, v147
    v_mfma_f32_16x16x32_bf16 v[184:187], v[126:129], v[84:87], v[184:187]
    ds_read_b128 v[72:75], v156 offset:38912
    v_and_b32 v27, 0xffff0000, v147
    v_mfma_f32_16x16x32_bf16 v[180:183], v[126:129], v[80:83], v[180:183]
    ds_read_b64_tr_b16 v[116:117], v12 offset:24576
    v_add_f32 v16, v16, v26
    v_mfma_f32_16x16x32_bf16 v[176:179], v[126:129], v[76:79], v[176:179]
    s_waitcnt lgkmcnt(14)
    ds_read_b64_tr_b16 v[118:119], v13 offset:24576
    v_add_f32 v17, v17, v27
    s_waitcnt lgkmcnt(14)
    v_mfma_f32_16x16x32_bf16 v[192:195], v[130:133], v[76:79], v[192:195]
    ds_read_b64_tr_b16 v[120:121], v14 offset:24576
    v_lshlrev_b32 v24, 16, v148
    v_mfma_f32_16x16x32_bf16 v[196:199], v[130:133], v[80:83], v[196:199]
    s_waitcnt lgkmcnt(14)
    ds_read_b64_tr_b16 v[96:97], v9 offset:36864
    v_and_b32 v25, 0xffff0000, v148
    v_mfma_f32_16x16x32_bf16 v[200:203], v[130:133], v[84:87], v[200:203]
    s_waitcnt lgkmcnt(14)
    ds_read_b64_tr_b16 v[98:99], v9 offset:37632
    v_add_f32 v18, v18, v24
    v_mfma_f32_16x16x32_bf16 v[204:207], v[130:133], v[88:91], v[204:207]
    s_waitcnt lgkmcnt(14)
    ds_read_b64_tr_b16 v[100:101], v10 offset:24576
    v_add_f32 v19, v19, v25
    v_mfma_f32_16x16x32_bf16 v[220:223], v[134:137], v[88:91], v[220:223]
    s_waitcnt lgkmcnt(14)
    ds_read_b64_tr_b16 v[102:103], v10 offset:25344
    v_lshlrev_b32 v26, 16, v149
    v_mfma_f32_16x16x32_bf16 v[216:219], v[134:137], v[84:87], v[216:219]
    s_waitcnt lgkmcnt(14)
    ds_read_b64_tr_b16 v[104:105], v10 offset:36864
    v_and_b32 v27, 0xffff0000, v149
    v_mfma_f32_16x16x32_bf16 v[212:215], v[134:137], v[80:83], v[212:215]
    s_waitcnt lgkmcnt(14)
    ds_read_b64_tr_b16 v[106:107], v10 offset:37632
    v_add_f32 v18, v18, v26
    v_mfma_f32_16x16x32_bf16 v[208:211], v[134:137], v[76:79], v[208:211]
    s_waitcnt lgkmcnt(14)
    ds_read_b64_tr_b16 v[108:109], v11 offset:24576
    v_add_f32 v19, v19, v27
    v_mfma_f32_16x16x32_bf16 v[224:227], v[138:141], v[76:79], v[224:227]
    s_waitcnt lgkmcnt(14)
    ds_read_b64_tr_b16 v[110:111], v11 offset:25344
    v_lshlrev_b32 v24, 16, v150
    v_mfma_f32_16x16x32_bf16 v[228:231], v[138:141], v[80:83], v[228:231]
    s_waitcnt lgkmcnt(14)
    ds_read_b64_tr_b16 v[112:113], v11 offset:36864
    v_and_b32 v25, 0xffff0000, v150
    v_mfma_f32_16x16x32_bf16 v[232:235], v[138:141], v[84:87], v[232:235]
    s_waitcnt lgkmcnt(14)
    ds_read_b64_tr_b16 v[114:115], v11 offset:37632
    v_add_f32 v20, v20, v24
    v_mfma_f32_16x16x32_bf16 v[236:239], v[138:141], v[88:91], v[236:239]
    v_add_f32 v21, v21, v25
    v_mfma_f32_16x16x32_bf16 v[252:255], v[142:145], v[88:91], v[252:255]
    v_lshlrev_b32 v26, 16, v151
    v_mfma_f32_16x16x32_bf16 v[248:251], v[142:145], v[84:87], v[248:251]
    v_and_b32 v27, 0xffff0000, v151
    v_mfma_f32_16x16x32_bf16 v[244:247], v[142:145], v[80:83], v[244:247]
    v_add_f32 v20, v20, v26
    v_mfma_f32_16x16x32_bf16 v[240:243], v[142:145], v[76:79], v[240:243]
    v_add_f32 v21, v21, v27
    v_mfma_f32_16x16x32_bf16 v[160:163], v[92:95], v[60:63], v[160:163]
    s_waitcnt lgkmcnt(14)
    ds_read_b128 v[76:79], v157 offset:32768
    buffer_load_dword v159, v158, s[16:19], s79 offen offset:192 sc1
    v_mfma_f32_16x16x32_bf16 v[164:167], v[92:95], v[64:67], v[164:167]
    s_waitcnt lgkmcnt(14)
    ds_read_b64_tr_b16 v[122:123], v9 offset:30720
    v_mfma_f32_16x16x32_bf16 v[168:171], v[92:95], v[68:71], v[168:171]
    s_waitcnt lgkmcnt(14)
    ds_read_b64_tr_b16 v[124:125], v9 offset:31488
    s_waitcnt lgkmcnt(13)
    v_lshlrev_b32 v24, 16, v116
    v_and_b32 v25, 0xffff0000, v116
    v_add_f32 v16, v16, v24
    v_mfma_f32_16x16x32_bf16 v[172:175], v[92:95], v[72:75], v[172:175]
    ds_read_b128 v[80:83], v157 offset:34816
    v_add_f32 v17, v17, v25
    v_lshlrev_b32 v26, 16, v117
    v_and_b32 v27, 0xffff0000, v117
    s_waitcnt lgkmcnt(12)
    v_mfma_f32_16x16x32_bf16 v[188:191], v[96:99], v[72:75], v[188:191]
    ds_read_b128 v[84:87], v157 offset:36864
    v_add_f32 v16, v16, v26
    v_add_f32 v17, v17, v27
    v_lshlrev_b32 v24, 16, v118
    v_mfma_f32_16x16x32_bf16 v[184:187], v[96:99], v[68:71], v[184:187]
    ds_read_b128 v[88:91], v157 offset:38912
    v_and_b32 v25, 0xffff0000, v118
    v_add_f32 v18, v18, v24
    v_add_f32 v19, v19, v25
    v_mfma_f32_16x16x32_bf16 v[180:183], v[96:99], v[64:67], v[180:183]
    ds_read_b64_tr_b16 v[146:147], v12 offset:30720
    v_lshlrev_b32 v26, 16, v119
    v_and_b32 v27, 0xffff0000, v119
    v_add_f32 v18, v18, v26
    v_mfma_f32_16x16x32_bf16 v[176:179], v[96:99], v[60:63], v[176:179]
    s_waitcnt lgkmcnt(14)
    ds_read_b64_tr_b16 v[148:149], v13 offset:30720
    v_add_f32 v19, v19, v27
    v_lshlrev_b32 v24, 16, v120
    s_waitcnt lgkmcnt(14)
    v_mfma_f32_16x16x32_bf16 v[192:195], v[100:103], v[60:63], v[192:195]
    ds_read_b64_tr_b16 v[150:151], v14 offset:30720
    v_and_b32 v25, 0xffff0000, v120
    v_add_f32 v20, v20, v24
    v_mfma_f32_16x16x32_bf16 v[196:199], v[100:103], v[64:67], v[196:199]
    s_waitcnt lgkmcnt(14)
    ds_read_b64_tr_b16 v[126:127], v9 offset:43008
    v_add_f32 v21, v21, v25
    v_lshlrev_b32 v26, 16, v121
    v_mfma_f32_16x16x32_bf16 v[200:203], v[100:103], v[68:71], v[200:203]
    s_waitcnt lgkmcnt(14)
    ds_read_b64_tr_b16 v[128:129], v9 offset:43776
    v_and_b32 v27, 0xffff0000, v121
    v_add_f32 v20, v20, v26
    v_mfma_f32_16x16x32_bf16 v[204:207], v[100:103], v[72:75], v[204:207]
    s_waitcnt lgkmcnt(14)
    ds_read_b64_tr_b16 v[130:131], v10 offset:30720
    v_add_f32 v21, v21, v27
    s_waitcnt lgkmcnt(3)
    v_mfma_f32_16x16x32_bf16 v[220:223], v[104:107], v[72:75], v[220:223]
    ds_read_b64_tr_b16 v[132:133], v10 offset:31488
    v_lshlrev_b32 v24, 16, v146
    v_and_b32 v25, 0xffff0000, v146
    v_mfma_f32_16x16x32_bf16 v[216:219], v[104:107], v[68:71], v[216:219]
    ds_read_b64_tr_b16 v[134:135], v10 offset:43008
    v_add_f32 v16, v16, v24
    v_add_f32 v17, v17, v25
    v_mfma_f32_16x16x32_bf16 v[212:215], v[104:107], v[64:67], v[212:215]
    ds_read_b64_tr_b16 v[136:137], v10 offset:43776
    v_lshlrev_b32 v26, 16, v147
    v_and_b32 v27, 0xffff0000, v147
    v_mfma_f32_16x16x32_bf16 v[208:211], v[104:107], v[60:63], v[208:211]
    ds_read_b64_tr_b16 v[138:139], v11 offset:30720
    v_add_f32 v16, v16, v26
    v_add_f32 v17, v17, v27
    v_mfma_f32_16x16x32_bf16 v[224:227], v[108:111], v[60:63], v[224:227]
    ds_read_b64_tr_b16 v[140:141], v11 offset:31488
    v_lshlrev_b32 v24, 16, v148
    v_and_b32 v25, 0xffff0000, v148
    v_mfma_f32_16x16x32_bf16 v[228:231], v[108:111], v[64:67], v[228:231]
    ds_read_b64_tr_b16 v[142:143], v11 offset:43008
    v_add_f32 v18, v18, v24
    v_add_f32 v19, v19, v25
    v_mfma_f32_16x16x32_bf16 v[232:235], v[108:111], v[68:71], v[232:235]
    ds_read_b64_tr_b16 v[144:145], v11 offset:43776
    v_lshlrev_b32 v26, 16, v149
    v_and_b32 v27, 0xffff0000, v149
    v_mfma_f32_16x16x32_bf16 v[236:239], v[108:111], v[72:75], v[236:239]
    v_add_f32 v18, v18, v26
    v_add_f32 v19, v19, v27
    v_mfma_f32_16x16x32_bf16 v[252:255], v[112:115], v[72:75], v[252:255]
    v_lshlrev_b32 v24, 16, v150
    v_and_b32 v25, 0xffff0000, v150
    v_mfma_f32_16x16x32_bf16 v[248:251], v[112:115], v[68:71], v[248:251]
    v_add_f32 v20, v20, v24
    v_add_f32 v21, v21, v25
    v_mfma_f32_16x16x32_bf16 v[244:247], v[112:115], v[64:67], v[244:247]
    v_lshlrev_b32 v26, 16, v151
    v_and_b32 v27, 0xffff0000, v151
    v_mfma_f32_16x16x32_bf16 v[240:243], v[112:115], v[60:63], v[240:243]
    v_add_f32 v20, v20, v26
    v_add_f32 v21, v21, v27
    s_barrier
    v_mfma_f32_16x16x32_bf16 v[160:163], v[122:125], v[76:79], v[160:163]
    v_add_f32 v16, v16, v17
    v_add_f32 v18, v18, v19
    v_mfma_f32_16x16x32_bf16 v[164:167], v[122:125], v[80:83], v[164:167]
    v_add_f32 v20, v20, v21
    v_mov_b32 v17, v16
    v_mfma_f32_16x16x32_bf16 v[168:171], v[122:125], v[84:87], v[168:171]
    v_mov_b32 v19, v18
    v_mov_b32 v21, v20
    v_mfma_f32_16x16x32_bf16 v[172:175], v[122:125], v[88:91], v[172:175]
    s_mul_i32 s32, s20, 192
    s_add_u32 s32, s32, 159744
    s_waitcnt lgkmcnt(8)
    v_mfma_f32_16x16x32_bf16 v[188:191], v[126:129], v[88:91], v[188:191]
    v_permlane32_swap_b32 v16, v17
    v_permlane32_swap_b32 v18, v19
    v_mfma_f32_16x16x32_bf16 v[184:187], v[126:129], v[84:87], v[184:187]
    v_permlane32_swap_b32 v20, v21
    v_and_b32 v24, 15, v1
    v_mfma_f32_16x16x32_bf16 v[180:183], v[126:129], v[80:83], v[180:183]
    v_add_f32 v16, v16, v17
    v_add_f32 v18, v18, v19
    v_mfma_f32_16x16x32_bf16 v[176:179], v[126:129], v[76:79], v[176:179]
    v_add_f32 v20, v20, v21
    v_mov_b32 v17, v16
    s_waitcnt lgkmcnt(6)
    v_mfma_f32_16x16x32_bf16 v[192:195], v[130:133], v[76:79], v[192:195]
    v_mov_b32 v19, v18
    v_mov_b32 v21, v20
    v_mfma_f32_16x16x32_bf16 v[196:199], v[130:133], v[80:83], v[196:199]
    v_lshl_add_u32 v25, v24, 2, s32
    s_nop 0
    v_mfma_f32_16x16x32_bf16 v[200:203], v[130:133], v[84:87], v[200:203]
    v_permlane16_swap_b32 v16, v17
    v_permlane16_swap_b32 v18, v19
    v_mfma_f32_16x16x32_bf16 v[204:207], v[130:133], v[88:91], v[204:207]
    v_permlane16_swap_b32 v20, v21
    s_nop 0
    s_waitcnt lgkmcnt(4)
    v_mfma_f32_16x16x32_bf16 v[220:223], v[134:137], v[88:91], v[220:223]
    v_add_f32 v16, v16, v17
    v_add_f32 v18, v18, v19
    v_mfma_f32_16x16x32_bf16 v[216:219], v[134:137], v[84:87], v[216:219]
    v_add_f32 v20, v20, v21
    ds_write_b32 v25, v16 offset:0
    ds_write_b32 v25, v18 offset:64
    ds_write_b32 v25, v20 offset:128
    v_mfma_f32_16x16x32_bf16 v[212:215], v[134:137], v[80:83], v[212:215]
    s_waitcnt lgkmcnt(0)
    s_barrier
    ds_read_b128 v[92:95], v152 offset:0
    v_mfma_f32_16x16x32_bf16 v[208:211], v[134:137], v[76:79], v[208:211]
    ds_read_b128 v[44:47], v152 offset:64
    ds_read_b128 v[96:99], v152 offset:768
    v_mfma_f32_16x16x32_bf16 v[224:227], v[138:141], v[76:79], v[224:227]
    ds_read_b128 v[48:51], v152 offset:832
    ds_read_b128 v[100:103], v153 offset:0
    v_mfma_f32_16x16x32_bf16 v[228:231], v[138:141], v[80:83], v[228:231]
    ds_read_b128 v[52:55], v153 offset:64
    v_mfma_f32_16x16x32_bf16 v[232:235], v[138:141], v[84:87], v[232:235]
    ds_read_b128 v[104:107], v153 offset:768
    v_mfma_f32_16x16x32_bf16 v[236:239], v[138:141], v[88:91], v[236:239]
    ds_read_b128 v[56:59], v153 offset:832
    v_mfma_f32_16x16x32_bf16 v[252:255], v[142:145], v[88:91], v[252:255]
    ds_read_b128 v[108:111], v154 offset:0
    v_mfma_f32_16x16x32_bf16 v[248:251], v[142:145], v[84:87], v[248:251]
    ds_read_b128 v[60:63], v154 offset:64
    v_mfma_f32_16x16x32_bf16 v[244:247], v[142:145], v[80:83], v[244:247]
    ds_read_b128 v[112:115], v154 offset:768
    v_mfma_f32_16x16x32_bf16 v[240:243], v[142:145], v[76:79], v[240:243]
    ds_read_b128 v[64:67], v154 offset:832
    s_waitcnt vmcnt(1)
    v_mul_f32 v76, v36, v36
    v_mul_f32 v68, 0xbfb8aa3b, v36
    v_mul_f32 v78, v38, v38
    v_mul_f32 v70, 0xbfb8aa3b, v38
    v_mul_f32 v80, v40, v40
    v_mul_f32 v72, 0xbfb8aa3b, v40
    v_mul_f32 v82, v42, v42
    v_mul_f32 v74, 0xbfb8aa3b, v42
    v_rcp_f32 v76, v76
    v_rcp_f32 v78, v78
    v_rcp_f32 v80, v80
    v_rcp_f32 v82, v82
    s_waitcnt lgkmcnt(0)
    v_pk_add_f32 v[92:93], v[92:93], v[44:45]
    v_pk_add_f32 v[94:95], v[94:95], v[46:47]
    v_pk_add_f32 v[96:97], v[96:97], v[48:49]
    v_pk_add_f32 v[98:99], v[98:99], v[50:51]
    v_pk_add_f32 v[100:101], v[100:101], v[52:53]
    v_pk_add_f32 v[102:103], v[102:103], v[54:55]
    v_pk_add_f32 v[104:105], v[104:105], v[56:57]
    v_pk_add_f32 v[106:107], v[106:107], v[58:59]
    v_pk_add_f32 v[108:109], v[108:109], v[60:61]
    v_pk_add_f32 v[110:111], v[110:111], v[62:63]
    v_pk_add_f32 v[112:113], v[112:113], v[64:65]
    v_pk_add_f32 v[114:115], v[114:115], v[66:67]
    s_lshl_b32 s32, s31, 12
    s_add_u32 s32, s32, 143360
    s_lshl_b32 s33, s27, 10
    v_lshrrev_b32 v53, 1, v15
    s_add_u32 s34, s32, s33
    v_add_u32 v52, s34, v53
    s_add_u32 s34, s32, 2048
    v_add_u32 v59, s34, v53
    s_xor_b32 s33, s33, 1024
    s_add_u32 s34, s32, s33
    v_add_u32 v53, s34, v53
    s_lshl_b32 s33, s27, 11
    s_add_u32 s53, s53, s33
    s_cmp_eq_u32 s27, 0
    s_cselect_b64 s[56:57], -1, 0
    v_cndmask_b32 v58, v52, v59, s[56:57]
    v_cndmask_b32 v52, v59, v52, s[56:57]
    v_pk_fma_f32 v[160:161], v[28:29], v[92:93], v[160:161] op_sel_hi:[0,1,1]
    v_pk_fma_f32 v[162:163], v[28:29], v[94:95], v[162:163] op_sel_hi:[0,1,1]
    v_pk_fma_f32 v[192:193], v[28:29], v[100:101], v[192:193] op_sel_hi:[0,1,1]
    v_pk_fma_f32 v[194:195], v[28:29], v[102:103], v[194:195] op_sel_hi:[0,1,1]
    v_pk_fma_f32 v[224:225], v[28:29], v[108:109], v[224:225] op_sel_hi:[0,1,1]
    v_pk_fma_f32 v[226:227], v[28:29], v[110:111], v[226:227] op_sel_hi:[0,1,1]
    v_pk_mul_f32 v[122:123], v[160:161], v[68:69] op_sel_hi:[1,0]
    v_pk_fma_f32 v[176:177], v[28:29], v[96:97], v[176:177] op_sel_hi:[0,1,1]
    v_pk_mul_f32 v[124:125], v[162:163], v[68:69] op_sel_hi:[1,0]
    v_pk_fma_f32 v[178:179], v[28:29], v[98:99], v[178:179] op_sel_hi:[0,1,1]
    v_pk_mul_f32 v[126:127], v[192:193], v[68:69] op_sel_hi:[1,0]
    v_pk_fma_f32 v[208:209], v[28:29], v[104:105], v[208:209] op_sel_hi:[0,1,1]
    v_pk_mul_f32 v[128:129], v[194:195], v[68:69] op_sel_hi:[1,0]
    v_pk_fma_f32 v[210:211], v[28:29], v[106:107], v[210:211] op_sel_hi:[0,1,1]
    v_pk_mul_f32 v[130:131], v[224:225], v[68:69] op_sel_hi:[1,0]
    v_pk_fma_f32 v[240:241], v[28:29], v[112:113], v[240:241] op_sel_hi:[0,1,1]
    v_pk_mul_f32 v[132:133], v[226:227], v[68:69] op_sel_hi:[1,0]
    v_pk_fma_f32 v[242:243], v[28:29], v[114:115], v[242:243] op_sel_hi:[0,1,1]
    v_exp_f32 v122, v122
    v_exp_f32 v123, v123
    v_exp_f32 v124, v124
    v_exp_f32 v125, v125
    v_exp_f32 v126, v126
    v_exp_f32 v127, v127
    v_exp_f32 v128, v128
    v_exp_f32 v129, v129
    v_exp_f32 v130, v130
    v_exp_f32 v131, v131
    v_exp_f32 v132, v132
    v_exp_f32 v133, v133
    v_pk_mul_f32 v[160:161], v[160:161], v[176:177]
    v_pk_fma_f32 v[122:123], v[122:123], v[76:77], v[76:77] op_sel_hi:[1,0,0]
    v_pk_mul_f32 v[162:163], v[162:163], v[178:179]
    v_pk_fma_f32 v[124:125], v[124:125], v[76:77], v[76:77] op_sel_hi:[1,0,0]
    v_pk_mul_f32 v[192:193], v[192:193], v[208:209]
    v_pk_fma_f32 v[126:127], v[126:127], v[76:77], v[76:77] op_sel_hi:[1,0,0]
    v_pk_mul_f32 v[194:195], v[194:195], v[210:211]
    v_pk_fma_f32 v[128:129], v[128:129], v[76:77], v[76:77] op_sel_hi:[1,0,0]
    v_pk_mul_f32 v[224:225], v[224:225], v[240:241]
    v_pk_fma_f32 v[130:131], v[130:131], v[76:77], v[76:77] op_sel_hi:[1,0,0]
    v_pk_mul_f32 v[226:227], v[226:227], v[242:243]
    v_pk_fma_f32 v[132:133], v[132:133], v[76:77], v[76:77] op_sel_hi:[1,0,0]
    v_rcp_f32 v122, v122
    v_rcp_f32 v123, v123
    v_rcp_f32 v124, v124
    v_rcp_f32 v125, v125
    v_rcp_f32 v126, v126
    v_rcp_f32 v127, v127
    v_rcp_f32 v128, v128
    v_rcp_f32 v129, v129
    v_rcp_f32 v130, v130
    v_rcp_f32 v131, v131
    v_rcp_f32 v132, v132
    v_rcp_f32 v133, v133
    s_nop 0
    v_pk_mul_f32 v[160:161], v[160:161], v[122:123]
    v_pk_mul_f32 v[162:163], v[162:163], v[124:125]
    v_pk_mul_f32 v[192:193], v[192:193], v[126:127]
    v_pk_mul_f32 v[194:195], v[194:195], v[128:129]
    v_pk_mul_f32 v[224:225], v[224:225], v[130:131]
    v_pk_mul_f32 v[226:227], v[226:227], v[132:133]
    v_cvt_pk_bf16_f32 v136, v160, v161
    v_cvt_pk_bf16_f32 v137, v162, v163
    v_cvt_pk_bf16_f32 v138, v192, v193
    v_cvt_pk_bf16_f32 v139, v194, v195
    v_cvt_pk_bf16_f32 v140, v224, v225
    v_cvt_pk_bf16_f32 v141, v226, v227
    buffer_store_dwordx4 v[136:139], v15, s[16:19], s52 offen offset:0 sc1
    ds_write_b64 v58, v[140:141] offset:0
    v_mov_b32 v54, v140
    v_mov_b32 v55, v141
    v_pk_fma_f32 v[164:165], v[30:31], v[92:93], v[164:165] op_sel_hi:[0,1,1]
    v_pk_fma_f32 v[166:167], v[30:31], v[94:95], v[166:167] op_sel_hi:[0,1,1]
    v_pk_fma_f32 v[196:197], v[30:31], v[100:101], v[196:197] op_sel_hi:[0,1,1]
    v_pk_fma_f32 v[198:199], v[30:31], v[102:103], v[198:199] op_sel_hi:[0,1,1]
    v_pk_fma_f32 v[228:229], v[30:31], v[108:109], v[228:229] op_sel_hi:[0,1,1]
    v_pk_fma_f32 v[230:231], v[30:31], v[110:111], v[230:231] op_sel_hi:[0,1,1]
    v_pk_mul_f32 v[122:123], v[164:165], v[70:71] op_sel_hi:[1,0]
    v_pk_fma_f32 v[180:181], v[30:31], v[96:97], v[180:181] op_sel_hi:[0,1,1]
    v_pk_mul_f32 v[124:125], v[166:167], v[70:71] op_sel_hi:[1,0]
    v_pk_fma_f32 v[182:183], v[30:31], v[98:99], v[182:183] op_sel_hi:[0,1,1]
    v_pk_mul_f32 v[126:127], v[196:197], v[70:71] op_sel_hi:[1,0]
    v_pk_fma_f32 v[212:213], v[30:31], v[104:105], v[212:213] op_sel_hi:[0,1,1]
    v_pk_mul_f32 v[128:129], v[198:199], v[70:71] op_sel_hi:[1,0]
    v_pk_fma_f32 v[214:215], v[30:31], v[106:107], v[214:215] op_sel_hi:[0,1,1]
    v_pk_mul_f32 v[130:131], v[228:229], v[70:71] op_sel_hi:[1,0]
    v_pk_fma_f32 v[244:245], v[30:31], v[112:113], v[244:245] op_sel_hi:[0,1,1]
    v_pk_mul_f32 v[132:133], v[230:231], v[70:71] op_sel_hi:[1,0]
    v_pk_fma_f32 v[246:247], v[30:31], v[114:115], v[246:247] op_sel_hi:[0,1,1]
    v_exp_f32 v122, v122
    v_exp_f32 v123, v123
    v_exp_f32 v124, v124
    v_exp_f32 v125, v125
    v_exp_f32 v126, v126
    v_exp_f32 v127, v127
    v_exp_f32 v128, v128
    v_exp_f32 v129, v129
    v_exp_f32 v130, v130
    v_exp_f32 v131, v131
    v_exp_f32 v132, v132
    v_exp_f32 v133, v133
    v_pk_mul_f32 v[164:165], v[164:165], v[180:181]
    v_pk_fma_f32 v[122:123], v[122:123], v[78:79], v[78:79] op_sel_hi:[1,0,0]
    v_pk_mul_f32 v[166:167], v[166:167], v[182:183]
    v_pk_fma_f32 v[124:125], v[124:125], v[78:79], v[78:79] op_sel_hi:[1,0,0]
    v_pk_mul_f32 v[196:197], v[196:197], v[212:213]
    v_pk_fma_f32 v[126:127], v[126:127], v[78:79], v[78:79] op_sel_hi:[1,0,0]
    v_pk_mul_f32 v[198:199], v[198:199], v[214:215]
    v_pk_fma_f32 v[128:129], v[128:129], v[78:79], v[78:79] op_sel_hi:[1,0,0]
    v_pk_mul_f32 v[228:229], v[228:229], v[244:245]
    v_pk_fma_f32 v[130:131], v[130:131], v[78:79], v[78:79] op_sel_hi:[1,0,0]
    v_pk_mul_f32 v[230:231], v[230:231], v[246:247]
    v_pk_fma_f32 v[132:133], v[132:133], v[78:79], v[78:79] op_sel_hi:[1,0,0]
    v_rcp_f32 v122, v122
    v_rcp_f32 v123, v123
    v_rcp_f32 v124, v124
    v_rcp_f32 v125, v125
    v_rcp_f32 v126, v126
    v_rcp_f32 v127, v127
    v_rcp_f32 v128, v128
    v_rcp_f32 v129, v129
    v_rcp_f32 v130, v130
    v_rcp_f32 v131, v131
    v_rcp_f32 v132, v132
    v_rcp_f32 v133, v133
    s_nop 0
    v_pk_mul_f32 v[164:165], v[164:165], v[122:123]
    v_pk_mul_f32 v[166:167], v[166:167], v[124:125]
    v_pk_mul_f32 v[196:197], v[196:197], v[126:127]
    v_pk_mul_f32 v[198:199], v[198:199], v[128:129]
    v_pk_mul_f32 v[228:229], v[228:229], v[130:131]
    v_pk_mul_f32 v[230:231], v[230:231], v[132:133]
    v_cvt_pk_bf16_f32 v144, v164, v165
    v_cvt_pk_bf16_f32 v145, v166, v167
    v_cvt_pk_bf16_f32 v146, v196, v197
    v_cvt_pk_bf16_f32 v147, v198, v199
    v_cvt_pk_bf16_f32 v148, v228, v229
    v_cvt_pk_bf16_f32 v149, v230, v231
    buffer_store_dwordx4 v[144:147], v15, s[16:19], s52 offen offset:1024 sc1
    ds_write_b64 v58, v[148:149] offset:512
    v_mov_b32 v56, v148
    v_mov_b32 v57, v149
    v_pk_fma_f32 v[168:169], v[32:33], v[92:93], v[168:169] op_sel_hi:[0,1,1]
    v_pk_fma_f32 v[170:171], v[32:33], v[94:95], v[170:171] op_sel_hi:[0,1,1]
    v_pk_fma_f32 v[200:201], v[32:33], v[100:101], v[200:201] op_sel_hi:[0,1,1]
    v_pk_fma_f32 v[202:203], v[32:33], v[102:103], v[202:203] op_sel_hi:[0,1,1]
    v_pk_fma_f32 v[232:233], v[32:33], v[108:109], v[232:233] op_sel_hi:[0,1,1]
    v_pk_fma_f32 v[234:235], v[32:33], v[110:111], v[234:235] op_sel_hi:[0,1,1]
    v_pk_mul_f32 v[122:123], v[168:169], v[72:73] op_sel_hi:[1,0]
    v_pk_fma_f32 v[184:185], v[32:33], v[96:97], v[184:185] op_sel_hi:[0,1,1]
    v_pk_mul_f32 v[124:125], v[170:171], v[72:73] op_sel_hi:[1,0]
    v_pk_fma_f32 v[186:187], v[32:33], v[98:99], v[186:187] op_sel_hi:[0,1,1]
    v_pk_mul_f32 v[126:127], v[200:201], v[72:73] op_sel_hi:[1,0]
    v_pk_fma_f32 v[216:217], v[32:33], v[104:105], v[216:217] op_sel_hi:[0,1,1]
    v_pk_mul_f32 v[128:129], v[202:203], v[72:73] op_sel_hi:[1,0]
    v_pk_fma_f32 v[218:219], v[32:33], v[106:107], v[218:219] op_sel_hi:[0,1,1]
    v_pk_mul_f32 v[130:131], v[232:233], v[72:73] op_sel_hi:[1,0]
    v_pk_fma_f32 v[248:249], v[32:33], v[112:113], v[248:249] op_sel_hi:[0,1,1]
    v_pk_mul_f32 v[132:133], v[234:235], v[72:73] op_sel_hi:[1,0]
    v_pk_fma_f32 v[250:251], v[32:33], v[114:115], v[250:251] op_sel_hi:[0,1,1]
    v_exp_f32 v122, v122
    v_exp_f32 v123, v123
    v_exp_f32 v124, v124
    v_exp_f32 v125, v125
    v_exp_f32 v126, v126
    v_exp_f32 v127, v127
    v_exp_f32 v128, v128
    v_exp_f32 v129, v129
    v_exp_f32 v130, v130
    v_exp_f32 v131, v131
    v_exp_f32 v132, v132
    v_exp_f32 v133, v133
    v_pk_mul_f32 v[168:169], v[168:169], v[184:185]
    v_pk_fma_f32 v[122:123], v[122:123], v[80:81], v[80:81] op_sel_hi:[1,0,0]
    v_pk_mul_f32 v[170:171], v[170:171], v[186:187]
    v_pk_fma_f32 v[124:125], v[124:125], v[80:81], v[80:81] op_sel_hi:[1,0,0]
    v_pk_mul_f32 v[200:201], v[200:201], v[216:217]
    v_pk_fma_f32 v[126:127], v[126:127], v[80:81], v[80:81] op_sel_hi:[1,0,0]
    v_pk_mul_f32 v[202:203], v[202:203], v[218:219]
    v_pk_fma_f32 v[128:129], v[128:129], v[80:81], v[80:81] op_sel_hi:[1,0,0]
    v_pk_mul_f32 v[232:233], v[232:233], v[248:249]
    v_pk_fma_f32 v[130:131], v[130:131], v[80:81], v[80:81] op_sel_hi:[1,0,0]
    v_pk_mul_f32 v[234:235], v[234:235], v[250:251]
    v_pk_fma_f32 v[132:133], v[132:133], v[80:81], v[80:81] op_sel_hi:[1,0,0]
    v_rcp_f32 v122, v122
    v_rcp_f32 v123, v123
    v_rcp_f32 v124, v124
    v_rcp_f32 v125, v125
    v_rcp_f32 v126, v126
    v_rcp_f32 v127, v127
    v_rcp_f32 v128, v128
    v_rcp_f32 v129, v129
    v_rcp_f32 v130, v130
    v_rcp_f32 v131, v131
    v_rcp_f32 v132, v132
    v_rcp_f32 v133, v133
    s_nop 0
    v_pk_mul_f32 v[168:169], v[168:169], v[122:123]
    v_pk_mul_f32 v[170:171], v[170:171], v[124:125]
    v_pk_mul_f32 v[200:201], v[200:201], v[126:127]
    v_pk_mul_f32 v[202:203], v[202:203], v[128:129]
    v_pk_mul_f32 v[232:233], v[232:233], v[130:131]
    v_pk_mul_f32 v[234:235], v[234:235], v[132:133]
    v_cvt_pk_bf16_f32 v136, v168, v169
    v_cvt_pk_bf16_f32 v137, v170, v171
    v_cvt_pk_bf16_f32 v138, v200, v201
    v_cvt_pk_bf16_f32 v139, v202, v203
    v_cvt_pk_bf16_f32 v140, v232, v233
    v_cvt_pk_bf16_f32 v141, v234, v235
    buffer_store_dwordx4 v[136:139], v15, s[16:19], s52 offen offset:2048 sc1
    ds_write_b64 v52, v[140:141] offset:0
    v_cndmask_b32 v54, v140, v54, s[56:57]
    v_cndmask_b32 v55, v141, v55, s[56:57]
    v_pk_fma_f32 v[172:173], v[34:35], v[92:93], v[172:173] op_sel_hi:[0,1,1]
    v_pk_fma_f32 v[174:175], v[34:35], v[94:95], v[174:175] op_sel_hi:[0,1,1]
    v_pk_fma_f32 v[204:205], v[34:35], v[100:101], v[204:205] op_sel_hi:[0,1,1]
    v_pk_fma_f32 v[206:207], v[34:35], v[102:103], v[206:207] op_sel_hi:[0,1,1]
    v_pk_fma_f32 v[236:237], v[34:35], v[108:109], v[236:237] op_sel_hi:[0,1,1]
    v_pk_fma_f32 v[238:239], v[34:35], v[110:111], v[238:239] op_sel_hi:[0,1,1]
    v_pk_mul_f32 v[122:123], v[172:173], v[74:75] op_sel_hi:[1,0]
    v_pk_fma_f32 v[188:189], v[34:35], v[96:97], v[188:189] op_sel_hi:[0,1,1]
    v_pk_mul_f32 v[124:125], v[174:175], v[74:75] op_sel_hi:[1,0]
    v_pk_fma_f32 v[190:191], v[34:35], v[98:99], v[190:191] op_sel_hi:[0,1,1]
    v_pk_mul_f32 v[126:127], v[204:205], v[74:75] op_sel_hi:[1,0]
    v_pk_fma_f32 v[220:221], v[34:35], v[104:105], v[220:221] op_sel_hi:[0,1,1]
    v_pk_mul_f32 v[128:129], v[206:207], v[74:75] op_sel_hi:[1,0]
    v_pk_fma_f32 v[222:223], v[34:35], v[106:107], v[222:223] op_sel_hi:[0,1,1]
    v_pk_mul_f32 v[130:131], v[236:237], v[74:75] op_sel_hi:[1,0]
    v_pk_fma_f32 v[252:253], v[34:35], v[112:113], v[252:253] op_sel_hi:[0,1,1]
    v_pk_mul_f32 v[132:133], v[238:239], v[74:75] op_sel_hi:[1,0]
    v_pk_fma_f32 v[254:255], v[34:35], v[114:115], v[254:255] op_sel_hi:[0,1,1]
    v_exp_f32 v122, v122
    v_exp_f32 v123, v123
    v_exp_f32 v124, v124
    v_exp_f32 v125, v125
    v_exp_f32 v126, v126
    v_exp_f32 v127, v127
    v_exp_f32 v128, v128
    v_exp_f32 v129, v129
    v_exp_f32 v130, v130
    v_exp_f32 v131, v131
    v_exp_f32 v132, v132
    v_exp_f32 v133, v133
    v_pk_mul_f32 v[172:173], v[172:173], v[188:189]
    v_pk_fma_f32 v[122:123], v[122:123], v[82:83], v[82:83] op_sel_hi:[1,0,0]
    v_pk_mul_f32 v[174:175], v[174:175], v[190:191]
    v_pk_fma_f32 v[124:125], v[124:125], v[82:83], v[82:83] op_sel_hi:[1,0,0]
    v_pk_mul_f32 v[204:205], v[204:205], v[220:221]
    v_pk_fma_f32 v[126:127], v[126:127], v[82:83], v[82:83] op_sel_hi:[1,0,0]
    v_pk_mul_f32 v[206:207], v[206:207], v[222:223]
    v_pk_fma_f32 v[128:129], v[128:129], v[82:83], v[82:83] op_sel_hi:[1,0,0]
    v_pk_mul_f32 v[236:237], v[236:237], v[252:253]
    v_pk_fma_f32 v[130:131], v[130:131], v[82:83], v[82:83] op_sel_hi:[1,0,0]
    v_pk_mul_f32 v[238:239], v[238:239], v[254:255]
    v_pk_fma_f32 v[132:133], v[132:133], v[82:83], v[82:83] op_sel_hi:[1,0,0]
    v_rcp_f32 v122, v122
    v_rcp_f32 v123, v123
    v_rcp_f32 v124, v124
    v_rcp_f32 v125, v125
    v_rcp_f32 v126, v126
    v_rcp_f32 v127, v127
    v_rcp_f32 v128, v128
    v_rcp_f32 v129, v129
    v_rcp_f32 v130, v130
    v_rcp_f32 v131, v131
    v_rcp_f32 v132, v132
    v_rcp_f32 v133, v133
    s_nop 0
    v_pk_mul_f32 v[172:173], v[172:173], v[122:123]
    v_pk_mul_f32 v[174:175], v[174:175], v[124:125]
    v_pk_mul_f32 v[204:205], v[204:205], v[126:127]
    v_pk_mul_f32 v[206:207], v[206:207], v[128:129]
    v_pk_mul_f32 v[236:237], v[236:237], v[130:131]
    v_pk_mul_f32 v[238:239], v[238:239], v[132:133]
    v_cvt_pk_bf16_f32 v144, v172, v173
    v_cvt_pk_bf16_f32 v145, v174, v175
    v_cvt_pk_bf16_f32 v146, v204, v205
    v_cvt_pk_bf16_f32 v147, v206, v207
    v_cvt_pk_bf16_f32 v148, v236, v237
    v_cvt_pk_bf16_f32 v149, v238, v239
    buffer_store_dwordx4 v[144:147], v15, s[16:19], s52 offen offset:3072 sc1
    ds_write_b64 v52, v[148:149] offset:512
    v_cndmask_b32 v56, v148, v56, s[56:57]
    v_cndmask_b32 v57, v149, v57, s[56:57]
    s_waitcnt lgkmcnt(0)
    s_barrier
    ds_read_b64 v[44:45], v53
    ds_read_b64 v[48:49], v53 offset:512
    s_waitcnt lgkmcnt(0)
    v_cndmask_b32 v46, v54, v44, s[56:57]
    v_cndmask_b32 v47, v55, v45, s[56:57]
    v_cndmask_b32 v44, v44, v54, s[56:57]
    v_cndmask_b32 v45, v45, v55, s[56:57]
    buffer_store_dwordx4 v[44:47], v15, s[16:19], s53 offen offset:0 sc1
    v_cndmask_b32 v50, v56, v48, s[56:57]
    v_cndmask_b32 v51, v57, v49, s[56:57]
    v_cndmask_b32 v48, v48, v56, s[56:57]
    v_cndmask_b32 v49, v49, v57, s[56:57]
    buffer_store_dwordx4 v[48:51], v15, s[16:19], s53 offen offset:1024 sc1
    s_branch L_k1_end_e
L_k1_ffn_spin:
    s_mov_b32 s51, 0
L_k1_ffn_spin2:
    s_sleep 4
    buffer_load_dword v159, v158, s[44:47], 0 offen sc1
    s_add_u32 s51, s51, 1
    s_cmp_ge_u32 s51, 1000000
    s_waitcnt vmcnt(0)
    s_cbranch_scc1 L_k1_ffn_go
    v_cmp_eq_u32 vcc, 0, v159
    s_cbranch_vccnz L_k1_ffn_spin2
    s_branch L_k1_ffn_go
L_k1_kv:
    s_sub_u32 s22, s35, 18
    s_mov_b32 s12, s36
    s_and_b32 s13, s37, 0xffff
    s_mov_b32 s14, 2457600
    s_mov_b32 s15, 0x20000
    s_lshl_b32 s28, s20, 10
    s_add_u32 s29, s28, 8192
    s_add_u32 s30, s28, 16384
    s_lshl_b32 s33, s20, 6
    s_mul_i32 s34, s22, 160
    s_add_u32 s34, s34, 1280
    s_add_u32 s38, s33, 0
    v_add_u32 v44, s38, v1
    v_mul_u32_u24 v45, 52429, v44
    v_lshrrev_b32 v45, 20, v45
    v_mul_u32_u24 v47, 20, v45
    v_sub_u32 v47, v44, v47
    v_bfe_u32 v48, v45, 3, 1
    v_mul_u32_u24 v48, 18, v48
    v_add_u32 v47, v47, v48
    v_subrev_u32 v48, 20, v47
    v_min_u32 v47, v47, v48
    v_mul_u32_u24 v48, 3840, v45
    v_lshl_add_u32 v48, v47, 4, v48
    v_cmp_lt_u32 vcc, 9, v47
    v_add_u32 v50, 1120, v48
    s_nop 0
    v_cndmask_b32 v48, v48, v50, vcc
    v_add_u32 v6, s34, v48
    s_add_u32 s38, s33, 512
    v_add_u32 v44, s38, v1
    v_mul_u32_u24 v45, 52429, v44
    v_lshrrev_b32 v45, 20, v45
    v_mul_u32_u24 v47, 20, v45
    v_sub_u32 v47, v44, v47
    v_bfe_u32 v48, v45, 3, 1
    v_mul_u32_u24 v48, 18, v48
    v_add_u32 v47, v47, v48
    v_subrev_u32 v48, 20, v47
    v_min_u32 v47, v47, v48
    v_mul_u32_u24 v48, 3840, v45
    v_lshl_add_u32 v48, v47, 4, v48
    v_cmp_lt_u32 vcc, 9, v47
    v_add_u32 v50, 1120, v48
    s_nop 0
    v_cndmask_b32 v48, v48, v50, vcc
    v_add_u32 v7, s34, v48
    s_add_u32 s38, s33, 1024
    v_add_u32 v44, s38, v1
    v_mul_u32_u24 v45, 52429, v44
    v_lshrrev_b32 v45, 20, v45
    v_mul_u32_u24 v47, 20, v45
    v_sub_u32 v47, v44, v47
    v_bfe_u32 v48, v45, 3, 1
    v_mul_u32_u24 v48, 18, v48
    v_add_u32 v47, v47, v48
    v_subrev_u32 v48, 20, v47
    v_min_u32 v47, v47, v48
    v_mul_u32_u24 v48, 3840, v45
    v_lshl_add_u32 v48, v47, 4, v48
    v_cmp_lt_u32 vcc, 9, v47
    v_add_u32 v50, 1120, v48
    s_nop 0
    v_cndmask_b32 v48, v48, v50, vcc
    v_add_u32 v8, s34, v48
    v_cmp_lt_u32 vcc, 63, v45
    v_mov_b32 v50, 0x40000000
    s_nop 0
    v_cndmask_b32 v8, v8, v50, vcc
    s_mul_i32 s24, s25, 245760
    s_mov_b32 s62, s25
    s_and_b32 s63, s25, 1
    s_add_u32 s23, s23, 128
    s_cmp_eq_u32 s23, 1280
    s_cselect_b32 s23, 0, s23
    s_add_u32 m0, s28, 0
    s_xor_b32 s24, 0, s62
    s_mul_i32 s24, s24, 245760
    buffer_load_dwordx4 v6, s[12:15], s24 offen  lds
    s_add_u32 m0, s29, 0
    s_nop 0
    buffer_load_dwordx4 v7, s[12:15], s24 offen  lds
    s_add_u32 m0, s30, 0
    s_nop 0
    buffer_load_dwordx4 v8, s[12:15], s24 offen  lds
    s_and_b32 s32, s2, 7
    s_lshr_b32 s33, s2, 3
    s_lshr_b32 s82, s32, 1
    s_lshl_b32 s82, s82, 3
    s_and_b32 s34, s33, 7
    s_add_u32 s82, s82, s34
    s_and_b32 s83, s32, 1
    s_lshl_b32 s83, s83, 2
    s_lshr_b32 s34, s33, 3
    s_add_u32 s83, s83, s34
    s_lshl_b32 s79, s82, 3
    s_add_u32 s79, s79, s83
    s_lshl_b32 s79, s79, 9
    s_add_u32 s79, s79, 14560256
    s_lshl_b32 s68, s21, 14
    s_lshl_b32 s69, s35, 2
    s_sub_u32 s34, s69, 32
    s_cmp_ge_u32 s35, 26
    s_cselect_b32 s69, s34, s69
    s_add_u32 s68, s68, s69
    s_sub_u32 s69, s35, 18
    s_lshl_b32 s34, s69, 8
    s_lshl_b32 s38, s21, 2
    s_add_u32 s34, s34, s38
    s_add_u32 s34, s34, 131072
    s_cmp_lt_u32 s69, 8
    s_cselect_b32 s68, s34, s68
    s_cselect_b32 s69, 2, 32
    s_cselect_b32 s85, 7, 9
    s_lshl_b32 s34, s21, 1
    s_add_u32 s34, s34, s35
    s_add_u32 s34, s34, 18
    s_lshl_b32 s34, s34, 2
    s_cmp_ge_u32 s35, 30
    s_cselect_b32 s68, s34, s68
    s_cselect_b32 s69, 256, s69
    s_add_u32 s68, s68, 14560256
    v_lshrrev_b32 v47, 4, v1
    v_bfe_u32 v48, v1, 2, 2
    v_lshl_add_u32 v48, v47, 3, v48
    v_mul_u32_u24 v48, 320, v48
    v_and_b32 v49, 1, v47
    v_lshlrev_b32 v49, 5, v49
    v_bfe_u32 v50, v1, 1, 3
    v_xor_b32 v50, v50, v47
    v_and_b32 v51, 15, v1
    v_lshlrev_b32 v52, 7, v51
    v_lshl_add_u32 v52, v50, 4, v52
    s_lshl_b32 s32, s31, 13
    s_add_u32 s32, s32, 98304
    v_add_u32 v156, s32, v52
    v_xor_b32 v52, 64, v52
    v_add_u32 v157, s32, v52
    s_lshl_b32 s32, s21, 2
    s_add_u32 s32, s32, s31
    s_lshl_b32 s49, s32, 8
    s_add_u32 s49, s49, 14543872
    s_add_u32 s50, s49, 8192
    v_lshlrev_b32 v158, 2, v51
    s_mul_i32 s32, s27, 160
    v_add_u32 v53, s32, v49
    v_subrev_u32 v54, 320, v53
    v_min_u32 v53, v53, v54
    v_lshl_add_u32 v53, v46, 3, v53
    v_add_u32 v9, v53, v48
    s_add_u32 s32, s32, 128
    v_add_u32 v53, s32, v49
    v_subrev_u32 v54, 320, v53
    v_min_u32 v53, v53, v54
    v_lshl_add_u32 v53, v46, 3, v53
    v_add_u32 v10, v53, v48
    s_mul_i32 s32, s20, 3
    s_add_u32 s32, s32, 0
    s_and_b32 s33, s32, 1
    s_mul_i32 s33, s33, 1280
    s_lshr_b32 s32, s32, 1
    s_min_u32 s32, s32, 9
    s_lshl_b32 s32, s32, 5
    v_add_u32 v53, s32, v49
    v_subrev_u32 v54, 320, v53
    v_min_u32 v53, v53, v54
    v_lshl_add_u32 v53, v46, 3, v53
    v_add3_u32 v12, v53, v48, s33
    s_mul_i32 s32, s20, 3
    s_add_u32 s32, s32, 1
    s_and_b32 s33, s32, 1
    s_mul_i32 s33, s33, 1280
    s_lshr_b32 s32, s32, 1
    s_min_u32 s32, s32, 9
    s_lshl_b32 s32, s32, 5
    v_add_u32 v53, s32, v49
    v_subrev_u32 v54, 320, v53
    v_min_u32 v53, v53, v54
    v_lshl_add_u32 v53, v46, 3, v53
    v_add3_u32 v13, v53, v48, s33
    s_mul_i32 s32, s20, 3
    s_add_u32 s32, s32, 2
    s_and_b32 s33, s32, 1
    s_mul_i32 s33, s33, 1280
    s_lshr_b32 s32, s32, 1
    s_min_u32 s32, s32, 9
    s_lshl_b32 s32, s32, 5
    v_add_u32 v53, s32, v49
    v_subrev_u32 v54, 320, v53
    v_min_u32 v53, v53, v54
    v_lshl_add_u32 v53, v46, 3, v53
    v_add3_u32 v14, v53, v48, s33
    s_mul_i32 s32, s27, 640
    s_add_u32 s32, s32, 159744
    v_lshl_add_u32 v152, v51, 2, s32
    v_lshlrev_b32 v155, 4, v47
    s_min_u32 s36, s20, 4
    s_lshl_b32 s33, s36, 13
    v_add_u32 v240, s33, v15
    s_add_u32 s33, s33, 32768
    v_add_u32 v241, s33, v15
    s_lshl_b32 s38, s21, 5
    s_lshl_b32 s39, s22, 2
    s_add_u32 s38, s38, s39
    s_mul_i32 s38, s38, 1920
    s_add_u32 s38, s38, 14041088
    s_lshl_b32 s33, s36, 4
    v_add_u32 v53, s33, v51
    v_mul_u32_u24 v54, 3277, v53
    v_lshrrev_b32 v54, 16, v54
    v_mul_u32_u24 v55, 20, v54
    v_sub_u32 v55, v53, v55
    v_mul_u32_u24 v56, 1920, v54
    v_lshl_add_u32 v56, v55, 4, v56
    v_add_u32 v56, s38, v56
    v_mov_b32 v57, 0x40000000
    v_add_u32 v54, 1, v54
    s_lshl_b32 s33, s36, 2
    s_add_u32 s33, s33, 1
    v_add_u32 v53, s33, v47
    v_mul_u32_u24 v55, 52, v53
    v_lshrrev_b32 v55, 8, v55
    v_cmp_eq_u32 vcc, v55, v54
    v_mul_u32_u24 v55, 5, v55
    v_sub_u32 v53, v53, v55
    v_mul_u32_u24 v53, 320, v53
    v_add_u32 v53, v53, v56
    v_cndmask_b32 v242, v57, v53, vcc
    s_lshl_b32 s33, s36, 2
    s_add_u32 s33, s33, 5
    v_add_u32 v53, s33, v47
    v_mul_u32_u24 v55, 52, v53
    v_lshrrev_b32 v55, 8, v55
    v_cmp_eq_u32 vcc, v55, v54
    v_mul_u32_u24 v55, 5, v55
    v_sub_u32 v53, v53, v55
    v_mul_u32_u24 v53, 320, v53
    v_add_u32 v53, v53, v56
    v_cndmask_b32 v243, v57, v53, vcc
    s_lshl_b32 s33, s36, 2
    s_add_u32 s33, s33, 9
    v_add_u32 v53, s33, v47
    v_mul_u32_u24 v55, 52, v53
    v_lshrrev_b32 v55, 8, v55
    v_cmp_eq_u32 vcc, v55, v54
    v_mul_u32_u24 v55, 5, v55
    v_sub_u32 v53, v53, v55
    v_mul_u32_u24 v53, 320, v53
    v_add_u32 v53, v53, v56
    v_cndmask_b32 v244, v57, v53, vcc
    v_cmp_eq_u32 vcc, 0, v47
    v_add_u32 v56, 1600, v56
    s_mul_i32 s32, s27, 40960
    v_cndmask_b32 v245, v57, v56, vcc
    s_lshl_b32 s33, s31, 11
    s_add_u32 s32, s32, s33
    v_add_u32 v246, s32, v15
    v_mov_b32 v248, 0x3f803f80
    v_mov_b32 v249, 0x3f803f80
    v_mov_b32 v250, 0x3f803f80
    v_mov_b32 v251, 0x3f803f80
    v_mov_b32 v16, 0
    v_mov_b32 v17, 0
    v_mov_b32 v18, 0
    v_mov_b32 v19, 0
    v_mov_b32 v20, 0
    v_mov_b32 v21, 0
    s_add_u32 m0, s28, 24576
    s_xor_b32 s24, 1, s62
    s_mul_i32 s24, s24, 245760
    buffer_load_dwordx4 v6, s[12:15], s24 offen  lds
    s_add_u32 m0, s29, 24576
    s_nop 0
    buffer_load_dwordx4 v7, s[12:15], s24 offen  lds
    s_add_u32 m0, s30, 24576
    s_nop 0
    buffer_load_dwordx4 v8, s[12:15], s24 offen  lds
    s_add_u32 m0, s26, 32768
    s_xor_b32 s23, 1, s62
    s_lshl_b32 s23, s23, 7
    buffer_load_dwordx4 v2, s[8:11], s23 offen  lds
    s_add_u32 m0, s26, 33792
    s_nop 0
    buffer_load_dwordx4 v3, s[8:11], s23 offen  lds
    s_add_u32 m0, s26, 34816
    s_nop 0
    buffer_load_dwordx4 v4, s[8:11], s23 offen  lds
    s_add_u32 m0, s26, 35840
    s_nop 0
    buffer_load_dwordx4 v5, s[8:11], s23 offen  lds
    s_add_u32 m0, s28, 49152
    s_xor_b32 s24, 2, s62
    s_mul_i32 s24, s24, 245760
    buffer_load_dwordx4 v6, s[12:15], s24 offen  lds
    s_add_u32 m0, s29, 49152
    s_nop 0
    buffer_load_dwordx4 v7, s[12:15], s24 offen  lds
    s_add_u32 m0, s30, 49152
    s_nop 0
    buffer_load_dwordx4 v8, s[12:15], s24 offen  lds
    s_waitcnt vmcnt(10)
    s_barrier
    ds_read_b128 v[60:63], v156 offset:0
    ds_read_b64_tr_b16 v[92:93], v9 offset:0
    ds_read_b64_tr_b16 v[94:95], v9 offset:1280
    ds_read_b128 v[64:67], v156 offset:2048
    ds_read_b128 v[68:71], v156 offset:4096
    ds_read_b128 v[72:75], v156 offset:6144
    ds_read_b64_tr_b16 v[116:117], v12 offset:0
    ds_read_b64_tr_b16 v[118:119], v13 offset:0
    ds_read_b64_tr_b16 v[120:121], v14 offset:0
    ds_read_b64_tr_b16 v[96:97], v9 offset:32
    ds_read_b64_tr_b16 v[98:99], v9 offset:1312
    ds_read_b64_tr_b16 v[100:101], v9 offset:64
    ds_read_b64_tr_b16 v[102:103], v9 offset:1344
    ds_read_b64_tr_b16 v[104:105], v9 offset:96
    ds_read_b64_tr_b16 v[106:107], v9 offset:1376
    s_waitcnt lgkmcnt(14)
    ds_read_b64_tr_b16 v[108:109], v10 offset:0
    s_waitcnt lgkmcnt(14)
    ds_read_b64_tr_b16 v[110:111], v10 offset:1280
    s_cmp_eq_u32 s27, 1
    s_cbranch_scc0 L_prio_kv
    s_setprio 1
L_prio_kv:
    s_waitcnt lgkmcnt(14)
    v_mfma_f32_16x16x32_bf16 v[160:163], v[60:63], v[92:95], 0
    ds_read_b128 v[76:79], v157 offset:0
    s_waitcnt lgkmcnt(14)
    ds_read_b64_tr_b16 v[122:123], v9 offset:10240
    v_mfma_f32_16x16x32_bf16 v[164:167], v[64:67], v[92:95], 0
    s_waitcnt lgkmcnt(14)
    ds_read_b64_tr_b16 v[124:125], v9 offset:11520
    v_mfma_f32_16x16x32_bf16 v[168:171], v[68:71], v[92:95], 0
    s_waitcnt lgkmcnt(14)
    ds_read_b128 v[80:83], v157 offset:2048
    s_waitcnt lgkmcnt(12)
    v_lshlrev_b32 v24, 16, v116
    v_and_b32 v25, 0xffff0000, v116
    v_mfma_f32_16x16x32_bf16 v[172:175], v[72:75], v[92:95], 0
    ds_read_b128 v[84:87], v157 offset:4096
    v_add_f32 v16, v16, v24
    v_add_f32 v17, v17, v25
    s_waitcnt lgkmcnt(11)
    v_mfma_f32_16x16x32_bf16 v[188:191], v[72:75], v[96:99], 0
    ds_read_b128 v[88:91], v157 offset:6144
    v_lshlrev_b32 v26, 16, v117
    v_and_b32 v27, 0xffff0000, v117
    v_mfma_f32_16x16x32_bf16 v[184:187], v[68:71], v[96:99], 0
    ds_read_b64_tr_b16 v[146:147], v12 offset:10240
    v_add_f32 v16, v16, v26
    v_add_f32 v17, v17, v27
    v_mfma_f32_16x16x32_bf16 v[180:183], v[64:67], v[96:99], 0
    ds_read_b64_tr_b16 v[148:149], v13 offset:10240
    v_lshlrev_b32 v24, 16, v118
    v_and_b32 v25, 0xffff0000, v118
    v_mfma_f32_16x16x32_bf16 v[176:179], v[60:63], v[96:99], 0
    ds_read_b64_tr_b16 v[150:151], v14 offset:10240
    v_add_f32 v18, v18, v24
    v_add_f32 v19, v19, v25
    s_waitcnt lgkmcnt(13)
    v_mfma_f32_16x16x32_bf16 v[192:195], v[60:63], v[100:103], 0
    ds_read_b64_tr_b16 v[126:127], v9 offset:10272
    v_lshlrev_b32 v26, 16, v119
    v_mfma_f32_16x16x32_bf16 v[196:199], v[64:67], v[100:103], 0
    ds_read_b64_tr_b16 v[128:129], v9 offset:11552
    v_and_b32 v27, 0xffff0000, v119
    v_mfma_f32_16x16x32_bf16 v[200:203], v[68:71], v[100:103], 0
    s_waitcnt lgkmcnt(14)
    ds_read_b64_tr_b16 v[130:131], v9 offset:10304
    v_add_f32 v18, v18, v26
    v_mfma_f32_16x16x32_bf16 v[204:207], v[72:75], v[100:103], 0
    s_waitcnt lgkmcnt(14)
    ds_read_b64_tr_b16 v[132:133], v9 offset:11584
    v_add_f32 v19, v19, v27
    v_mfma_f32_16x16x32_bf16 v[220:223], v[72:75], v[104:107], 0
    s_waitcnt lgkmcnt(14)
    ds_read_b64_tr_b16 v[134:135], v9 offset:10336
    v_lshlrev_b32 v24, 16, v120
    v_mfma_f32_16x16x32_bf16 v[216:219], v[68:71], v[104:107], 0
    s_waitcnt lgkmcnt(14)
    ds_read_b64_tr_b16 v[136:137], v9 offset:11616
    v_and_b32 v25, 0xffff0000, v120
    v_mfma_f32_16x16x32_bf16 v[212:215], v[64:67], v[104:107], 0
    s_waitcnt lgkmcnt(14)
    ds_read_b64_tr_b16 v[138:139], v10 offset:10240
    v_add_f32 v20, v20, v24
    v_mfma_f32_16x16x32_bf16 v[208:211], v[60:63], v[104:107], 0
    s_waitcnt lgkmcnt(14)
    ds_read_b64_tr_b16 v[140:141], v10 offset:11520
    v_add_f32 v21, v21, v25
    v_mfma_f32_16x16x32_bf16 v[224:227], v[60:63], v[108:111], 0
    v_lshlrev_b32 v26, 16, v121
    v_mfma_f32_16x16x32_bf16 v[228:231], v[64:67], v[108:111], 0
    v_and_b32 v27, 0xffff0000, v121
    v_mfma_f32_16x16x32_bf16 v[232:235], v[68:71], v[108:111], 0
    v_add_f32 v20, v20, v26
    v_mfma_f32_16x16x32_bf16 v[236:239], v[72:75], v[108:111], 0
    v_add_f32 v21, v21, v27
    s_waitcnt vmcnt(3) lgkmcnt(11)
    s_barrier
    v_mfma_f32_16x16x32_bf16 v[160:163], v[76:79], v[122:125], v[160:163]
    ds_read_b128 v[60:63], v156 offset:32768
    ds_read_b64_tr_b16 v[92:93], v9 offset:24576
    s_add_u32 m0, s26, 0
    s_xor_b32 s23, 2, s62
    s_lshl_b32 s23, s23, 7
    buffer_load_dwordx4 v2, s[8:11], s23 offen  lds
    v_mfma_f32_16x16x32_bf16 v[164:167], v[80:83], v[122:125], v[164:167]
    ds_read_b64_tr_b16 v[94:95], v9 offset:25856
    v_mfma_f32_16x16x32_bf16 v[168:171], v[84:87], v[122:125], v[168:171]
    ds_read_b128 v[64:67], v156 offset:34816
    s_waitcnt lgkmcnt(12)
    v_lshlrev_b32 v24, 16, v146
    v_and_b32 v25, 0xffff0000, v146
    s_add_u32 m0, s26, 1024
    s_nop 0
    buffer_load_dwordx4 v3, s[8:11], s23 offen  lds
    v_mfma_f32_16x16x32_bf16 v[172:175], v[88:91], v[122:125], v[172:175]
    ds_read_b128 v[68:71], v156 offset:36864
    v_add_f32 v16, v16, v24
    v_add_f32 v17, v17, v25
    s_waitcnt lgkmcnt(11)
    v_mfma_f32_16x16x32_bf16 v[188:191], v[88:91], v[126:129], v[188:191]
    ds_read_b128 v[72:75], v156 offset:38912
    v_lshlrev_b32 v26, 16, v147
    v_and_b32 v27, 0xffff0000, v147
    s_add_u32 m0, s26, 2048
    s_nop 0
    buffer_load_dwordx4 v4, s[8:11], s23 offen  lds
    v_mfma_f32_16x16x32_bf16 v[184:187], v[84:87], v[126:129], v[184:187]
    ds_read_b64_tr_b16 v[116:117], v12 offset:24576
    v_add_f32 v16, v16, v26
    v_add_f32 v17, v17, v27
    v_mfma_f32_16x16x32_bf16 v[180:183], v[80:83], v[126:129], v[180:183]
    ds_read_b64_tr_b16 v[118:119], v13 offset:24576
    v_lshlrev_b32 v24, 16, v148
    v_and_b32 v25, 0xffff0000, v148
    s_add_u32 m0, s26, 3072
    s_nop 0
    buffer_load_dwordx4 v5, s[8:11], s23 offen  lds
    v_mfma_f32_16x16x32_bf16 v[176:179], v[76:79], v[126:129], v[176:179]
    ds_read_b64_tr_b16 v[120:121], v14 offset:24576
    v_add_f32 v18, v18, v24
    v_add_f32 v19, v19, v25
    s_waitcnt lgkmcnt(13)
    v_mfma_f32_16x16x32_bf16 v[192:195], v[76:79], v[130:133], v[192:195]
    ds_read_b64_tr_b16 v[96:97], v9 offset:24608
    v_lshlrev_b32 v26, 16, v149
    s_add_u32 m0, s28, 73728
    s_xor_b32 s24, 3, s62
    s_mul_i32 s24, s24, 245760
    buffer_load_dwordx4 v6, s[12:15], s24 offen  lds
    v_mfma_f32_16x16x32_bf16 v[196:199], v[80:83], v[130:133], v[196:199]
    ds_read_b64_tr_b16 v[98:99], v9 offset:25888
    v_and_b32 v27, 0xffff0000, v149
    v_mfma_f32_16x16x32_bf16 v[200:203], v[84:87], v[130:133], v[200:203]
    s_waitcnt lgkmcnt(14)
    ds_read_b64_tr_b16 v[100:101], v9 offset:24640
    v_add_f32 v18, v18, v26
    s_add_u32 m0, s29, 73728
    s_nop 0
    buffer_load_dwordx4 v7, s[12:15], s24 offen  lds
    v_mfma_f32_16x16x32_bf16 v[204:207], v[88:91], v[130:133], v[204:207]
    s_waitcnt lgkmcnt(14)
    ds_read_b64_tr_b16 v[102:103], v9 offset:25920
    v_add_f32 v19, v19, v27
    v_mfma_f32_16x16x32_bf16 v[220:223], v[88:91], v[134:137], v[220:223]
    s_waitcnt lgkmcnt(14)
    ds_read_b64_tr_b16 v[104:105], v9 offset:24672
    v_lshlrev_b32 v24, 16, v150
    s_add_u32 m0, s30, 73728
    s_nop 0
    buffer_load_dwordx4 v8, s[12:15], s24 offen  lds
    v_mfma_f32_16x16x32_bf16 v[216:219], v[84:87], v[134:137], v[216:219]
    s_waitcnt lgkmcnt(14)
    ds_read_b64_tr_b16 v[106:107], v9 offset:25952
    v_and_b32 v25, 0xffff0000, v150
    v_mfma_f32_16x16x32_bf16 v[212:215], v[80:83], v[134:137], v[212:215]
    s_waitcnt lgkmcnt(14)
    ds_read_b64_tr_b16 v[108:109], v10 offset:24576
    v_add_f32 v20, v20, v24
    v_mfma_f32_16x16x32_bf16 v[208:211], v[76:79], v[134:137], v[208:211]
    s_waitcnt lgkmcnt(14)
    ds_read_b64_tr_b16 v[110:111], v10 offset:25856
    v_add_f32 v21, v21, v25
    v_mfma_f32_16x16x32_bf16 v[224:227], v[76:79], v[138:141], v[224:227]
    v_lshlrev_b32 v26, 16, v151
    v_mfma_f32_16x16x32_bf16 v[228:231], v[80:83], v[138:141], v[228:231]
    v_and_b32 v27, 0xffff0000, v151
    v_mfma_f32_16x16x32_bf16 v[232:235], v[84:87], v[138:141], v[232:235]
    v_add_f32 v20, v20, v26
    v_mfma_f32_16x16x32_bf16 v[236:239], v[88:91], v[138:141], v[236:239]
    v_add_f32 v21, v21, v27
    s_waitcnt lgkmcnt(14)
    v_mfma_f32_16x16x32_bf16 v[160:163], v[60:63], v[92:95], v[160:163]
    ds_read_b128 v[76:79], v157 offset:32768
    s_waitcnt lgkmcnt(14)
    ds_read_b64_tr_b16 v[122:123], v9 offset:34816
    v_mfma_f32_16x16x32_bf16 v[164:167], v[64:67], v[92:95], v[164:167]
    s_waitcnt lgkmcnt(14)
    ds_read_b64_tr_b16 v[124:125], v9 offset:36096
    v_mfma_f32_16x16x32_bf16 v[168:171], v[68:71], v[92:95], v[168:171]
    s_waitcnt lgkmcnt(14)
    ds_read_b128 v[80:83], v157 offset:34816
    s_waitcnt lgkmcnt(12)
    v_lshlrev_b32 v24, 16, v116
    v_and_b32 v25, 0xffff0000, v116
    v_mfma_f32_16x16x32_bf16 v[172:175], v[72:75], v[92:95], v[172:175]
    ds_read_b128 v[84:87], v157 offset:36864
    v_add_f32 v16, v16, v24
    v_add_f32 v17, v17, v25
    s_waitcnt lgkmcnt(11)
    v_mfma_f32_16x16x32_bf16 v[188:191], v[72:75], v[96:99], v[188:191]
    ds_read_b128 v[88:91], v157 offset:38912
    v_lshlrev_b32 v26, 16, v117
    v_and_b32 v27, 0xffff0000, v117
    v_mfma_f32_16x16x32_bf16 v[184:187], v[68:71], v[96:99], v[184:187]
    ds_read_b64_tr_b16 v[146:147], v12 offset:34816
    v_add_f32 v16, v16, v26
    v_add_f32 v17, v17, v27
    v_mfma_f32_16x16x32_bf16 v[180:183], v[64:67], v[96:99], v[180:183]
    ds_read_b64_tr_b16 v[148:149], v13 offset:34816
    v_lshlrev_b32 v24, 16, v118
    v_and_b32 v25, 0xffff0000, v118
    v_mfma_f32_16x16x32_bf16 v[176:179], v[60:63], v[96:99], v[176:179]
    ds_read_b64_tr_b16 v[150:151], v14 offset:34816
    v_add_f32 v18, v18, v24
    v_add_f32 v19, v19, v25
    s_waitcnt lgkmcnt(13)
    v_mfma_f32_16x16x32_bf16 v[192:195], v[60:63], v[100:103], v[192:195]
    ds_read_b64_tr_b16 v[126:127], v9 offset:34848
    v_lshlrev_b32 v26, 16, v119
    v_mfma_f32_16x16x32_bf16 v[196:199], v[64:67], v[100:103], v[196:199]
    ds_read_b64_tr_b16 v[128:129], v9 offset:36128
    v_and_b32 v27, 0xffff0000, v119
    v_mfma_f32_16x16x32_bf16 v[200:203], v[68:71], v[100:103], v[200:203]
    s_waitcnt lgkmcnt(14)
    ds_read_b64_tr_b16 v[130:131], v9 offset:34880
    v_add_f32 v18, v18, v26
    v_mfma_f32_16x16x32_bf16 v[204:207], v[72:75], v[100:103], v[204:207]
    s_waitcnt lgkmcnt(14)
    ds_read_b64_tr_b16 v[132:133], v9 offset:36160
    v_add_f32 v19, v19, v27
    v_mfma_f32_16x16x32_bf16 v[220:223], v[72:75], v[104:107], v[220:223]
    s_waitcnt lgkmcnt(14)
    ds_read_b64_tr_b16 v[134:135], v9 offset:34912
    v_lshlrev_b32 v24, 16, v120
    v_mfma_f32_16x16x32_bf16 v[216:219], v[68:71], v[104:107], v[216:219]
    s_waitcnt lgkmcnt(14)
    ds_read_b64_tr_b16 v[136:137], v9 offset:36192
    v_and_b32 v25, 0xffff0000, v120
    v_mfma_f32_16x16x32_bf16 v[212:215], v[64:67], v[104:107], v[212:215]
    s_waitcnt lgkmcnt(14)
    ds_read_b64_tr_b16 v[138:139], v10 offset:34816
    v_add_f32 v20, v20, v24
    v_mfma_f32_16x16x32_bf16 v[208:211], v[60:63], v[104:107], v[208:211]
    s_waitcnt lgkmcnt(14)
    ds_read_b64_tr_b16 v[140:141], v10 offset:36096
    v_add_f32 v21, v21, v25
    v_mfma_f32_16x16x32_bf16 v[224:227], v[60:63], v[108:111], v[224:227]
    v_lshlrev_b32 v26, 16, v121
    v_mfma_f32_16x16x32_bf16 v[228:231], v[64:67], v[108:111], v[228:231]
    v_and_b32 v27, 0xffff0000, v121
    v_mfma_f32_16x16x32_bf16 v[232:235], v[68:71], v[108:111], v[232:235]
    v_add_f32 v20, v20, v26
    v_mfma_f32_16x16x32_bf16 v[236:239], v[72:75], v[108:111], v[236:239]
    v_add_f32 v21, v21, v27
    s_waitcnt vmcnt(3) lgkmcnt(11)
    s_barrier
    v_add_u32 v9, 49152, v9
    v_add_u32 v10, 49152, v10
    v_add_u32 v12, 49152, v12
    v_add_u32 v13, 49152, v13
    v_add_u32 v14, 49152, v14
    v_mfma_f32_16x16x32_bf16 v[160:163], v[76:79], v[122:125], v[160:163]
    ds_read_b128 v[60:63], v156 offset:0
    ds_read_b64_tr_b16 v[92:93], v9 offset:0
    s_add_u32 m0, s26, 32768
    s_xor_b32 s23, 3, s62
    s_lshl_b32 s23, s23, 7
    buffer_load_dwordx4 v2, s[8:11], s23 offen  lds
    v_mfma_f32_16x16x32_bf16 v[164:167], v[80:83], v[122:125], v[164:167]
    ds_read_b64_tr_b16 v[94:95], v9 offset:1280
    v_mfma_f32_16x16x32_bf16 v[168:171], v[84:87], v[122:125], v[168:171]
    ds_read_b128 v[64:67], v156 offset:2048
    s_waitcnt lgkmcnt(12)
    v_lshlrev_b32 v24, 16, v146
    v_and_b32 v25, 0xffff0000, v146
    s_add_u32 m0, s26, 33792
    s_nop 0
    buffer_load_dwordx4 v3, s[8:11], s23 offen  lds
    v_mfma_f32_16x16x32_bf16 v[172:175], v[88:91], v[122:125], v[172:175]
    ds_read_b128 v[68:71], v156 offset:4096
    v_add_f32 v16, v16, v24
    v_add_f32 v17, v17, v25
    s_waitcnt lgkmcnt(11)
    v_mfma_f32_16x16x32_bf16 v[188:191], v[88:91], v[126:129], v[188:191]
    ds_read_b128 v[72:75], v156 offset:6144
    v_lshlrev_b32 v26, 16, v147
    v_and_b32 v27, 0xffff0000, v147
    s_add_u32 m0, s26, 34816
    s_nop 0
    buffer_load_dwordx4 v4, s[8:11], s23 offen  lds
    v_mfma_f32_16x16x32_bf16 v[184:187], v[84:87], v[126:129], v[184:187]
    ds_read_b64_tr_b16 v[116:117], v12 offset:0
    v_add_f32 v16, v16, v26
    v_add_f32 v17, v17, v27
    v_mfma_f32_16x16x32_bf16 v[180:183], v[80:83], v[126:129], v[180:183]
    ds_read_b64_tr_b16 v[118:119], v13 offset:0
    v_lshlrev_b32 v24, 16, v148
    v_and_b32 v25, 0xffff0000, v148
    s_add_u32 m0, s26, 35840
    s_nop 0
    buffer_load_dwordx4 v5, s[8:11], s23 offen  lds
    v_mfma_f32_16x16x32_bf16 v[176:179], v[76:79], v[126:129], v[176:179]
    ds_read_b64_tr_b16 v[120:121], v14 offset:0
    v_add_f32 v18, v18, v24
    v_add_f32 v19, v19, v25
    s_waitcnt lgkmcnt(13)
    v_mfma_f32_16x16x32_bf16 v[192:195], v[76:79], v[130:133], v[192:195]
    ds_read_b64_tr_b16 v[96:97], v9 offset:32
    v_lshlrev_b32 v26, 16, v149
    s_add_u32 m0, s28, 0
    s_xor_b32 s24, 4, s62
    s_mul_i32 s24, s24, 245760
    buffer_load_dwordx4 v6, s[12:15], s24 offen  lds
    v_mfma_f32_16x16x32_bf16 v[196:199], v[80:83], v[130:133], v[196:199]
    ds_read_b64_tr_b16 v[98:99], v9 offset:1312
    v_and_b32 v27, 0xffff0000, v149
    v_mfma_f32_16x16x32_bf16 v[200:203], v[84:87], v[130:133], v[200:203]
    s_waitcnt lgkmcnt(14)
    ds_read_b64_tr_b16 v[100:101], v9 offset:64
    v_add_f32 v18, v18, v26
    s_add_u32 m0, s29, 0
    s_nop 0
    buffer_load_dwordx4 v7, s[12:15], s24 offen  lds
    v_mfma_f32_16x16x32_bf16 v[204:207], v[88:91], v[130:133], v[204:207]
    s_waitcnt lgkmcnt(14)
    ds_read_b64_tr_b16 v[102:103], v9 offset:1344
    v_add_f32 v19, v19, v27
    v_mfma_f32_16x16x32_bf16 v[220:223], v[88:91], v[134:137], v[220:223]
    s_waitcnt lgkmcnt(14)
    ds_read_b64_tr_b16 v[104:105], v9 offset:96
    v_lshlrev_b32 v24, 16, v150
    s_add_u32 m0, s30, 0
    s_nop 0
    buffer_load_dwordx4 v8, s[12:15], s24 offen  lds
    v_mfma_f32_16x16x32_bf16 v[216:219], v[84:87], v[134:137], v[216:219]
    s_waitcnt lgkmcnt(14)
    ds_read_b64_tr_b16 v[106:107], v9 offset:1376
    v_and_b32 v25, 0xffff0000, v150
    v_mfma_f32_16x16x32_bf16 v[212:215], v[80:83], v[134:137], v[212:215]
    s_waitcnt lgkmcnt(14)
    ds_read_b64_tr_b16 v[108:109], v10 offset:0
    v_add_f32 v20, v20, v24
    v_mfma_f32_16x16x32_bf16 v[208:211], v[76:79], v[134:137], v[208:211]
    s_waitcnt lgkmcnt(14)
    ds_read_b64_tr_b16 v[110:111], v10 offset:1280
    v_add_f32 v21, v21, v25
    v_mfma_f32_16x16x32_bf16 v[224:227], v[76:79], v[138:141], v[224:227]
    v_lshlrev_b32 v26, 16, v151
    v_mfma_f32_16x16x32_bf16 v[228:231], v[80:83], v[138:141], v[228:231]
    v_and_b32 v27, 0xffff0000, v151
    v_mfma_f32_16x16x32_bf16 v[232:235], v[84:87], v[138:141], v[232:235]
    v_add_f32 v20, v20, v26
    v_mfma_f32_16x16x32_bf16 v[236:239], v[88:91], v[138:141], v[236:239]
    v_add_f32 v21, v21, v27
    s_waitcnt lgkmcnt(14)
    v_mfma_f32_16x16x32_bf16 v[160:163], v[60:63], v[92:95], v[160:163]
    ds_read_b128 v[76:79], v157 offset:0
    s_waitcnt lgkmcnt(14)
    ds_read_b64_tr_b16 v[122:123], v9 offset:10240
    v_mfma_f32_16x16x32_bf16 v[164:167], v[64:67], v[92:95], v[164:167]
    s_waitcnt lgkmcnt(14)
    ds_read_b64_tr_b16 v[124:125], v9 offset:11520
    v_mfma_f32_16x16x32_bf16 v[168:171], v[68:71], v[92:95], v[168:171]
    s_waitcnt lgkmcnt(14)
    ds_read_b128 v[80:83], v157 offset:2048
    s_waitcnt lgkmcnt(12)
    v_lshlrev_b32 v24, 16, v116
    v_and_b32 v25, 0xffff0000, v116
    v_mfma_f32_16x16x32_bf16 v[172:175], v[72:75], v[92:95], v[172:175]
    ds_read_b128 v[84:87], v157 offset:4096
    v_add_f32 v16, v16, v24
    v_add_f32 v17, v17, v25
    s_waitcnt lgkmcnt(11)
    v_mfma_f32_16x16x32_bf16 v[188:191], v[72:75], v[96:99], v[188:191]
    ds_read_b128 v[88:91], v157 offset:6144
    v_lshlrev_b32 v26, 16, v117
    v_and_b32 v27, 0xffff0000, v117
    v_mfma_f32_16x16x32_bf16 v[184:187], v[68:71], v[96:99], v[184:187]
    ds_read_b64_tr_b16 v[146:147], v12 offset:10240
    v_add_f32 v16, v16, v26
    v_add_f32 v17, v17, v27
    v_mfma_f32_16x16x32_bf16 v[180:183], v[64:67], v[96:99], v[180:183]
    ds_read_b64_tr_b16 v[148:149], v13 offset:10240
    v_lshlrev_b32 v24, 16, v118
    v_and_b32 v25, 0xffff0000, v118
    v_mfma_f32_16x16x32_bf16 v[176:179], v[60:63], v[96:99], v[176:179]
    ds_read_b64_tr_b16 v[150:151], v14 offset:10240
    v_add_f32 v18, v18, v24
    v_add_f32 v19, v19, v25
    s_waitcnt lgkmcnt(13)
    v_mfma_f32_16x16x32_bf16 v[192:195], v[60:63], v[100:103], v[192:195]
    ds_read_b64_tr_b16 v[126:127], v9 offset:10272
    v_lshlrev_b32 v26, 16, v119
    v_mfma_f32_16x16x32_bf16 v[196:199], v[64:67], v[100:103], v[196:199]
    ds_read_b64_tr_b16 v[128:129], v9 offset:11552
    v_and_b32 v27, 0xffff0000, v119
    v_mfma_f32_16x16x32_bf16 v[200:203], v[68:71], v[100:103], v[200:203]
    s_waitcnt lgkmcnt(14)
    ds_read_b64_tr_b16 v[130:131], v9 offset:10304
    v_add_f32 v18, v18, v26
    v_mfma_f32_16x16x32_bf16 v[204:207], v[72:75], v[100:103], v[204:207]
    s_waitcnt lgkmcnt(14)
    ds_read_b64_tr_b16 v[132:133], v9 offset:11584
    v_add_f32 v19, v19, v27
    v_mfma_f32_16x16x32_bf16 v[220:223], v[72:75], v[104:107], v[220:223]
    s_waitcnt lgkmcnt(14)
    ds_read_b64_tr_b16 v[134:135], v9 offset:10336
    v_lshlrev_b32 v24, 16, v120
    v_mfma_f32_16x16x32_bf16 v[216:219], v[68:71], v[104:107], v[216:219]
    s_waitcnt lgkmcnt(14)
    ds_read_b64_tr_b16 v[136:137], v9 offset:11616
    v_and_b32 v25, 0xffff0000, v120
    v_mfma_f32_16x16x32_bf16 v[212:215], v[64:67], v[104:107], v[212:215]
    s_waitcnt lgkmcnt(14)
    ds_read_b64_tr_b16 v[138:139], v10 offset:10240
    v_add_f32 v20, v20, v24
    v_mfma_f32_16x16x32_bf16 v[208:211], v[60:63], v[104:107], v[208:211]
    s_waitcnt lgkmcnt(14)
    ds_read_b64_tr_b16 v[140:141], v10 offset:11520
    v_add_f32 v21, v21, v25
    v_mfma_f32_16x16x32_bf16 v[224:227], v[60:63], v[108:111], v[224:227]
    v_lshlrev_b32 v26, 16, v121
    v_mfma_f32_16x16x32_bf16 v[228:231], v[64:67], v[108:111], v[228:231]
    v_and_b32 v27, 0xffff0000, v121
    v_mfma_f32_16x16x32_bf16 v[232:235], v[68:71], v[108:111], v[232:235]
    v_add_f32 v20, v20, v26
    v_mfma_f32_16x16x32_bf16 v[236:239], v[72:75], v[108:111], v[236:239]
    v_add_f32 v21, v21, v27
    s_waitcnt vmcnt(3) lgkmcnt(11)
    s_barrier
    v_mfma_f32_16x16x32_bf16 v[160:163], v[76:79], v[122:125], v[160:163]
    ds_read_b128 v[60:63], v156 offset:32768
    ds_read_b64_tr_b16 v[92:93], v9 offset:24576
    s_add_u32 m0, s26, 0
    s_xor_b32 s23, 4, s62
    s_lshl_b32 s23, s23, 7
    buffer_load_dwordx4 v2, s[8:11], s23 offen  lds
    v_mfma_f32_16x16x32_bf16 v[164:167], v[80:83], v[122:125], v[164:167]
    ds_read_b64_tr_b16 v[94:95], v9 offset:25856
    v_mfma_f32_16x16x32_bf16 v[168:171], v[84:87], v[122:125], v[168:171]
    ds_read_b128 v[64:67], v156 offset:34816
    s_waitcnt lgkmcnt(12)
    v_lshlrev_b32 v24, 16, v146
    v_and_b32 v25, 0xffff0000, v146
    s_add_u32 m0, s26, 1024
    s_nop 0
    buffer_load_dwordx4 v3, s[8:11], s23 offen  lds
    v_mfma_f32_16x16x32_bf16 v[172:175], v[88:91], v[122:125], v[172:175]
    ds_read_b128 v[68:71], v156 offset:36864
    v_add_f32 v16, v16, v24
    v_add_f32 v17, v17, v25
    s_waitcnt lgkmcnt(11)
    v_mfma_f32_16x16x32_bf16 v[188:191], v[88:91], v[126:129], v[188:191]
    ds_read_b128 v[72:75], v156 offset:38912
    v_lshlrev_b32 v26, 16, v147
    v_and_b32 v27, 0xffff0000, v147
    s_add_u32 m0, s26, 2048
    s_nop 0
    buffer_load_dwordx4 v4, s[8:11], s23 offen  lds
    v_mfma_f32_16x16x32_bf16 v[184:187], v[84:87], v[126:129], v[184:187]
    ds_read_b64_tr_b16 v[116:117], v12 offset:24576
    v_add_f32 v16, v16, v26
    v_add_f32 v17, v17, v27
    v_mfma_f32_16x16x32_bf16 v[180:183], v[80:83], v[126:129], v[180:183]
    ds_read_b64_tr_b16 v[118:119], v13 offset:24576
    v_lshlrev_b32 v24, 16, v148
    v_and_b32 v25, 0xffff0000, v148
    s_add_u32 m0, s26, 3072
    s_nop 0
    buffer_load_dwordx4 v5, s[8:11], s23 offen  lds
    v_mfma_f32_16x16x32_bf16 v[176:179], v[76:79], v[126:129], v[176:179]
    ds_read_b64_tr_b16 v[120:121], v14 offset:24576
    v_add_f32 v18, v18, v24
    v_add_f32 v19, v19, v25
    s_waitcnt lgkmcnt(13)
    v_mfma_f32_16x16x32_bf16 v[192:195], v[76:79], v[130:133], v[192:195]
    ds_read_b64_tr_b16 v[96:97], v9 offset:24608
    v_lshlrev_b32 v26, 16, v149
    s_add_u32 m0, s28, 24576
    s_xor_b32 s24, 5, s62
    s_mul_i32 s24, s24, 245760
    buffer_load_dwordx4 v6, s[12:15], s24 offen  lds
    v_mfma_f32_16x16x32_bf16 v[196:199], v[80:83], v[130:133], v[196:199]
    ds_read_b64_tr_b16 v[98:99], v9 offset:25888
    v_and_b32 v27, 0xffff0000, v149
    v_mfma_f32_16x16x32_bf16 v[200:203], v[84:87], v[130:133], v[200:203]
    s_waitcnt lgkmcnt(14)
    ds_read_b64_tr_b16 v[100:101], v9 offset:24640
    v_add_f32 v18, v18, v26
    s_add_u32 m0, s29, 24576
    s_nop 0
    buffer_load_dwordx4 v7, s[12:15], s24 offen  lds
    v_mfma_f32_16x16x32_bf16 v[204:207], v[88:91], v[130:133], v[204:207]
    s_waitcnt lgkmcnt(14)
    ds_read_b64_tr_b16 v[102:103], v9 offset:25920
    v_add_f32 v19, v19, v27
    v_mfma_f32_16x16x32_bf16 v[220:223], v[88:91], v[134:137], v[220:223]
    s_waitcnt lgkmcnt(14)
    ds_read_b64_tr_b16 v[104:105], v9 offset:24672
    v_lshlrev_b32 v24, 16, v150
    s_add_u32 m0, s30, 24576
    s_nop 0
    buffer_load_dwordx4 v8, s[12:15], s24 offen  lds
    v_mfma_f32_16x16x32_bf16 v[216:219], v[84:87], v[134:137], v[216:219]
    s_waitcnt lgkmcnt(14)
    ds_read_b64_tr_b16 v[106:107], v9 offset:25952
    v_and_b32 v25, 0xffff0000, v150
    v_mfma_f32_16x16x32_bf16 v[212:215], v[80:83], v[134:137], v[212:215]
    s_waitcnt lgkmcnt(14)
    ds_read_b64_tr_b16 v[108:109], v10 offset:24576
    v_add_f32 v20, v20, v24
    v_mfma_f32_16x16x32_bf16 v[208:211], v[76:79], v[134:137], v[208:211]
    s_waitcnt lgkmcnt(14)
    ds_read_b64_tr_b16 v[110:111], v10 offset:25856
    v_add_f32 v21, v21, v25
    v_mfma_f32_16x16x32_bf16 v[224:227], v[76:79], v[138:141], v[224:227]
    v_lshlrev_b32 v26, 16, v151
    v_mfma_f32_16x16x32_bf16 v[228:231], v[80:83], v[138:141], v[228:231]
    v_and_b32 v27, 0xffff0000, v151
    v_mfma_f32_16x16x32_bf16 v[232:235], v[84:87], v[138:141], v[232:235]
    v_add_f32 v20, v20, v26
    v_mfma_f32_16x16x32_bf16 v[236:239], v[88:91], v[138:141], v[236:239]
    v_add_f32 v21, v21, v27
    s_waitcnt lgkmcnt(14)
    v_mfma_f32_16x16x32_bf16 v[160:163], v[60:63], v[92:95], v[160:163]
    ds_read_b128 v[76:79], v157 offset:32768
    s_waitcnt lgkmcnt(14)
    ds_read_b64_tr_b16 v[122:123], v9 offset:34816
    v_mfma_f32_16x16x32_bf16 v[164:167], v[64:67], v[92:95], v[164:167]
    s_waitcnt lgkmcnt(14)
    ds_read_b64_tr_b16 v[124:125], v9 offset:36096
    v_mfma_f32_16x16x32_bf16 v[168:171], v[68:71], v[92:95], v[168:171]
    s_waitcnt lgkmcnt(14)
    ds_read_b128 v[80:83], v157 offset:34816
    s_waitcnt lgkmcnt(12)
    v_lshlrev_b32 v24, 16, v116
    v_and_b32 v25, 0xffff0000, v116
    v_mfma_f32_16x16x32_bf16 v[172:175], v[72:75], v[92:95], v[172:175]
    ds_read_b128 v[84:87], v157 offset:36864
    v_add_f32 v16, v16, v24
    v_add_f32 v17, v17, v25
    s_waitcnt lgkmcnt(11)
    v_mfma_f32_16x16x32_bf16 v[188:191], v[72:75], v[96:99], v[188:191]
    ds_read_b128 v[88:91], v157 offset:38912
    v_lshlrev_b32 v26, 16, v117
    v_and_b32 v27, 0xffff0000, v117
    v_mfma_f32_16x16x32_bf16 v[184:187], v[68:71], v[96:99], v[184:187]
    ds_read_b64_tr_b16 v[146:147], v12 offset:34816
    v_add_f32 v16, v16, v26
    v_add_f32 v17, v17, v27
    v_mfma_f32_16x16x32_bf16 v[180:183], v[64:67], v[96:99], v[180:183]
    ds_read_b64_tr_b16 v[148:149], v13 offset:34816
    v_lshlrev_b32 v24, 16, v118
    v_and_b32 v25, 0xffff0000, v118
    v_mfma_f32_16x16x32_bf16 v[176:179], v[60:63], v[96:99], v[176:179]
    ds_read_b64_tr_b16 v[150:151], v14 offset:34816
    v_add_f32 v18, v18, v24
    v_add_f32 v19, v19, v25
    s_waitcnt lgkmcnt(13)
    v_mfma_f32_16x16x32_bf16 v[192:195], v[60:63], v[100:103], v[192:195]
    ds_read_b64_tr_b16 v[126:127], v9 offset:34848
    v_lshlrev_b32 v26, 16, v119
    v_mfma_f32_16x16x32_bf16 v[196:199], v[64:67], v[100:103], v[196:199]
    ds_read_b64_tr_b16 v[128:129], v9 offset:36128
    v_and_b32 v27, 0xffff0000, v119
    v_mfma_f32_16x16x32_bf16 v[200:203], v[68:71], v[100:103], v[200:203]
    s_waitcnt lgkmcnt(14)
    ds_read_b64_tr_b16 v[130:131], v9 offset:34880
    v_add_f32 v18, v18, v26
    v_mfma_f32_16x16x32_bf16 v[204:207], v[72:75], v[100:103], v[204:207]
    s_waitcnt lgkmcnt(14)
    ds_read_b64_tr_b16 v[132:133], v9 offset:36160
    v_add_f32 v19, v19, v27
    v_mfma_f32_16x16x32_bf16 v[220:223], v[72:75], v[104:107], v[220:223]
    s_waitcnt lgkmcnt(14)
    ds_read_b64_tr_b16 v[134:135], v9 offset:34912
    v_lshlrev_b32 v24, 16, v120
    v_mfma_f32_16x16x32_bf16 v[216:219], v[68:71], v[104:107], v[216:219]
    s_waitcnt lgkmcnt(14)
    ds_read_b64_tr_b16 v[136:137], v9 offset:36192
    v_and_b32 v25, 0xffff0000, v120
    v_mfma_f32_16x16x32_bf16 v[212:215], v[64:67], v[104:107], v[212:215]
    s_waitcnt lgkmcnt(14)
    ds_read_b64_tr_b16 v[138:139], v10 offset:34816
    v_add_f32 v20, v20, v24
    v_mfma_f32_16x16x32_bf16 v[208:211], v[60:63], v[104:107], v[208:211]
    s_waitcnt lgkmcnt(14)
    ds_read_b64_tr_b16 v[140:141], v10 offset:36096
    v_add_f32 v21, v21, v25
    v_mfma_f32_16x16x32_bf16 v[224:227], v[60:63], v[108:111], v[224:227]
    v_lshlrev_b32 v26, 16, v121
    v_mfma_f32_16x16x32_bf16 v[228:231], v[64:67], v[108:111], v[228:231]
    v_and_b32 v27, 0xffff0000, v121
    v_mfma_f32_16x16x32_bf16 v[232:235], v[68:71], v[108:111], v[232:235]
    v_add_f32 v20, v20, v26
    v_mfma_f32_16x16x32_bf16 v[236:239], v[72:75], v[108:111], v[236:239]
    v_add_f32 v21, v21, v27
    s_waitcnt vmcnt(3) lgkmcnt(11)
    s_barrier
    v_subrev_u32 v9, 49152, v9
    v_subrev_u32 v10, 49152, v10
    v_subrev_u32 v12, 49152, v12
    v_subrev_u32 v13, 49152, v13
    v_subrev_u32 v14, 49152, v14
    v_mfma_f32_16x16x32_bf16 v[160:163], v[76:79], v[122:125], v[160:163]
    ds_read_b128 v[60:63], v156 offset:0
    ds_read_b64_tr_b16 v[92:93], v9 offset:0
    s_add_u32 m0, s26, 32768
    s_xor_b32 s23, 5, s62
    s_lshl_b32 s23, s23, 7
    buffer_load_dwordx4 v2, s[8:11], s23 offen  lds
    v_mfma_f32_16x16x32_bf16 v[164:167], v[80:83], v[122:125], v[164:167]
    ds_read_b64_tr_b16 v[94:95], v9 offset:1280
    v_mfma_f32_16x16x32_bf16 v[168:171], v[84:87], v[122:125], v[168:171]
    ds_read_b128 v[64:67], v156 offset:2048
    s_waitcnt lgkmcnt(12)
    v_lshlrev_b32 v24, 16, v146
    v_and_b32 v25, 0xffff0000, v146
    s_add_u32 m0, s26, 33792
    s_nop 0
    buffer_load_dwordx4 v3, s[8:11], s23 offen  lds
    v_mfma_f32_16x16x32_bf16 v[172:175], v[88:91], v[122:125], v[172:175]
    ds_read_b128 v[68:71], v156 offset:4096
    v_add_f32 v16, v16, v24
    v_add_f32 v17, v17, v25
    s_waitcnt lgkmcnt(11)
    v_mfma_f32_16x16x32_bf16 v[188:191], v[88:91], v[126:129], v[188:191]
    ds_read_b128 v[72:75], v156 offset:6144
    v_lshlrev_b32 v26, 16, v147
    v_and_b32 v27, 0xffff0000, v147
    s_add_u32 m0, s26, 34816
    s_nop 0
    buffer_load_dwordx4 v4, s[8:11], s23 offen  lds
    v_mfma_f32_16x16x32_bf16 v[184:187], v[84:87], v[126:129], v[184:187]
    ds_read_b64_tr_b16 v[116:117], v12 offset:0
    v_add_f32 v16, v16, v26
    v_add_f32 v17, v17, v27
    v_mfma_f32_16x16x32_bf16 v[180:183], v[80:83], v[126:129], v[180:183]
    ds_read_b64_tr_b16 v[118:119], v13 offset:0
    v_lshlrev_b32 v24, 16, v148
    v_and_b32 v25, 0xffff0000, v148
    s_add_u32 m0, s26, 35840
    s_nop 0
    buffer_load_dwordx4 v5, s[8:11], s23 offen  lds
    v_mfma_f32_16x16x32_bf16 v[176:179], v[76:79], v[126:129], v[176:179]
    ds_read_b64_tr_b16 v[120:121], v14 offset:0
    v_add_f32 v18, v18, v24
    v_add_f32 v19, v19, v25
    s_waitcnt lgkmcnt(13)
    v_mfma_f32_16x16x32_bf16 v[192:195], v[76:79], v[130:133], v[192:195]
    ds_read_b64_tr_b16 v[96:97], v9 offset:32
    v_lshlrev_b32 v26, 16, v149
    s_add_u32 m0, s28, 49152
    s_xor_b32 s24, 6, s62
    s_mul_i32 s24, s24, 245760
    buffer_load_dwordx4 v6, s[12:15], s24 offen  lds
    v_mfma_f32_16x16x32_bf16 v[196:199], v[80:83], v[130:133], v[196:199]
    ds_read_b64_tr_b16 v[98:99], v9 offset:1312
    v_and_b32 v27, 0xffff0000, v149
    v_mfma_f32_16x16x32_bf16 v[200:203], v[84:87], v[130:133], v[200:203]
    s_waitcnt lgkmcnt(14)
    ds_read_b64_tr_b16 v[100:101], v9 offset:64
    v_add_f32 v18, v18, v26
    s_add_u32 m0, s29, 49152
    s_nop 0
    buffer_load_dwordx4 v7, s[12:15], s24 offen  lds
    v_mfma_f32_16x16x32_bf16 v[204:207], v[88:91], v[130:133], v[204:207]
    s_waitcnt lgkmcnt(14)
    ds_read_b64_tr_b16 v[102:103], v9 offset:1344
    v_add_f32 v19, v19, v27
    v_mfma_f32_16x16x32_bf16 v[220:223], v[88:91], v[134:137], v[220:223]
    s_waitcnt lgkmcnt(14)
    ds_read_b64_tr_b16 v[104:105], v9 offset:96
    v_lshlrev_b32 v24, 16, v150
    s_add_u32 m0, s30, 49152
    s_nop 0
    buffer_load_dwordx4 v8, s[12:15], s24 offen  lds
    v_mfma_f32_16x16x32_bf16 v[216:219], v[84:87], v[134:137], v[216:219]
    s_waitcnt lgkmcnt(14)
    ds_read_b64_tr_b16 v[106:107], v9 offset:1376
    v_and_b32 v25, 0xffff0000, v150
    v_mfma_f32_16x16x32_bf16 v[212:215], v[80:83], v[134:137], v[212:215]
    s_waitcnt lgkmcnt(14)
    ds_read_b64_tr_b16 v[108:109], v10 offset:0
    v_add_f32 v20, v20, v24
    v_mfma_f32_16x16x32_bf16 v[208:211], v[76:79], v[134:137], v[208:211]
    s_waitcnt lgkmcnt(14)
    ds_read_b64_tr_b16 v[110:111], v10 offset:1280
    v_add_f32 v21, v21, v25
    v_mfma_f32_16x16x32_bf16 v[224:227], v[76:79], v[138:141], v[224:227]
    v_lshlrev_b32 v26, 16, v151
    v_mfma_f32_16x16x32_bf16 v[228:231], v[80:83], v[138:141], v[228:231]
    v_and_b32 v27, 0xffff0000, v151
    v_mfma_f32_16x16x32_bf16 v[232:235], v[84:87], v[138:141], v[232:235]
    v_add_f32 v20, v20, v26
    v_mfma_f32_16x16x32_bf16 v[236:239], v[88:91], v[138:141], v[236:239]
    v_add_f32 v21, v21, v27
    s_waitcnt lgkmcnt(14)
    v_mfma_f32_16x16x32_bf16 v[160:163], v[60:63], v[92:95], v[160:163]
    ds_read_b128 v[76:79], v157 offset:0
    s_waitcnt lgkmcnt(14)
    ds_read_b64_tr_b16 v[122:123], v9 offset:10240
    v_mfma_f32_16x16x32_bf16 v[164:167], v[64:67], v[92:95], v[164:167]
    s_waitcnt lgkmcnt(14)
    ds_read_b64_tr_b16 v[124:125], v9 offset:11520
    v_mfma_f32_16x16x32_bf16 v[168:171], v[68:71], v[92:95], v[168:171]
    s_waitcnt lgkmcnt(14)
    ds_read_b128 v[80:83], v157 offset:2048
    s_waitcnt lgkmcnt(12)
    v_lshlrev_b32 v24, 16, v116
    v_and_b32 v25, 0xffff0000, v116
    v_mfma_f32_16x16x32_bf16 v[172:175], v[72:75], v[92:95], v[172:175]
    ds_read_b128 v[84:87], v157 offset:4096
    v_add_f32 v16, v16, v24
    v_add_f32 v17, v17, v25
    s_waitcnt lgkmcnt(11)
    v_mfma_f32_16x16x32_bf16 v[188:191], v[72:75], v[96:99], v[188:191]
    ds_read_b128 v[88:91], v157 offset:6144
    v_lshlrev_b32 v26, 16, v117
    v_and_b32 v27, 0xffff0000, v117
    v_mfma_f32_16x16x32_bf16 v[184:187], v[68:71], v[96:99], v[184:187]
    ds_read_b64_tr_b16 v[146:147], v12 offset:10240
    v_add_f32 v16, v16, v26
    v_add_f32 v17, v17, v27
    v_mfma_f32_16x16x32_bf16 v[180:183], v[64:67], v[96:99], v[180:183]
    ds_read_b64_tr_b16 v[148:149], v13 offset:10240
    v_lshlrev_b32 v24, 16, v118
    v_and_b32 v25, 0xffff0000, v118
    v_mfma_f32_16x16x32_bf16 v[176:179], v[60:63], v[96:99], v[176:179]
    ds_read_b64_tr_b16 v[150:151], v14 offset:10240
    v_add_f32 v18, v18, v24
    v_add_f32 v19, v19, v25
    s_waitcnt lgkmcnt(13)
    v_mfma_f32_16x16x32_bf16 v[192:195], v[60:63], v[100:103], v[192:195]
    ds_read_b64_tr_b16 v[126:127], v9 offset:10272
    v_lshlrev_b32 v26, 16, v119
    v_mfma_f32_16x16x32_bf16 v[196:199], v[64:67], v[100:103], v[196:199]
    ds_read_b64_tr_b16 v[128:129], v9 offset:11552
    v_and_b32 v27, 0xffff0000, v119
    v_mfma_f32_16x16x32_bf16 v[200:203], v[68:71], v[100:103], v[200:203]
    s_waitcnt lgkmcnt(14)
    ds_read_b64_tr_b16 v[130:131], v9 offset:10304
    v_add_f32 v18, v18, v26
    v_mfma_f32_16x16x32_bf16 v[204:207], v[72:75], v[100:103], v[204:207]
    s_waitcnt lgkmcnt(14)
    ds_read_b64_tr_b16 v[132:133], v9 offset:11584
    v_add_f32 v19, v19, v27
    v_mfma_f32_16x16x32_bf16 v[220:223], v[72:75], v[104:107], v[220:223]
    s_waitcnt lgkmcnt(14)
    ds_read_b64_tr_b16 v[134:135], v9 offset:10336
    v_lshlrev_b32 v24, 16, v120
    v_mfma_f32_16x16x32_bf16 v[216:219], v[68:71], v[104:107], v[216:219]
    s_waitcnt lgkmcnt(14)
    ds_read_b64_tr_b16 v[136:137], v9 offset:11616
    v_and_b32 v25, 0xffff0000, v120
    v_mfma_f32_16x16x32_bf16 v[212:215], v[64:67], v[104:107], v[212:215]
    s_waitcnt lgkmcnt(14)
    ds_read_b64_tr_b16 v[138:139], v10 offset:10240
    v_add_f32 v20, v20, v24
    v_mfma_f32_16x16x32_bf16 v[208:211], v[60:63], v[104:107], v[208:211]
    s_waitcnt lgkmcnt(14)
    ds_read_b64_tr_b16 v[140:141], v10 offset:11520
    v_add_f32 v21, v21, v25
    v_mfma_f32_16x16x32_bf16 v[224:227], v[60:63], v[108:111], v[224:227]
    v_lshlrev_b32 v26, 16, v121
    v_mfma_f32_16x16x32_bf16 v[228:231], v[64:67], v[108:111], v[228:231]
    v_and_b32 v27, 0xffff0000, v121
    v_mfma_f32_16x16x32_bf16 v[232:235], v[68:71], v[108:111], v[232:235]
    v_add_f32 v20, v20, v26
    v_mfma_f32_16x16x32_bf16 v[236:239], v[72:75], v[108:111], v[236:239]
    v_add_f32 v21, v21, v27
    s_waitcnt vmcnt(3) lgkmcnt(11)
    s_barrier
    v_mfma_f32_16x16x32_bf16 v[160:163], v[76:79], v[122:125], v[160:163]
    ds_read_b128 v[60:63], v156 offset:32768
    ds_read_b64_tr_b16 v[92:93], v9 offset:24576
    s_add_u32 m0, s26, 0
    s_xor_b32 s23, 6, s62
    s_lshl_b32 s23, s23, 7
    buffer_load_dwordx4 v2, s[8:11], s23 offen  lds
    v_mfma_f32_16x16x32_bf16 v[164:167], v[80:83], v[122:125], v[164:167]
    ds_read_b64_tr_b16 v[94:95], v9 offset:25856
    v_mfma_f32_16x16x32_bf16 v[168:171], v[84:87], v[122:125], v[168:171]
    ds_read_b128 v[64:67], v156 offset:34816
    s_waitcnt lgkmcnt(12)
    v_lshlrev_b32 v24, 16, v146
    v_and_b32 v25, 0xffff0000, v146
    s_add_u32 m0, s26, 1024
    s_nop 0
    buffer_load_dwordx4 v3, s[8:11], s23 offen  lds
    v_mfma_f32_16x16x32_bf16 v[172:175], v[88:91], v[122:125], v[172:175]
    ds_read_b128 v[68:71], v156 offset:36864
    v_add_f32 v16, v16, v24
    v_add_f32 v17, v17, v25
    s_waitcnt lgkmcnt(11)
    v_mfma_f32_16x16x32_bf16 v[188:191], v[88:91], v[126:129], v[188:191]
    ds_read_b128 v[72:75], v156 offset:38912
    v_lshlrev_b32 v26, 16, v147
    v_and_b32 v27, 0xffff0000, v147
    s_add_u32 m0, s26, 2048
    s_nop 0
    buffer_load_dwordx4 v4, s[8:11], s23 offen  lds
    v_mfma_f32_16x16x32_bf16 v[184:187], v[84:87], v[126:129], v[184:187]
    ds_read_b64_tr_b16 v[116:117], v12 offset:24576
    v_add_f32 v16, v16, v26
    v_add_f32 v17, v17, v27
    v_mfma_f32_16x16x32_bf16 v[180:183], v[80:83], v[126:129], v[180:183]
    ds_read_b64_tr_b16 v[118:119], v13 offset:24576
    v_lshlrev_b32 v24, 16, v148
    v_and_b32 v25, 0xffff0000, v148
    s_add_u32 m0, s26, 3072
    s_nop 0
    buffer_load_dwordx4 v5, s[8:11], s23 offen  lds
    v_mfma_f32_16x16x32_bf16 v[176:179], v[76:79], v[126:129], v[176:179]
    ds_read_b64_tr_b16 v[120:121], v14 offset:24576
    v_add_f32 v18, v18, v24
    v_add_f32 v19, v19, v25
    s_waitcnt lgkmcnt(13)
    v_mfma_f32_16x16x32_bf16 v[192:195], v[76:79], v[130:133], v[192:195]
    ds_read_b64_tr_b16 v[96:97], v9 offset:24608
    v_lshlrev_b32 v26, 16, v149
    s_add_u32 m0, s28, 73728
    s_xor_b32 s24, 7, s62
    s_mul_i32 s24, s24, 245760
    buffer_load_dwordx4 v6, s[12:15], s24 offen  lds
    v_mfma_f32_16x16x32_bf16 v[196:199], v[80:83], v[130:133], v[196:199]
    ds_read_b64_tr_b16 v[98:99], v9 offset:25888
    v_and_b32 v27, 0xffff0000, v149
    v_mfma_f32_16x16x32_bf16 v[200:203], v[84:87], v[130:133], v[200:203]
    s_waitcnt lgkmcnt(14)
    ds_read_b64_tr_b16 v[100:101], v9 offset:24640
    v_add_f32 v18, v18, v26
    s_add_u32 m0, s29, 73728
    s_nop 0
    buffer_load_dwordx4 v7, s[12:15], s24 offen  lds
    v_mfma_f32_16x16x32_bf16 v[204:207], v[88:91], v[130:133], v[204:207]
    s_waitcnt lgkmcnt(14)
    ds_read_b64_tr_b16 v[102:103], v9 offset:25920
    v_add_f32 v19, v19, v27
    v_mfma_f32_16x16x32_bf16 v[220:223], v[88:91], v[134:137], v[220:223]
    s_waitcnt lgkmcnt(14)
    ds_read_b64_tr_b16 v[104:105], v9 offset:24672
    v_lshlrev_b32 v24, 16, v150
    s_add_u32 m0, s30, 73728
    s_nop 0
    buffer_load_dwordx4 v8, s[12:15], s24 offen  lds
    v_mfma_f32_16x16x32_bf16 v[216:219], v[84:87], v[134:137], v[216:219]
    s_waitcnt lgkmcnt(14)
    ds_read_b64_tr_b16 v[106:107], v9 offset:25952
    v_and_b32 v25, 0xffff0000, v150
    v_mfma_f32_16x16x32_bf16 v[212:215], v[80:83], v[134:137], v[212:215]
    s_waitcnt lgkmcnt(14)
    ds_read_b64_tr_b16 v[108:109], v10 offset:24576
    v_add_f32 v20, v20, v24
    v_mfma_f32_16x16x32_bf16 v[208:211], v[76:79], v[134:137], v[208:211]
    s_waitcnt lgkmcnt(14)
    ds_read_b64_tr_b16 v[110:111], v10 offset:25856
    v_add_f32 v21, v21, v25
    v_mfma_f32_16x16x32_bf16 v[224:227], v[76:79], v[138:141], v[224:227]
    v_lshlrev_b32 v26, 16, v151
    v_mfma_f32_16x16x32_bf16 v[228:231], v[80:83], v[138:141], v[228:231]
    v_and_b32 v27, 0xffff0000, v151
    v_mfma_f32_16x16x32_bf16 v[232:235], v[84:87], v[138:141], v[232:235]
    v_add_f32 v20, v20, v26
    v_mfma_f32_16x16x32_bf16 v[236:239], v[88:91], v[138:141], v[236:239]
    v_add_f32 v21, v21, v27
    s_waitcnt lgkmcnt(14)
    v_mfma_f32_16x16x32_bf16 v[160:163], v[60:63], v[92:95], v[160:163]
    ds_read_b128 v[76:79], v157 offset:32768
    s_waitcnt lgkmcnt(14)
    ds_read_b64_tr_b16 v[122:123], v9 offset:34816
    v_mfma_f32_16x16x32_bf16 v[164:167], v[64:67], v[92:95], v[164:167]
    s_waitcnt lgkmcnt(14)
    ds_read_b64_tr_b16 v[124:125], v9 offset:36096
    v_mfma_f32_16x16x32_bf16 v[168:171], v[68:71], v[92:95], v[168:171]
    s_waitcnt lgkmcnt(14)
    ds_read_b128 v[80:83], v157 offset:34816
    s_waitcnt lgkmcnt(12)
    v_lshlrev_b32 v24, 16, v116
    v_and_b32 v25, 0xffff0000, v116
    v_mfma_f32_16x16x32_bf16 v[172:175], v[72:75], v[92:95], v[172:175]
    ds_read_b128 v[84:87], v157 offset:36864
    v_add_f32 v16, v16, v24
    v_add_f32 v17, v17, v25
    s_waitcnt lgkmcnt(11)
    v_mfma_f32_16x16x32_bf16 v[188:191], v[72:75], v[96:99], v[188:191]
    ds_read_b128 v[88:91], v157 offset:38912
    v_lshlrev_b32 v26, 16, v117
    v_and_b32 v27, 0xffff0000, v117
    v_mfma_f32_16x16x32_bf16 v[184:187], v[68:71], v[96:99], v[184:187]
    ds_read_b64_tr_b16 v[146:147], v12 offset:34816
    v_add_f32 v16, v16, v26
    v_add_f32 v17, v17, v27
    v_mfma_f32_16x16x32_bf16 v[180:183], v[64:67], v[96:99], v[180:183]
    ds_read_b64_tr_b16 v[148:149], v13 offset:34816
    v_lshlrev_b32 v24, 16, v118
    v_and_b32 v25, 0xffff0000, v118
    v_mfma_f32_16x16x32_bf16 v[176:179], v[60:63], v[96:99], v[176:179]
    ds_read_b64_tr_b16 v[150:151], v14 offset:34816
    v_add_f32 v18, v18, v24
    v_add_f32 v19, v19, v25
    s_waitcnt lgkmcnt(13)
    v_mfma_f32_16x16x32_bf16 v[192:195], v[60:63], v[100:103], v[192:195]
    ds_read_b64_tr_b16 v[126:127], v9 offset:34848
    v_lshlrev_b32 v26, 16, v119
    v_mfma_f32_16x16x32_bf16 v[196:199], v[64:67], v[100:103], v[196:199]
    ds_read_b64_tr_b16 v[128:129], v9 offset:36128
    v_and_b32 v27, 0xffff0000, v119
    v_mfma_f32_16x16x32_bf16 v[200:203], v[68:71], v[100:103], v[200:203]
    s_waitcnt lgkmcnt(14)
    ds_read_b64_tr_b16 v[130:131], v9 offset:34880
    v_add_f32 v18, v18, v26
    v_mfma_f32_16x16x32_bf16 v[204:207], v[72:75], v[100:103], v[204:207]
    s_waitcnt lgkmcnt(14)
    ds_read_b64_tr_b16 v[132:133], v9 offset:36160
    v_add_f32 v19, v19, v27
    v_mfma_f32_16x16x32_bf16 v[220:223], v[72:75], v[104:107], v[220:223]
    s_waitcnt lgkmcnt(14)
    ds_read_b64_tr_b16 v[134:135], v9 offset:34912
    v_lshlrev_b32 v24, 16, v120
    v_mfma_f32_16x16x32_bf16 v[216:219], v[68:71], v[104:107], v[216:219]
    s_waitcnt lgkmcnt(14)
    ds_read_b64_tr_b16 v[136:137], v9 offset:36192
    v_and_b32 v25, 0xffff0000, v120
    v_mfma_f32_16x16x32_bf16 v[212:215], v[64:67], v[104:107], v[212:215]
    s_waitcnt lgkmcnt(14)
    ds_read_b64_tr_b16 v[138:139], v10 offset:34816
    v_add_f32 v20, v20, v24
    v_mfma_f32_16x16x32_bf16 v[208:211], v[60:63], v[104:107], v[208:211]
    s_waitcnt lgkmcnt(14)
    ds_read_b64_tr_b16 v[140:141], v10 offset:36096
    v_add_f32 v21, v21, v25
    v_mfma_f32_16x16x32_bf16 v[224:227], v[60:63], v[108:111], v[224:227]
    v_lshlrev_b32 v26, 16, v121
    v_mfma_f32_16x16x32_bf16 v[228:231], v[64:67], v[108:111], v[228:231]
    v_and_b32 v27, 0xffff0000, v121
    v_mfma_f32_16x16x32_bf16 v[232:235], v[68:71], v[108:111], v[232:235]
    v_add_f32 v20, v20, v26
    v_mfma_f32_16x16x32_bf16 v[236:239], v[72:75], v[108:111], v[236:239]
    v_add_f32 v21, v21, v27
    s_waitcnt vmcnt(3) lgkmcnt(11)
    s_barrier
    v_add_u32 v9, 49152, v9
    v_add_u32 v10, 49152, v10
    v_add_u32 v12, 49152, v12
    v_add_u32 v13, 49152, v13
    v_add_u32 v14, 49152, v14
    v_mfma_f32_16x16x32_bf16 v[160:163], v[76:79], v[122:125], v[160:163]
    ds_read_b128 v[60:63], v156 offset:0
    ds_read_b64_tr_b16 v[92:93], v9 offset:0
    s_add_u32 m0, s26, 32768
    s_xor_b32 s23, 7, s62
    s_lshl_b32 s23, s23, 7
    buffer_load_dwordx4 v2, s[8:11], s23 offen  lds
    v_mfma_f32_16x16x32_bf16 v[164:167], v[80:83], v[122:125], v[164:167]
    ds_read_b64_tr_b16 v[94:95], v9 offset:1280
    v_mfma_f32_16x16x32_bf16 v[168:171], v[84:87], v[122:125], v[168:171]
    ds_read_b128 v[64:67], v156 offset:2048
    s_waitcnt lgkmcnt(12)
    v_lshlrev_b32 v24, 16, v146
    v_and_b32 v25, 0xffff0000, v146
    s_add_u32 m0, s26, 33792
    s_nop 0
    buffer_load_dwordx4 v3, s[8:11], s23 offen  lds
    v_mfma_f32_16x16x32_bf16 v[172:175], v[88:91], v[122:125], v[172:175]
    ds_read_b128 v[68:71], v156 offset:4096
    v_add_f32 v16, v16, v24
    v_add_f32 v17, v17, v25
    s_waitcnt lgkmcnt(11)
    v_mfma_f32_16x16x32_bf16 v[188:191], v[88:91], v[126:129], v[188:191]
    ds_read_b128 v[72:75], v156 offset:6144
    v_lshlrev_b32 v26, 16, v147
    v_and_b32 v27, 0xffff0000, v147
    s_add_u32 m0, s26, 34816
    s_nop 0
    buffer_load_dwordx4 v4, s[8:11], s23 offen  lds
    v_mfma_f32_16x16x32_bf16 v[184:187], v[84:87], v[126:129], v[184:187]
    ds_read_b64_tr_b16 v[116:117], v12 offset:0
    v_add_f32 v16, v16, v26
    v_add_f32 v17, v17, v27
    v_mfma_f32_16x16x32_bf16 v[180:183], v[80:83], v[126:129], v[180:183]
    ds_read_b64_tr_b16 v[118:119], v13 offset:0
    v_lshlrev_b32 v24, 16, v148
    v_and_b32 v25, 0xffff0000, v148
    s_add_u32 m0, s26, 35840
    s_nop 0
    buffer_load_dwordx4 v5, s[8:11], s23 offen  lds
    v_mfma_f32_16x16x32_bf16 v[176:179], v[76:79], v[126:129], v[176:179]
    ds_read_b64_tr_b16 v[120:121], v14 offset:0
    v_add_f32 v18, v18, v24
    v_add_f32 v19, v19, v25
    s_waitcnt lgkmcnt(13)
    v_mfma_f32_16x16x32_bf16 v[192:195], v[76:79], v[130:133], v[192:195]
    ds_read_b64_tr_b16 v[96:97], v9 offset:32
    v_lshlrev_b32 v26, 16, v149
    s_add_u32 m0, s28, 0
    s_xor_b32 s24, 8, s63
    s_mul_i32 s24, s24, 245760
    buffer_load_dwordx4 v6, s[12:15], s24 offen  lds
    v_mfma_f32_16x16x32_bf16 v[196:199], v[80:83], v[130:133], v[196:199]
    ds_read_b64_tr_b16 v[98:99], v9 offset:1312
    v_and_b32 v27, 0xffff0000, v149
    v_mfma_f32_16x16x32_bf16 v[200:203], v[84:87], v[130:133], v[200:203]
    s_waitcnt lgkmcnt(14)
    ds_read_b64_tr_b16 v[100:101], v9 offset:64
    v_add_f32 v18, v18, v26
    s_add_u32 m0, s29, 0
    s_nop 0
    buffer_load_dwordx4 v7, s[12:15], s24 offen  lds
    v_mfma_f32_16x16x32_bf16 v[204:207], v[88:91], v[130:133], v[204:207]
    s_waitcnt lgkmcnt(14)
    ds_read_b64_tr_b16 v[102:103], v9 offset:1344
    v_add_f32 v19, v19, v27
    v_mfma_f32_16x16x32_bf16 v[220:223], v[88:91], v[134:137], v[220:223]
    s_waitcnt lgkmcnt(14)
    ds_read_b64_tr_b16 v[104:105], v9 offset:96
    v_lshlrev_b32 v24, 16, v150
    s_add_u32 m0, s30, 0
    s_nop 0
    buffer_load_dwordx4 v8, s[12:15], s24 offen  lds
    v_mfma_f32_16x16x32_bf16 v[216:219], v[84:87], v[134:137], v[216:219]
    s_waitcnt lgkmcnt(14)
    ds_read_b64_tr_b16 v[106:107], v9 offset:1376
    v_and_b32 v25, 0xffff0000, v150
    v_mfma_f32_16x16x32_bf16 v[212:215], v[80:83], v[134:137], v[212:215]
    s_waitcnt lgkmcnt(14)
    ds_read_b64_tr_b16 v[108:109], v10 offset:0
    v_add_f32 v20, v20, v24
    v_mfma_f32_16x16x32_bf16 v[208:211], v[76:79], v[134:137], v[208:211]
    s_waitcnt lgkmcnt(14)
    ds_read_b64_tr_b16 v[110:111], v10 offset:1280
    v_add_f32 v21, v21, v25
    v_mfma_f32_16x16x32_bf16 v[224:227], v[76:79], v[138:141], v[224:227]
    v_lshlrev_b32 v26, 16, v151
    v_mfma_f32_16x16x32_bf16 v[228:231], v[80:83], v[138:141], v[228:231]
    v_and_b32 v27, 0xffff0000, v151
    v_mfma_f32_16x16x32_bf16 v[232:235], v[84:87], v[138:141], v[232:235]
    v_add_f32 v20, v20, v26
    v_mfma_f32_16x16x32_bf16 v[236:239], v[88:91], v[138:141], v[236:239]
    v_add_f32 v21, v21, v27
    s_waitcnt lgkmcnt(14)
    v_mfma_f32_16x16x32_bf16 v[160:163], v[60:63], v[92:95], v[160:163]
    ds_read_b128 v[76:79], v157 offset:0
    s_waitcnt lgkmcnt(14)
    ds_read_b64_tr_b16 v[122:123], v9 offset:10240
    buffer_load_dword v159, v158, s[44:47], 0 offen sc1
    v_mfma_f32_16x16x32_bf16 v[164:167], v[64:67], v[92:95], v[164:167]
    s_waitcnt lgkmcnt(14)
    ds_read_b64_tr_b16 v[124:125], v9 offset:11520
    v_mfma_f32_16x16x32_bf16 v[168:171], v[68:71], v[92:95], v[168:171]
    s_waitcnt lgkmcnt(14)
    ds_read_b128 v[80:83], v157 offset:2048
    s_waitcnt lgkmcnt(12)
    v_lshlrev_b32 v24, 16, v116
    v_and_b32 v25, 0xffff0000, v116
    v_mfma_f32_16x16x32_bf16 v[172:175], v[72:75], v[92:95], v[172:175]
    ds_read_b128 v[84:87], v157 offset:4096
    v_add_f32 v16, v16, v24
    v_add_f32 v17, v17, v25
    s_waitcnt lgkmcnt(11)
    v_mfma_f32_16x16x32_bf16 v[188:191], v[72:75], v[96:99], v[188:191]
    ds_read_b128 v[88:91], v157 offset:6144
    v_lshlrev_b32 v26, 16, v117
    v_and_b32 v27, 0xffff0000, v117
    v_mfma_f32_16x16x32_bf16 v[184:187], v[68:71], v[96:99], v[184:187]
    ds_read_b64_tr_b16 v[146:147], v12 offset:10240
    v_add_f32 v16, v16, v26
    v_add_f32 v17, v17, v27
    v_mfma_f32_16x16x32_bf16 v[180:183], v[64:67], v[96:99], v[180:183]
    ds_read_b64_tr_b16 v[148:149], v13 offset:10240
    v_lshlrev_b32 v24, 16, v118
    v_and_b32 v25, 0xffff0000, v118
    v_mfma_f32_16x16x32_bf16 v[176:179], v[60:63], v[96:99], v[176:179]
    ds_read_b64_tr_b16 v[150:151], v14 offset:10240
    v_add_f32 v18, v18, v24
    v_add_f32 v19, v19, v25
    s_waitcnt lgkmcnt(13)
    v_mfma_f32_16x16x32_bf16 v[192:195], v[60:63], v[100:103], v[192:195]
    ds_read_b64_tr_b16 v[126:127], v9 offset:10272
    v_lshlrev_b32 v26, 16, v119
    v_mfma_f32_16x16x32_bf16 v[196:199], v[64:67], v[100:103], v[196:199]
    ds_read_b64_tr_b16 v[128:129], v9 offset:11552
    v_and_b32 v27, 0xffff0000, v119
    v_mfma_f32_16x16x32_bf16 v[200:203], v[68:71], v[100:103], v[200:203]
    s_waitcnt lgkmcnt(14)
    ds_read_b64_tr_b16 v[130:131], v9 offset:10304
    v_add_f32 v18, v18, v26
    v_mfma_f32_16x16x32_bf16 v[204:207], v[72:75], v[100:103], v[204:207]
    s_waitcnt lgkmcnt(14)
    ds_read_b64_tr_b16 v[132:133], v9 offset:11584
    v_add_f32 v19, v19, v27
    v_mfma_f32_16x16x32_bf16 v[220:223], v[72:75], v[104:107], v[220:223]
    s_waitcnt lgkmcnt(14)
    ds_read_b64_tr_b16 v[134:135], v9 offset:10336
    v_lshlrev_b32 v24, 16, v120
    v_mfma_f32_16x16x32_bf16 v[216:219], v[68:71], v[104:107], v[216:219]
    s_waitcnt lgkmcnt(14)
    ds_read_b64_tr_b16 v[136:137], v9 offset:11616
    v_and_b32 v25, 0xffff0000, v120
    v_mfma_f32_16x16x32_bf16 v[212:215], v[64:67], v[104:107], v[212:215]
    s_waitcnt lgkmcnt(14)
    ds_read_b64_tr_b16 v[138:139], v10 offset:10240
    v_add_f32 v20, v20, v24
    v_mfma_f32_16x16x32_bf16 v[208:211], v[60:63], v[104:107], v[208:211]
    s_waitcnt lgkmcnt(14)
    ds_read_b64_tr_b16 v[140:141], v10 offset:11520
    v_add_f32 v21, v21, v25
    v_mfma_f32_16x16x32_bf16 v[224:227], v[60:63], v[108:111], v[224:227]
    v_lshlrev_b32 v26, 16, v121
    v_mfma_f32_16x16x32_bf16 v[228:231], v[64:67], v[108:111], v[228:231]
    v_and_b32 v27, 0xffff0000, v121
    v_mfma_f32_16x16x32_bf16 v[232:235], v[68:71], v[108:111], v[232:235]
    v_add_f32 v20, v20, v26
    v_mfma_f32_16x16x32_bf16 v[236:239], v[72:75], v[108:111], v[236:239]
    v_add_f32 v21, v21, v27
    s_waitcnt vmcnt(4) lgkmcnt(11)
    s_barrier
    v_mfma_f32_16x16x32_bf16 v[160:163], v[76:79], v[122:125], v[160:163]
    ds_read_b128 v[60:63], v156 offset:32768
    ds_read_b64_tr_b16 v[92:93], v9 offset:24576
    s_add_u32 m0, s26, 0
    s_xor_b32 s23, 8, s63
    s_lshl_b32 s23, s23, 7
    buffer_load_dwordx4 v2, s[8:11], s23 offen  lds
    v_mfma_f32_16x16x32_bf16 v[164:167], v[80:83], v[122:125], v[164:167]
    ds_read_b64_tr_b16 v[94:95], v9 offset:25856
    v_mfma_f32_16x16x32_bf16 v[168:171], v[84:87], v[122:125], v[168:171]
    ds_read_b128 v[64:67], v156 offset:34816
    s_waitcnt lgkmcnt(12)
    v_lshlrev_b32 v24, 16, v146
    v_and_b32 v25, 0xffff0000, v146
    s_add_u32 m0, s26, 1024
    s_nop 0
    buffer_load_dwordx4 v3, s[8:11], s23 offen  lds
    v_mfma_f32_16x16x32_bf16 v[172:175], v[88:91], v[122:125], v[172:175]
    ds_read_b128 v[68:71], v156 offset:36864
    v_add_f32 v16, v16, v24
    v_add_f32 v17, v17, v25
    s_waitcnt lgkmcnt(11)
    v_mfma_f32_16x16x32_bf16 v[188:191], v[88:91], v[126:129], v[188:191]
    ds_read_b128 v[72:75], v156 offset:38912
    v_lshlrev_b32 v26, 16, v147
    v_and_b32 v27, 0xffff0000, v147
    s_add_u32 m0, s26, 2048
    s_nop 0
    buffer_load_dwordx4 v4, s[8:11], s23 offen  lds
    v_mfma_f32_16x16x32_bf16 v[184:187], v[84:87], v[126:129], v[184:187]
    ds_read_b64_tr_b16 v[116:117], v12 offset:24576
    v_add_f32 v16, v16, v26
    v_add_f32 v17, v17, v27
    v_mfma_f32_16x16x32_bf16 v[180:183], v[80:83], v[126:129], v[180:183]
    ds_read_b64_tr_b16 v[118:119], v13 offset:24576
    v_lshlrev_b32 v24, 16, v148
    v_and_b32 v25, 0xffff0000, v148
    s_add_u32 m0, s26, 3072
    s_nop 0
    buffer_load_dwordx4 v5, s[8:11], s23 offen  lds
    v_mfma_f32_16x16x32_bf16 v[176:179], v[76:79], v[126:129], v[176:179]
    ds_read_b64_tr_b16 v[120:121], v14 offset:24576
    v_add_f32 v18, v18, v24
    v_add_f32 v19, v19, v25
    s_waitcnt lgkmcnt(13)
    v_mfma_f32_16x16x32_bf16 v[192:195], v[76:79], v[130:133], v[192:195]
    ds_read_b64_tr_b16 v[96:97], v9 offset:24608
    v_lshlrev_b32 v26, 16, v149
    s_add_u32 m0, s28, 24576
    s_xor_b32 s24, 9, s63
    s_mul_i32 s24, s24, 245760
    buffer_load_dwordx4 v6, s[12:15], s24 offen  lds
    v_mfma_f32_16x16x32_bf16 v[196:199], v[80:83], v[130:133], v[196:199]
    ds_read_b64_tr_b16 v[98:99], v9 offset:25888
    v_and_b32 v27, 0xffff0000, v149
    v_mfma_f32_16x16x32_bf16 v[200:203], v[84:87], v[130:133], v[200:203]
    s_waitcnt lgkmcnt(14)
    ds_read_b64_tr_b16 v[100:101], v9 offset:24640
    v_add_f32 v18, v18, v26
    s_add_u32 m0, s29, 24576
    s_nop 0
    buffer_load_dwordx4 v7, s[12:15], s24 offen  lds
    v_mfma_f32_16x16x32_bf16 v[204:207], v[88:91], v[130:133], v[204:207]
    s_waitcnt lgkmcnt(14)
    ds_read_b64_tr_b16 v[102:103], v9 offset:25920
    v_add_f32 v19, v19, v27
    v_mfma_f32_16x16x32_bf16 v[220:223], v[88:91], v[134:137], v[220:223]
    s_waitcnt lgkmcnt(14)
    ds_read_b64_tr_b16 v[104:105], v9 offset:24672
    v_lshlrev_b32 v24, 16, v150
    s_add_u32 m0, s30, 24576
    s_nop 0
    buffer_load_dwordx4 v8, s[12:15], s24 offen  lds
    v_mfma_f32_16x16x32_bf16 v[216:219], v[84:87], v[134:137], v[216:219]
    s_waitcnt lgkmcnt(14)
    ds_read_b64_tr_b16 v[106:107], v9 offset:25952
    v_and_b32 v25, 0xffff0000, v150
    v_mfma_f32_16x16x32_bf16 v[212:215], v[80:83], v[134:137], v[212:215]
    s_waitcnt lgkmcnt(14)
    ds_read_b64_tr_b16 v[108:109], v10 offset:24576
    v_add_f32 v20, v20, v24
    v_mfma_f32_16x16x32_bf16 v[208:211], v[76:79], v[134:137], v[208:211]
    s_waitcnt lgkmcnt(14)
    ds_read_b64_tr_b16 v[110:111], v10 offset:25856
    v_add_f32 v21, v21, v25
    v_mfma_f32_16x16x32_bf16 v[224:227], v[76:79], v[138:141], v[224:227]
    v_lshlrev_b32 v26, 16, v151
    v_mfma_f32_16x16x32_bf16 v[228:231], v[80:83], v[138:141], v[228:231]
    v_and_b32 v27, 0xffff0000, v151
    v_mfma_f32_16x16x32_bf16 v[232:235], v[84:87], v[138:141], v[232:235]
    v_add_f32 v20, v20, v26
    v_mfma_f32_16x16x32_bf16 v[236:239], v[88:91], v[138:141], v[236:239]
    v_add_f32 v21, v21, v27
    s_waitcnt lgkmcnt(14)
    v_mfma_f32_16x16x32_bf16 v[160:163], v[60:63], v[92:95], v[160:163]
    ds_read_b128 v[76:79], v157 offset:32768
    s_waitcnt lgkmcnt(14)
    ds_read_b64_tr_b16 v[122:123], v9 offset:34816
    v_mfma_f32_16x16x32_bf16 v[164:167], v[64:67], v[92:95], v[164:167]
    s_waitcnt lgkmcnt(14)
    ds_read_b64_tr_b16 v[124:125], v9 offset:36096
    v_mfma_f32_16x16x32_bf16 v[168:171], v[68:71], v[92:95], v[168:171]
    s_waitcnt lgkmcnt(14)
    ds_read_b128 v[80:83], v157 offset:34816
    s_waitcnt lgkmcnt(12)
    v_lshlrev_b32 v24, 16, v116
    v_and_b32 v25, 0xffff0000, v116
    v_mfma_f32_16x16x32_bf16 v[172:175], v[72:75], v[92:95], v[172:175]
    ds_read_b128 v[84:87], v157 offset:36864
    v_add_f32 v16, v16, v24
    v_add_f32 v17, v17, v25
    s_waitcnt lgkmcnt(11)
    v_mfma_f32_16x16x32_bf16 v[188:191], v[72:75], v[96:99], v[188:191]
    ds_read_b128 v[88:91], v157 offset:38912
    v_lshlrev_b32 v26, 16, v117
    v_and_b32 v27, 0xffff0000, v117
    v_mfma_f32_16x16x32_bf16 v[184:187], v[68:71], v[96:99], v[184:187]
    ds_read_b64_tr_b16 v[146:147], v12 offset:34816
    v_add_f32 v16, v16, v26
    v_add_f32 v17, v17, v27
    v_mfma_f32_16x16x32_bf16 v[180:183], v[64:67], v[96:99], v[180:183]
    ds_read_b64_tr_b16 v[148:149], v13 offset:34816
    v_lshlrev_b32 v24, 16, v118
    v_and_b32 v25, 0xffff0000, v118
    v_mfma_f32_16x16x32_bf16 v[176:179], v[60:63], v[96:99], v[176:179]
    ds_read_b64_tr_b16 v[150:151], v14 offset:34816
    v_add_f32 v18, v18, v24
    v_add_f32 v19, v19, v25
    s_waitcnt lgkmcnt(13)
    v_mfma_f32_16x16x32_bf16 v[192:195], v[60:63], v[100:103], v[192:195]
    ds_read_b64_tr_b16 v[126:127], v9 offset:34848
    v_lshlrev_b32 v26, 16, v119
    v_mfma_f32_16x16x32_bf16 v[196:199], v[64:67], v[100:103], v[196:199]
    ds_read_b64_tr_b16 v[128:129], v9 offset:36128
    v_and_b32 v27, 0xffff0000, v119
    v_mfma_f32_16x16x32_bf16 v[200:203], v[68:71], v[100:103], v[200:203]
    s_waitcnt lgkmcnt(14)
    ds_read_b64_tr_b16 v[130:131], v9 offset:34880
    v_add_f32 v18, v18, v26
    v_mfma_f32_16x16x32_bf16 v[204:207], v[72:75], v[100:103], v[204:207]
    s_waitcnt lgkmcnt(14)
    ds_read_b64_tr_b16 v[132:133], v9 offset:36160
    v_add_f32 v19, v19, v27
    v_mfma_f32_16x16x32_bf16 v[220:223], v[72:75], v[104:107], v[220:223]
    s_waitcnt lgkmcnt(14)
    ds_read_b64_tr_b16 v[134:135], v9 offset:34912
    v_lshlrev_b32 v24, 16, v120
    v_mfma_f32_16x16x32_bf16 v[216:219], v[68:71], v[104:107], v[216:219]
    s_waitcnt lgkmcnt(14)
    ds_read_b64_tr_b16 v[136:137], v9 offset:36192
    v_and_b32 v25, 0xffff0000, v120
    v_mfma_f32_16x16x32_bf16 v[212:215], v[64:67], v[104:107], v[212:215]
    s_waitcnt lgkmcnt(14)
    ds_read_b64_tr_b16 v[138:139], v10 offset:34816
    v_add_f32 v20, v20, v24
    v_mfma_f32_16x16x32_bf16 v[208:211], v[60:63], v[104:107], v[208:211]
    s_waitcnt lgkmcnt(14)
    ds_read_b64_tr_b16 v[140:141], v10 offset:36096
    v_add_f32 v21, v21, v25
    v_mfma_f32_16x16x32_bf16 v[224:227], v[60:63], v[108:111], v[224:227]
    v_lshlrev_b32 v26, 16, v121
    v_mfma_f32_16x16x32_bf16 v[228:231], v[64:67], v[108:111], v[228:231]
    v_and_b32 v27, 0xffff0000, v121
    v_mfma_f32_16x16x32_bf16 v[232:235], v[68:71], v[108:111], v[232:235]
    v_add_f32 v20, v20, v26
    v_mfma_f32_16x16x32_bf16 v[236:239], v[72:75], v[108:111], v[236:239]
    v_add_f32 v21, v21, v27
    s_waitcnt vmcnt(3) lgkmcnt(11)
    s_barrier
    v_subrev_u32 v9, 49152, v9
    v_subrev_u32 v10, 49152, v10
    v_subrev_u32 v12, 49152, v12
    v_subrev_u32 v13, 49152, v13
    v_subrev_u32 v14, 49152, v14
    v_mfma_f32_16x16x32_bf16 v[160:163], v[76:79], v[122:125], v[160:163]
    ds_read_b128 v[60:63], v156 offset:0
    ds_read_b64_tr_b16 v[92:93], v9 offset:0
    s_add_u32 m0, s26, 32768
    s_xor_b32 s23, 9, s63
    s_lshl_b32 s23, s23, 7
    buffer_load_dwordx4 v2, s[8:11], s23 offen  lds
    v_mfma_f32_16x16x32_bf16 v[164:167], v[80:83], v[122:125], v[164:167]
    ds_read_b64_tr_b16 v[94:95], v9 offset:1280
    v_mfma_f32_16x16x32_bf16 v[168:171], v[84:87], v[122:125], v[168:171]
    ds_read_b128 v[64:67], v156 offset:2048
    s_waitcnt lgkmcnt(12)
    v_lshlrev_b32 v24, 16, v146
    v_and_b32 v25, 0xffff0000, v146
    s_add_u32 m0, s26, 33792
    s_nop 0
    buffer_load_dwordx4 v3, s[8:11], s23 offen  lds
    v_mfma_f32_16x16x32_bf16 v[172:175], v[88:91], v[122:125], v[172:175]
    ds_read_b128 v[68:71], v156 offset:4096
    v_add_f32 v16, v16, v24
    v_add_f32 v17, v17, v25
    s_waitcnt lgkmcnt(11)
    v_mfma_f32_16x16x32_bf16 v[188:191], v[88:91], v[126:129], v[188:191]
    ds_read_b128 v[72:75], v156 offset:6144
    v_lshlrev_b32 v26, 16, v147
    v_and_b32 v27, 0xffff0000, v147
    s_add_u32 m0, s26, 34816
    s_nop 0
    buffer_load_dwordx4 v4, s[8:11], s23 offen  lds
    v_mfma_f32_16x16x32_bf16 v[184:187], v[84:87], v[126:129], v[184:187]
    ds_read_b64_tr_b16 v[116:117], v12 offset:0
    v_add_f32 v16, v16, v26
    v_add_f32 v17, v17, v27
    v_mfma_f32_16x16x32_bf16 v[180:183], v[80:83], v[126:129], v[180:183]
    ds_read_b64_tr_b16 v[118:119], v13 offset:0
    v_lshlrev_b32 v24, 16, v148
    v_and_b32 v25, 0xffff0000, v148
    s_add_u32 m0, s26, 35840
    s_nop 0
    buffer_load_dwordx4 v5, s[8:11], s23 offen  lds
    v_mfma_f32_16x16x32_bf16 v[176:179], v[76:79], v[126:129], v[176:179]
    ds_read_b64_tr_b16 v[120:121], v14 offset:0
    v_add_f32 v18, v18, v24
    v_add_f32 v19, v19, v25
    s_waitcnt lgkmcnt(13)
    v_mfma_f32_16x16x32_bf16 v[192:195], v[76:79], v[130:133], v[192:195]
    ds_read_b64_tr_b16 v[96:97], v9 offset:32
    v_lshlrev_b32 v26, 16, v149
    v_mfma_f32_16x16x32_bf16 v[196:199], v[80:83], v[130:133], v[196:199]
    ds_read_b64_tr_b16 v[98:99], v9 offset:1312
    v_and_b32 v27, 0xffff0000, v149
    v_mfma_f32_16x16x32_bf16 v[200:203], v[84:87], v[130:133], v[200:203]
    s_waitcnt lgkmcnt(14)
    ds_read_b64_tr_b16 v[100:101], v9 offset:64
    v_add_f32 v18, v18, v26
    v_mfma_f32_16x16x32_bf16 v[204:207], v[88:91], v[130:133], v[204:207]
    s_waitcnt lgkmcnt(14)
    ds_read_b64_tr_b16 v[102:103], v9 offset:1344
    v_add_f32 v19, v19, v27
    v_mfma_f32_16x16x32_bf16 v[220:223], v[88:91], v[134:137], v[220:223]
    s_waitcnt lgkmcnt(14)
    ds_read_b64_tr_b16 v[104:105], v9 offset:96
    v_lshlrev_b32 v24, 16, v150
    v_mfma_f32_16x16x32_bf16 v[216:219], v[84:87], v[134:137], v[216:219]
    s_waitcnt lgkmcnt(14)
    ds_read_b64_tr_b16 v[106:107], v9 offset:1376
    v_and_b32 v25, 0xffff0000, v150
    v_mfma_f32_16x16x32_bf16 v[212:215], v[80:83], v[134:137], v[212:215]
    s_waitcnt lgkmcnt(14)
    ds_read_b64_tr_b16 v[108:109], v10 offset:0
    v_add_f32 v20, v20, v24
    v_mfma_f32_16x16x32_bf16 v[208:211], v[76:79], v[134:137], v[208:211]
    s_waitcnt lgkmcnt(14)
    ds_read_b64_tr_b16 v[110:111], v10 offset:1280
    v_add_f32 v21, v21, v25
    v_mfma_f32_16x16x32_bf16 v[224:227], v[76:79], v[138:141], v[224:227]
    v_lshlrev_b32 v26, 16, v151
    v_mfma_f32_16x16x32_bf16 v[228:231], v[80:83], v[138:141], v[228:231]
    v_and_b32 v27, 0xffff0000, v151
    v_mfma_f32_16x16x32_bf16 v[232:235], v[84:87], v[138:141], v[232:235]
    v_add_f32 v20, v20, v26
    v_mfma_f32_16x16x32_bf16 v[236:239], v[88:91], v[138:141], v[236:239]
    v_add_f32 v21, v21, v27
    v_cmp_eq_u32 vcc, 0, v159
    s_cbranch_vccnz L_k1_kv_spin
L_k1_kv_go:
    s_waitcnt lgkmcnt(14)
    v_mfma_f32_16x16x32_bf16 v[160:163], v[60:63], v[92:95], v[160:163]
    ds_read_b128 v[76:79], v157 offset:0
    s_waitcnt lgkmcnt(14)
    ds_read_b64_tr_b16 v[122:123], v9 offset:10240
    buffer_load_dwordx4 v[28:31], v155, s[16:19], s49 offen offset:0 sc1
    v_mfma_f32_16x16x32_bf16 v[164:167], v[64:67], v[92:95], v[164:167]
    s_waitcnt lgkmcnt(14)
    ds_read_b64_tr_b16 v[124:125], v9 offset:11520
    v_mfma_f32_16x16x32_bf16 v[168:171], v[68:71], v[92:95], v[168:171]
    s_waitcnt lgkmcnt(14)
    ds_read_b128 v[80:83], v157 offset:2048
    s_waitcnt lgkmcnt(12)
    v_lshlrev_b32 v24, 16, v116
    v_and_b32 v25, 0xffff0000, v116
    buffer_load_dwordx4 v[44:47], v155, s[16:19], s50 offen offset:0 sc1
    v_mfma_f32_16x16x32_bf16 v[172:175], v[72:75], v[92:95], v[172:175]
    ds_read_b128 v[84:87], v157 offset:4096
    v_add_f32 v16, v16, v24
    v_add_f32 v17, v17, v25
    s_waitcnt lgkmcnt(11)
    v_mfma_f32_16x16x32_bf16 v[188:191], v[72:75], v[96:99], v[188:191]
    ds_read_b128 v[88:91], v157 offset:6144
    v_lshlrev_b32 v26, 16, v117
    v_and_b32 v27, 0xffff0000, v117
    buffer_load_dwordx4 v[32:35], v155, s[16:19], s49 offen offset:64 sc1
    v_mfma_f32_16x16x32_bf16 v[184:187], v[68:71], v[96:99], v[184:187]
    ds_read_b64_tr_b16 v[146:147], v12 offset:10240
    v_add_f32 v16, v16, v26
    v_add_f32 v17, v17, v27
    v_mfma_f32_16x16x32_bf16 v[180:183], v[64:67], v[96:99], v[180:183]
    ds_read_b64_tr_b16 v[148:149], v13 offset:10240
    v_lshlrev_b32 v24, 16, v118
    v_and_b32 v25, 0xffff0000, v118
    buffer_load_dwordx4 v[48:51], v155, s[16:19], s50 offen offset:64 sc1
    v_mfma_f32_16x16x32_bf16 v[176:179], v[60:63], v[96:99], v[176:179]
    ds_read_b64_tr_b16 v[150:151], v14 offset:10240
    v_add_f32 v18, v18, v24
    v_add_f32 v19, v19, v25
    s_waitcnt lgkmcnt(13)
    v_mfma_f32_16x16x32_bf16 v[192:195], v[60:63], v[100:103], v[192:195]
    ds_read_b64_tr_b16 v[126:127], v9 offset:10272
    v_lshlrev_b32 v26, 16, v119
    buffer_load_dwordx4 v[36:39], v155, s[16:19], s49 offen offset:128 sc1
    v_mfma_f32_16x16x32_bf16 v[196:199], v[64:67], v[100:103], v[196:199]
    ds_read_b64_tr_b16 v[128:129], v9 offset:11552
    v_and_b32 v27, 0xffff0000, v119
    v_mfma_f32_16x16x32_bf16 v[200:203], v[68:71], v[100:103], v[200:203]
    s_waitcnt lgkmcnt(14)
    ds_read_b64_tr_b16 v[130:131], v9 offset:10304
    v_add_f32 v18, v18, v26
    buffer_load_dwordx4 v[52:55], v155, s[16:19], s50 offen offset:128 sc1
    v_mfma_f32_16x16x32_bf16 v[204:207], v[72:75], v[100:103], v[204:207]
    s_waitcnt lgkmcnt(14)
    ds_read_b64_tr_b16 v[132:133], v9 offset:11584
    v_add_f32 v19, v19, v27
    v_mfma_f32_16x16x32_bf16 v[220:223], v[72:75], v[104:107], v[220:223]
    s_waitcnt lgkmcnt(14)
    ds_read_b64_tr_b16 v[134:135], v9 offset:10336
    v_lshlrev_b32 v24, 16, v120
    buffer_load_dwordx4 v[40:43], v155, s[16:19], s49 offen offset:192 sc1
    v_mfma_f32_16x16x32_bf16 v[216:219], v[68:71], v[104:107], v[216:219]
    s_waitcnt lgkmcnt(14)
    ds_read_b64_tr_b16 v[136:137], v9 offset:11616
    v_and_b32 v25, 0xffff0000, v120
    v_mfma_f32_16x16x32_bf16 v[212:215], v[64:67], v[104:107], v[212:215]
    s_waitcnt lgkmcnt(14)
    ds_read_b64_tr_b16 v[138:139], v10 offset:10240
    v_add_f32 v20, v20, v24
    buffer_load_dwordx4 v[56:59], v155, s[16:19], s50 offen offset:192 sc1
    v_mfma_f32_16x16x32_bf16 v[208:211], v[60:63], v[104:107], v[208:211]
    s_waitcnt lgkmcnt(14)
    ds_read_b64_tr_b16 v[140:141], v10 offset:11520
    v_add_f32 v21, v21, v25
    v_mfma_f32_16x16x32_bf16 v[224:227], v[60:63], v[108:111], v[224:227]
    v_lshlrev_b32 v26, 16, v121
    v_mfma_f32_16x16x32_bf16 v[228:231], v[64:67], v[108:111], v[228:231]
    v_and_b32 v27, 0xffff0000, v121
    v_mfma_f32_16x16x32_bf16 v[232:235], v[68:71], v[108:111], v[232:235]
    v_add_f32 v20, v20, v26
    v_mfma_f32_16x16x32_bf16 v[236:239], v[72:75], v[108:111], v[236:239]
    v_add_f32 v21, v21, v27
    s_waitcnt vmcnt(8) lgkmcnt(11)
    s_barrier
    v_mfma_f32_16x16x32_bf16 v[160:163], v[76:79], v[122:125], v[160:163]
    ds_read_b128 v[60:63], v156 offset:32768
    ds_read_b64_tr_b16 v[92:93], v9 offset:24576
    v_mfma_f32_16x16x32_bf16 v[164:167], v[80:83], v[122:125], v[164:167]
    ds_read_b64_tr_b16 v[94:95], v9 offset:25856
    v_mfma_f32_16x16x32_bf16 v[168:171], v[84:87], v[122:125], v[168:171]
    ds_read_b128 v[64:67], v156 offset:34816
    s_waitcnt lgkmcnt(12)
    v_lshlrev_b32 v24, 16, v146
    v_and_b32 v25, 0xffff0000, v146
    v_mfma_f32_16x16x32_bf16 v[172:175], v[88:91], v[122:125], v[172:175]
    ds_read_b128 v[68:71], v156 offset:36864
    v_add_f32 v16, v16, v24
    v_add_f32 v17, v17, v25
    s_waitcnt lgkmcnt(11)
    v_mfma_f32_16x16x32_bf16 v[188:191], v[88:91], v[126:129], v[188:191]
    ds_read_b128 v[72:75], v156 offset:38912
    v_lshlrev_b32 v26, 16, v147
    v_and_b32 v27, 0xffff0000, v147
    v_mfma_f32_16x16x32_bf16 v[184:187], v[84:87], v[126:129], v[184:187]
    ds_read_b64_tr_b16 v[116:117], v12 offset:24576
    v_add_f32 v16, v16, v26
    v_add_f32 v17, v17, v27
    v_mfma_f32_16x16x32_bf16 v[180:183], v[80:83], v[126:129], v[180:183]
    ds_read_b64_tr_b16 v[118:119], v13 offset:24576
    v_lshlrev_b32 v24, 16, v148
    v_and_b32 v25, 0xffff0000, v148
    v_mfma_f32_16x16x32_bf16 v[176:179], v[76:79], v[126:129], v[176:179]
    ds_read_b64_tr_b16 v[120:121], v14 offset:24576
    v_add_f32 v18, v18, v24
    v_add_f32 v19, v19, v25
    s_waitcnt lgkmcnt(13)
    v_mfma_f32_16x16x32_bf16 v[192:195], v[76:79], v[130:133], v[192:195]
    ds_read_b64_tr_b16 v[96:97], v9 offset:24608
    v_lshlrev_b32 v26, 16, v149
    v_mfma_f32_16x16x32_bf16 v[196:199], v[80:83], v[130:133], v[196:199]
    ds_read_b64_tr_b16 v[98:99], v9 offset:25888
    v_and_b32 v27, 0xffff0000, v149
    v_mfma_f32_16x16x32_bf16 v[200:203], v[84:87], v[130:133], v[200:203]
    s_waitcnt lgkmcnt(14)
    ds_read_b64_tr_b16 v[100:101], v9 offset:24640
    v_add_f32 v18, v18, v26
    v_mfma_f32_16x16x32_bf16 v[204:207], v[88:91], v[130:133], v[204:207]
    s_waitcnt lgkmcnt(14)
    ds_read_b64_tr_b16 v[102:103], v9 offset:25920
    v_add_f32 v19, v19, v27
    v_mfma_f32_16x16x32_bf16 v[220:223], v[88:91], v[134:137], v[220:223]
    s_waitcnt lgkmcnt(14)
    ds_read_b64_tr_b16 v[104:105], v9 offset:24672
    v_lshlrev_b32 v24, 16, v150
    v_mfma_f32_16x16x32_bf16 v[216:219], v[84:87], v[134:137], v[216:219]
    s_waitcnt lgkmcnt(14)
    ds_read_b64_tr_b16 v[106:107], v9 offset:25952
    v_and_b32 v25, 0xffff0000, v150
    v_mfma_f32_16x16x32_bf16 v[212:215], v[80:83], v[134:137], v[212:215]
    s_waitcnt lgkmcnt(14)
    ds_read_b64_tr_b16 v[108:109], v10 offset:24576
    v_add_f32 v20, v20, v24
    v_mfma_f32_16x16x32_bf16 v[208:211], v[76:79], v[134:137], v[208:211]
    s_waitcnt lgkmcnt(14)
    ds_read_b64_tr_b16 v[110:111], v10 offset:25856
    v_add_f32 v21, v21, v25
    v_mfma_f32_16x16x32_bf16 v[224:227], v[76:79], v[138:141], v[224:227]
    v_lshlrev_b32 v26, 16, v151
    v_mfma_f32_16x16x32_bf16 v[228:231], v[80:83], v[138:141], v[228:231]
    v_and_b32 v27, 0xffff0000, v151
    v_mfma_f32_16x16x32_bf16 v[232:235], v[84:87], v[138:141], v[232:235]
    v_add_f32 v20, v20, v26
    v_mfma_f32_16x16x32_bf16 v[236:239], v[88:91], v[138:141], v[236:239]
    v_add_f32 v21, v21, v27
    s_waitcnt lgkmcnt(14)
    v_mfma_f32_16x16x32_bf16 v[160:163], v[60:63], v[92:95], v[160:163]
    ds_read_b128 v[76:79], v157 offset:32768
    s_waitcnt lgkmcnt(14)
    ds_read_b64_tr_b16 v[122:123], v9 offset:34816
    buffer_load_dword v159, v158, s[16:19], s79 offen offset:192 sc1
    v_mfma_f32_16x16x32_bf16 v[164:167], v[64:67], v[92:95], v[164:167]
    s_waitcnt lgkmcnt(14)
    ds_read_b64_tr_b16 v[124:125], v9 offset:36096
    v_mfma_f32_16x16x32_bf16 v[168:171], v[68:71], v[92:95], v[168:171]
    s_waitcnt lgkmcnt(14)
    ds_read_b128 v[80:83], v157 offset:34816
    s_waitcnt lgkmcnt(12)
    v_lshlrev_b32 v24, 16, v116
    v_and_b32 v25, 0xffff0000, v116
    v_add_f32 v16, v16, v24
    v_mfma_f32_16x16x32_bf16 v[172:175], v[72:75], v[92:95], v[172:175]
    ds_read_b128 v[84:87], v157 offset:36864
    v_add_f32 v17, v17, v25
    v_lshlrev_b32 v26, 16, v117
    v_and_b32 v27, 0xffff0000, v117
    s_waitcnt lgkmcnt(11)
    v_mfma_f32_16x16x32_bf16 v[188:191], v[72:75], v[96:99], v[188:191]
    ds_read_b128 v[88:91], v157 offset:38912
    v_add_f32 v16, v16, v26
    v_add_f32 v17, v17, v27
    v_lshlrev_b32 v24, 16, v118
    v_mfma_f32_16x16x32_bf16 v[184:187], v[68:71], v[96:99], v[184:187]
    ds_read_b64_tr_b16 v[146:147], v12 offset:34816
    v_and_b32 v25, 0xffff0000, v118
    v_add_f32 v18, v18, v24
    v_add_f32 v19, v19, v25
    v_mfma_f32_16x16x32_bf16 v[180:183], v[64:67], v[96:99], v[180:183]
    ds_read_b64_tr_b16 v[148:149], v13 offset:34816
    v_lshlrev_b32 v26, 16, v119
    v_and_b32 v27, 0xffff0000, v119
    v_add_f32 v18, v18, v26
    v_mfma_f32_16x16x32_bf16 v[176:179], v[60:63], v[96:99], v[176:179]
    ds_read_b64_tr_b16 v[150:151], v14 offset:34816
    v_add_f32 v19, v19, v27
    v_lshlrev_b32 v24, 16, v120
    v_and_b32 v25, 0xffff0000, v120
    s_waitcnt lgkmcnt(13)
    v_mfma_f32_16x16x32_bf16 v[192:195], v[60:63], v[100:103], v[192:195]
    ds_read_b64_tr_b16 v[126:127], v9 offset:34848
    v_add_f32 v20, v20, v24
    v_add_f32 v21, v21, v25
    v_lshlrev_b32 v26, 16, v121
    v_mfma_f32_16x16x32_bf16 v[196:199], v[64:67], v[100:103], v[196:199]
    ds_read_b64_tr_b16 v[128:129], v9 offset:36128
    v_and_b32 v27, 0xffff0000, v121
    v_add_f32 v20, v20, v26
    v_add_f32 v21, v21, v27
    v_mfma_f32_16x16x32_bf16 v[200:203], v[68:71], v[100:103], v[200:203]
    s_waitcnt lgkmcnt(14)
    ds_read_b64_tr_b16 v[130:131], v9 offset:34880
    s_waitcnt lgkmcnt(3)
    v_lshlrev_b32 v24, 16, v146
    v_and_b32 v25, 0xffff0000, v146
    v_mfma_f32_16x16x32_bf16 v[204:207], v[72:75], v[100:103], v[204:207]
    ds_read_b64_tr_b16 v[132:133], v9 offset:36160
    v_add_f32 v16, v16, v24
    v_add_f32 v17, v17, v25
    v_lshlrev_b32 v26, 16, v147
    v_mfma_f32_16x16x32_bf16 v[220:223], v[72:75], v[104:107], v[220:223]
    ds_read_b64_tr_b16 v[134:135], v9 offset:34912
    v_and_b32 v27, 0xffff0000, v147
    v_add_f32 v16, v16, v26
    v_add_f32 v17, v17, v27
    v_mfma_f32_16x16x32_bf16 v[216:219], v[68:71], v[104:107], v[216:219]
    ds_read_b64_tr_b16 v[136:137], v9 offset:36192
    v_lshlrev_b32 v24, 16, v148
    v_and_b32 v25, 0xffff0000, v148
    v_add_f32 v18, v18, v24
    v_mfma_f32_16x16x32_bf16 v[212:215], v[64:67], v[104:107], v[212:215]
    ds_read_b64_tr_b16 v[138:139], v10 offset:34816
    v_add_f32 v19, v19, v25
    v_lshlrev_b32 v26, 16, v149
    v_and_b32 v27, 0xffff0000, v149
    v_mfma_f32_16x16x32_bf16 v[208:211], v[60:63], v[104:107], v[208:211]
    ds_read_b64_tr_b16 v[140:141], v10 offset:36096
    v_add_f32 v18, v18, v26
    v_add_f32 v19, v19, v27
    v_mfma_f32_16x16x32_bf16 v[224:227], v[60:63], v[108:111], v[224:227]
    v_lshlrev_b32 v24, 16, v150
    v_and_b32 v25, 0xffff0000, v150
    v_mfma_f32_16x16x32_bf16 v[228:231], v[64:67], v[108:111], v[228:231]
    v_add_f32 v20, v20, v24
    v_add_f32 v21, v21, v25
    v_mfma_f32_16x16x32_bf16 v[232:235], v[68:71], v[108:111], v[232:235]
    v_lshlrev_b32 v26, 16, v151
    v_and_b32 v27, 0xffff0000, v151
    v_mfma_f32_16x16x32_bf16 v[236:239], v[72:75], v[108:111], v[236:239]
    v_add_f32 v20, v20, v26
    v_add_f32 v21, v21, v27
    s_barrier
    v_mfma_f32_16x16x32_bf16 v[160:163], v[76:79], v[122:125], v[160:163]
    v_add_f32 v16, v16, v17
    v_add_f32 v18, v18, v19
    v_mfma_f32_16x16x32_bf16 v[164:167], v[80:83], v[122:125], v[164:167]
    v_add_f32 v20, v20, v21
    v_mov_b32 v17, v16
    v_mfma_f32_16x16x32_bf16 v[168:171], v[84:87], v[122:125], v[168:171]
    v_mov_b32 v19, v18
    v_mov_b32 v21, v20
    v_mfma_f32_16x16x32_bf16 v[172:175], v[88:91], v[122:125], v[172:175]
    s_mul_i32 s32, s20, 192
    s_add_u32 s32, s32, 159744
    s_waitcnt lgkmcnt(6)
    v_mfma_f32_16x16x32_bf16 v[188:191], v[88:91], v[126:129], v[188:191]
    v_permlane32_swap_b32 v16, v17
    v_permlane32_swap_b32 v18, v19
    v_mfma_f32_16x16x32_bf16 v[184:187], v[84:87], v[126:129], v[184:187]
    v_permlane32_swap_b32 v20, v21
    v_and_b32 v24, 15, v1
    v_mfma_f32_16x16x32_bf16 v[180:183], v[80:83], v[126:129], v[180:183]
    v_add_f32 v16, v16, v17
    v_add_f32 v18, v18, v19
    v_mfma_f32_16x16x32_bf16 v[176:179], v[76:79], v[126:129], v[176:179]
    v_add_f32 v20, v20, v21
    v_mov_b32 v17, v16
    s_waitcnt lgkmcnt(4)
    v_mfma_f32_16x16x32_bf16 v[192:195], v[76:79], v[130:133], v[192:195]
    v_mov_b32 v19, v18
    v_mov_b32 v21, v20
    v_mfma_f32_16x16x32_bf16 v[196:199], v[80:83], v[130:133], v[196:199]
    v_lshl_add_u32 v25, v24, 2, s32
    s_nop 0
    v_mfma_f32_16x16x32_bf16 v[200:203], v[84:87], v[130:133], v[200:203]
    v_permlane16_swap_b32 v16, v17
    v_permlane16_swap_b32 v18, v19
    v_mfma_f32_16x16x32_bf16 v[204:207], v[88:91], v[130:133], v[204:207]
    v_permlane16_swap_b32 v20, v21
    s_nop 0
    s_waitcnt lgkmcnt(2)
    v_mfma_f32_16x16x32_bf16 v[220:223], v[88:91], v[134:137], v[220:223]
    v_add_f32 v16, v16, v17
    v_add_f32 v18, v18, v19
    v_mfma_f32_16x16x32_bf16 v[216:219], v[84:87], v[134:137], v[216:219]
    v_add_f32 v20, v20, v21
    ds_write_b32 v25, v16 offset:0
    ds_write_b32 v25, v18 offset:64
    ds_write_b32 v25, v20 offset:128
    v_mfma_f32_16x16x32_bf16 v[212:215], v[80:83], v[134:137], v[212:215]
    s_waitcnt lgkmcnt(0)
    s_barrier
    ds_read_b32 v92, v152 offset:0
    v_mfma_f32_16x16x32_bf16 v[208:211], v[76:79], v[134:137], v[208:211]
    ds_read_b32 v102, v152 offset:64
    ds_read_b32 v94, v152 offset:128
    v_mfma_f32_16x16x32_bf16 v[224:227], v[76:79], v[138:141], v[224:227]
    ds_read_b32 v104, v152 offset:192
    ds_read_b32 v96, v152 offset:256
    v_mfma_f32_16x16x32_bf16 v[228:231], v[80:83], v[138:141], v[228:231]
    ds_read_b32 v106, v152 offset:320
    ds_read_b32 v98, v152 offset:384
    v_mfma_f32_16x16x32_bf16 v[232:235], v[84:87], v[138:141], v[232:235]
    ds_read_b32 v108, v152 offset:448
    ds_read_b32 v100, v152 offset:512
    v_mfma_f32_16x16x32_bf16 v[236:239], v[88:91], v[138:141], v[236:239]
    ds_read_b32 v110, v152 offset:576
    v_mov_b32 v22, 0x358637bd
    s_waitcnt vmcnt(1)
    s_waitcnt lgkmcnt(0)
    v_add_f32 v92, v92, v102
    v_add_f32 v94, v94, v104
    v_add_f32 v96, v96, v106
    v_add_f32 v98, v98, v108
    v_add_f32 v100, v100, v110
    s_cmp_eq_u32 s27, 0
    s_cbranch_scc0 L_k1_kv_v
    s_setprio 1
    v_mul_f32 v60, 0x3fb8aa3b, v44
    v_mul_f32 v61, 0x3fb8aa3b, v45
    v_mul_f32 v62, 0x3fb8aa3b, v46
    v_mul_f32 v63, 0x3fb8aa3b, v47
    v_mul_f32 v64, 0x3fb8aa3b, v48
    v_mul_f32 v65, 0x3fb8aa3b, v49
    v_mul_f32 v66, 0x3fb8aa3b, v50
    v_mul_f32 v67, 0x3fb8aa3b, v51
    v_mul_f32 v68, 0x3fb8aa3b, v52
    v_mul_f32 v69, 0x3fb8aa3b, v53
    v_mul_f32 v70, 0x3fb8aa3b, v54
    v_mul_f32 v71, 0x3fb8aa3b, v55
    v_mul_f32 v72, 0x3fb8aa3b, v56
    v_mul_f32 v73, 0x3fb8aa3b, v57
    v_mul_f32 v74, 0x3fb8aa3b, v58
    v_mul_f32 v75, 0x3fb8aa3b, v59
    v_pk_fma_f32 v[160:161], v[28:29], v[92:93], v[160:161] op_sel_hi:[1,0,1]
    v_pk_fma_f32 v[162:163], v[30:31], v[92:93], v[162:163] op_sel_hi:[1,0,1]
    v_pk_fma_f32 v[164:165], v[32:33], v[92:93], v[164:165] op_sel_hi:[1,0,1]
    v_pk_fma_f32 v[166:167], v[34:35], v[92:93], v[166:167] op_sel_hi:[1,0,1]
    v_pk_fma_f32 v[168:169], v[36:37], v[92:93], v[168:169] op_sel_hi:[1,0,1]
    v_pk_fma_f32 v[170:171], v[38:39], v[92:93], v[170:171] op_sel_hi:[1,0,1]
    v_pk_fma_f32 v[172:173], v[40:41], v[92:93], v[172:173] op_sel_hi:[1,0,1]
    v_pk_fma_f32 v[174:175], v[42:43], v[92:93], v[174:175] op_sel_hi:[1,0,1]
    v_pk_mul_f32 v[112:113], v[160:161], v[60:61]
    v_pk_mul_f32 v[114:115], v[162:163], v[62:63]
    v_pk_mul_f32 v[116:117], v[164:165], v[64:65]
    v_pk_mul_f32 v[118:119], v[166:167], v[66:67]
    v_pk_mul_f32 v[120:121], v[168:169], v[68:69]
    v_pk_mul_f32 v[122:123], v[170:171], v[70:71]
    v_pk_mul_f32 v[124:125], v[172:173], v[72:73]
    v_pk_mul_f32 v[126:127], v[174:175], v[74:75]
    v_max_f32 v160, 0, v160
    v_max_f32 v161, 0, v161
    v_max_f32 v162, 0, v162
    v_max_f32 v163, 0, v163
    v_max_f32 v164, 0, v164
    v_max_f32 v165, 0, v165
    v_max_f32 v166, 0, v166
    v_max_f32 v167, 0, v167
    v_max_f32 v168, 0, v168
    v_max_f32 v169, 0, v169
    v_max_f32 v170, 0, v170
    v_max_f32 v171, 0, v171
    v_max_f32 v172, 0, v172
    v_max_f32 v173, 0, v173
    v_max_f32 v174, 0, v174
    v_max_f32 v175, 0, v175
    v_exp_f32_e64 v112, v112 clamp
    v_exp_f32_e64 v113, v113 clamp
    v_exp_f32_e64 v114, v114 clamp
    v_exp_f32_e64 v115, v115 clamp
    v_exp_f32_e64 v116, v116 clamp
    v_exp_f32_e64 v117, v117 clamp
    v_exp_f32_e64 v118, v118 clamp
    v_exp_f32_e64 v119, v119 clamp
    v_exp_f32_e64 v120, v120 clamp
    v_exp_f32_e64 v121, v121 clamp
    v_exp_f32_e64 v122, v122 clamp
    v_exp_f32_e64 v123, v123 clamp
    v_exp_f32_e64 v124, v124 clamp
    v_exp_f32_e64 v125, v125 clamp
    v_exp_f32_e64 v126, v126 clamp
    v_exp_f32_e64 v127, v127 clamp
    s_nop 0
    v_pk_add_f32 v[112:113], v[112:113], v[22:23] op_sel_hi:[1,0]
    v_pk_add_f32 v[114:115], v[114:115], v[22:23] op_sel_hi:[1,0]
    v_pk_add_f32 v[116:117], v[116:117], v[22:23] op_sel_hi:[1,0]
    v_pk_add_f32 v[118:119], v[118:119], v[22:23] op_sel_hi:[1,0]
    v_pk_add_f32 v[120:121], v[120:121], v[22:23] op_sel_hi:[1,0]
    v_pk_add_f32 v[122:123], v[122:123], v[22:23] op_sel_hi:[1,0]
    v_pk_add_f32 v[124:125], v[124:125], v[22:23] op_sel_hi:[1,0]
    v_pk_add_f32 v[126:127], v[126:127], v[22:23] op_sel_hi:[1,0]
    v_pk_fma_f32 v[160:161], v[160:161], v[44:45], v[112:113]
    v_pk_fma_f32 v[162:163], v[162:163], v[46:47], v[114:115]
    v_pk_fma_f32 v[164:165], v[164:165], v[48:49], v[116:117]
    v_pk_fma_f32 v[166:167], v[166:167], v[50:51], v[118:119]
    v_pk_fma_f32 v[168:169], v[168:169], v[52:53], v[120:121]
    v_pk_fma_f32 v[170:171], v[170:171], v[54:55], v[122:123]
    v_pk_fma_f32 v[172:173], v[172:173], v[56:57], v[124:125]
    v_pk_fma_f32 v[174:175], v[174:175], v[58:59], v[126:127]
    v_cvt_pk_bf16_f32 v128, v160, v161
    v_cvt_pk_bf16_f32 v129, v162, v163
    v_cvt_pk_bf16_f32 v130, v164, v165
    v_cvt_pk_bf16_f32 v131, v166, v167
    v_cvt_pk_bf16_f32 v132, v168, v169
    v_cvt_pk_bf16_f32 v133, v170, v171
    v_cvt_pk_bf16_f32 v134, v172, v173
    v_cvt_pk_bf16_f32 v135, v174, v175
    ds_write_b128 v246, v[128:131] offset:0
    ds_write_b128 v246, v[132:135] offset:1024
    v_pk_fma_f32 v[176:177], v[28:29], v[94:95], v[176:177] op_sel_hi:[1,0,1]
    v_pk_fma_f32 v[178:179], v[30:31], v[94:95], v[178:179] op_sel_hi:[1,0,1]
    v_pk_fma_f32 v[180:181], v[32:33], v[94:95], v[180:181] op_sel_hi:[1,0,1]
    v_pk_fma_f32 v[182:183], v[34:35], v[94:95], v[182:183] op_sel_hi:[1,0,1]
    v_pk_fma_f32 v[184:185], v[36:37], v[94:95], v[184:185] op_sel_hi:[1,0,1]
    v_pk_fma_f32 v[186:187], v[38:39], v[94:95], v[186:187] op_sel_hi:[1,0,1]
    v_pk_fma_f32 v[188:189], v[40:41], v[94:95], v[188:189] op_sel_hi:[1,0,1]
    v_pk_fma_f32 v[190:191], v[42:43], v[94:95], v[190:191] op_sel_hi:[1,0,1]
    v_pk_mul_f32 v[112:113], v[176:177], v[60:61]
    v_pk_mul_f32 v[114:115], v[178:179], v[62:63]
    v_pk_mul_f32 v[116:117], v[180:181], v[64:65]
    v_pk_mul_f32 v[118:119], v[182:183], v[66:67]
    v_pk_mul_f32 v[120:121], v[184:185], v[68:69]
    v_pk_mul_f32 v[122:123], v[186:187], v[70:71]
    v_pk_mul_f32 v[124:125], v[188:189], v[72:73]
    v_pk_mul_f32 v[126:127], v[190:191], v[74:75]
    v_max_f32 v176, 0, v176
    v_max_f32 v177, 0, v177
    v_max_f32 v178, 0, v178
    v_max_f32 v179, 0, v179
    v_max_f32 v180, 0, v180
    v_max_f32 v181, 0, v181
    v_max_f32 v182, 0, v182
    v_max_f32 v183, 0, v183
    v_max_f32 v184, 0, v184
    v_max_f32 v185, 0, v185
    v_max_f32 v186, 0, v186
    v_max_f32 v187, 0, v187
    v_max_f32 v188, 0, v188
    v_max_f32 v189, 0, v189
    v_max_f32 v190, 0, v190
    v_max_f32 v191, 0, v191
    v_exp_f32_e64 v112, v112 clamp
    v_exp_f32_e64 v113, v113 clamp
    v_exp_f32_e64 v114, v114 clamp
    v_exp_f32_e64 v115, v115 clamp
    v_exp_f32_e64 v116, v116 clamp
    v_exp_f32_e64 v117, v117 clamp
    v_exp_f32_e64 v118, v118 clamp
    v_exp_f32_e64 v119, v119 clamp
    v_exp_f32_e64 v120, v120 clamp
    v_exp_f32_e64 v121, v121 clamp
    v_exp_f32_e64 v122, v122 clamp
    v_exp_f32_e64 v123, v123 clamp
    v_exp_f32_e64 v124, v124 clamp
    v_exp_f32_e64 v125, v125 clamp
    v_exp_f32_e64 v126, v126 clamp
    v_exp_f32_e64 v127, v127 clamp
    s_nop 0
    v_pk_add_f32 v[112:113], v[112:113], v[22:23] op_sel_hi:[1,0]
    v_pk_add_f32 v[114:115], v[114:115], v[22:23] op_sel_hi:[1,0]
    v_pk_add_f32 v[116:117], v[116:117], v[22:23] op_sel_hi:[1,0]
    v_pk_add_f32 v[118:119], v[118:119], v[22:23] op_sel_hi:[1,0]
    v_pk_add_f32 v[120:121], v[120:121], v[22:23] op_sel_hi:[1,0]
    v_pk_add_f32 v[122:123], v[122:123], v[22:23] op_sel_hi:[1,0]
    v_pk_add_f32 v[124:125], v[124:125], v[22:23] op_sel_hi:[1,0]
    v_pk_add_f32 v[126:127], v[126:127], v[22:23] op_sel_hi:[1,0]
    v_pk_fma_f32 v[176:177], v[176:177], v[44:45], v[112:113]
    v_pk_fma_f32 v[178:179], v[178:179], v[46:47], v[114:115]
    v_pk_fma_f32 v[180:181], v[180:181], v[48:49], v[116:117]
    v_pk_fma_f32 v[182:183], v[182:183], v[50:51], v[118:119]
    v_pk_fma_f32 v[184:185], v[184:185], v[52:53], v[120:121]
    v_pk_fma_f32 v[186:187], v[186:187], v[54:55], v[122:123]
    v_pk_fma_f32 v[188:189], v[188:189], v[56:57], v[124:125]
    v_pk_fma_f32 v[190:191], v[190:191], v[58:59], v[126:127]
    v_cvt_pk_bf16_f32 v136, v176, v177
    v_cvt_pk_bf16_f32 v137, v178, v179
    v_cvt_pk_bf16_f32 v138, v180, v181
    v_cvt_pk_bf16_f32 v139, v182, v183
    v_cvt_pk_bf16_f32 v140, v184, v185
    v_cvt_pk_bf16_f32 v141, v186, v187
    v_cvt_pk_bf16_f32 v142, v188, v189
    v_cvt_pk_bf16_f32 v143, v190, v191
    ds_write_b128 v246, v[136:139] offset:8192
    ds_write_b128 v246, v[140:143] offset:9216
    v_pk_fma_f32 v[192:193], v[28:29], v[96:97], v[192:193] op_sel_hi:[1,0,1]
    v_pk_fma_f32 v[194:195], v[30:31], v[96:97], v[194:195] op_sel_hi:[1,0,1]
    v_pk_fma_f32 v[196:197], v[32:33], v[96:97], v[196:197] op_sel_hi:[1,0,1]
    v_pk_fma_f32 v[198:199], v[34:35], v[96:97], v[198:199] op_sel_hi:[1,0,1]
    v_pk_fma_f32 v[200:201], v[36:37], v[96:97], v[200:201] op_sel_hi:[1,0,1]
    v_pk_fma_f32 v[202:203], v[38:39], v[96:97], v[202:203] op_sel_hi:[1,0,1]
    v_pk_fma_f32 v[204:205], v[40:41], v[96:97], v[204:205] op_sel_hi:[1,0,1]
    v_pk_fma_f32 v[206:207], v[42:43], v[96:97], v[206:207] op_sel_hi:[1,0,1]
    v_pk_mul_f32 v[112:113], v[192:193], v[60:61]
    v_pk_mul_f32 v[114:115], v[194:195], v[62:63]
    v_pk_mul_f32 v[116:117], v[196:197], v[64:65]
    v_pk_mul_f32 v[118:119], v[198:199], v[66:67]
    v_pk_mul_f32 v[120:121], v[200:201], v[68:69]
    v_pk_mul_f32 v[122:123], v[202:203], v[70:71]
    v_pk_mul_f32 v[124:125], v[204:205], v[72:73]
    v_pk_mul_f32 v[126:127], v[206:207], v[74:75]
    v_max_f32 v192, 0, v192
    v_max_f32 v193, 0, v193
    v_max_f32 v194, 0, v194
    v_max_f32 v195, 0, v195
    v_max_f32 v196, 0, v196
    v_max_f32 v197, 0, v197
    v_max_f32 v198, 0, v198
    v_max_f32 v199, 0, v199
    v_max_f32 v200, 0, v200
    v_max_f32 v201, 0, v201
    v_max_f32 v202, 0, v202
    v_max_f32 v203, 0, v203
    v_max_f32 v204, 0, v204
    v_max_f32 v205, 0, v205
    v_max_f32 v206, 0, v206
    v_max_f32 v207, 0, v207
    v_exp_f32_e64 v112, v112 clamp
    v_exp_f32_e64 v113, v113 clamp
    v_exp_f32_e64 v114, v114 clamp
    v_exp_f32_e64 v115, v115 clamp
    v_exp_f32_e64 v116, v116 clamp
    v_exp_f32_e64 v117, v117 clamp
    v_exp_f32_e64 v118, v118 clamp
    v_exp_f32_e64 v119, v119 clamp
    v_exp_f32_e64 v120, v120 clamp
    v_exp_f32_e64 v121, v121 clamp
    v_exp_f32_e64 v122, v122 clamp
    v_exp_f32_e64 v123, v123 clamp
    v_exp_f32_e64 v124, v124 clamp
    v_exp_f32_e64 v125, v125 clamp
    v_exp_f32_e64 v126, v126 clamp
    v_exp_f32_e64 v127, v127 clamp
    s_nop 0
    v_pk_add_f32 v[112:113], v[112:113], v[22:23] op_sel_hi:[1,0]
    v_pk_add_f32 v[114:115], v[114:115], v[22:23] op_sel_hi:[1,0]
    v_pk_add_f32 v[116:117], v[116:117], v[22:23] op_sel_hi:[1,0]
    v_pk_add_f32 v[118:119], v[118:119], v[22:23] op_sel_hi:[1,0]
    v_pk_add_f32 v[120:121], v[120:121], v[22:23] op_sel_hi:[1,0]
    v_pk_add_f32 v[122:123], v[122:123], v[22:23] op_sel_hi:[1,0]
    v_pk_add_f32 v[124:125], v[124:125], v[22:23] op_sel_hi:[1,0]
    v_pk_add_f32 v[126:127], v[126:127], v[22:23] op_sel_hi:[1,0]
    v_pk_fma_f32 v[192:193], v[192:193], v[44:45], v[112:113]
    v_pk_fma_f32 v[194:195], v[194:195], v[46:47], v[114:115]
    v_pk_fma_f32 v[196:197], v[196:197], v[48:49], v[116:117]
    v_pk_fma_f32 v[198:199], v[198:199], v[50:51], v[118:119]
    v_pk_fma_f32 v[200:201], v[200:201], v[52:53], v[120:121]
    v_pk_fma_f32 v[202:203], v[202:203], v[54:55], v[122:123]
    v_pk_fma_f32 v[204:205], v[204:205], v[56:57], v[124:125]
    v_pk_fma_f32 v[206:207], v[206:207], v[58:59], v[126:127]
    v_cvt_pk_bf16_f32 v128, v192, v193
    v_cvt_pk_bf16_f32 v129, v194, v195
    v_cvt_pk_bf16_f32 v130, v196, v197
    v_cvt_pk_bf16_f32 v131, v198, v199
    v_cvt_pk_bf16_f32 v132, v200, v201
    v_cvt_pk_bf16_f32 v133, v202, v203
    v_cvt_pk_bf16_f32 v134, v204, v205
    v_cvt_pk_bf16_f32 v135, v206, v207
    ds_write_b128 v246, v[128:131] offset:16384
    ds_write_b128 v246, v[132:135] offset:17408
    v_pk_fma_f32 v[208:209], v[28:29], v[98:99], v[208:209] op_sel_hi:[1,0,1]
    v_pk_fma_f32 v[210:211], v[30:31], v[98:99], v[210:211] op_sel_hi:[1,0,1]
    v_pk_fma_f32 v[212:213], v[32:33], v[98:99], v[212:213] op_sel_hi:[1,0,1]
    v_pk_fma_f32 v[214:215], v[34:35], v[98:99], v[214:215] op_sel_hi:[1,0,1]
    v_pk_fma_f32 v[216:217], v[36:37], v[98:99], v[216:217] op_sel_hi:[1,0,1]
    v_pk_fma_f32 v[218:219], v[38:39], v[98:99], v[218:219] op_sel_hi:[1,0,1]
    v_pk_fma_f32 v[220:221], v[40:41], v[98:99], v[220:221] op_sel_hi:[1,0,1]
    v_pk_fma_f32 v[222:223], v[42:43], v[98:99], v[222:223] op_sel_hi:[1,0,1]
    v_pk_mul_f32 v[112:113], v[208:209], v[60:61]
    v_pk_mul_f32 v[114:115], v[210:211], v[62:63]
    v_pk_mul_f32 v[116:117], v[212:213], v[64:65]
    v_pk_mul_f32 v[118:119], v[214:215], v[66:67]
    v_pk_mul_f32 v[120:121], v[216:217], v[68:69]
    v_pk_mul_f32 v[122:123], v[218:219], v[70:71]
    v_pk_mul_f32 v[124:125], v[220:221], v[72:73]
    v_pk_mul_f32 v[126:127], v[222:223], v[74:75]
    v_max_f32 v208, 0, v208
    v_max_f32 v209, 0, v209
    v_max_f32 v210, 0, v210
    v_max_f32 v211, 0, v211
    v_max_f32 v212, 0, v212
    v_max_f32 v213, 0, v213
    v_max_f32 v214, 0, v214
    v_max_f32 v215, 0, v215
    v_max_f32 v216, 0, v216
    v_max_f32 v217, 0, v217
    v_max_f32 v218, 0, v218
    v_max_f32 v219, 0, v219
    v_max_f32 v220, 0, v220
    v_max_f32 v221, 0, v221
    v_max_f32 v222, 0, v222
    v_max_f32 v223, 0, v223
    v_exp_f32_e64 v112, v112 clamp
    v_exp_f32_e64 v113, v113 clamp
    v_exp_f32_e64 v114, v114 clamp
    v_exp_f32_e64 v115, v115 clamp
    v_exp_f32_e64 v116, v116 clamp
    v_exp_f32_e64 v117, v117 clamp
    v_exp_f32_e64 v118, v118 clamp
    v_exp_f32_e64 v119, v119 clamp
    v_exp_f32_e64 v120, v120 clamp
    v_exp_f32_e64 v121, v121 clamp
    v_exp_f32_e64 v122, v122 clamp
    v_exp_f32_e64 v123, v123 clamp
    v_exp_f32_e64 v124, v124 clamp
    v_exp_f32_e64 v125, v125 clamp
    v_exp_f32_e64 v126, v126 clamp
    v_exp_f32_e64 v127, v127 clamp
    s_nop 0
    v_pk_add_f32 v[112:113], v[112:113], v[22:23] op_sel_hi:[1,0]
    v_pk_add_f32 v[114:115], v[114:115], v[22:23] op_sel_hi:[1,0]
    v_pk_add_f32 v[116:117], v[116:117], v[22:23] op_sel_hi:[1,0]
    v_pk_add_f32 v[118:119], v[118:119], v[22:23] op_sel_hi:[1,0]
    v_pk_add_f32 v[120:121], v[120:121], v[22:23] op_sel_hi:[1,0]
    v_pk_add_f32 v[122:123], v[122:123], v[22:23] op_sel_hi:[1,0]
    v_pk_add_f32 v[124:125], v[124:125], v[22:23] op_sel_hi:[1,0]
    v_pk_add_f32 v[126:127], v[126:127], v[22:23] op_sel_hi:[1,0]
    v_pk_fma_f32 v[208:209], v[208:209], v[44:45], v[112:113]
    v_pk_fma_f32 v[210:211], v[210:211], v[46:47], v[114:115]
    v_pk_fma_f32 v[212:213], v[212:213], v[48:49], v[116:117]
    v_pk_fma_f32 v[214:215], v[214:215], v[50:51], v[118:119]
    v_pk_fma_f32 v[216:217], v[216:217], v[52:53], v[120:121]
    v_pk_fma_f32 v[218:219], v[218:219], v[54:55], v[122:123]
    v_pk_fma_f32 v[220:221], v[220:221], v[56:57], v[124:125]
    v_pk_fma_f32 v[222:223], v[222:223], v[58:59], v[126:127]
    v_cvt_pk_bf16_f32 v136, v208, v209
    v_cvt_pk_bf16_f32 v137, v210, v211
    v_cvt_pk_bf16_f32 v138, v212, v213
    v_cvt_pk_bf16_f32 v139, v214, v215
    v_cvt_pk_bf16_f32 v140, v216, v217
    v_cvt_pk_bf16_f32 v141, v218, v219
    v_cvt_pk_bf16_f32 v142, v220, v221
    v_cvt_pk_bf16_f32 v143, v222, v223
    ds_write_b128 v246, v[136:139] offset:24576
    ds_write_b128 v246, v[140:143] offset:25600
    v_pk_fma_f32 v[224:225], v[28:29], v[100:101], v[224:225] op_sel_hi:[1,0,1]
    v_pk_fma_f32 v[226:227], v[30:31], v[100:101], v[226:227] op_sel_hi:[1,0,1]
    v_pk_fma_f32 v[228:229], v[32:33], v[100:101], v[228:229] op_sel_hi:[1,0,1]
    v_pk_fma_f32 v[230:231], v[34:35], v[100:101], v[230:231] op_sel_hi:[1,0,1]
    v_pk_fma_f32 v[232:233], v[36:37], v[100:101], v[232:233] op_sel_hi:[1,0,1]
    v_pk_fma_f32 v[234:235], v[38:39], v[100:101], v[234:235] op_sel_hi:[1,0,1]
    v_pk_fma_f32 v[236:237], v[40:41], v[100:101], v[236:237] op_sel_hi:[1,0,1]
    v_pk_fma_f32 v[238:239], v[42:43], v[100:101], v[238:239] op_sel_hi:[1,0,1]
    v_pk_mul_f32 v[112:113], v[224:225], v[60:61]
    v_pk_mul_f32 v[114:115], v[226:227], v[62:63]
    v_pk_mul_f32 v[116:117], v[228:229], v[64:65]
    v_pk_mul_f32 v[118:119], v[230:231], v[66:67]
    v_pk_mul_f32 v[120:121], v[232:233], v[68:69]
    v_pk_mul_f32 v[122:123], v[234:235], v[70:71]
    v_pk_mul_f32 v[124:125], v[236:237], v[72:73]
    v_pk_mul_f32 v[126:127], v[238:239], v[74:75]
    v_max_f32 v224, 0, v224
    v_max_f32 v225, 0, v225
    v_max_f32 v226, 0, v226
    v_max_f32 v227, 0, v227
    v_max_f32 v228, 0, v228
    v_max_f32 v229, 0, v229
    v_max_f32 v230, 0, v230
    v_max_f32 v231, 0, v231
    v_max_f32 v232, 0, v232
    v_max_f32 v233, 0, v233
    v_max_f32 v234, 0, v234
    v_max_f32 v235, 0, v235
    v_max_f32 v236, 0, v236
    v_max_f32 v237, 0, v237
    v_max_f32 v238, 0, v238
    v_max_f32 v239, 0, v239
    v_exp_f32_e64 v112, v112 clamp
    v_exp_f32_e64 v113, v113 clamp
    v_exp_f32_e64 v114, v114 clamp
    v_exp_f32_e64 v115, v115 clamp
    v_exp_f32_e64 v116, v116 clamp
    v_exp_f32_e64 v117, v117 clamp
    v_exp_f32_e64 v118, v118 clamp
    v_exp_f32_e64 v119, v119 clamp
    v_exp_f32_e64 v120, v120 clamp
    v_exp_f32_e64 v121, v121 clamp
    v_exp_f32_e64 v122, v122 clamp
    v_exp_f32_e64 v123, v123 clamp
    v_exp_f32_e64 v124, v124 clamp
    v_exp_f32_e64 v125, v125 clamp
    v_exp_f32_e64 v126, v126 clamp
    v_exp_f32_e64 v127, v127 clamp
    s_nop 0
    v_pk_add_f32 v[112:113], v[112:113], v[22:23] op_sel_hi:[1,0]
    v_pk_add_f32 v[114:115], v[114:115], v[22:23] op_sel_hi:[1,0]
    v_pk_add_f32 v[116:117], v[116:117], v[22:23] op_sel_hi:[1,0]
    v_pk_add_f32 v[118:119], v[118:119], v[22:23] op_sel_hi:[1,0]
    v_pk_add_f32 v[120:121], v[120:121], v[22:23] op_sel_hi:[1,0]
    v_pk_add_f32 v[122:123], v[122:123], v[22:23] op_sel_hi:[1,0]
    v_pk_add_f32 v[124:125], v[124:125], v[22:23] op_sel_hi:[1,0]
    v_pk_add_f32 v[126:127], v[126:127], v[22:23] op_sel_hi:[1,0]
    v_pk_fma_f32 v[224:225], v[224:225], v[44:45], v[112:113]
    v_pk_fma_f32 v[226:227], v[226:227], v[46:47], v[114:115]
    v_pk_fma_f32 v[228:229], v[228:229], v[48:49], v[116:117]
    v_pk_fma_f32 v[230:231], v[230:231], v[50:51], v[118:119]
    v_pk_fma_f32 v[232:233], v[232:233], v[52:53], v[120:121]
    v_pk_fma_f32 v[234:235], v[234:235], v[54:55], v[122:123]
    v_pk_fma_f32 v[236:237], v[236:237], v[56:57], v[124:125]
    v_pk_fma_f32 v[238:239], v[238:239], v[58:59], v[126:127]
    v_cvt_pk_bf16_f32 v128, v224, v225
    v_cvt_pk_bf16_f32 v129, v226, v227
    v_cvt_pk_bf16_f32 v130, v228, v229
    v_cvt_pk_bf16_f32 v131, v230, v231
    v_cvt_pk_bf16_f32 v132, v232, v233
    v_cvt_pk_bf16_f32 v133, v234, v235
    v_cvt_pk_bf16_f32 v134, v236, v237
    v_cvt_pk_bf16_f32 v135, v238, v239
    ds_write_b128 v246, v[128:131] offset:32768
    ds_write_b128 v246, v[132:135] offset:33792
    s_branch L_k1_kv_x
L_k1_kv_v:
    v_pk_fma_f32 v[160:161], v[28:29], v[92:93], v[160:161] op_sel_hi:[1,0,1]
    v_pk_fma_f32 v[162:163], v[30:31], v[92:93], v[162:163] op_sel_hi:[1,0,1]
    v_pk_fma_f32 v[164:165], v[32:33], v[92:93], v[164:165] op_sel_hi:[1,0,1]
    v_pk_fma_f32 v[166:167], v[34:35], v[92:93], v[166:167] op_sel_hi:[1,0,1]
    v_pk_fma_f32 v[168:169], v[36:37], v[92:93], v[168:169] op_sel_hi:[1,0,1]
    v_pk_fma_f32 v[170:171], v[38:39], v[92:93], v[170:171] op_sel_hi:[1,0,1]
    v_pk_fma_f32 v[172:173], v[40:41], v[92:93], v[172:173] op_sel_hi:[1,0,1]
    v_pk_fma_f32 v[174:175], v[42:43], v[92:93], v[174:175] op_sel_hi:[1,0,1]
    v_pk_mul_f32 v[160:161], v[160:161], v[44:45]
    v_pk_mul_f32 v[162:163], v[162:163], v[46:47]
    v_pk_mul_f32 v[164:165], v[164:165], v[48:49]
    v_pk_mul_f32 v[166:167], v[166:167], v[50:51]
    v_pk_mul_f32 v[168:169], v[168:169], v[52:53]
    v_pk_mul_f32 v[170:171], v[170:171], v[54:55]
    v_pk_mul_f32 v[172:173], v[172:173], v[56:57]
    v_pk_mul_f32 v[174:175], v[174:175], v[58:59]
    v_cvt_pk_bf16_f32 v128, v160, v161
    v_cvt_pk_bf16_f32 v129, v162, v163
    v_cvt_pk_bf16_f32 v130, v164, v165
    v_cvt_pk_bf16_f32 v131, v166, v167
    v_cvt_pk_bf16_f32 v132, v168, v169
    v_cvt_pk_bf16_f32 v133, v170, v171
    v_cvt_pk_bf16_f32 v134, v172, v173
    v_cvt_pk_bf16_f32 v135, v174, v175
    ds_write_b128 v246, v[128:131] offset:0
    ds_write_b128 v246, v[132:135] offset:1024
    v_pk_fma_f32 v[176:177], v[28:29], v[94:95], v[176:177] op_sel_hi:[1,0,1]
    v_pk_fma_f32 v[178:179], v[30:31], v[94:95], v[178:179] op_sel_hi:[1,0,1]
    v_pk_fma_f32 v[180:181], v[32:33], v[94:95], v[180:181] op_sel_hi:[1,0,1]
    v_pk_fma_f32 v[182:183], v[34:35], v[94:95], v[182:183] op_sel_hi:[1,0,1]
    v_pk_fma_f32 v[184:185], v[36:37], v[94:95], v[184:185] op_sel_hi:[1,0,1]
    v_pk_fma_f32 v[186:187], v[38:39], v[94:95], v[186:187] op_sel_hi:[1,0,1]
    v_pk_fma_f32 v[188:189], v[40:41], v[94:95], v[188:189] op_sel_hi:[1,0,1]
    v_pk_fma_f32 v[190:191], v[42:43], v[94:95], v[190:191] op_sel_hi:[1,0,1]
    v_pk_mul_f32 v[176:177], v[176:177], v[44:45]
    v_pk_mul_f32 v[178:179], v[178:179], v[46:47]
    v_pk_mul_f32 v[180:181], v[180:181], v[48:49]
    v_pk_mul_f32 v[182:183], v[182:183], v[50:51]
    v_pk_mul_f32 v[184:185], v[184:185], v[52:53]
    v_pk_mul_f32 v[186:187], v[186:187], v[54:55]
    v_pk_mul_f32 v[188:189], v[188:189], v[56:57]
    v_pk_mul_f32 v[190:191], v[190:191], v[58:59]
    v_cvt_pk_bf16_f32 v136, v176, v177
    v_cvt_pk_bf16_f32 v137, v178, v179
    v_cvt_pk_bf16_f32 v138, v180, v181
    v_cvt_pk_bf16_f32 v139, v182, v183
    v_cvt_pk_bf16_f32 v140, v184, v185
    v_cvt_pk_bf16_f32 v141, v186, v187
    v_cvt_pk_bf16_f32 v142, v188, v189
    v_cvt_pk_bf16_f32 v143, v190, v191
    ds_write_b128 v246, v[136:139] offset:8192
    ds_write_b128 v246, v[140:143] offset:9216
    v_pk_fma_f32 v[192:193], v[28:29], v[96:97], v[192:193] op_sel_hi:[1,0,1]
    v_pk_fma_f32 v[194:195], v[30:31], v[96:97], v[194:195] op_sel_hi:[1,0,1]
    v_pk_fma_f32 v[196:197], v[32:33], v[96:97], v[196:197] op_sel_hi:[1,0,1]
    v_pk_fma_f32 v[198:199], v[34:35], v[96:97], v[198:199] op_sel_hi:[1,0,1]
    v_pk_fma_f32 v[200:201], v[36:37], v[96:97], v[200:201] op_sel_hi:[1,0,1]
    v_pk_fma_f32 v[202:203], v[38:39], v[96:97], v[202:203] op_sel_hi:[1,0,1]
    v_pk_fma_f32 v[204:205], v[40:41], v[96:97], v[204:205] op_sel_hi:[1,0,1]
    v_pk_fma_f32 v[206:207], v[42:43], v[96:97], v[206:207] op_sel_hi:[1,0,1]
    v_pk_mul_f32 v[192:193], v[192:193], v[44:45]
    v_pk_mul_f32 v[194:195], v[194:195], v[46:47]
    v_pk_mul_f32 v[196:197], v[196:197], v[48:49]
    v_pk_mul_f32 v[198:199], v[198:199], v[50:51]
    v_pk_mul_f32 v[200:201], v[200:201], v[52:53]
    v_pk_mul_f32 v[202:203], v[202:203], v[54:55]
    v_pk_mul_f32 v[204:205], v[204:205], v[56:57]
    v_pk_mul_f32 v[206:207], v[206:207], v[58:59]
    v_cvt_pk_bf16_f32 v128, v192, v193
    v_cvt_pk_bf16_f32 v129, v194, v195
    v_cvt_pk_bf16_f32 v130, v196, v197
    v_cvt_pk_bf16_f32 v131, v198, v199
    v_cvt_pk_bf16_f32 v132, v200, v201
    v_cvt_pk_bf16_f32 v133, v202, v203
    v_cvt_pk_bf16_f32 v134, v204, v205
    v_cvt_pk_bf16_f32 v135, v206, v207
    ds_write_b128 v246, v[128:131] offset:16384
    ds_write_b128 v246, v[132:135] offset:17408
    v_pk_fma_f32 v[208:209], v[28:29], v[98:99], v[208:209] op_sel_hi:[1,0,1]
    v_pk_fma_f32 v[210:211], v[30:31], v[98:99], v[210:211] op_sel_hi:[1,0,1]
    v_pk_fma_f32 v[212:213], v[32:33], v[98:99], v[212:213] op_sel_hi:[1,0,1]
    v_pk_fma_f32 v[214:215], v[34:35], v[98:99], v[214:215] op_sel_hi:[1,0,1]
    v_pk_fma_f32 v[216:217], v[36:37], v[98:99], v[216:217] op_sel_hi:[1,0,1]
    v_pk_fma_f32 v[218:219], v[38:39], v[98:99], v[218:219] op_sel_hi:[1,0,1]
    v_pk_fma_f32 v[220:221], v[40:41], v[98:99], v[220:221] op_sel_hi:[1,0,1]
    v_pk_fma_f32 v[222:223], v[42:43], v[98:99], v[222:223] op_sel_hi:[1,0,1]
    v_pk_mul_f32 v[208:209], v[208:209], v[44:45]
    v_pk_mul_f32 v[210:211], v[210:211], v[46:47]
    v_pk_mul_f32 v[212:213], v[212:213], v[48:49]
    v_pk_mul_f32 v[214:215], v[214:215], v[50:51]
    v_pk_mul_f32 v[216:217], v[216:217], v[52:53]
    v_pk_mul_f32 v[218:219], v[218:219], v[54:55]
    v_pk_mul_f32 v[220:221], v[220:221], v[56:57]
    v_pk_mul_f32 v[222:223], v[222:223], v[58:59]
    v_cvt_pk_bf16_f32 v136, v208, v209
    v_cvt_pk_bf16_f32 v137, v210, v211
    v_cvt_pk_bf16_f32 v138, v212, v213
    v_cvt_pk_bf16_f32 v139, v214, v215
    v_cvt_pk_bf16_f32 v140, v216, v217
    v_cvt_pk_bf16_f32 v141, v218, v219
    v_cvt_pk_bf16_f32 v142, v220, v221
    v_cvt_pk_bf16_f32 v143, v222, v223
    ds_write_b128 v246, v[136:139] offset:24576
    ds_write_b128 v246, v[140:143] offset:25600
    v_pk_fma_f32 v[224:225], v[28:29], v[100:101], v[224:225] op_sel_hi:[1,0,1]
    v_pk_fma_f32 v[226:227], v[30:31], v[100:101], v[226:227] op_sel_hi:[1,0,1]
    v_pk_fma_f32 v[228:229], v[32:33], v[100:101], v[228:229] op_sel_hi:[1,0,1]
    v_pk_fma_f32 v[230:231], v[34:35], v[100:101], v[230:231] op_sel_hi:[1,0,1]
    v_pk_fma_f32 v[232:233], v[36:37], v[100:101], v[232:233] op_sel_hi:[1,0,1]
    v_pk_fma_f32 v[234:235], v[38:39], v[100:101], v[234:235] op_sel_hi:[1,0,1]
    v_pk_fma_f32 v[236:237], v[40:41], v[100:101], v[236:237] op_sel_hi:[1,0,1]
    v_pk_fma_f32 v[238:239], v[42:43], v[100:101], v[238:239] op_sel_hi:[1,0,1]
    v_pk_mul_f32 v[224:225], v[224:225], v[44:45]
    v_pk_mul_f32 v[226:227], v[226:227], v[46:47]
    v_pk_mul_f32 v[228:229], v[228:229], v[48:49]
    v_pk_mul_f32 v[230:231], v[230:231], v[50:51]
    v_pk_mul_f32 v[232:233], v[232:233], v[52:53]
    v_pk_mul_f32 v[234:235], v[234:235], v[54:55]
    v_pk_mul_f32 v[236:237], v[236:237], v[56:57]
    v_pk_mul_f32 v[238:239], v[238:239], v[58:59]
    v_cvt_pk_bf16_f32 v128, v224, v225
    v_cvt_pk_bf16_f32 v129, v226, v227
    v_cvt_pk_bf16_f32 v130, v228, v229
    v_cvt_pk_bf16_f32 v131, v230, v231
    v_cvt_pk_bf16_f32 v132, v232, v233
    v_cvt_pk_bf16_f32 v133, v234, v235
    v_cvt_pk_bf16_f32 v134, v236, v237
    v_cvt_pk_bf16_f32 v135, v238, v239
    ds_write_b128 v246, v[128:131] offset:32768
    ds_write_b128 v246, v[132:135] offset:33792
L_k1_kv_x:
    s_waitcnt lgkmcnt(0)
    s_barrier
    s_cmp_ge_u32 s20, 5
    s_cbranch_scc1 L_k1_end
    ds_read_b128 v[28:31], v240 offset:0
    ds_read_b128 v[60:63], v241 offset:0
    ds_read_b128 v[92:95], v241 offset:8192
    ds_read_b128 v[124:127], v241 offset:16384
    ds_read_b128 v[32:35], v240 offset:1024
    ds_read_b128 v[64:67], v241 offset:1024
    ds_read_b128 v[96:99], v241 offset:9216
    ds_read_b128 v[128:131], v241 offset:17408
    ds_read_b128 v[36:39], v240 offset:2048
    ds_read_b128 v[68:71], v241 offset:2048
    ds_read_b128 v[100:103], v241 offset:10240
    ds_read_b128 v[132:135], v241 offset:18432
    s_waitcnt lgkmcnt(8)
    v_mfma_f32_16x16x32_bf16 v[160:163], v[60:63], v[28:31], 0
    v_mfma_f32_16x16x32_bf16 v[164:167], v[92:95], v[28:31], 0
    v_mfma_f32_16x16x32_bf16 v[168:171], v[124:127], v[28:31], 0
    v_mfma_f32_16x16x32_bf16 v[172:175], v[248:251], v[28:31], 0
    ds_read_b128 v[40:43], v240 offset:3072
    ds_read_b128 v[72:75], v241 offset:3072
    ds_read_b128 v[104:107], v241 offset:11264
    ds_read_b128 v[136:139], v241 offset:19456
    s_waitcnt lgkmcnt(8)
    v_mfma_f32_16x16x32_bf16 v[160:163], v[64:67], v[32:35], v[160:163]
    v_mfma_f32_16x16x32_bf16 v[164:167], v[96:99], v[32:35], v[164:167]
    v_mfma_f32_16x16x32_bf16 v[168:171], v[128:131], v[32:35], v[168:171]
    v_mfma_f32_16x16x32_bf16 v[172:175], v[248:251], v[32:35], v[172:175]
    ds_read_b128 v[44:47], v240 offset:4096
    ds_read_b128 v[76:79], v241 offset:4096
    ds_read_b128 v[108:111], v241 offset:12288
    ds_read_b128 v[140:143], v241 offset:20480
    s_waitcnt lgkmcnt(8)
    v_mfma_f32_16x16x32_bf16 v[160:163], v[68:71], v[36:39], v[160:163]
    v_mfma_f32_16x16x32_bf16 v[164:167], v[100:103], v[36:39], v[164:167]
    v_mfma_f32_16x16x32_bf16 v[168:171], v[132:135], v[36:39], v[168:171]
    v_mfma_f32_16x16x32_bf16 v[172:175], v[248:251], v[36:39], v[172:175]
    ds_read_b128 v[48:51], v240 offset:5120
    ds_read_b128 v[80:83], v241 offset:5120
    ds_read_b128 v[112:115], v241 offset:13312
    ds_read_b128 v[144:147], v241 offset:21504
    s_waitcnt lgkmcnt(8)
    v_mfma_f32_16x16x32_bf16 v[160:163], v[72:75], v[40:43], v[160:163]
    v_mfma_f32_16x16x32_bf16 v[164:167], v[104:107], v[40:43], v[164:167]
    v_mfma_f32_16x16x32_bf16 v[168:171], v[136:139], v[40:43], v[168:171]
    v_mfma_f32_16x16x32_bf16 v[172:175], v[248:251], v[40:43], v[172:175]
    ds_read_b128 v[52:55], v240 offset:6144
    ds_read_b128 v[84:87], v241 offset:6144
    ds_read_b128 v[116:119], v241 offset:14336
    ds_read_b128 v[148:151], v241 offset:22528
    s_waitcnt lgkmcnt(8)
    v_mfma_f32_16x16x32_bf16 v[160:163], v[76:79], v[44:47], v[160:163]
    v_mfma_f32_16x16x32_bf16 v[164:167], v[108:111], v[44:47], v[164:167]
    v_mfma_f32_16x16x32_bf16 v[168:171], v[140:143], v[44:47], v[168:171]
    v_mfma_f32_16x16x32_bf16 v[172:175], v[248:251], v[44:47], v[172:175]
    ds_read_b128 v[56:59], v240 offset:7168
    ds_read_b128 v[88:91], v241 offset:7168
    ds_read_b128 v[120:123], v241 offset:15360
    ds_read_b128 v[152:155], v241 offset:23552
    s_waitcnt lgkmcnt(8)
    v_mfma_f32_16x16x32_bf16 v[160:163], v[80:83], v[48:51], v[160:163]
    v_mfma_f32_16x16x32_bf16 v[164:167], v[112:115], v[48:51], v[164:167]
    v_mfma_f32_16x16x32_bf16 v[168:171], v[144:147], v[48:51], v[168:171]
    v_mfma_f32_16x16x32_bf16 v[172:175], v[248:251], v[48:51], v[172:175]
    s_waitcnt lgkmcnt(4)
    v_mfma_f32_16x16x32_bf16 v[160:163], v[84:87], v[52:55], v[160:163]
    v_mfma_f32_16x16x32_bf16 v[164:167], v[116:119], v[52:55], v[164:167]
    v_mfma_f32_16x16x32_bf16 v[168:171], v[148:151], v[52:55], v[168:171]
    v_mfma_f32_16x16x32_bf16 v[172:175], v[248:251], v[52:55], v[172:175]
    s_waitcnt lgkmcnt(0)
    v_mfma_f32_16x16x32_bf16 v[160:163], v[88:91], v[56:59], v[160:163]
    v_mfma_f32_16x16x32_bf16 v[164:167], v[120:123], v[56:59], v[164:167]
    v_mfma_f32_16x16x32_bf16 v[168:171], v[152:155], v[56:59], v[168:171]
    v_mfma_f32_16x16x32_bf16 v[172:175], v[248:251], v[56:59], v[172:175]
    s_nop 4
    buffer_store_dwordx4 v[160:163], v242, s[16:19], 0 offen sc1
    buffer_store_dwordx4 v[164:167], v243, s[16:19], 0 offen sc1
    buffer_store_dwordx4 v[168:171], v244, s[16:19], 0 offen sc1
    buffer_store_dwordx4 v[172:175], v245, s[16:19], 0 offen sc1
    s_branch L_k1_end
L_k1_kv_spin:
    s_mov_b32 s51, 0
L_k1_kv_spin2:
    s_sleep 4
    buffer_load_dword v159, v158, s[44:47], 0 offen sc1
    s_add_u32 s51, s51, 1
    s_cmp_ge_u32 s51, 1000000
    s_waitcnt vmcnt(0)
    s_cbranch_scc1 L_k1_kv_go
    v_cmp_eq_u32 vcc, 0, v159
    s_cbranch_vccnz L_k1_kv_spin2
    s_branch L_k1_kv_go
L_k1_q:
    s_sub_u32 s22, s35, 26
    s_mov_b32 s12, s36
    s_and_b32 s13, s37, 0xffff
    s_mov_b32 s14, 2457600
    s_mov_b32 s15, 0x20000
    s_lshl_b32 s28, s20, 10
    s_add_u32 s29, s28, 8192
    s_add_u32 s30, s28, 16384
    s_lshl_b32 s33, s20, 6
    s_mul_i32 s34, s22, 320
    s_add_u32 s38, s33, 0
    v_add_u32 v44, s38, v1
    v_mul_u32_u24 v45, 52429, v44
    v_lshrrev_b32 v45, 20, v45
    v_mul_u32_u24 v47, 20, v45
    v_sub_u32 v47, v44, v47
    v_mul_u32_u24 v48, 3840, v45
    v_lshl_add_u32 v48, v47, 4, v48
    v_add_u32 v6, s34, v48
    s_add_u32 s38, s33, 512
    v_add_u32 v44, s38, v1
    v_mul_u32_u24 v45, 52429, v44
    v_lshrrev_b32 v45, 20, v45
    v_mul_u32_u24 v47, 20, v45
    v_sub_u32 v47, v44, v47
    v_mul_u32_u24 v48, 3840, v45
    v_lshl_add_u32 v48, v47, 4, v48
    v_add_u32 v7, s34, v48
    s_add_u32 s38, s33, 1024
    v_add_u32 v44, s38, v1
    v_mul_u32_u24 v45, 52429, v44
    v_lshrrev_b32 v45, 20, v45
    v_mul_u32_u24 v47, 20, v45
    v_sub_u32 v47, v44, v47
    v_mul_u32_u24 v48, 3840, v45
    v_lshl_add_u32 v48, v47, 4, v48
    v_add_u32 v8, s34, v48
    v_cmp_lt_u32 vcc, 63, v45
    v_mov_b32 v50, 0x40000000
    s_nop 0
    v_cndmask_b32 v8, v8, v50, vcc
    s_mul_i32 s24, s25, 245760
    s_mov_b32 s62, s25
    s_and_b32 s63, s25, 1
    s_add_u32 s23, s23, 128
    s_cmp_eq_u32 s23, 1280
    s_cselect_b32 s23, 0, s23
    s_add_u32 m0, s28, 0
    s_xor_b32 s24, 0, s62
    s_mul_i32 s24, s24, 245760
    buffer_load_dwordx4 v6, s[12:15], s24 offen  lds
    s_add_u32 m0, s29, 0
    s_nop 0
    buffer_load_dwordx4 v7, s[12:15], s24 offen  lds
    s_add_u32 m0, s30, 0
    s_nop 0
    buffer_load_dwordx4 v8, s[12:15], s24 offen  lds
    s_and_b32 s32, s2, 7
    s_lshr_b32 s33, s2, 3
    s_lshr_b32 s82, s32, 1
    s_lshl_b32 s82, s82, 3
    s_and_b32 s34, s33, 7
    s_add_u32 s82, s82, s34
    s_and_b32 s83, s32, 1
    s_lshl_b32 s83, s83, 2
    s_lshr_b32 s34, s33, 3
    s_add_u32 s83, s83, s34
    s_lshl_b32 s79, s82, 3
    s_add_u32 s79, s79, s83
    s_lshl_b32 s79, s79, 9
    s_add_u32 s79, s79, 14560256
    s_lshl_b32 s68, s21, 14
    s_lshl_b32 s69, s35, 2
    s_sub_u32 s34, s69, 32
    s_cmp_ge_u32 s35, 26
    s_cselect_b32 s69, s34, s69
    s_add_u32 s68, s68, s69
    s_sub_u32 s69, s35, 18
    s_lshl_b32 s34, s69, 8
    s_lshl_b32 s38, s21, 2
    s_add_u32 s34, s34, s38
    s_add_u32 s34, s34, 131072
    s_cmp_lt_u32 s69, 8
    s_cselect_b32 s68, s34, s68
    s_cselect_b32 s69, 2, 32
    s_cselect_b32 s85, 7, 9
    s_lshl_b32 s34, s21, 1
    s_add_u32 s34, s34, s35
    s_add_u32 s34, s34, 18
    s_lshl_b32 s34, s34, 2
    s_cmp_ge_u32 s35, 30
    s_cselect_b32 s68, s34, s68
    s_cselect_b32 s69, 256, s69
    s_add_u32 s68, s68, 14560256
    v_lshrrev_b32 v47, 4, v1
    v_bfe_u32 v48, v1, 2, 2
    v_lshl_add_u32 v48, v47, 3, v48
    v_mul_u32_u24 v48, 320, v48
    v_and_b32 v49, 1, v47
    v_lshlrev_b32 v49, 5, v49
    v_bfe_u32 v50, v1, 1, 3
    v_xor_b32 v50, v50, v47
    v_and_b32 v51, 15, v1
    v_lshlrev_b32 v52, 7, v51
    v_lshl_add_u32 v52, v50, 4, v52
    s_lshl_b32 s32, s31, 13
    s_add_u32 s32, s32, 98304
    v_add_u32 v156, s32, v52
    v_xor_b32 v52, 64, v52
    v_add_u32 v157, s32, v52
    s_lshl_b32 s32, s21, 2
    s_add_u32 s32, s32, s31
    s_lshl_b32 s49, s32, 8
    s_add_u32 s49, s49, 14543872
    s_add_u32 s50, s49, 8192
    v_lshlrev_b32 v158, 2, v51
    v_mul_u32_u24 v53, 80, v46
    v_add_u32 v53, v53, v48
    s_mul_i32 s32, s27, 6
    s_add_u32 s33, s27, 4
    s_lshl_b32 s34, s32, 3
    v_add_u32 v9, s34, v53
    s_lshl_b32 s34, s32, 7
    s_add_u32 s34, s34, 159744
    v_lshl_add_u32 v152, v47, 4, s34
    s_lshl_b32 s34, s33, 3
    v_add_u32 v10, s34, v53
    s_lshl_b32 s34, s33, 7
    s_add_u32 s34, s34, 159744
    v_lshl_add_u32 v153, v47, 4, s34
    s_mul_i32 s32, s20, 3
    s_add_u32 s32, s32, 0
    s_and_b32 s33, s32, 1
    s_mul_i32 s33, s33, 1280
    s_lshr_b32 s32, s32, 1
    s_min_u32 s32, s32, 9
    s_lshl_b32 s32, s32, 3
    s_add_u32 s32, s32, s33
    v_add_u32 v12, s32, v53
    s_mul_i32 s32, s20, 3
    s_add_u32 s32, s32, 1
    s_and_b32 s33, s32, 1
    s_mul_i32 s33, s33, 1280
    s_lshr_b32 s32, s32, 1
    s_min_u32 s32, s32, 9
    s_lshl_b32 s32, s32, 3
    s_add_u32 s32, s32, s33
    v_add_u32 v13, s32, v53
    s_mul_i32 s32, s20, 3
    s_add_u32 s32, s32, 2
    s_and_b32 s33, s32, 1
    s_mul_i32 s33, s33, 1280
    s_lshr_b32 s32, s32, 1
    s_min_u32 s32, s32, 9
    s_lshl_b32 s32, s32, 3
    s_add_u32 s32, s32, s33
    v_add_u32 v14, s32, v53
    v_lshlrev_b32 v155, 2, v51
    s_lshl_b32 s32, s21, 2
    s_add_u32 s32, s32, s31
    s_mul_i32 s32, s32, 20
    s_mul_i32 s33, s22, 5
    s_add_u32 s32, s32, s33
    s_lshl_b32 s32, s32, 12
    s_add_u32 s32, s32, 7077888
    s_mul_i32 s33, s27, 12288
    s_add_u32 s52, s32, s33
    s_add_u32 s53, s32, 8192
    v_mov_b32 v16, 0
    v_mov_b32 v17, 0
    v_mov_b32 v18, 0
    v_mov_b32 v19, 0
    v_mov_b32 v20, 0
    v_mov_b32 v21, 0
    s_add_u32 m0, s28, 24576
    s_xor_b32 s24, 1, s62
    s_mul_i32 s24, s24, 245760
    buffer_load_dwordx4 v6, s[12:15], s24 offen  lds
    s_add_u32 m0, s29, 24576
    s_nop 0
    buffer_load_dwordx4 v7, s[12:15], s24 offen  lds
    s_add_u32 m0, s30, 24576
    s_nop 0
    buffer_load_dwordx4 v8, s[12:15], s24 offen  lds
    s_add_u32 m0, s26, 32768
    s_xor_b32 s23, 1, s62
    s_lshl_b32 s23, s23, 7
    buffer_load_dwordx4 v2, s[8:11], s23 offen  lds
    s_add_u32 m0, s26, 33792
    s_nop 0
    buffer_load_dwordx4 v3, s[8:11], s23 offen  lds
    s_add_u32 m0, s26, 34816
    s_nop 0
    buffer_load_dwordx4 v4, s[8:11], s23 offen  lds
    s_add_u32 m0, s26, 35840
    s_nop 0
    buffer_load_dwordx4 v5, s[8:11], s23 offen  lds
    s_add_u32 m0, s28, 49152
    s_xor_b32 s24, 2, s62
    s_mul_i32 s24, s24, 245760
    buffer_load_dwordx4 v6, s[12:15], s24 offen  lds
    s_add_u32 m0, s29, 49152
    s_nop 0
    buffer_load_dwordx4 v7, s[12:15], s24 offen  lds
    s_add_u32 m0, s30, 49152
    s_nop 0
    buffer_load_dwordx4 v8, s[12:15], s24 offen  lds
    s_waitcnt vmcnt(10)
    s_barrier
    ds_read_b128 v[60:63], v156 offset:0
    ds_read_b64_tr_b16 v[92:93], v9 offset:0
    ds_read_b64_tr_b16 v[94:95], v9 offset:1280
    ds_read_b128 v[64:67], v156 offset:2048
    ds_read_b128 v[68:71], v156 offset:4096
    ds_read_b128 v[72:75], v156 offset:6144
    ds_read_b64_tr_b16 v[116:117], v12 offset:0
    ds_read_b64_tr_b16 v[118:119], v13 offset:0
    ds_read_b64_tr_b16 v[120:121], v14 offset:0
    ds_read_b64_tr_b16 v[96:97], v9 offset:8
    ds_read_b64_tr_b16 v[98:99], v9 offset:1288
    ds_read_b64_tr_b16 v[100:101], v9 offset:16
    ds_read_b64_tr_b16 v[102:103], v9 offset:1296
    ds_read_b64_tr_b16 v[104:105], v9 offset:24
    ds_read_b64_tr_b16 v[106:107], v9 offset:1304
    s_waitcnt lgkmcnt(14)
    ds_read_b64_tr_b16 v[108:109], v10 offset:0
    s_waitcnt lgkmcnt(14)
    ds_read_b64_tr_b16 v[110:111], v10 offset:1280
    s_cmp_eq_u32 s27, 1
    s_cbranch_scc0 L_prio_q
    s_setprio 1
L_prio_q:
    s_waitcnt lgkmcnt(14)
    v_mfma_f32_16x16x32_bf16 v[160:163], v[92:95], v[60:63], 0
    ds_read_b128 v[76:79], v157 offset:0
    s_waitcnt lgkmcnt(14)
    ds_read_b64_tr_b16 v[122:123], v9 offset:10240
    v_mfma_f32_16x16x32_bf16 v[164:167], v[92:95], v[64:67], 0
    s_waitcnt lgkmcnt(14)
    ds_read_b64_tr_b16 v[124:125], v9 offset:11520
    v_mfma_f32_16x16x32_bf16 v[168:171], v[92:95], v[68:71], 0
    s_waitcnt lgkmcnt(14)
    ds_read_b128 v[80:83], v157 offset:2048
    s_waitcnt lgkmcnt(12)
    v_lshlrev_b32 v24, 16, v116
    v_and_b32 v25, 0xffff0000, v116
    v_mfma_f32_16x16x32_bf16 v[172:175], v[92:95], v[72:75], 0
    ds_read_b128 v[84:87], v157 offset:4096
    v_add_f32 v16, v16, v24
    v_add_f32 v17, v17, v25
    s_waitcnt lgkmcnt(11)
    v_mfma_f32_16x16x32_bf16 v[188:191], v[96:99], v[72:75], 0
    ds_read_b128 v[88:91], v157 offset:6144
    v_lshlrev_b32 v26, 16, v117
    v_and_b32 v27, 0xffff0000, v117
    v_mfma_f32_16x16x32_bf16 v[184:187], v[96:99], v[68:71], 0
    ds_read_b64_tr_b16 v[146:147], v12 offset:10240
    v_add_f32 v16, v16, v26
    v_add_f32 v17, v17, v27
    v_mfma_f32_16x16x32_bf16 v[180:183], v[96:99], v[64:67], 0
    ds_read_b64_tr_b16 v[148:149], v13 offset:10240
    v_lshlrev_b32 v24, 16, v118
    v_and_b32 v25, 0xffff0000, v118
    v_mfma_f32_16x16x32_bf16 v[176:179], v[96:99], v[60:63], 0
    ds_read_b64_tr_b16 v[150:151], v14 offset:10240
    v_add_f32 v18, v18, v24
    v_add_f32 v19, v19, v25
    s_waitcnt lgkmcnt(13)
    v_mfma_f32_16x16x32_bf16 v[192:195], v[100:103], v[60:63], 0
    ds_read_b64_tr_b16 v[126:127], v9 offset:10248
    v_lshlrev_b32 v26, 16, v119
    v_mfma_f32_16x16x32_bf16 v[196:199], v[100:103], v[64:67], 0
    ds_read_b64_tr_b16 v[128:129], v9 offset:11528
    v_and_b32 v27, 0xffff0000, v119
    v_mfma_f32_16x16x32_bf16 v[200:203], v[100:103], v[68:71], 0
    s_waitcnt lgkmcnt(14)
    ds_read_b64_tr_b16 v[130:131], v9 offset:10256
    v_add_f32 v18, v18, v26
    v_mfma_f32_16x16x32_bf16 v[204:207], v[100:103], v[72:75], 0
    s_waitcnt lgkmcnt(14)
    ds_read_b64_tr_b16 v[132:133], v9 offset:11536
    v_add_f32 v19, v19, v27
    v_mfma_f32_16x16x32_bf16 v[220:223], v[104:107], v[72:75], 0
    s_waitcnt lgkmcnt(14)
    ds_read_b64_tr_b16 v[134:135], v9 offset:10264
    v_lshlrev_b32 v24, 16, v120
    v_mfma_f32_16x16x32_bf16 v[216:219], v[104:107], v[68:71], 0
    s_waitcnt lgkmcnt(14)
    ds_read_b64_tr_b16 v[136:137], v9 offset:11544
    v_and_b32 v25, 0xffff0000, v120
    v_mfma_f32_16x16x32_bf16 v[212:215], v[104:107], v[64:67], 0
    s_waitcnt lgkmcnt(14)
    ds_read_b64_tr_b16 v[138:139], v10 offset:10240
    v_add_f32 v20, v20, v24
    v_mfma_f32_16x16x32_bf16 v[208:211], v[104:107], v[60:63], 0
    s_waitcnt lgkmcnt(14)
    ds_read_b64_tr_b16 v[140:141], v10 offset:11520
    v_add_f32 v21, v21, v25
    v_mfma_f32_16x16x32_bf16 v[224:227], v[108:111], v[60:63], 0
    v_lshlrev_b32 v26, 16, v121
    v_mfma_f32_16x16x32_bf16 v[228:231], v[108:111], v[64:67], 0
    v_and_b32 v27, 0xffff0000, v121
    v_mfma_f32_16x16x32_bf16 v[232:235], v[108:111], v[68:71], 0
    v_add_f32 v20, v20, v26
    v_mfma_f32_16x16x32_bf16 v[236:239], v[108:111], v[72:75], 0
    v_add_f32 v21, v21, v27
    s_waitcnt vmcnt(3) lgkmcnt(11)
    s_barrier
    v_mfma_f32_16x16x32_bf16 v[160:163], v[122:125], v[76:79], v[160:163]
    ds_read_b128 v[60:63], v156 offset:32768
    ds_read_b64_tr_b16 v[92:93], v9 offset:24576
    s_add_u32 m0, s26, 0
    s_xor_b32 s23, 2, s62
    s_lshl_b32 s23, s23, 7
    buffer_load_dwordx4 v2, s[8:11], s23 offen  lds
    v_mfma_f32_16x16x32_bf16 v[164:167], v[122:125], v[80:83], v[164:167]
    ds_read_b64_tr_b16 v[94:95], v9 offset:25856
    v_mfma_f32_16x16x32_bf16 v[168:171], v[122:125], v[84:87], v[168:171]
    ds_read_b128 v[64:67], v156 offset:34816
    s_waitcnt lgkmcnt(12)
    v_lshlrev_b32 v24, 16, v146
    v_and_b32 v25, 0xffff0000, v146
    s_add_u32 m0, s26, 1024
    s_nop 0
    buffer_load_dwordx4 v3, s[8:11], s23 offen  lds
    v_mfma_f32_16x16x32_bf16 v[172:175], v[122:125], v[88:91], v[172:175]
    ds_read_b128 v[68:71], v156 offset:36864
    v_add_f32 v16, v16, v24
    v_add_f32 v17, v17, v25
    s_waitcnt lgkmcnt(11)
    v_mfma_f32_16x16x32_bf16 v[188:191], v[126:129], v[88:91], v[188:191]
    ds_read_b128 v[72:75], v156 offset:38912
    v_lshlrev_b32 v26, 16, v147
    v_and_b32 v27, 0xffff0000, v147
    s_add_u32 m0, s26, 2048
    s_nop 0
    buffer_load_dwordx4 v4, s[8:11], s23 offen  lds
    v_mfma_f32_16x16x32_bf16 v[184:187], v[126:129], v[84:87], v[184:187]
    ds_read_b64_tr_b16 v[116:117], v12 offset:24576
    v_add_f32 v16, v16, v26
    v_add_f32 v17, v17, v27
    v_mfma_f32_16x16x32_bf16 v[180:183], v[126:129], v[80:83], v[180:183]
    ds_read_b64_tr_b16 v[118:119], v13 offset:24576
    v_lshlrev_b32 v24, 16, v148
    v_and_b32 v25, 0xffff0000, v148
    s_add_u32 m0, s26, 3072
    s_nop 0
    buffer_load_dwordx4 v5, s[8:11], s23 offen  lds
    v_mfma_f32_16x16x32_bf16 v[176:179], v[126:129], v[76:79], v[176:179]
    ds_read_b64_tr_b16 v[120:121], v14 offset:24576
    v_add_f32 v18, v18, v24
    v_add_f32 v19, v19, v25
    s_waitcnt lgkmcnt(13)
    v_mfma_f32_16x16x32_bf16 v[192:195], v[130:133], v[76:79], v[192:195]
    ds_read_b64_tr_b16 v[96:97], v9 offset:24584
    v_lshlrev_b32 v26, 16, v149
    s_add_u32 m0, s28, 73728
    s_xor_b32 s24, 3, s62
    s_mul_i32 s24, s24, 245760
    buffer_load_dwordx4 v6, s[12:15], s24 offen  lds
    v_mfma_f32_16x16x32_bf16 v[196:199], v[130:133], v[80:83], v[196:199]
    ds_read_b64_tr_b16 v[98:99], v9 offset:25864
    v_and_b32 v27, 0xffff0000, v149
    v_mfma_f32_16x16x32_bf16 v[200:203], v[130:133], v[84:87], v[200:203]
    s_waitcnt lgkmcnt(14)
    ds_read_b64_tr_b16 v[100:101], v9 offset:24592
    v_add_f32 v18, v18, v26
    s_add_u32 m0, s29, 73728
    s_nop 0
    buffer_load_dwordx4 v7, s[12:15], s24 offen  lds
    v_mfma_f32_16x16x32_bf16 v[204:207], v[130:133], v[88:91], v[204:207]
    s_waitcnt lgkmcnt(14)
    ds_read_b64_tr_b16 v[102:103], v9 offset:25872
    v_add_f32 v19, v19, v27
    v_mfma_f32_16x16x32_bf16 v[220:223], v[134:137], v[88:91], v[220:223]
    s_waitcnt lgkmcnt(14)
    ds_read_b64_tr_b16 v[104:105], v9 offset:24600
    v_lshlrev_b32 v24, 16, v150
    s_add_u32 m0, s30, 73728
    s_nop 0
    buffer_load_dwordx4 v8, s[12:15], s24 offen  lds
    v_mfma_f32_16x16x32_bf16 v[216:219], v[134:137], v[84:87], v[216:219]
    s_waitcnt lgkmcnt(14)
    ds_read_b64_tr_b16 v[106:107], v9 offset:25880
    v_and_b32 v25, 0xffff0000, v150
    v_mfma_f32_16x16x32_bf16 v[212:215], v[134:137], v[80:83], v[212:215]
    s_waitcnt lgkmcnt(14)
    ds_read_b64_tr_b16 v[108:109], v10 offset:24576
    v_add_f32 v20, v20, v24
    v_mfma_f32_16x16x32_bf16 v[208:211], v[134:137], v[76:79], v[208:211]
    s_waitcnt lgkmcnt(14)
    ds_read_b64_tr_b16 v[110:111], v10 offset:25856
    v_add_f32 v21, v21, v25
    v_mfma_f32_16x16x32_bf16 v[224:227], v[138:141], v[76:79], v[224:227]
    v_lshlrev_b32 v26, 16, v151
    v_mfma_f32_16x16x32_bf16 v[228:231], v[138:141], v[80:83], v[228:231]
    v_and_b32 v27, 0xffff0000, v151
    v_mfma_f32_16x16x32_bf16 v[232:235], v[138:141], v[84:87], v[232:235]
    v_add_f32 v20, v20, v26
    v_mfma_f32_16x16x32_bf16 v[236:239], v[138:141], v[88:91], v[236:239]
    v_add_f32 v21, v21, v27
    s_waitcnt lgkmcnt(14)
    v_mfma_f32_16x16x32_bf16 v[160:163], v[92:95], v[60:63], v[160:163]
    ds_read_b128 v[76:79], v157 offset:32768
    s_waitcnt lgkmcnt(14)
    ds_read_b64_tr_b16 v[122:123], v9 offset:34816
    v_mfma_f32_16x16x32_bf16 v[164:167], v[92:95], v[64:67], v[164:167]
    s_waitcnt lgkmcnt(14)
    ds_read_b64_tr_b16 v[124:125], v9 offset:36096
    v_mfma_f32_16x16x32_bf16 v[168:171], v[92:95], v[68:71], v[168:171]
    s_waitcnt lgkmcnt(14)
    ds_read_b128 v[80:83], v157 offset:34816
    s_waitcnt lgkmcnt(12)
    v_lshlrev_b32 v24, 16, v116
    v_and_b32 v25, 0xffff0000, v116
    v_mfma_f32_16x16x32_bf16 v[172:175], v[92:95], v[72:75], v[172:175]
    ds_read_b128 v[84:87], v157 offset:36864
    v_add_f32 v16, v16, v24
    v_add_f32 v17, v17, v25
    s_waitcnt lgkmcnt(11)
    v_mfma_f32_16x16x32_bf16 v[188:191], v[96:99], v[72:75], v[188:191]
    ds_read_b128 v[88:91], v157 offset:38912
    v_lshlrev_b32 v26, 16, v117
    v_and_b32 v27, 0xffff0000, v117
    v_mfma_f32_16x16x32_bf16 v[184:187], v[96:99], v[68:71], v[184:187]
    ds_read_b64_tr_b16 v[146:147], v12 offset:34816
    v_add_f32 v16, v16, v26
    v_add_f32 v17, v17, v27
    v_mfma_f32_16x16x32_bf16 v[180:183], v[96:99], v[64:67], v[180:183]
    ds_read_b64_tr_b16 v[148:149], v13 offset:34816
    v_lshlrev_b32 v24, 16, v118
    v_and_b32 v25, 0xffff0000, v118
    v_mfma_f32_16x16x32_bf16 v[176:179], v[96:99], v[60:63], v[176:179]
    ds_read_b64_tr_b16 v[150:151], v14 offset:34816
    v_add_f32 v18, v18, v24
    v_add_f32 v19, v19, v25
    s_waitcnt lgkmcnt(13)
    v_mfma_f32_16x16x32_bf16 v[192:195], v[100:103], v[60:63], v[192:195]
    ds_read_b64_tr_b16 v[126:127], v9 offset:34824
    v_lshlrev_b32 v26, 16, v119
    v_mfma_f32_16x16x32_bf16 v[196:199], v[100:103], v[64:67], v[196:199]
    ds_read_b64_tr_b16 v[128:129], v9 offset:36104
    v_and_b32 v27, 0xffff0000, v119
    v_mfma_f32_16x16x32_bf16 v[200:203], v[100:103], v[68:71], v[200:203]
    s_waitcnt lgkmcnt(14)
    ds_read_b64_tr_b16 v[130:131], v9 offset:34832
    v_add_f32 v18, v18, v26
    v_mfma_f32_16x16x32_bf16 v[204:207], v[100:103], v[72:75], v[204:207]
    s_waitcnt lgkmcnt(14)
    ds_read_b64_tr_b16 v[132:133], v9 offset:36112
    v_add_f32 v19, v19, v27
    v_mfma_f32_16x16x32_bf16 v[220:223], v[104:107], v[72:75], v[220:223]
    s_waitcnt lgkmcnt(14)
    ds_read_b64_tr_b16 v[134:135], v9 offset:34840
    v_lshlrev_b32 v24, 16, v120
    v_mfma_f32_16x16x32_bf16 v[216:219], v[104:107], v[68:71], v[216:219]
    s_waitcnt lgkmcnt(14)
    ds_read_b64_tr_b16 v[136:137], v9 offset:36120
    v_and_b32 v25, 0xffff0000, v120
    v_mfma_f32_16x16x32_bf16 v[212:215], v[104:107], v[64:67], v[212:215]
    s_waitcnt lgkmcnt(14)
    ds_read_b64_tr_b16 v[138:139], v10 offset:34816
    v_add_f32 v20, v20, v24
    v_mfma_f32_16x16x32_bf16 v[208:211], v[104:107], v[60:63], v[208:211]
    s_waitcnt lgkmcnt(14)
    ds_read_b64_tr_b16 v[140:141], v10 offset:36096
    v_add_f32 v21, v21, v25
    v_mfma_f32_16x16x32_bf16 v[224:227], v[108:111], v[60:63], v[224:227]
    v_lshlrev_b32 v26, 16, v121
    v_mfma_f32_16x16x32_bf16 v[228:231], v[108:111], v[64:67], v[228:231]
    v_and_b32 v27, 0xffff0000, v121
    v_mfma_f32_16x16x32_bf16 v[232:235], v[108:111], v[68:71], v[232:235]
    v_add_f32 v20, v20, v26
    v_mfma_f32_16x16x32_bf16 v[236:239], v[108:111], v[72:75], v[236:239]
    v_add_f32 v21, v21, v27
    s_waitcnt vmcnt(3) lgkmcnt(11)
    s_barrier
    v_add_u32 v9, 49152, v9
    v_add_u32 v10, 49152, v10
    v_add_u32 v12, 49152, v12
    v_add_u32 v13, 49152, v13
    v_add_u32 v14, 49152, v14
    v_mfma_f32_16x16x32_bf16 v[160:163], v[122:125], v[76:79], v[160:163]
    ds_read_b128 v[60:63], v156 offset:0
    ds_read_b64_tr_b16 v[92:93], v9 offset:0
    s_add_u32 m0, s26, 32768
    s_xor_b32 s23, 3, s62
    s_lshl_b32 s23, s23, 7
    buffer_load_dwordx4 v2, s[8:11], s23 offen  lds
    v_mfma_f32_16x16x32_bf16 v[164:167], v[122:125], v[80:83], v[164:167]
    ds_read_b64_tr_b16 v[94:95], v9 offset:1280
    v_mfma_f32_16x16x32_bf16 v[168:171], v[122:125], v[84:87], v[168:171]
    ds_read_b128 v[64:67], v156 offset:2048
    s_waitcnt lgkmcnt(12)
    v_lshlrev_b32 v24, 16, v146
    v_and_b32 v25, 0xffff0000, v146
    s_add_u32 m0, s26, 33792
    s_nop 0
    buffer_load_dwordx4 v3, s[8:11], s23 offen  lds
    v_mfma_f32_16x16x32_bf16 v[172:175], v[122:125], v[88:91], v[172:175]
    ds_read_b128 v[68:71], v156 offset:4096
    v_add_f32 v16, v16, v24
    v_add_f32 v17, v17, v25
    s_waitcnt lgkmcnt(11)
    v_mfma_f32_16x16x32_bf16 v[188:191], v[126:129], v[88:91], v[188:191]
    ds_read_b128 v[72:75], v156 offset:6144
    v_lshlrev_b32 v26, 16, v147
    v_and_b32 v27, 0xffff0000, v147
    s_add_u32 m0, s26, 34816
    s_nop 0
    buffer_load_dwordx4 v4, s[8:11], s23 offen  lds
    v_mfma_f32_16x16x32_bf16 v[184:187], v[126:129], v[84:87], v[184:187]
    ds_read_b64_tr_b16 v[116:117], v12 offset:0
    v_add_f32 v16, v16, v26
    v_add_f32 v17, v17, v27
    v_mfma_f32_16x16x32_bf16 v[180:183], v[126:129], v[80:83], v[180:183]
    ds_read_b64_tr_b16 v[118:119], v13 offset:0
    v_lshlrev_b32 v24, 16, v148
    v_and_b32 v25, 0xffff0000, v148
    s_add_u32 m0, s26, 35840
    s_nop 0
    buffer_load_dwordx4 v5, s[8:11], s23 offen  lds
    v_mfma_f32_16x16x32_bf16 v[176:179], v[126:129], v[76:79], v[176:179]
    ds_read_b64_tr_b16 v[120:121], v14 offset:0
    v_add_f32 v18, v18, v24
    v_add_f32 v19, v19, v25
    s_waitcnt lgkmcnt(13)
    v_mfma_f32_16x16x32_bf16 v[192:195], v[130:133], v[76:79], v[192:195]
    ds_read_b64_tr_b16 v[96:97], v9 offset:8
    v_lshlrev_b32 v26, 16, v149
    s_add_u32 m0, s28, 0
    s_xor_b32 s24, 4, s62
    s_mul_i32 s24, s24, 245760
    buffer_load_dwordx4 v6, s[12:15], s24 offen  lds
    v_mfma_f32_16x16x32_bf16 v[196:199], v[130:133], v[80:83], v[196:199]
    ds_read_b64_tr_b16 v[98:99], v9 offset:1288
    v_and_b32 v27, 0xffff0000, v149
    v_mfma_f32_16x16x32_bf16 v[200:203], v[130:133], v[84:87], v[200:203]
    s_waitcnt lgkmcnt(14)
    ds_read_b64_tr_b16 v[100:101], v9 offset:16
    v_add_f32 v18, v18, v26
    s_add_u32 m0, s29, 0
    s_nop 0
    buffer_load_dwordx4 v7, s[12:15], s24 offen  lds
    v_mfma_f32_16x16x32_bf16 v[204:207], v[130:133], v[88:91], v[204:207]
    s_waitcnt lgkmcnt(14)
    ds_read_b64_tr_b16 v[102:103], v9 offset:1296
    v_add_f32 v19, v19, v27
    v_mfma_f32_16x16x32_bf16 v[220:223], v[134:137], v[88:91], v[220:223]
    s_waitcnt lgkmcnt(14)
    ds_read_b64_tr_b16 v[104:105], v9 offset:24
    v_lshlrev_b32 v24, 16, v150
    s_add_u32 m0, s30, 0
    s_nop 0
    buffer_load_dwordx4 v8, s[12:15], s24 offen  lds
    v_mfma_f32_16x16x32_bf16 v[216:219], v[134:137], v[84:87], v[216:219]
    s_waitcnt lgkmcnt(14)
    ds_read_b64_tr_b16 v[106:107], v9 offset:1304
    v_and_b32 v25, 0xffff0000, v150
    v_mfma_f32_16x16x32_bf16 v[212:215], v[134:137], v[80:83], v[212:215]
    s_waitcnt lgkmcnt(14)
    ds_read_b64_tr_b16 v[108:109], v10 offset:0
    v_add_f32 v20, v20, v24
    v_mfma_f32_16x16x32_bf16 v[208:211], v[134:137], v[76:79], v[208:211]
    s_waitcnt lgkmcnt(14)
    ds_read_b64_tr_b16 v[110:111], v10 offset:1280
    v_add_f32 v21, v21, v25
    v_mfma_f32_16x16x32_bf16 v[224:227], v[138:141], v[76:79], v[224:227]
    v_lshlrev_b32 v26, 16, v151
    v_mfma_f32_16x16x32_bf16 v[228:231], v[138:141], v[80:83], v[228:231]
    v_and_b32 v27, 0xffff0000, v151
    v_mfma_f32_16x16x32_bf16 v[232:235], v[138:141], v[84:87], v[232:235]
    v_add_f32 v20, v20, v26
    v_mfma_f32_16x16x32_bf16 v[236:239], v[138:141], v[88:91], v[236:239]
    v_add_f32 v21, v21, v27
    s_waitcnt lgkmcnt(14)
    v_mfma_f32_16x16x32_bf16 v[160:163], v[92:95], v[60:63], v[160:163]
    ds_read_b128 v[76:79], v157 offset:0
    s_waitcnt lgkmcnt(14)
    ds_read_b64_tr_b16 v[122:123], v9 offset:10240
    v_mfma_f32_16x16x32_bf16 v[164:167], v[92:95], v[64:67], v[164:167]
    s_waitcnt lgkmcnt(14)
    ds_read_b64_tr_b16 v[124:125], v9 offset:11520
    v_mfma_f32_16x16x32_bf16 v[168:171], v[92:95], v[68:71], v[168:171]
    s_waitcnt lgkmcnt(14)
    ds_read_b128 v[80:83], v157 offset:2048
    s_waitcnt lgkmcnt(12)
    v_lshlrev_b32 v24, 16, v116
    v_and_b32 v25, 0xffff0000, v116
    v_mfma_f32_16x16x32_bf16 v[172:175], v[92:95], v[72:75], v[172:175]
    ds_read_b128 v[84:87], v157 offset:4096
    v_add_f32 v16, v16, v24
    v_add_f32 v17, v17, v25
    s_waitcnt lgkmcnt(11)
    v_mfma_f32_16x16x32_bf16 v[188:191], v[96:99], v[72:75], v[188:191]
    ds_read_b128 v[88:91], v157 offset:6144
    v_lshlrev_b32 v26, 16, v117
    v_and_b32 v27, 0xffff0000, v117
    v_mfma_f32_16x16x32_bf16 v[184:187], v[96:99], v[68:71], v[184:187]
    ds_read_b64_tr_b16 v[146:147], v12 offset:10240
    v_add_f32 v16, v16, v26
    v_add_f32 v17, v17, v27
    v_mfma_f32_16x16x32_bf16 v[180:183], v[96:99], v[64:67], v[180:183]
    ds_read_b64_tr_b16 v[148:149], v13 offset:10240
    v_lshlrev_b32 v24, 16, v118
    v_and_b32 v25, 0xffff0000, v118
    v_mfma_f32_16x16x32_bf16 v[176:179], v[96:99], v[60:63], v[176:179]
    ds_read_b64_tr_b16 v[150:151], v14 offset:10240
    v_add_f32 v18, v18, v24
    v_add_f32 v19, v19, v25
    s_waitcnt lgkmcnt(13)
    v_mfma_f32_16x16x32_bf16 v[192:195], v[100:103], v[60:63], v[192:195]
    ds_read_b64_tr_b16 v[126:127], v9 offset:10248
    v_lshlrev_b32 v26, 16, v119
    v_mfma_f32_16x16x32_bf16 v[196:199], v[100:103], v[64:67], v[196:199]
    ds_read_b64_tr_b16 v[128:129], v9 offset:11528
    v_and_b32 v27, 0xffff0000, v119
    v_mfma_f32_16x16x32_bf16 v[200:203], v[100:103], v[68:71], v[200:203]
    s_waitcnt lgkmcnt(14)
    ds_read_b64_tr_b16 v[130:131], v9 offset:10256
    v_add_f32 v18, v18, v26
    v_mfma_f32_16x16x32_bf16 v[204:207], v[100:103], v[72:75], v[204:207]
    s_waitcnt lgkmcnt(14)
    ds_read_b64_tr_b16 v[132:133], v9 offset:11536
    v_add_f32 v19, v19, v27
    v_mfma_f32_16x16x32_bf16 v[220:223], v[104:107], v[72:75], v[220:223]
    s_waitcnt lgkmcnt(14)
    ds_read_b64_tr_b16 v[134:135], v9 offset:10264
    v_lshlrev_b32 v24, 16, v120
    v_mfma_f32_16x16x32_bf16 v[216:219], v[104:107], v[68:71], v[216:219]
    s_waitcnt lgkmcnt(14)
    ds_read_b64_tr_b16 v[136:137], v9 offset:11544
    v_and_b32 v25, 0xffff0000, v120
    v_mfma_f32_16x16x32_bf16 v[212:215], v[104:107], v[64:67], v[212:215]
    s_waitcnt lgkmcnt(14)
    ds_read_b64_tr_b16 v[138:139], v10 offset:10240
    v_add_f32 v20, v20, v24
    v_mfma_f32_16x16x32_bf16 v[208:211], v[104:107], v[60:63], v[208:211]
    s_waitcnt lgkmcnt(14)
    ds_read_b64_tr_b16 v[140:141], v10 offset:11520
    v_add_f32 v21, v21, v25
    v_mfma_f32_16x16x32_bf16 v[224:227], v[108:111], v[60:63], v[224:227]
    v_lshlrev_b32 v26, 16, v121
    v_mfma_f32_16x16x32_bf16 v[228:231], v[108:111], v[64:67], v[228:231]
    v_and_b32 v27, 0xffff0000, v121
    v_mfma_f32_16x16x32_bf16 v[232:235], v[108:111], v[68:71], v[232:235]
    v_add_f32 v20, v20, v26
    v_mfma_f32_16x16x32_bf16 v[236:239], v[108:111], v[72:75], v[236:239]
    v_add_f32 v21, v21, v27
    s_waitcnt vmcnt(3) lgkmcnt(11)
    s_barrier
    v_mfma_f32_16x16x32_bf16 v[160:163], v[122:125], v[76:79], v[160:163]
    ds_read_b128 v[60:63], v156 offset:32768
    ds_read_b64_tr_b16 v[92:93], v9 offset:24576
    s_add_u32 m0, s26, 0
    s_xor_b32 s23, 4, s62
    s_lshl_b32 s23, s23, 7
    buffer_load_dwordx4 v2, s[8:11], s23 offen  lds
    v_mfma_f32_16x16x32_bf16 v[164:167], v[122:125], v[80:83], v[164:167]
    ds_read_b64_tr_b16 v[94:95], v9 offset:25856
    v_mfma_f32_16x16x32_bf16 v[168:171], v[122:125], v[84:87], v[168:171]
    ds_read_b128 v[64:67], v156 offset:34816
    s_waitcnt lgkmcnt(12)
    v_lshlrev_b32 v24, 16, v146
    v_and_b32 v25, 0xffff0000, v146
    s_add_u32 m0, s26, 1024
    s_nop 0
    buffer_load_dwordx4 v3, s[8:11], s23 offen  lds
    v_mfma_f32_16x16x32_bf16 v[172:175], v[122:125], v[88:91], v[172:175]
    ds_read_b128 v[68:71], v156 offset:36864
    v_add_f32 v16, v16, v24
    v_add_f32 v17, v17, v25
    s_waitcnt lgkmcnt(11)
    v_mfma_f32_16x16x32_bf16 v[188:191], v[126:129], v[88:91], v[188:191]
    ds_read_b128 v[72:75], v156 offset:38912
    v_lshlrev_b32 v26, 16, v147
    v_and_b32 v27, 0xffff0000, v147
    s_add_u32 m0, s26, 2048
    s_nop 0
    buffer_load_dwordx4 v4, s[8:11], s23 offen  lds
    v_mfma_f32_16x16x32_bf16 v[184:187], v[126:129], v[84:87], v[184:187]
    ds_read_b64_tr_b16 v[116:117], v12 offset:24576
    v_add_f32 v16, v16, v26
    v_add_f32 v17, v17, v27
    v_mfma_f32_16x16x32_bf16 v[180:183], v[126:129], v[80:83], v[180:183]
    ds_read_b64_tr_b16 v[118:119], v13 offset:24576
    v_lshlrev_b32 v24, 16, v148
    v_and_b32 v25, 0xffff0000, v148
    s_add_u32 m0, s26, 3072
    s_nop 0
    buffer_load_dwordx4 v5, s[8:11], s23 offen  lds
    v_mfma_f32_16x16x32_bf16 v[176:179], v[126:129], v[76:79], v[176:179]
    ds_read_b64_tr_b16 v[120:121], v14 offset:24576
    v_add_f32 v18, v18, v24
    v_add_f32 v19, v19, v25
    s_waitcnt lgkmcnt(13)
    v_mfma_f32_16x16x32_bf16 v[192:195], v[130:133], v[76:79], v[192:195]
    ds_read_b64_tr_b16 v[96:97], v9 offset:24584
    v_lshlrev_b32 v26, 16, v149
    s_add_u32 m0, s28, 24576
    s_xor_b32 s24, 5, s62
    s_mul_i32 s24, s24, 245760
    buffer_load_dwordx4 v6, s[12:15], s24 offen  lds
    v_mfma_f32_16x16x32_bf16 v[196:199], v[130:133], v[80:83], v[196:199]
    ds_read_b64_tr_b16 v[98:99], v9 offset:25864
    v_and_b32 v27, 0xffff0000, v149
    v_mfma_f32_16x16x32_bf16 v[200:203], v[130:133], v[84:87], v[200:203]
    s_waitcnt lgkmcnt(14)
    ds_read_b64_tr_b16 v[100:101], v9 offset:24592
    v_add_f32 v18, v18, v26
    s_add_u32 m0, s29, 24576
    s_nop 0
    buffer_load_dwordx4 v7, s[12:15], s24 offen  lds
    v_mfma_f32_16x16x32_bf16 v[204:207], v[130:133], v[88:91], v[204:207]
    s_waitcnt lgkmcnt(14)
    ds_read_b64_tr_b16 v[102:103], v9 offset:25872
    v_add_f32 v19, v19, v27
    v_mfma_f32_16x16x32_bf16 v[220:223], v[134:137], v[88:91], v[220:223]
    s_waitcnt lgkmcnt(14)
    ds_read_b64_tr_b16 v[104:105], v9 offset:24600
    v_lshlrev_b32 v24, 16, v150
    s_add_u32 m0, s30, 24576
    s_nop 0
    buffer_load_dwordx4 v8, s[12:15], s24 offen  lds
    v_mfma_f32_16x16x32_bf16 v[216:219], v[134:137], v[84:87], v[216:219]
    s_waitcnt lgkmcnt(14)
    ds_read_b64_tr_b16 v[106:107], v9 offset:25880
    v_and_b32 v25, 0xffff0000, v150
    v_mfma_f32_16x16x32_bf16 v[212:215], v[134:137], v[80:83], v[212:215]
    s_waitcnt lgkmcnt(14)
    ds_read_b64_tr_b16 v[108:109], v10 offset:24576
    v_add_f32 v20, v20, v24
    v_mfma_f32_16x16x32_bf16 v[208:211], v[134:137], v[76:79], v[208:211]
    s_waitcnt lgkmcnt(14)
    ds_read_b64_tr_b16 v[110:111], v10 offset:25856
    v_add_f32 v21, v21, v25
    v_mfma_f32_16x16x32_bf16 v[224:227], v[138:141], v[76:79], v[224:227]
    v_lshlrev_b32 v26, 16, v151
    v_mfma_f32_16x16x32_bf16 v[228:231], v[138:141], v[80:83], v[228:231]
    v_and_b32 v27, 0xffff0000, v151
    v_mfma_f32_16x16x32_bf16 v[232:235], v[138:141], v[84:87], v[232:235]
    v_add_f32 v20, v20, v26
    v_mfma_f32_16x16x32_bf16 v[236:239], v[138:141], v[88:91], v[236:239]
    v_add_f32 v21, v21, v27
    s_waitcnt lgkmcnt(14)
    v_mfma_f32_16x16x32_bf16 v[160:163], v[92:95], v[60:63], v[160:163]
    ds_read_b128 v[76:79], v157 offset:32768
    s_waitcnt lgkmcnt(14)
    ds_read_b64_tr_b16 v[122:123], v9 offset:34816
    v_mfma_f32_16x16x32_bf16 v[164:167], v[92:95], v[64:67], v[164:167]
    s_waitcnt lgkmcnt(14)
    ds_read_b64_tr_b16 v[124:125], v9 offset:36096
    v_mfma_f32_16x16x32_bf16 v[168:171], v[92:95], v[68:71], v[168:171]
    s_waitcnt lgkmcnt(14)
    ds_read_b128 v[80:83], v157 offset:34816
    s_waitcnt lgkmcnt(12)
    v_lshlrev_b32 v24, 16, v116
    v_and_b32 v25, 0xffff0000, v116
    v_mfma_f32_16x16x32_bf16 v[172:175], v[92:95], v[72:75], v[172:175]
    ds_read_b128 v[84:87], v157 offset:36864
    v_add_f32 v16, v16, v24
    v_add_f32 v17, v17, v25
    s_waitcnt lgkmcnt(11)
    v_mfma_f32_16x16x32_bf16 v[188:191], v[96:99], v[72:75], v[188:191]
    ds_read_b128 v[88:91], v157 offset:38912
    v_lshlrev_b32 v26, 16, v117
    v_and_b32 v27, 0xffff0000, v117
    v_mfma_f32_16x16x32_bf16 v[184:187], v[96:99], v[68:71], v[184:187]
    ds_read_b64_tr_b16 v[146:147], v12 offset:34816
    v_add_f32 v16, v16, v26
    v_add_f32 v17, v17, v27
    v_mfma_f32_16x16x32_bf16 v[180:183], v[96:99], v[64:67], v[180:183]
    ds_read_b64_tr_b16 v[148:149], v13 offset:34816
    v_lshlrev_b32 v24, 16, v118
    v_and_b32 v25, 0xffff0000, v118
    v_mfma_f32_16x16x32_bf16 v[176:179], v[96:99], v[60:63], v[176:179]
    ds_read_b64_tr_b16 v[150:151], v14 offset:34816
    v_add_f32 v18, v18, v24
    v_add_f32 v19, v19, v25
    s_waitcnt lgkmcnt(13)
    v_mfma_f32_16x16x32_bf16 v[192:195], v[100:103], v[60:63], v[192:195]
    ds_read_b64_tr_b16 v[126:127], v9 offset:34824
    v_lshlrev_b32 v26, 16, v119
    v_mfma_f32_16x16x32_bf16 v[196:199], v[100:103], v[64:67], v[196:199]
    ds_read_b64_tr_b16 v[128:129], v9 offset:36104
    v_and_b32 v27, 0xffff0000, v119
    v_mfma_f32_16x16x32_bf16 v[200:203], v[100:103], v[68:71], v[200:203]
    s_waitcnt lgkmcnt(14)
    ds_read_b64_tr_b16 v[130:131], v9 offset:34832
    v_add_f32 v18, v18, v26
    v_mfma_f32_16x16x32_bf16 v[204:207], v[100:103], v[72:75], v[204:207]
    s_waitcnt lgkmcnt(14)
    ds_read_b64_tr_b16 v[132:133], v9 offset:36112
    v_add_f32 v19, v19, v27
    v_mfma_f32_16x16x32_bf16 v[220:223], v[104:107], v[72:75], v[220:223]
    s_waitcnt lgkmcnt(14)
    ds_read_b64_tr_b16 v[134:135], v9 offset:34840
    v_lshlrev_b32 v24, 16, v120
    v_mfma_f32_16x16x32_bf16 v[216:219], v[104:107], v[68:71], v[216:219]
    s_waitcnt lgkmcnt(14)
    ds_read_b64_tr_b16 v[136:137], v9 offset:36120
    v_and_b32 v25, 0xffff0000, v120
    v_mfma_f32_16x16x32_bf16 v[212:215], v[104:107], v[64:67], v[212:215]
    s_waitcnt lgkmcnt(14)
    ds_read_b64_tr_b16 v[138:139], v10 offset:34816
    v_add_f32 v20, v20, v24
    v_mfma_f32_16x16x32_bf16 v[208:211], v[104:107], v[60:63], v[208:211]
    s_waitcnt lgkmcnt(14)
    ds_read_b64_tr_b16 v[140:141], v10 offset:36096
    v_add_f32 v21, v21, v25
    v_mfma_f32_16x16x32_bf16 v[224:227], v[108:111], v[60:63], v[224:227]
    v_lshlrev_b32 v26, 16, v121
    v_mfma_f32_16x16x32_bf16 v[228:231], v[108:111], v[64:67], v[228:231]
    v_and_b32 v27, 0xffff0000, v121
    v_mfma_f32_16x16x32_bf16 v[232:235], v[108:111], v[68:71], v[232:235]
    v_add_f32 v20, v20, v26
    v_mfma_f32_16x16x32_bf16 v[236:239], v[108:111], v[72:75], v[236:239]
    v_add_f32 v21, v21, v27
    s_waitcnt vmcnt(3) lgkmcnt(11)
    s_barrier
    v_subrev_u32 v9, 49152, v9
    v_subrev_u32 v10, 49152, v10
    v_subrev_u32 v12, 49152, v12
    v_subrev_u32 v13, 49152, v13
    v_subrev_u32 v14, 49152, v14
    v_mfma_f32_16x16x32_bf16 v[160:163], v[122:125], v[76:79], v[160:163]
    ds_read_b128 v[60:63], v156 offset:0
    ds_read_b64_tr_b16 v[92:93], v9 offset:0
    s_add_u32 m0, s26, 32768
    s_xor_b32 s23, 5, s62
    s_lshl_b32 s23, s23, 7
    buffer_load_dwordx4 v2, s[8:11], s23 offen  lds
    v_mfma_f32_16x16x32_bf16 v[164:167], v[122:125], v[80:83], v[164:167]
    ds_read_b64_tr_b16 v[94:95], v9 offset:1280
    v_mfma_f32_16x16x32_bf16 v[168:171], v[122:125], v[84:87], v[168:171]
    ds_read_b128 v[64:67], v156 offset:2048
    s_waitcnt lgkmcnt(12)
    v_lshlrev_b32 v24, 16, v146
    v_and_b32 v25, 0xffff0000, v146
    s_add_u32 m0, s26, 33792
    s_nop 0
    buffer_load_dwordx4 v3, s[8:11], s23 offen  lds
    v_mfma_f32_16x16x32_bf16 v[172:175], v[122:125], v[88:91], v[172:175]
    ds_read_b128 v[68:71], v156 offset:4096
    v_add_f32 v16, v16, v24
    v_add_f32 v17, v17, v25
    s_waitcnt lgkmcnt(11)
    v_mfma_f32_16x16x32_bf16 v[188:191], v[126:129], v[88:91], v[188:191]
    ds_read_b128 v[72:75], v156 offset:6144
    v_lshlrev_b32 v26, 16, v147
    v_and_b32 v27, 0xffff0000, v147
    s_add_u32 m0, s26, 34816
    s_nop 0
    buffer_load_dwordx4 v4, s[8:11], s23 offen  lds
    v_mfma_f32_16x16x32_bf16 v[184:187], v[126:129], v[84:87], v[184:187]
    ds_read_b64_tr_b16 v[116:117], v12 offset:0
    v_add_f32 v16, v16, v26
    v_add_f32 v17, v17, v27
    v_mfma_f32_16x16x32_bf16 v[180:183], v[126:129], v[80:83], v[180:183]
    ds_read_b64_tr_b16 v[118:119], v13 offset:0
    v_lshlrev_b32 v24, 16, v148
    v_and_b32 v25, 0xffff0000, v148
    s_add_u32 m0, s26, 35840
    s_nop 0
    buffer_load_dwordx4 v5, s[8:11], s23 offen  lds
    v_mfma_f32_16x16x32_bf16 v[176:179], v[126:129], v[76:79], v[176:179]
    ds_read_b64_tr_b16 v[120:121], v14 offset:0
    v_add_f32 v18, v18, v24
    v_add_f32 v19, v19, v25
    s_waitcnt lgkmcnt(13)
    v_mfma_f32_16x16x32_bf16 v[192:195], v[130:133], v[76:79], v[192:195]
    ds_read_b64_tr_b16 v[96:97], v9 offset:8
    v_lshlrev_b32 v26, 16, v149
    s_add_u32 m0, s28, 49152
    s_xor_b32 s24, 6, s62
    s_mul_i32 s24, s24, 245760
    buffer_load_dwordx4 v6, s[12:15], s24 offen  lds
    v_mfma_f32_16x16x32_bf16 v[196:199], v[130:133], v[80:83], v[196:199]
    ds_read_b64_tr_b16 v[98:99], v9 offset:1288
    v_and_b32 v27, 0xffff0000, v149
    v_mfma_f32_16x16x32_bf16 v[200:203], v[130:133], v[84:87], v[200:203]
    s_waitcnt lgkmcnt(14)
    ds_read_b64_tr_b16 v[100:101], v9 offset:16
    v_add_f32 v18, v18, v26
    s_add_u32 m0, s29, 49152
    s_nop 0
    buffer_load_dwordx4 v7, s[12:15], s24 offen  lds
    v_mfma_f32_16x16x32_bf16 v[204:207], v[130:133], v[88:91], v[204:207]
    s_waitcnt lgkmcnt(14)
    ds_read_b64_tr_b16 v[102:103], v9 offset:1296
    v_add_f32 v19, v19, v27
    v_mfma_f32_16x16x32_bf16 v[220:223], v[134:137], v[88:91], v[220:223]
    s_waitcnt lgkmcnt(14)
    ds_read_b64_tr_b16 v[104:105], v9 offset:24
    v_lshlrev_b32 v24, 16, v150
    s_add_u32 m0, s30, 49152
    s_nop 0
    buffer_load_dwordx4 v8, s[12:15], s24 offen  lds
    v_mfma_f32_16x16x32_bf16 v[216:219], v[134:137], v[84:87], v[216:219]
    s_waitcnt lgkmcnt(14)
    ds_read_b64_tr_b16 v[106:107], v9 offset:1304
    v_and_b32 v25, 0xffff0000, v150
    v_mfma_f32_16x16x32_bf16 v[212:215], v[134:137], v[80:83], v[212:215]
    s_waitcnt lgkmcnt(14)
    ds_read_b64_tr_b16 v[108:109], v10 offset:0
    v_add_f32 v20, v20, v24
    v_mfma_f32_16x16x32_bf16 v[208:211], v[134:137], v[76:79], v[208:211]
    s_waitcnt lgkmcnt(14)
    ds_read_b64_tr_b16 v[110:111], v10 offset:1280
    v_add_f32 v21, v21, v25
    v_mfma_f32_16x16x32_bf16 v[224:227], v[138:141], v[76:79], v[224:227]
    v_lshlrev_b32 v26, 16, v151
    v_mfma_f32_16x16x32_bf16 v[228:231], v[138:141], v[80:83], v[228:231]
    v_and_b32 v27, 0xffff0000, v151
    v_mfma_f32_16x16x32_bf16 v[232:235], v[138:141], v[84:87], v[232:235]
    v_add_f32 v20, v20, v26
    v_mfma_f32_16x16x32_bf16 v[236:239], v[138:141], v[88:91], v[236:239]
    v_add_f32 v21, v21, v27
    s_waitcnt lgkmcnt(14)
    v_mfma_f32_16x16x32_bf16 v[160:163], v[92:95], v[60:63], v[160:163]
    ds_read_b128 v[76:79], v157 offset:0
    s_waitcnt lgkmcnt(14)
    ds_read_b64_tr_b16 v[122:123], v9 offset:10240
    v_mfma_f32_16x16x32_bf16 v[164:167], v[92:95], v[64:67], v[164:167]
    s_waitcnt lgkmcnt(14)
    ds_read_b64_tr_b16 v[124:125], v9 offset:11520
    v_mfma_f32_16x16x32_bf16 v[168:171], v[92:95], v[68:71], v[168:171]
    s_waitcnt lgkmcnt(14)
    ds_read_b128 v[80:83], v157 offset:2048
    s_waitcnt lgkmcnt(12)
    v_lshlrev_b32 v24, 16, v116
    v_and_b32 v25, 0xffff0000, v116
    v_mfma_f32_16x16x32_bf16 v[172:175], v[92:95], v[72:75], v[172:175]
    ds_read_b128 v[84:87], v157 offset:4096
    v_add_f32 v16, v16, v24
    v_add_f32 v17, v17, v25
    s_waitcnt lgkmcnt(11)
    v_mfma_f32_16x16x32_bf16 v[188:191], v[96:99], v[72:75], v[188:191]
    ds_read_b128 v[88:91], v157 offset:6144
    v_lshlrev_b32 v26, 16, v117
    v_and_b32 v27, 0xffff0000, v117
    v_mfma_f32_16x16x32_bf16 v[184:187], v[96:99], v[68:71], v[184:187]
    ds_read_b64_tr_b16 v[146:147], v12 offset:10240
    v_add_f32 v16, v16, v26
    v_add_f32 v17, v17, v27
    v_mfma_f32_16x16x32_bf16 v[180:183], v[96:99], v[64:67], v[180:183]
    ds_read_b64_tr_b16 v[148:149], v13 offset:10240
    v_lshlrev_b32 v24, 16, v118
    v_and_b32 v25, 0xffff0000, v118
    v_mfma_f32_16x16x32_bf16 v[176:179], v[96:99], v[60:63], v[176:179]
    ds_read_b64_tr_b16 v[150:151], v14 offset:10240
    v_add_f32 v18, v18, v24
    v_add_f32 v19, v19, v25
    s_waitcnt lgkmcnt(13)
    v_mfma_f32_16x16x32_bf16 v[192:195], v[100:103], v[60:63], v[192:195]
    ds_read_b64_tr_b16 v[126:127], v9 offset:10248
    v_lshlrev_b32 v26, 16, v119
    v_mfma_f32_16x16x32_bf16 v[196:199], v[100:103], v[64:67], v[196:199]
    ds_read_b64_tr_b16 v[128:129], v9 offset:11528
    v_and_b32 v27, 0xffff0000, v119
    v_mfma_f32_16x16x32_bf16 v[200:203], v[100:103], v[68:71], v[200:203]
    s_waitcnt lgkmcnt(14)
    ds_read_b64_tr_b16 v[130:131], v9 offset:10256
    v_add_f32 v18, v18, v26
    v_mfma_f32_16x16x32_bf16 v[204:207], v[100:103], v[72:75], v[204:207]
    s_waitcnt lgkmcnt(14)
    ds_read_b64_tr_b16 v[132:133], v9 offset:11536
    v_add_f32 v19, v19, v27
    v_mfma_f32_16x16x32_bf16 v[220:223], v[104:107], v[72:75], v[220:223]
    s_waitcnt lgkmcnt(14)
    ds_read_b64_tr_b16 v[134:135], v9 offset:10264
    v_lshlrev_b32 v24, 16, v120
    v_mfma_f32_16x16x32_bf16 v[216:219], v[104:107], v[68:71], v[216:219]
    s_waitcnt lgkmcnt(14)
    ds_read_b64_tr_b16 v[136:137], v9 offset:11544
    v_and_b32 v25, 0xffff0000, v120
    v_mfma_f32_16x16x32_bf16 v[212:215], v[104:107], v[64:67], v[212:215]
    s_waitcnt lgkmcnt(14)
    ds_read_b64_tr_b16 v[138:139], v10 offset:10240
    v_add_f32 v20, v20, v24
    v_mfma_f32_16x16x32_bf16 v[208:211], v[104:107], v[60:63], v[208:211]
    s_waitcnt lgkmcnt(14)
    ds_read_b64_tr_b16 v[140:141], v10 offset:11520
    v_add_f32 v21, v21, v25
    v_mfma_f32_16x16x32_bf16 v[224:227], v[108:111], v[60:63], v[224:227]
    v_lshlrev_b32 v26, 16, v121
    v_mfma_f32_16x16x32_bf16 v[228:231], v[108:111], v[64:67], v[228:231]
    v_and_b32 v27, 0xffff0000, v121
    v_mfma_f32_16x16x32_bf16 v[232:235], v[108:111], v[68:71], v[232:235]
    v_add_f32 v20, v20, v26
    v_mfma_f32_16x16x32_bf16 v[236:239], v[108:111], v[72:75], v[236:239]
    v_add_f32 v21, v21, v27
    s_waitcnt vmcnt(3) lgkmcnt(11)
    s_barrier
    v_mfma_f32_16x16x32_bf16 v[160:163], v[122:125], v[76:79], v[160:163]
    ds_read_b128 v[60:63], v156 offset:32768
    ds_read_b64_tr_b16 v[92:93], v9 offset:24576
    s_add_u32 m0, s26, 0
    s_xor_b32 s23, 6, s62
    s_lshl_b32 s23, s23, 7
    buffer_load_dwordx4 v2, s[8:11], s23 offen  lds
    v_mfma_f32_16x16x32_bf16 v[164:167], v[122:125], v[80:83], v[164:167]
    ds_read_b64_tr_b16 v[94:95], v9 offset:25856
    v_mfma_f32_16x16x32_bf16 v[168:171], v[122:125], v[84:87], v[168:171]
    ds_read_b128 v[64:67], v156 offset:34816
    s_waitcnt lgkmcnt(12)
    v_lshlrev_b32 v24, 16, v146
    v_and_b32 v25, 0xffff0000, v146
    s_add_u32 m0, s26, 1024
    s_nop 0
    buffer_load_dwordx4 v3, s[8:11], s23 offen  lds
    v_mfma_f32_16x16x32_bf16 v[172:175], v[122:125], v[88:91], v[172:175]
    ds_read_b128 v[68:71], v156 offset:36864
    v_add_f32 v16, v16, v24
    v_add_f32 v17, v17, v25
    s_waitcnt lgkmcnt(11)
    v_mfma_f32_16x16x32_bf16 v[188:191], v[126:129], v[88:91], v[188:191]
    ds_read_b128 v[72:75], v156 offset:38912
    v_lshlrev_b32 v26, 16, v147
    v_and_b32 v27, 0xffff0000, v147
    s_add_u32 m0, s26, 2048
    s_nop 0
    buffer_load_dwordx4 v4, s[8:11], s23 offen  lds
    v_mfma_f32_16x16x32_bf16 v[184:187], v[126:129], v[84:87], v[184:187]
    ds_read_b64_tr_b16 v[116:117], v12 offset:24576
    v_add_f32 v16, v16, v26
    v_add_f32 v17, v17, v27
    v_mfma_f32_16x16x32_bf16 v[180:183], v[126:129], v[80:83], v[180:183]
    ds_read_b64_tr_b16 v[118:119], v13 offset:24576
    v_lshlrev_b32 v24, 16, v148
    v_and_b32 v25, 0xffff0000, v148
    s_add_u32 m0, s26, 3072
    s_nop 0
    buffer_load_dwordx4 v5, s[8:11], s23 offen  lds
    v_mfma_f32_16x16x32_bf16 v[176:179], v[126:129], v[76:79], v[176:179]
    ds_read_b64_tr_b16 v[120:121], v14 offset:24576
    v_add_f32 v18, v18, v24
    v_add_f32 v19, v19, v25
    s_waitcnt lgkmcnt(13)
    v_mfma_f32_16x16x32_bf16 v[192:195], v[130:133], v[76:79], v[192:195]
    ds_read_b64_tr_b16 v[96:97], v9 offset:24584
    v_lshlrev_b32 v26, 16, v149
    s_add_u32 m0, s28, 73728
    s_xor_b32 s24, 7, s62
    s_mul_i32 s24, s24, 245760
    buffer_load_dwordx4 v6, s[12:15], s24 offen  lds
    v_mfma_f32_16x16x32_bf16 v[196:199], v[130:133], v[80:83], v[196:199]
    ds_read_b64_tr_b16 v[98:99], v9 offset:25864
    v_and_b32 v27, 0xffff0000, v149
    v_mfma_f32_16x16x32_bf16 v[200:203], v[130:133], v[84:87], v[200:203]
    s_waitcnt lgkmcnt(14)
    ds_read_b64_tr_b16 v[100:101], v9 offset:24592
    v_add_f32 v18, v18, v26
    s_add_u32 m0, s29, 73728
    s_nop 0
    buffer_load_dwordx4 v7, s[12:15], s24 offen  lds
    v_mfma_f32_16x16x32_bf16 v[204:207], v[130:133], v[88:91], v[204:207]
    s_waitcnt lgkmcnt(14)
    ds_read_b64_tr_b16 v[102:103], v9 offset:25872
    v_add_f32 v19, v19, v27
    v_mfma_f32_16x16x32_bf16 v[220:223], v[134:137], v[88:91], v[220:223]
    s_waitcnt lgkmcnt(14)
    ds_read_b64_tr_b16 v[104:105], v9 offset:24600
    v_lshlrev_b32 v24, 16, v150
    s_add_u32 m0, s30, 73728
    s_nop 0
    buffer_load_dwordx4 v8, s[12:15], s24 offen  lds
    v_mfma_f32_16x16x32_bf16 v[216:219], v[134:137], v[84:87], v[216:219]
    s_waitcnt lgkmcnt(14)
    ds_read_b64_tr_b16 v[106:107], v9 offset:25880
    v_and_b32 v25, 0xffff0000, v150
    v_mfma_f32_16x16x32_bf16 v[212:215], v[134:137], v[80:83], v[212:215]
    s_waitcnt lgkmcnt(14)
    ds_read_b64_tr_b16 v[108:109], v10 offset:24576
    v_add_f32 v20, v20, v24
    v_mfma_f32_16x16x32_bf16 v[208:211], v[134:137], v[76:79], v[208:211]
    s_waitcnt lgkmcnt(14)
    ds_read_b64_tr_b16 v[110:111], v10 offset:25856
    v_add_f32 v21, v21, v25
    v_mfma_f32_16x16x32_bf16 v[224:227], v[138:141], v[76:79], v[224:227]
    v_lshlrev_b32 v26, 16, v151
    v_mfma_f32_16x16x32_bf16 v[228:231], v[138:141], v[80:83], v[228:231]
    v_and_b32 v27, 0xffff0000, v151
    v_mfma_f32_16x16x32_bf16 v[232:235], v[138:141], v[84:87], v[232:235]
    v_add_f32 v20, v20, v26
    v_mfma_f32_16x16x32_bf16 v[236:239], v[138:141], v[88:91], v[236:239]
    v_add_f32 v21, v21, v27
    s_waitcnt lgkmcnt(14)
    v_mfma_f32_16x16x32_bf16 v[160:163], v[92:95], v[60:63], v[160:163]
    ds_read_b128 v[76:79], v157 offset:32768
    s_waitcnt lgkmcnt(14)
    ds_read_b64_tr_b16 v[122:123], v9 offset:34816
    v_mfma_f32_16x16x32_bf16 v[164:167], v[92:95], v[64:67], v[164:167]
    s_waitcnt lgkmcnt(14)
    ds_read_b64_tr_b16 v[124:125], v9 offset:36096
    v_mfma_f32_16x16x32_bf16 v[168:171], v[92:95], v[68:71], v[168:171]
    s_waitcnt lgkmcnt(14)
    ds_read_b128 v[80:83], v157 offset:34816
    s_waitcnt lgkmcnt(12)
    v_lshlrev_b32 v24, 16, v116
    v_and_b32 v25, 0xffff0000, v116
    v_mfma_f32_16x16x32_bf16 v[172:175], v[92:95], v[72:75], v[172:175]
    ds_read_b128 v[84:87], v157 offset:36864
    v_add_f32 v16, v16, v24
    v_add_f32 v17, v17, v25
    s_waitcnt lgkmcnt(11)
    v_mfma_f32_16x16x32_bf16 v[188:191], v[96:99], v[72:75], v[188:191]
    ds_read_b128 v[88:91], v157 offset:38912
    v_lshlrev_b32 v26, 16, v117
    v_and_b32 v27, 0xffff0000, v117
    v_mfma_f32_16x16x32_bf16 v[184:187], v[96:99], v[68:71], v[184:187]
    ds_read_b64_tr_b16 v[146:147], v12 offset:34816
    v_add_f32 v16, v16, v26
    v_add_f32 v17, v17, v27
    v_mfma_f32_16x16x32_bf16 v[180:183], v[96:99], v[64:67], v[180:183]
    ds_read_b64_tr_b16 v[148:149], v13 offset:34816
    v_lshlrev_b32 v24, 16, v118
    v_and_b32 v25, 0xffff0000, v118
    v_mfma_f32_16x16x32_bf16 v[176:179], v[96:99], v[60:63], v[176:179]
    ds_read_b64_tr_b16 v[150:151], v14 offset:34816
    v_add_f32 v18, v18, v24
    v_add_f32 v19, v19, v25
    s_waitcnt lgkmcnt(13)
    v_mfma_f32_16x16x32_bf16 v[192:195], v[100:103], v[60:63], v[192:195]
    ds_read_b64_tr_b16 v[126:127], v9 offset:34824
    v_lshlrev_b32 v26, 16, v119
    v_mfma_f32_16x16x32_bf16 v[196:199], v[100:103], v[64:67], v[196:199]
    ds_read_b64_tr_b16 v[128:129], v9 offset:36104
    v_and_b32 v27, 0xffff0000, v119
    v_mfma_f32_16x16x32_bf16 v[200:203], v[100:103], v[68:71], v[200:203]
    s_waitcnt lgkmcnt(14)
    ds_read_b64_tr_b16 v[130:131], v9 offset:34832
    v_add_f32 v18, v18, v26
    v_mfma_f32_16x16x32_bf16 v[204:207], v[100:103], v[72:75], v[204:207]
    s_waitcnt lgkmcnt(14)
    ds_read_b64_tr_b16 v[132:133], v9 offset:36112
    v_add_f32 v19, v19, v27
    v_mfma_f32_16x16x32_bf16 v[220:223], v[104:107], v[72:75], v[220:223]
    s_waitcnt lgkmcnt(14)
    ds_read_b64_tr_b16 v[134:135], v9 offset:34840
    v_lshlrev_b32 v24, 16, v120
    v_mfma_f32_16x16x32_bf16 v[216:219], v[104:107], v[68:71], v[216:219]
    s_waitcnt lgkmcnt(14)
    ds_read_b64_tr_b16 v[136:137], v9 offset:36120
    v_and_b32 v25, 0xffff0000, v120
    v_mfma_f32_16x16x32_bf16 v[212:215], v[104:107], v[64:67], v[212:215]
    s_waitcnt lgkmcnt(14)
    ds_read_b64_tr_b16 v[138:139], v10 offset:34816
    v_add_f32 v20, v20, v24
    v_mfma_f32_16x16x32_bf16 v[208:211], v[104:107], v[60:63], v[208:211]
    s_waitcnt lgkmcnt(14)
    ds_read_b64_tr_b16 v[140:141], v10 offset:36096
    v_add_f32 v21, v21, v25
    v_mfma_f32_16x16x32_bf16 v[224:227], v[108:111], v[60:63], v[224:227]
    v_lshlrev_b32 v26, 16, v121
    v_mfma_f32_16x16x32_bf16 v[228:231], v[108:111], v[64:67], v[228:231]
    v_and_b32 v27, 0xffff0000, v121
    v_mfma_f32_16x16x32_bf16 v[232:235], v[108:111], v[68:71], v[232:235]
    v_add_f32 v20, v20, v26
    v_mfma_f32_16x16x32_bf16 v[236:239], v[108:111], v[72:75], v[236:239]
    v_add_f32 v21, v21, v27
    s_waitcnt vmcnt(3) lgkmcnt(11)
    s_barrier
    v_add_u32 v9, 49152, v9
    v_add_u32 v10, 49152, v10
    v_add_u32 v12, 49152, v12
    v_add_u32 v13, 49152, v13
    v_add_u32 v14, 49152, v14
    v_mfma_f32_16x16x32_bf16 v[160:163], v[122:125], v[76:79], v[160:163]
    ds_read_b128 v[60:63], v156 offset:0
    ds_read_b64_tr_b16 v[92:93], v9 offset:0
    s_add_u32 m0, s26, 32768
    s_xor_b32 s23, 7, s62
    s_lshl_b32 s23, s23, 7
    buffer_load_dwordx4 v2, s[8:11], s23 offen  lds
    v_mfma_f32_16x16x32_bf16 v[164:167], v[122:125], v[80:83], v[164:167]
    ds_read_b64_tr_b16 v[94:95], v9 offset:1280
    v_mfma_f32_16x16x32_bf16 v[168:171], v[122:125], v[84:87], v[168:171]
    ds_read_b128 v[64:67], v156 offset:2048
    s_waitcnt lgkmcnt(12)
    v_lshlrev_b32 v24, 16, v146
    v_and_b32 v25, 0xffff0000, v146
    s_add_u32 m0, s26, 33792
    s_nop 0
    buffer_load_dwordx4 v3, s[8:11], s23 offen  lds
    v_mfma_f32_16x16x32_bf16 v[172:175], v[122:125], v[88:91], v[172:175]
    ds_read_b128 v[68:71], v156 offset:4096
    v_add_f32 v16, v16, v24
    v_add_f32 v17, v17, v25
    s_waitcnt lgkmcnt(11)
    v_mfma_f32_16x16x32_bf16 v[188:191], v[126:129], v[88:91], v[188:191]
    ds_read_b128 v[72:75], v156 offset:6144
    v_lshlrev_b32 v26, 16, v147
    v_and_b32 v27, 0xffff0000, v147
    s_add_u32 m0, s26, 34816
    s_nop 0
    buffer_load_dwordx4 v4, s[8:11], s23 offen  lds
    v_mfma_f32_16x16x32_bf16 v[184:187], v[126:129], v[84:87], v[184:187]
    ds_read_b64_tr_b16 v[116:117], v12 offset:0
    v_add_f32 v16, v16, v26
    v_add_f32 v17, v17, v27
    v_mfma_f32_16x16x32_bf16 v[180:183], v[126:129], v[80:83], v[180:183]
    ds_read_b64_tr_b16 v[118:119], v13 offset:0
    v_lshlrev_b32 v24, 16, v148
    v_and_b32 v25, 0xffff0000, v148
    s_add_u32 m0, s26, 35840
    s_nop 0
    buffer_load_dwordx4 v5, s[8:11], s23 offen  lds
    v_mfma_f32_16x16x32_bf16 v[176:179], v[126:129], v[76:79], v[176:179]
    ds_read_b64_tr_b16 v[120:121], v14 offset:0
    v_add_f32 v18, v18, v24
    v_add_f32 v19, v19, v25
    s_waitcnt lgkmcnt(13)
    v_mfma_f32_16x16x32_bf16 v[192:195], v[130:133], v[76:79], v[192:195]
    ds_read_b64_tr_b16 v[96:97], v9 offset:8
    v_lshlrev_b32 v26, 16, v149
    s_add_u32 m0, s28, 0
    s_xor_b32 s24, 8, s63
    s_mul_i32 s24, s24, 245760
    buffer_load_dwordx4 v6, s[12:15], s24 offen  lds
    v_mfma_f32_16x16x32_bf16 v[196:199], v[130:133], v[80:83], v[196:199]
    ds_read_b64_tr_b16 v[98:99], v9 offset:1288
    v_and_b32 v27, 0xffff0000, v149
    v_mfma_f32_16x16x32_bf16 v[200:203], v[130:133], v[84:87], v[200:203]
    s_waitcnt lgkmcnt(14)
    ds_read_b64_tr_b16 v[100:101], v9 offset:16
    v_add_f32 v18, v18, v26
    s_add_u32 m0, s29, 0
    s_nop 0
    buffer_load_dwordx4 v7, s[12:15], s24 offen  lds
    v_mfma_f32_16x16x32_bf16 v[204:207], v[130:133], v[88:91], v[204:207]
    s_waitcnt lgkmcnt(14)
    ds_read_b64_tr_b16 v[102:103], v9 offset:1296
    v_add_f32 v19, v19, v27
    v_mfma_f32_16x16x32_bf16 v[220:223], v[134:137], v[88:91], v[220:223]
    s_waitcnt lgkmcnt(14)
    ds_read_b64_tr_b16 v[104:105], v9 offset:24
    v_lshlrev_b32 v24, 16, v150
    s_add_u32 m0, s30, 0
    s_nop 0
    buffer_load_dwordx4 v8, s[12:15], s24 offen  lds
    v_mfma_f32_16x16x32_bf16 v[216:219], v[134:137], v[84:87], v[216:219]
    s_waitcnt lgkmcnt(14)
    ds_read_b64_tr_b16 v[106:107], v9 offset:1304
    v_and_b32 v25, 0xffff0000, v150
    v_mfma_f32_16x16x32_bf16 v[212:215], v[134:137], v[80:83], v[212:215]
    s_waitcnt lgkmcnt(14)
    ds_read_b64_tr_b16 v[108:109], v10 offset:0
    v_add_f32 v20, v20, v24
    v_mfma_f32_16x16x32_bf16 v[208:211], v[134:137], v[76:79], v[208:211]
    s_waitcnt lgkmcnt(14)
    ds_read_b64_tr_b16 v[110:111], v10 offset:1280
    v_add_f32 v21, v21, v25
    v_mfma_f32_16x16x32_bf16 v[224:227], v[138:141], v[76:79], v[224:227]
    v_lshlrev_b32 v26, 16, v151
    v_mfma_f32_16x16x32_bf16 v[228:231], v[138:141], v[80:83], v[228:231]
    v_and_b32 v27, 0xffff0000, v151
    v_mfma_f32_16x16x32_bf16 v[232:235], v[138:141], v[84:87], v[232:235]
    v_add_f32 v20, v20, v26
    v_mfma_f32_16x16x32_bf16 v[236:239], v[138:141], v[88:91], v[236:239]
    v_add_f32 v21, v21, v27
    s_waitcnt lgkmcnt(14)
    v_mfma_f32_16x16x32_bf16 v[160:163], v[92:95], v[60:63], v[160:163]
    ds_read_b128 v[76:79], v157 offset:0
    s_waitcnt lgkmcnt(14)
    ds_read_b64_tr_b16 v[122:123], v9 offset:10240
    buffer_load_dword v159, v158, s[44:47], 0 offen sc1
    v_mfma_f32_16x16x32_bf16 v[164:167], v[92:95], v[64:67], v[164:167]
    s_waitcnt lgkmcnt(14)
    ds_read_b64_tr_b16 v[124:125], v9 offset:11520
    v_mfma_f32_16x16x32_bf16 v[168:171], v[92:95], v[68:71], v[168:171]
    s_waitcnt lgkmcnt(14)
    ds_read_b128 v[80:83], v157 offset:2048
    s_waitcnt lgkmcnt(12)
    v_lshlrev_b32 v24, 16, v116
    v_and_b32 v25, 0xffff0000, v116
    v_mfma_f32_16x16x32_bf16 v[172:175], v[92:95], v[72:75], v[172:175]
    ds_read_b128 v[84:87], v157 offset:4096
    v_add_f32 v16, v16, v24
    v_add_f32 v17, v17, v25
    s_waitcnt lgkmcnt(11)
    v_mfma_f32_16x16x32_bf16 v[188:191], v[96:99], v[72:75], v[188:191]
    ds_read_b128 v[88:91], v157 offset:6144
    v_lshlrev_b32 v26, 16, v117
    v_and_b32 v27, 0xffff0000, v117
    v_mfma_f32_16x16x32_bf16 v[184:187], v[96:99], v[68:71], v[184:187]
    ds_read_b64_tr_b16 v[146:147], v12 offset:10240
    v_add_f32 v16, v16, v26
    v_add_f32 v17, v17, v27
    v_mfma_f32_16x16x32_bf16 v[180:183], v[96:99], v[64:67], v[180:183]
    ds_read_b64_tr_b16 v[148:149], v13 offset:10240
    v_lshlrev_b32 v24, 16, v118
    v_and_b32 v25, 0xffff0000, v118
    v_mfma_f32_16x16x32_bf16 v[176:179], v[96:99], v[60:63], v[176:179]
    ds_read_b64_tr_b16 v[150:151], v14 offset:10240
    v_add_f32 v18, v18, v24
    v_add_f32 v19, v19, v25
    s_waitcnt lgkmcnt(13)
    v_mfma_f32_16x16x32_bf16 v[192:195], v[100:103], v[60:63], v[192:195]
    ds_read_b64_tr_b16 v[126:127], v9 offset:10248
    v_lshlrev_b32 v26, 16, v119
    v_mfma_f32_16x16x32_bf16 v[196:199], v[100:103], v[64:67], v[196:199]
    ds_read_b64_tr_b16 v[128:129], v9 offset:11528
    v_and_b32 v27, 0xffff0000, v119
    v_mfma_f32_16x16x32_bf16 v[200:203], v[100:103], v[68:71], v[200:203]
    s_waitcnt lgkmcnt(14)
    ds_read_b64_tr_b16 v[130:131], v9 offset:10256
    v_add_f32 v18, v18, v26
    v_mfma_f32_16x16x32_bf16 v[204:207], v[100:103], v[72:75], v[204:207]
    s_waitcnt lgkmcnt(14)
    ds_read_b64_tr_b16 v[132:133], v9 offset:11536
    v_add_f32 v19, v19, v27
    v_mfma_f32_16x16x32_bf16 v[220:223], v[104:107], v[72:75], v[220:223]
    s_waitcnt lgkmcnt(14)
    ds_read_b64_tr_b16 v[134:135], v9 offset:10264
    v_lshlrev_b32 v24, 16, v120
    v_mfma_f32_16x16x32_bf16 v[216:219], v[104:107], v[68:71], v[216:219]
    s_waitcnt lgkmcnt(14)
    ds_read_b64_tr_b16 v[136:137], v9 offset:11544
    v_and_b32 v25, 0xffff0000, v120
    v_mfma_f32_16x16x32_bf16 v[212:215], v[104:107], v[64:67], v[212:215]
    s_waitcnt lgkmcnt(14)
    ds_read_b64_tr_b16 v[138:139], v10 offset:10240
    v_add_f32 v20, v20, v24
    v_mfma_f32_16x16x32_bf16 v[208:211], v[104:107], v[60:63], v[208:211]
    s_waitcnt lgkmcnt(14)
    ds_read_b64_tr_b16 v[140:141], v10 offset:11520
    v_add_f32 v21, v21, v25
    v_mfma_f32_16x16x32_bf16 v[224:227], v[108:111], v[60:63], v[224:227]
    v_lshlrev_b32 v26, 16, v121
    v_mfma_f32_16x16x32_bf16 v[228:231], v[108:111], v[64:67], v[228:231]
    v_and_b32 v27, 0xffff0000, v121
    v_mfma_f32_16x16x32_bf16 v[232:235], v[108:111], v[68:71], v[232:235]
    v_add_f32 v20, v20, v26
    v_mfma_f32_16x16x32_bf16 v[236:239], v[108:111], v[72:75], v[236:239]
    v_add_f32 v21, v21, v27
    s_waitcnt vmcnt(4) lgkmcnt(11)
    s_barrier
    v_mfma_f32_16x16x32_bf16 v[160:163], v[122:125], v[76:79], v[160:163]
    ds_read_b128 v[60:63], v156 offset:32768
    ds_read_b64_tr_b16 v[92:93], v9 offset:24576
    s_add_u32 m0, s26, 0
    s_xor_b32 s23, 8, s63
    s_lshl_b32 s23, s23, 7
    buffer_load_dwordx4 v2, s[8:11], s23 offen  lds
    v_mfma_f32_16x16x32_bf16 v[164:167], v[122:125], v[80:83], v[164:167]
    ds_read_b64_tr_b16 v[94:95], v9 offset:25856
    v_mfma_f32_16x16x32_bf16 v[168:171], v[122:125], v[84:87], v[168:171]
    ds_read_b128 v[64:67], v156 offset:34816
    s_waitcnt lgkmcnt(12)
    v_lshlrev_b32 v24, 16, v146
    v_and_b32 v25, 0xffff0000, v146
    s_add_u32 m0, s26, 1024
    s_nop 0
    buffer_load_dwordx4 v3, s[8:11], s23 offen  lds
    v_mfma_f32_16x16x32_bf16 v[172:175], v[122:125], v[88:91], v[172:175]
    ds_read_b128 v[68:71], v156 offset:36864
    v_add_f32 v16, v16, v24
    v_add_f32 v17, v17, v25
    s_waitcnt lgkmcnt(11)
    v_mfma_f32_16x16x32_bf16 v[188:191], v[126:129], v[88:91], v[188:191]
    ds_read_b128 v[72:75], v156 offset:38912
    v_lshlrev_b32 v26, 16, v147
    v_and_b32 v27, 0xffff0000, v147
    s_add_u32 m0, s26, 2048
    s_nop 0
    buffer_load_dwordx4 v4, s[8:11], s23 offen  lds
    v_mfma_f32_16x16x32_bf16 v[184:187], v[126:129], v[84:87], v[184:187]
    ds_read_b64_tr_b16 v[116:117], v12 offset:24576
    v_add_f32 v16, v16, v26
    v_add_f32 v17, v17, v27
    v_mfma_f32_16x16x32_bf16 v[180:183], v[126:129], v[80:83], v[180:183]
    ds_read_b64_tr_b16 v[118:119], v13 offset:24576
    v_lshlrev_b32 v24, 16, v148
    v_and_b32 v25, 0xffff0000, v148
    s_add_u32 m0, s26, 3072
    s_nop 0
    buffer_load_dwordx4 v5, s[8:11], s23 offen  lds
    v_mfma_f32_16x16x32_bf16 v[176:179], v[126:129], v[76:79], v[176:179]
    ds_read_b64_tr_b16 v[120:121], v14 offset:24576
    v_add_f32 v18, v18, v24
    v_add_f32 v19, v19, v25
    s_waitcnt lgkmcnt(13)
    v_mfma_f32_16x16x32_bf16 v[192:195], v[130:133], v[76:79], v[192:195]
    ds_read_b64_tr_b16 v[96:97], v9 offset:24584
    v_lshlrev_b32 v26, 16, v149
    s_add_u32 m0, s28, 24576
    s_xor_b32 s24, 9, s63
    s_mul_i32 s24, s24, 245760
    buffer_load_dwordx4 v6, s[12:15], s24 offen  lds
    v_mfma_f32_16x16x32_bf16 v[196:199], v[130:133], v[80:83], v[196:199]
    ds_read_b64_tr_b16 v[98:99], v9 offset:25864
    v_and_b32 v27, 0xffff0000, v149
    v_mfma_f32_16x16x32_bf16 v[200:203], v[130:133], v[84:87], v[200:203]
    s_waitcnt lgkmcnt(14)
    ds_read_b64_tr_b16 v[100:101], v9 offset:24592
    v_add_f32 v18, v18, v26
    s_add_u32 m0, s29, 24576
    s_nop 0
    buffer_load_dwordx4 v7, s[12:15], s24 offen  lds
    v_mfma_f32_16x16x32_bf16 v[204:207], v[130:133], v[88:91], v[204:207]
    s_waitcnt lgkmcnt(14)
    ds_read_b64_tr_b16 v[102:103], v9 offset:25872
    v_add_f32 v19, v19, v27
    v_mfma_f32_16x16x32_bf16 v[220:223], v[134:137], v[88:91], v[220:223]
    s_waitcnt lgkmcnt(14)
    ds_read_b64_tr_b16 v[104:105], v9 offset:24600
    v_lshlrev_b32 v24, 16, v150
    s_add_u32 m0, s30, 24576
    s_nop 0
    buffer_load_dwordx4 v8, s[12:15], s24 offen  lds
    v_mfma_f32_16x16x32_bf16 v[216:219], v[134:137], v[84:87], v[216:219]
    s_waitcnt lgkmcnt(14)
    ds_read_b64_tr_b16 v[106:107], v9 offset:25880
    v_and_b32 v25, 0xffff0000, v150
    v_mfma_f32_16x16x32_bf16 v[212:215], v[134:137], v[80:83], v[212:215]
    s_waitcnt lgkmcnt(14)
    ds_read_b64_tr_b16 v[108:109], v10 offset:24576
    v_add_f32 v20, v20, v24
    v_mfma_f32_16x16x32_bf16 v[208:211], v[134:137], v[76:79], v[208:211]
    s_waitcnt lgkmcnt(14)
    ds_read_b64_tr_b16 v[110:111], v10 offset:25856
    v_add_f32 v21, v21, v25
    v_mfma_f32_16x16x32_bf16 v[224:227], v[138:141], v[76:79], v[224:227]
    v_lshlrev_b32 v26, 16, v151
    v_mfma_f32_16x16x32_bf16 v[228:231], v[138:141], v[80:83], v[228:231]
    v_and_b32 v27, 0xffff0000, v151
    v_mfma_f32_16x16x32_bf16 v[232:235], v[138:141], v[84:87], v[232:235]
    v_add_f32 v20, v20, v26
    v_mfma_f32_16x16x32_bf16 v[236:239], v[138:141], v[88:91], v[236:239]
    v_add_f32 v21, v21, v27
    s_waitcnt lgkmcnt(14)
    v_mfma_f32_16x16x32_bf16 v[160:163], v[92:95], v[60:63], v[160:163]
    ds_read_b128 v[76:79], v157 offset:32768
    s_waitcnt lgkmcnt(14)
    ds_read_b64_tr_b16 v[122:123], v9 offset:34816
    v_mfma_f32_16x16x32_bf16 v[164:167], v[92:95], v[64:67], v[164:167]
    s_waitcnt lgkmcnt(14)
    ds_read_b64_tr_b16 v[124:125], v9 offset:36096
    v_mfma_f32_16x16x32_bf16 v[168:171], v[92:95], v[68:71], v[168:171]
    s_waitcnt lgkmcnt(14)
    ds_read_b128 v[80:83], v157 offset:34816
    s_waitcnt lgkmcnt(12)
    v_lshlrev_b32 v24, 16, v116
    v_and_b32 v25, 0xffff0000, v116
    v_mfma_f32_16x16x32_bf16 v[172:175], v[92:95], v[72:75], v[172:175]
    ds_read_b128 v[84:87], v157 offset:36864
    v_add_f32 v16, v16, v24
    v_add_f32 v17, v17, v25
    s_waitcnt lgkmcnt(11)
    v_mfma_f32_16x16x32_bf16 v[188:191], v[96:99], v[72:75], v[188:191]
    ds_read_b128 v[88:91], v157 offset:38912
    v_lshlrev_b32 v26, 16, v117
    v_and_b32 v27, 0xffff0000, v117
    v_mfma_f32_16x16x32_bf16 v[184:187], v[96:99], v[68:71], v[184:187]
    ds_read_b64_tr_b16 v[146:147], v12 offset:34816
    v_add_f32 v16, v16, v26
    v_add_f32 v17, v17, v27
    v_mfma_f32_16x16x32_bf16 v[180:183], v[96:99], v[64:67], v[180:183]
    ds_read_b64_tr_b16 v[148:149], v13 offset:34816
    v_lshlrev_b32 v24, 16, v118
    v_and_b32 v25, 0xffff0000, v118
    v_mfma_f32_16x16x32_bf16 v[176:179], v[96:99], v[60:63], v[176:179]
    ds_read_b64_tr_b16 v[150:151], v14 offset:34816
    v_add_f32 v18, v18, v24
    v_add_f32 v19, v19, v25
    s_waitcnt lgkmcnt(13)
    v_mfma_f32_16x16x32_bf16 v[192:195], v[100:103], v[60:63], v[192:195]
    ds_read_b64_tr_b16 v[126:127], v9 offset:34824
    v_lshlrev_b32 v26, 16, v119
    v_mfma_f32_16x16x32_bf16 v[196:199], v[100:103], v[64:67], v[196:199]
    ds_read_b64_tr_b16 v[128:129], v9 offset:36104
    v_and_b32 v27, 0xffff0000, v119
    v_mfma_f32_16x16x32_bf16 v[200:203], v[100:103], v[68:71], v[200:203]
    s_waitcnt lgkmcnt(14)
    ds_read_b64_tr_b16 v[130:131], v9 offset:34832
    v_add_f32 v18, v18, v26
    v_mfma_f32_16x16x32_bf16 v[204:207], v[100:103], v[72:75], v[204:207]
    s_waitcnt lgkmcnt(14)
    ds_read_b64_tr_b16 v[132:133], v9 offset:36112
    v_add_f32 v19, v19, v27
    v_mfma_f32_16x16x32_bf16 v[220:223], v[104:107], v[72:75], v[220:223]
    s_waitcnt lgkmcnt(14)
    ds_read_b64_tr_b16 v[134:135], v9 offset:34840
    v_lshlrev_b32 v24, 16, v120
    v_mfma_f32_16x16x32_bf16 v[216:219], v[104:107], v[68:71], v[216:219]
    s_waitcnt lgkmcnt(14)
    ds_read_b64_tr_b16 v[136:137], v9 offset:36120
    v_and_b32 v25, 0xffff0000, v120
    v_mfma_f32_16x16x32_bf16 v[212:215], v[104:107], v[64:67], v[212:215]
    s_waitcnt lgkmcnt(14)
    ds_read_b64_tr_b16 v[138:139], v10 offset:34816
    v_add_f32 v20, v20, v24
    v_mfma_f32_16x16x32_bf16 v[208:211], v[104:107], v[60:63], v[208:211]
    s_waitcnt lgkmcnt(14)
    ds_read_b64_tr_b16 v[140:141], v10 offset:36096
    v_add_f32 v21, v21, v25
    v_mfma_f32_16x16x32_bf16 v[224:227], v[108:111], v[60:63], v[224:227]
    v_lshlrev_b32 v26, 16, v121
    v_mfma_f32_16x16x32_bf16 v[228:231], v[108:111], v[64:67], v[228:231]
    v_and_b32 v27, 0xffff0000, v121
    v_mfma_f32_16x16x32_bf16 v[232:235], v[108:111], v[68:71], v[232:235]
    v_add_f32 v20, v20, v26
    v_mfma_f32_16x16x32_bf16 v[236:239], v[108:111], v[72:75], v[236:239]
    v_add_f32 v21, v21, v27
    s_waitcnt vmcnt(3) lgkmcnt(11)
    s_barrier
    v_subrev_u32 v9, 49152, v9
    v_subrev_u32 v10, 49152, v10
    v_subrev_u32 v12, 49152, v12
    v_subrev_u32 v13, 49152, v13
    v_subrev_u32 v14, 49152, v14
    v_mfma_f32_16x16x32_bf16 v[160:163], v[122:125], v[76:79], v[160:163]
    ds_read_b128 v[60:63], v156 offset:0
    ds_read_b64_tr_b16 v[92:93], v9 offset:0
    s_add_u32 m0, s26, 32768
    s_xor_b32 s23, 9, s63
    s_lshl_b32 s23, s23, 7
    buffer_load_dwordx4 v2, s[8:11], s23 offen  lds
    v_mfma_f32_16x16x32_bf16 v[164:167], v[122:125], v[80:83], v[164:167]
    ds_read_b64_tr_b16 v[94:95], v9 offset:1280
    v_mfma_f32_16x16x32_bf16 v[168:171], v[122:125], v[84:87], v[168:171]
    ds_read_b128 v[64:67], v156 offset:2048
    s_waitcnt lgkmcnt(12)
    v_lshlrev_b32 v24, 16, v146
    v_and_b32 v25, 0xffff0000, v146
    s_add_u32 m0, s26, 33792
    s_nop 0
    buffer_load_dwordx4 v3, s[8:11], s23 offen  lds
    v_mfma_f32_16x16x32_bf16 v[172:175], v[122:125], v[88:91], v[172:175]
    ds_read_b128 v[68:71], v156 offset:4096
    v_add_f32 v16, v16, v24
    v_add_f32 v17, v17, v25
    s_waitcnt lgkmcnt(11)
    v_mfma_f32_16x16x32_bf16 v[188:191], v[126:129], v[88:91], v[188:191]
    ds_read_b128 v[72:75], v156 offset:6144
    v_lshlrev_b32 v26, 16, v147
    v_and_b32 v27, 0xffff0000, v147
    s_add_u32 m0, s26, 34816
    s_nop 0
    buffer_load_dwordx4 v4, s[8:11], s23 offen  lds
    v_mfma_f32_16x16x32_bf16 v[184:187], v[126:129], v[84:87], v[184:187]
    ds_read_b64_tr_b16 v[116:117], v12 offset:0
    v_add_f32 v16, v16, v26
    v_add_f32 v17, v17, v27
    v_mfma_f32_16x16x32_bf16 v[180:183], v[126:129], v[80:83], v[180:183]
    ds_read_b64_tr_b16 v[118:119], v13 offset:0
    v_lshlrev_b32 v24, 16, v148
    v_and_b32 v25, 0xffff0000, v148
    s_add_u32 m0, s26, 35840
    s_nop 0
    buffer_load_dwordx4 v5, s[8:11], s23 offen  lds
    v_mfma_f32_16x16x32_bf16 v[176:179], v[126:129], v[76:79], v[176:179]
    ds_read_b64_tr_b16 v[120:121], v14 offset:0
    v_add_f32 v18, v18, v24
    v_add_f32 v19, v19, v25
    s_waitcnt lgkmcnt(13)
    v_mfma_f32_16x16x32_bf16 v[192:195], v[130:133], v[76:79], v[192:195]
    ds_read_b64_tr_b16 v[96:97], v9 offset:8
    v_lshlrev_b32 v26, 16, v149
    v_mfma_f32_16x16x32_bf16 v[196:199], v[130:133], v[80:83], v[196:199]
    ds_read_b64_tr_b16 v[98:99], v9 offset:1288
    v_and_b32 v27, 0xffff0000, v149
    v_mfma_f32_16x16x32_bf16 v[200:203], v[130:133], v[84:87], v[200:203]
    s_waitcnt lgkmcnt(14)
    ds_read_b64_tr_b16 v[100:101], v9 offset:16
    v_add_f32 v18, v18, v26
    v_mfma_f32_16x16x32_bf16 v[204:207], v[130:133], v[88:91], v[204:207]
    s_waitcnt lgkmcnt(14)
    ds_read_b64_tr_b16 v[102:103], v9 offset:1296
    v_add_f32 v19, v19, v27
    v_mfma_f32_16x16x32_bf16 v[220:223], v[134:137], v[88:91], v[220:223]
    s_waitcnt lgkmcnt(14)
    ds_read_b64_tr_b16 v[104:105], v9 offset:24
    v_lshlrev_b32 v24, 16, v150
    v_mfma_f32_16x16x32_bf16 v[216:219], v[134:137], v[84:87], v[216:219]
    s_waitcnt lgkmcnt(14)
    ds_read_b64_tr_b16 v[106:107], v9 offset:1304
    v_and_b32 v25, 0xffff0000, v150
    v_mfma_f32_16x16x32_bf16 v[212:215], v[134:137], v[80:83], v[212:215]
    s_waitcnt lgkmcnt(14)
    ds_read_b64_tr_b16 v[108:109], v10 offset:0
    v_add_f32 v20, v20, v24
    v_mfma_f32_16x16x32_bf16 v[208:211], v[134:137], v[76:79], v[208:211]
    s_waitcnt lgkmcnt(14)
    ds_read_b64_tr_b16 v[110:111], v10 offset:1280
    v_add_f32 v21, v21, v25
    v_mfma_f32_16x16x32_bf16 v[224:227], v[138:141], v[76:79], v[224:227]
    v_lshlrev_b32 v26, 16, v151
    v_mfma_f32_16x16x32_bf16 v[228:231], v[138:141], v[80:83], v[228:231]
    v_and_b32 v27, 0xffff0000, v151
    v_mfma_f32_16x16x32_bf16 v[232:235], v[138:141], v[84:87], v[232:235]
    v_add_f32 v20, v20, v26
    v_mfma_f32_16x16x32_bf16 v[236:239], v[138:141], v[88:91], v[236:239]
    v_add_f32 v21, v21, v27
    v_cmp_eq_u32 vcc, 0, v159
    s_cbranch_vccnz L_k1_q_spin
L_k1_q_go:
    s_waitcnt lgkmcnt(14)
    v_mfma_f32_16x16x32_bf16 v[160:163], v[92:95], v[60:63], v[160:163]
    ds_read_b128 v[76:79], v157 offset:0
    s_waitcnt lgkmcnt(14)
    ds_read_b64_tr_b16 v[122:123], v9 offset:10240
    buffer_load_dword v28, v155, s[16:19], s49 offen offset:0 sc1
    v_mfma_f32_16x16x32_bf16 v[164:167], v[92:95], v[64:67], v[164:167]
    s_waitcnt lgkmcnt(14)
    ds_read_b64_tr_b16 v[124:125], v9 offset:11520
    v_mfma_f32_16x16x32_bf16 v[168:171], v[92:95], v[68:71], v[168:171]
    s_waitcnt lgkmcnt(14)
    ds_read_b128 v[80:83], v157 offset:2048
    s_waitcnt lgkmcnt(12)
    v_lshlrev_b32 v24, 16, v116
    v_and_b32 v25, 0xffff0000, v116
    buffer_load_dword v36, v155, s[16:19], s50 offen offset:0 sc1
    v_mfma_f32_16x16x32_bf16 v[172:175], v[92:95], v[72:75], v[172:175]
    ds_read_b128 v[84:87], v157 offset:4096
    v_add_f32 v16, v16, v24
    v_add_f32 v17, v17, v25
    s_waitcnt lgkmcnt(11)
    v_mfma_f32_16x16x32_bf16 v[188:191], v[96:99], v[72:75], v[188:191]
    ds_read_b128 v[88:91], v157 offset:6144
    v_lshlrev_b32 v26, 16, v117
    v_and_b32 v27, 0xffff0000, v117
    buffer_load_dword v30, v155, s[16:19], s49 offen offset:64 sc1
    v_mfma_f32_16x16x32_bf16 v[184:187], v[96:99], v[68:71], v[184:187]
    ds_read_b64_tr_b16 v[146:147], v12 offset:10240
    v_add_f32 v16, v16, v26
    v_add_f32 v17, v17, v27
    v_mfma_f32_16x16x32_bf16 v[180:183], v[96:99], v[64:67], v[180:183]
    ds_read_b64_tr_b16 v[148:149], v13 offset:10240
    v_lshlrev_b32 v24, 16, v118
    v_and_b32 v25, 0xffff0000, v118
    buffer_load_dword v38, v155, s[16:19], s50 offen offset:64 sc1
    v_mfma_f32_16x16x32_bf16 v[176:179], v[96:99], v[60:63], v[176:179]
    ds_read_b64_tr_b16 v[150:151], v14 offset:10240
    v_add_f32 v18, v18, v24
    v_add_f32 v19, v19, v25
    s_waitcnt lgkmcnt(13)
    v_mfma_f32_16x16x32_bf16 v[192:195], v[100:103], v[60:63], v[192:195]
    ds_read_b64_tr_b16 v[126:127], v9 offset:10248
    v_lshlrev_b32 v26, 16, v119
    buffer_load_dword v32, v155, s[16:19], s49 offen offset:128 sc1
    v_mfma_f32_16x16x32_bf16 v[196:199], v[100:103], v[64:67], v[196:199]
    ds_read_b64_tr_b16 v[128:129], v9 offset:11528
    v_and_b32 v27, 0xffff0000, v119
    v_mfma_f32_16x16x32_bf16 v[200:203], v[100:103], v[68:71], v[200:203]
    s_waitcnt lgkmcnt(14)
    ds_read_b64_tr_b16 v[130:131], v9 offset:10256
    v_add_f32 v18, v18, v26
    buffer_load_dword v40, v155, s[16:19], s50 offen offset:128 sc1
    v_mfma_f32_16x16x32_bf16 v[204:207], v[100:103], v[72:75], v[204:207]
    s_waitcnt lgkmcnt(14)
    ds_read_b64_tr_b16 v[132:133], v9 offset:11536
    v_add_f32 v19, v19, v27
    v_mfma_f32_16x16x32_bf16 v[220:223], v[104:107], v[72:75], v[220:223]
    s_waitcnt lgkmcnt(14)
    ds_read_b64_tr_b16 v[134:135], v9 offset:10264
    v_lshlrev_b32 v24, 16, v120
    buffer_load_dword v34, v155, s[16:19], s49 offen offset:192 sc1
    v_mfma_f32_16x16x32_bf16 v[216:219], v[104:107], v[68:71], v[216:219]
    s_waitcnt lgkmcnt(14)
    ds_read_b64_tr_b16 v[136:137], v9 offset:11544
    v_and_b32 v25, 0xffff0000, v120
    v_mfma_f32_16x16x32_bf16 v[212:215], v[104:107], v[64:67], v[212:215]
    s_waitcnt lgkmcnt(14)
    ds_read_b64_tr_b16 v[138:139], v10 offset:10240
    v_add_f32 v20, v20, v24
    buffer_load_dword v42, v155, s[16:19], s50 offen offset:192 sc1
    v_mfma_f32_16x16x32_bf16 v[208:211], v[104:107], v[60:63], v[208:211]
    s_waitcnt lgkmcnt(14)
    ds_read_b64_tr_b16 v[140:141], v10 offset:11520
    v_add_f32 v21, v21, v25
    v_mfma_f32_16x16x32_bf16 v[224:227], v[108:111], v[60:63], v[224:227]
    v_lshlrev_b32 v26, 16, v121
    v_mfma_f32_16x16x32_bf16 v[228:231], v[108:111], v[64:67], v[228:231]
    v_and_b32 v27, 0xffff0000, v121
    v_mfma_f32_16x16x32_bf16 v[232:235], v[108:111], v[68:71], v[232:235]
    v_add_f32 v20, v20, v26
    v_mfma_f32_16x16x32_bf16 v[236:239], v[108:111], v[72:75], v[236:239]
    v_add_f32 v21, v21, v27
    s_waitcnt vmcnt(8) lgkmcnt(11)
    s_barrier
    v_mfma_f32_16x16x32_bf16 v[160:163], v[122:125], v[76:79], v[160:163]
    ds_read_b128 v[60:63], v156 offset:32768
    ds_read_b64_tr_b16 v[92:93], v9 offset:24576
    v_mfma_f32_16x16x32_bf16 v[164:167], v[122:125], v[80:83], v[164:167]
    ds_read_b64_tr_b16 v[94:95], v9 offset:25856
    v_mfma_f32_16x16x32_bf16 v[168:171], v[122:125], v[84:87], v[168:171]
    ds_read_b128 v[64:67], v156 offset:34816
    s_waitcnt lgkmcnt(12)
    v_lshlrev_b32 v24, 16, v146
    v_and_b32 v25, 0xffff0000, v146
    v_mfma_f32_16x16x32_bf16 v[172:175], v[122:125], v[88:91], v[172:175]
    ds_read_b128 v[68:71], v156 offset:36864
    v_add_f32 v16, v16, v24
    v_add_f32 v17, v17, v25
    s_waitcnt lgkmcnt(11)
    v_mfma_f32_16x16x32_bf16 v[188:191], v[126:129], v[88:91], v[188:191]
    ds_read_b128 v[72:75], v156 offset:38912
    v_lshlrev_b32 v26, 16, v147
    v_and_b32 v27, 0xffff0000, v147
    v_mfma_f32_16x16x32_bf16 v[184:187], v[126:129], v[84:87], v[184:187]
    ds_read_b64_tr_b16 v[116:117], v12 offset:24576
    v_add_f32 v16, v16, v26
    v_add_f32 v17, v17, v27
    v_mfma_f32_16x16x32_bf16 v[180:183], v[126:129], v[80:83], v[180:183]
    ds_read_b64_tr_b16 v[118:119], v13 offset:24576
    v_lshlrev_b32 v24, 16, v148
    v_and_b32 v25, 0xffff0000, v148
    v_mfma_f32_16x16x32_bf16 v[176:179], v[126:129], v[76:79], v[176:179]
    ds_read_b64_tr_b16 v[120:121], v14 offset:24576
    v_add_f32 v18, v18, v24
    v_add_f32 v19, v19, v25
    s_waitcnt lgkmcnt(13)
    v_mfma_f32_16x16x32_bf16 v[192:195], v[130:133], v[76:79], v[192:195]
    ds_read_b64_tr_b16 v[96:97], v9 offset:24584
    v_lshlrev_b32 v26, 16, v149
    v_mfma_f32_16x16x32_bf16 v[196:199], v[130:133], v[80:83], v[196:199]
    ds_read_b64_tr_b16 v[98:99], v9 offset:25864
    v_and_b32 v27, 0xffff0000, v149
    v_mfma_f32_16x16x32_bf16 v[200:203], v[130:133], v[84:87], v[200:203]
    s_waitcnt lgkmcnt(14)
    ds_read_b64_tr_b16 v[100:101], v9 offset:24592
    v_add_f32 v18, v18, v26
    v_mfma_f32_16x16x32_bf16 v[204:207], v[130:133], v[88:91], v[204:207]
    s_waitcnt lgkmcnt(14)
    ds_read_b64_tr_b16 v[102:103], v9 offset:25872
    v_add_f32 v19, v19, v27
    v_mfma_f32_16x16x32_bf16 v[220:223], v[134:137], v[88:91], v[220:223]
    s_waitcnt lgkmcnt(14)
    ds_read_b64_tr_b16 v[104:105], v9 offset:24600
    v_lshlrev_b32 v24, 16, v150
    v_mfma_f32_16x16x32_bf16 v[216:219], v[134:137], v[84:87], v[216:219]
    s_waitcnt lgkmcnt(14)
    ds_read_b64_tr_b16 v[106:107], v9 offset:25880
    v_and_b32 v25, 0xffff0000, v150
    v_mfma_f32_16x16x32_bf16 v[212:215], v[134:137], v[80:83], v[212:215]
    s_waitcnt lgkmcnt(14)
    ds_read_b64_tr_b16 v[108:109], v10 offset:24576
    v_add_f32 v20, v20, v24
    v_mfma_f32_16x16x32_bf16 v[208:211], v[134:137], v[76:79], v[208:211]
    s_waitcnt lgkmcnt(14)
    ds_read_b64_tr_b16 v[110:111], v10 offset:25856
    v_add_f32 v21, v21, v25
    v_mfma_f32_16x16x32_bf16 v[224:227], v[138:141], v[76:79], v[224:227]
    v_lshlrev_b32 v26, 16, v151
    v_mfma_f32_16x16x32_bf16 v[228:231], v[138:141], v[80:83], v[228:231]
    v_and_b32 v27, 0xffff0000, v151
    v_mfma_f32_16x16x32_bf16 v[232:235], v[138:141], v[84:87], v[232:235]
    v_add_f32 v20, v20, v26
    v_mfma_f32_16x16x32_bf16 v[236:239], v[138:141], v[88:91], v[236:239]
    v_add_f32 v21, v21, v27
    s_waitcnt lgkmcnt(14)
    v_mfma_f32_16x16x32_bf16 v[160:163], v[92:95], v[60:63], v[160:163]
    ds_read_b128 v[76:79], v157 offset:32768
    s_waitcnt lgkmcnt(14)
    ds_read_b64_tr_b16 v[122:123], v9 offset:34816
    buffer_load_dword v159, v158, s[16:19], s79 offen offset:192 sc1
    v_mfma_f32_16x16x32_bf16 v[164:167], v[92:95], v[64:67], v[164:167]
    s_waitcnt lgkmcnt(14)
    ds_read_b64_tr_b16 v[124:125], v9 offset:36096
    v_mfma_f32_16x16x32_bf16 v[168:171], v[92:95], v[68:71], v[168:171]
    s_waitcnt lgkmcnt(14)
    ds_read_b128 v[80:83], v157 offset:34816
    s_waitcnt lgkmcnt(12)
    v_lshlrev_b32 v24, 16, v116
    v_and_b32 v25, 0xffff0000, v116
    v_add_f32 v16, v16, v24
    v_mfma_f32_16x16x32_bf16 v[172:175], v[92:95], v[72:75], v[172:175]
    ds_read_b128 v[84:87], v157 offset:36864
    v_add_f32 v17, v17, v25
    v_lshlrev_b32 v26, 16, v117
    v_and_b32 v27, 0xffff0000, v117
    s_waitcnt lgkmcnt(11)
    v_mfma_f32_16x16x32_bf16 v[188:191], v[96:99], v[72:75], v[188:191]
    ds_read_b128 v[88:91], v157 offset:38912
    v_add_f32 v16, v16, v26
    v_add_f32 v17, v17, v27
    v_lshlrev_b32 v24, 16, v118
    v_mfma_f32_16x16x32_bf16 v[184:187], v[96:99], v[68:71], v[184:187]
    ds_read_b64_tr_b16 v[146:147], v12 offset:34816
    v_and_b32 v25, 0xffff0000, v118
    v_add_f32 v18, v18, v24
    v_add_f32 v19, v19, v25
    v_mfma_f32_16x16x32_bf16 v[180:183], v[96:99], v[64:67], v[180:183]
    ds_read_b64_tr_b16 v[148:149], v13 offset:34816
    v_lshlrev_b32 v26, 16, v119
    v_and_b32 v27, 0xffff0000, v119
    v_add_f32 v18, v18, v26
    v_mfma_f32_16x16x32_bf16 v[176:179], v[96:99], v[60:63], v[176:179]
    ds_read_b64_tr_b16 v[150:151], v14 offset:34816
    v_add_f32 v19, v19, v27
    v_lshlrev_b32 v24, 16, v120
    v_and_b32 v25, 0xffff0000, v120
    s_waitcnt lgkmcnt(13)
    v_mfma_f32_16x16x32_bf16 v[192:195], v[100:103], v[60:63], v[192:195]
    ds_read_b64_tr_b16 v[126:127], v9 offset:34824
    v_add_f32 v20, v20, v24
    v_add_f32 v21, v21, v25
    v_lshlrev_b32 v26, 16, v121
    v_mfma_f32_16x16x32_bf16 v[196:199], v[100:103], v[64:67], v[196:199]
    ds_read_b64_tr_b16 v[128:129], v9 offset:36104
    v_and_b32 v27, 0xffff0000, v121
    v_add_f32 v20, v20, v26
    v_add_f32 v21, v21, v27
    v_mfma_f32_16x16x32_bf16 v[200:203], v[100:103], v[68:71], v[200:203]
    s_waitcnt lgkmcnt(14)
    ds_read_b64_tr_b16 v[130:131], v9 offset:34832
    s_waitcnt lgkmcnt(3)
    v_lshlrev_b32 v24, 16, v146
    v_and_b32 v25, 0xffff0000, v146
    v_mfma_f32_16x16x32_bf16 v[204:207], v[100:103], v[72:75], v[204:207]
    ds_read_b64_tr_b16 v[132:133], v9 offset:36112
    v_add_f32 v16, v16, v24
    v_add_f32 v17, v17, v25
    v_lshlrev_b32 v26, 16, v147
    v_mfma_f32_16x16x32_bf16 v[220:223], v[104:107], v[72:75], v[220:223]
    ds_read_b64_tr_b16 v[134:135], v9 offset:34840
    v_and_b32 v27, 0xffff0000, v147
    v_add_f32 v16, v16, v26
    v_add_f32 v17, v17, v27
    v_mfma_f32_16x16x32_bf16 v[216:219], v[104:107], v[68:71], v[216:219]
    ds_read_b64_tr_b16 v[136:137], v9 offset:36120
    v_lshlrev_b32 v24, 16, v148
    v_and_b32 v25, 0xffff0000, v148
    v_add_f32 v18, v18, v24
    v_mfma_f32_16x16x32_bf16 v[212:215], v[104:107], v[64:67], v[212:215]
    ds_read_b64_tr_b16 v[138:139], v10 offset:34816
    v_add_f32 v19, v19, v25
    v_lshlrev_b32 v26, 16, v149
    v_and_b32 v27, 0xffff0000, v149
    v_mfma_f32_16x16x32_bf16 v[208:211], v[104:107], v[60:63], v[208:211]
    ds_read_b64_tr_b16 v[140:141], v10 offset:36096
    v_add_f32 v18, v18, v26
    v_add_f32 v19, v19, v27
    v_mfma_f32_16x16x32_bf16 v[224:227], v[108:111], v[60:63], v[224:227]
    v_lshlrev_b32 v24, 16, v150
    v_and_b32 v25, 0xffff0000, v150
    v_mfma_f32_16x16x32_bf16 v[228:231], v[108:111], v[64:67], v[228:231]
    v_add_f32 v20, v20, v24
    v_add_f32 v21, v21, v25
    v_mfma_f32_16x16x32_bf16 v[232:235], v[108:111], v[68:71], v[232:235]
    v_lshlrev_b32 v26, 16, v151
    v_and_b32 v27, 0xffff0000, v151
    v_mfma_f32_16x16x32_bf16 v[236:239], v[108:111], v[72:75], v[236:239]
    v_add_f32 v20, v20, v26
    v_add_f32 v21, v21, v27
    s_barrier
    v_mfma_f32_16x16x32_bf16 v[160:163], v[122:125], v[76:79], v[160:163]
    v_add_f32 v16, v16, v17
    v_add_f32 v18, v18, v19
    v_add_f32 v20, v20, v21
    v_mfma_f32_16x16x32_bf16 v[164:167], v[122:125], v[80:83], v[164:167]
    v_mov_b32 v17, v16
    v_mov_b32 v19, v18
    v_mfma_f32_16x16x32_bf16 v[168:171], v[122:125], v[84:87], v[168:171]
    v_mov_b32 v21, v20
    s_mul_i32 s32, s20, 192
    v_mfma_f32_16x16x32_bf16 v[172:175], v[122:125], v[88:91], v[172:175]
    s_add_u32 s32, s32, 159744
    v_permlane32_swap_b32 v16, v17
    s_waitcnt lgkmcnt(6)
    v_mfma_f32_16x16x32_bf16 v[188:191], v[126:129], v[88:91], v[188:191]
    v_permlane32_swap_b32 v18, v19
    v_permlane32_swap_b32 v20, v21
    v_mfma_f32_16x16x32_bf16 v[184:187], v[126:129], v[84:87], v[184:187]
    v_and_b32 v24, 15, v1
    v_add_f32 v16, v16, v17
    v_mfma_f32_16x16x32_bf16 v[180:183], v[126:129], v[80:83], v[180:183]
    v_add_f32 v18, v18, v19
    v_add_f32 v20, v20, v21
    v_mfma_f32_16x16x32_bf16 v[176:179], v[126:129], v[76:79], v[176:179]
    v_mov_b32 v17, v16
    v_mov_b32 v19, v18
    s_waitcnt lgkmcnt(4)
    v_mfma_f32_16x16x32_bf16 v[192:195], v[130:133], v[76:79], v[192:195]
    v_mov_b32 v21, v20
    v_lshl_add_u32 v25, v24, 2, s32
    v_mfma_f32_16x16x32_bf16 v[196:199], v[130:133], v[80:83], v[196:199]
    s_nop 0
    v_permlane16_swap_b32 v16, v17
    v_mfma_f32_16x16x32_bf16 v[200:203], v[130:133], v[84:87], v[200:203]
    v_permlane16_swap_b32 v18, v19
    v_permlane16_swap_b32 v20, v21
    v_mfma_f32_16x16x32_bf16 v[204:207], v[130:133], v[88:91], v[204:207]
    s_nop 0
    v_add_f32 v16, v16, v17
    s_waitcnt lgkmcnt(2)
    v_mfma_f32_16x16x32_bf16 v[220:223], v[134:137], v[88:91], v[220:223]
    v_add_f32 v18, v18, v19
    v_add_f32 v20, v20, v21
    v_mfma_f32_16x16x32_bf16 v[216:219], v[134:137], v[84:87], v[216:219]
    ds_write_b32 v25, v16 offset:0
    ds_write_b32 v25, v18 offset:64
    ds_write_b32 v25, v20 offset:128
    s_waitcnt lgkmcnt(0)
    s_barrier
    v_mfma_f32_16x16x32_bf16 v[212:215], v[134:137], v[80:83], v[212:215]
    ds_read_b128 v[92:95], v152 offset:0
    ds_read_b128 v[44:47], v152 offset:64
    v_mfma_f32_16x16x32_bf16 v[208:211], v[134:137], v[76:79], v[208:211]
    ds_read_b128 v[96:99], v152 offset:128
    ds_read_b128 v[48:51], v152 offset:192
    v_mfma_f32_16x16x32_bf16 v[224:227], v[138:141], v[76:79], v[224:227]
    ds_read_b128 v[100:103], v152 offset:256
    ds_read_b128 v[52:55], v152 offset:320
    v_mfma_f32_16x16x32_bf16 v[228:231], v[138:141], v[80:83], v[228:231]
    ds_read_b128 v[104:107], v152 offset:384
    ds_read_b128 v[56:59], v152 offset:448
    v_mfma_f32_16x16x32_bf16 v[232:235], v[138:141], v[84:87], v[232:235]
    ds_read_b128 v[108:111], v153 offset:0
    ds_read_b128 v[60:63], v153 offset:64
    v_mfma_f32_16x16x32_bf16 v[236:239], v[138:141], v[88:91], v[236:239]
    v_mov_b32 v22, 0x358637bd
    s_add_u32 s54, s52, 4096
    s_waitcnt vmcnt(1)
    v_mul_f32 v64, 0x3fb8aa3b, v36
    v_mul_f32 v66, 0x3fb8aa3b, v38
    v_mul_f32 v68, 0x3fb8aa3b, v40
    v_mul_f32 v70, 0x3fb8aa3b, v42
    s_waitcnt lgkmcnt(0)
    v_pk_add_f32 v[92:93], v[92:93], v[44:45]
    v_pk_add_f32 v[94:95], v[94:95], v[46:47]
    v_pk_add_f32 v[96:97], v[96:97], v[48:49]
    v_pk_add_f32 v[98:99], v[98:99], v[50:51]
    v_pk_add_f32 v[100:101], v[100:101], v[52:53]
    v_pk_add_f32 v[102:103], v[102:103], v[54:55]
    v_pk_add_f32 v[104:105], v[104:105], v[56:57]
    v_pk_add_f32 v[106:107], v[106:107], v[58:59]
    v_pk_add_f32 v[108:109], v[108:109], v[60:61]
    v_pk_add_f32 v[110:111], v[110:111], v[62:63]
    s_lshl_b32 s32, s31, 12
    s_add_u32 s32, s32, 143360
    s_lshl_b32 s33, s27, 10
    v_lshrrev_b32 v53, 1, v15
    s_add_u32 s34, s32, s33
    v_add_u32 v52, s34, v53
    s_add_u32 s34, s32, 2048
    v_add_u32 v59, s34, v53
    s_xor_b32 s33, s33, 1024
    s_add_u32 s34, s32, s33
    v_add_u32 v53, s34, v53
    s_lshl_b32 s33, s27, 11
    s_add_u32 s53, s53, s33
    s_cmp_eq_u32 s27, 0
    s_cselect_b64 s[56:57], -1, 0
    v_cndmask_b32 v58, v52, v59, s[56:57]
    v_cndmask_b32 v52, v59, v52, s[56:57]
    v_pk_fma_f32 v[160:161], v[28:29], v[92:93], v[160:161] op_sel_hi:[0,1,1]
    v_pk_fma_f32 v[162:163], v[28:29], v[94:95], v[162:163] op_sel_hi:[0,1,1]
    v_pk_fma_f32 v[176:177], v[28:29], v[96:97], v[176:177] op_sel_hi:[0,1,1]
    v_pk_fma_f32 v[178:179], v[28:29], v[98:99], v[178:179] op_sel_hi:[0,1,1]
    v_pk_fma_f32 v[192:193], v[28:29], v[100:101], v[192:193] op_sel_hi:[0,1,1]
    v_pk_fma_f32 v[194:195], v[28:29], v[102:103], v[194:195] op_sel_hi:[0,1,1]
    v_pk_fma_f32 v[208:209], v[28:29], v[104:105], v[208:209] op_sel_hi:[0,1,1]
    v_pk_fma_f32 v[210:211], v[28:29], v[106:107], v[210:211] op_sel_hi:[0,1,1]
    v_pk_fma_f32 v[224:225], v[28:29], v[108:109], v[224:225] op_sel_hi:[0,1,1]
    v_pk_fma_f32 v[226:227], v[28:29], v[110:111], v[226:227] op_sel_hi:[0,1,1]
    v_pk_mul_f32 v[112:113], v[160:161], v[64:65] op_sel_hi:[1,0]
    v_pk_mul_f32 v[114:115], v[162:163], v[64:65] op_sel_hi:[1,0]
    v_pk_mul_f32 v[116:117], v[176:177], v[64:65] op_sel_hi:[1,0]
    v_pk_mul_f32 v[118:119], v[178:179], v[64:65] op_sel_hi:[1,0]
    v_pk_mul_f32 v[120:121], v[192:193], v[64:65] op_sel_hi:[1,0]
    v_pk_mul_f32 v[122:123], v[194:195], v[64:65] op_sel_hi:[1,0]
    v_pk_mul_f32 v[124:125], v[208:209], v[64:65] op_sel_hi:[1,0]
    v_pk_mul_f32 v[126:127], v[210:211], v[64:65] op_sel_hi:[1,0]
    v_pk_mul_f32 v[128:129], v[224:225], v[64:65] op_sel_hi:[1,0]
    v_pk_mul_f32 v[130:131], v[226:227], v[64:65] op_sel_hi:[1,0]
    v_max_f32 v160, 0, v160
    v_max_f32 v161, 0, v161
    v_max_f32 v162, 0, v162
    v_max_f32 v163, 0, v163
    v_max_f32 v176, 0, v176
    v_max_f32 v177, 0, v177
    v_max_f32 v178, 0, v178
    v_max_f32 v179, 0, v179
    v_max_f32 v192, 0, v192
    v_max_f32 v193, 0, v193
    v_max_f32 v194, 0, v194
    v_max_f32 v195, 0, v195
    v_max_f32 v208, 0, v208
    v_max_f32 v209, 0, v209
    v_max_f32 v210, 0, v210
    v_max_f32 v211, 0, v211
    v_max_f32 v224, 0, v224
    v_max_f32 v225, 0, v225
    v_max_f32 v226, 0, v226
    v_max_f32 v227, 0, v227
    v_exp_f32_e64 v112, v112 clamp
    v_exp_f32_e64 v113, v113 clamp
    v_exp_f32_e64 v114, v114 clamp
    v_exp_f32_e64 v115, v115 clamp
    v_exp_f32_e64 v116, v116 clamp
    v_exp_f32_e64 v117, v117 clamp
    v_exp_f32_e64 v118, v118 clamp
    v_exp_f32_e64 v119, v119 clamp
    v_exp_f32_e64 v120, v120 clamp
    v_exp_f32_e64 v121, v121 clamp
    v_exp_f32_e64 v122, v122 clamp
    v_exp_f32_e64 v123, v123 clamp
    v_exp_f32_e64 v124, v124 clamp
    v_exp_f32_e64 v125, v125 clamp
    v_exp_f32_e64 v126, v126 clamp
    v_exp_f32_e64 v127, v127 clamp
    v_exp_f32_e64 v128, v128 clamp
    v_exp_f32_e64 v129, v129 clamp
    v_exp_f32_e64 v130, v130 clamp
    v_exp_f32_e64 v131, v131 clamp
    s_nop 0
    v_pk_add_f32 v[112:113], v[112:113], v[22:23] op_sel_hi:[1,0]
    v_pk_add_f32 v[114:115], v[114:115], v[22:23] op_sel_hi:[1,0]
    v_pk_add_f32 v[116:117], v[116:117], v[22:23] op_sel_hi:[1,0]
    v_pk_add_f32 v[118:119], v[118:119], v[22:23] op_sel_hi:[1,0]
    v_pk_add_f32 v[120:121], v[120:121], v[22:23] op_sel_hi:[1,0]
    v_pk_add_f32 v[122:123], v[122:123], v[22:23] op_sel_hi:[1,0]
    v_pk_add_f32 v[124:125], v[124:125], v[22:23] op_sel_hi:[1,0]
    v_pk_add_f32 v[126:127], v[126:127], v[22:23] op_sel_hi:[1,0]
    v_pk_add_f32 v[128:129], v[128:129], v[22:23] op_sel_hi:[1,0]
    v_pk_add_f32 v[130:131], v[130:131], v[22:23] op_sel_hi:[1,0]
    v_pk_fma_f32 v[160:161], v[160:161], v[36:37], v[112:113] op_sel_hi:[1,0,1]
    v_pk_fma_f32 v[162:163], v[162:163], v[36:37], v[114:115] op_sel_hi:[1,0,1]
    v_pk_fma_f32 v[176:177], v[176:177], v[36:37], v[116:117] op_sel_hi:[1,0,1]
    v_pk_fma_f32 v[178:179], v[178:179], v[36:37], v[118:119] op_sel_hi:[1,0,1]
    v_pk_fma_f32 v[192:193], v[192:193], v[36:37], v[120:121] op_sel_hi:[1,0,1]
    v_pk_fma_f32 v[194:195], v[194:195], v[36:37], v[122:123] op_sel_hi:[1,0,1]
    v_pk_fma_f32 v[208:209], v[208:209], v[36:37], v[124:125] op_sel_hi:[1,0,1]
    v_pk_fma_f32 v[210:211], v[210:211], v[36:37], v[126:127] op_sel_hi:[1,0,1]
    v_pk_fma_f32 v[224:225], v[224:225], v[36:37], v[128:129] op_sel_hi:[1,0,1]
    v_pk_fma_f32 v[226:227], v[226:227], v[36:37], v[130:131] op_sel_hi:[1,0,1]
    v_cvt_pk_bf16_f32 v132, v160, v161
    v_cvt_pk_bf16_f32 v133, v162, v163
    v_cvt_pk_bf16_f32 v134, v176, v177
    v_cvt_pk_bf16_f32 v135, v178, v179
    v_cvt_pk_bf16_f32 v136, v192, v193
    v_cvt_pk_bf16_f32 v137, v194, v195
    v_cvt_pk_bf16_f32 v138, v208, v209
    v_cvt_pk_bf16_f32 v139, v210, v211
    v_cvt_pk_bf16_f32 v140, v224, v225
    v_cvt_pk_bf16_f32 v141, v226, v227
    buffer_store_dwordx4 v[132:135], v15, s[16:19], s52 offen offset:0 sc1
    buffer_store_dwordx4 v[136:139], v15, s[16:19], s54 offen offset:0 sc1
    ds_write_b64 v58, v[140:141] offset:0
    v_mov_b32 v54, v140
    v_mov_b32 v55, v141
    v_pk_fma_f32 v[164:165], v[30:31], v[92:93], v[164:165] op_sel_hi:[0,1,1]
    v_pk_fma_f32 v[166:167], v[30:31], v[94:95], v[166:167] op_sel_hi:[0,1,1]
    v_pk_fma_f32 v[180:181], v[30:31], v[96:97], v[180:181] op_sel_hi:[0,1,1]
    v_pk_fma_f32 v[182:183], v[30:31], v[98:99], v[182:183] op_sel_hi:[0,1,1]
    v_pk_fma_f32 v[196:197], v[30:31], v[100:101], v[196:197] op_sel_hi:[0,1,1]
    v_pk_fma_f32 v[198:199], v[30:31], v[102:103], v[198:199] op_sel_hi:[0,1,1]
    v_pk_fma_f32 v[212:213], v[30:31], v[104:105], v[212:213] op_sel_hi:[0,1,1]
    v_pk_fma_f32 v[214:215], v[30:31], v[106:107], v[214:215] op_sel_hi:[0,1,1]
    v_pk_fma_f32 v[228:229], v[30:31], v[108:109], v[228:229] op_sel_hi:[0,1,1]
    v_pk_fma_f32 v[230:231], v[30:31], v[110:111], v[230:231] op_sel_hi:[0,1,1]
    v_pk_mul_f32 v[112:113], v[164:165], v[66:67] op_sel_hi:[1,0]
    v_pk_mul_f32 v[114:115], v[166:167], v[66:67] op_sel_hi:[1,0]
    v_pk_mul_f32 v[116:117], v[180:181], v[66:67] op_sel_hi:[1,0]
    v_pk_mul_f32 v[118:119], v[182:183], v[66:67] op_sel_hi:[1,0]
    v_pk_mul_f32 v[120:121], v[196:197], v[66:67] op_sel_hi:[1,0]
    v_pk_mul_f32 v[122:123], v[198:199], v[66:67] op_sel_hi:[1,0]
    v_pk_mul_f32 v[124:125], v[212:213], v[66:67] op_sel_hi:[1,0]
    v_pk_mul_f32 v[126:127], v[214:215], v[66:67] op_sel_hi:[1,0]
    v_pk_mul_f32 v[128:129], v[228:229], v[66:67] op_sel_hi:[1,0]
    v_pk_mul_f32 v[130:131], v[230:231], v[66:67] op_sel_hi:[1,0]
    v_max_f32 v164, 0, v164
    v_max_f32 v165, 0, v165
    v_max_f32 v166, 0, v166
    v_max_f32 v167, 0, v167
    v_max_f32 v180, 0, v180
    v_max_f32 v181, 0, v181
    v_max_f32 v182, 0, v182
    v_max_f32 v183, 0, v183
    v_max_f32 v196, 0, v196
    v_max_f32 v197, 0, v197
    v_max_f32 v198, 0, v198
    v_max_f32 v199, 0, v199
    v_max_f32 v212, 0, v212
    v_max_f32 v213, 0, v213
    v_max_f32 v214, 0, v214
    v_max_f32 v215, 0, v215
    v_max_f32 v228, 0, v228
    v_max_f32 v229, 0, v229
    v_max_f32 v230, 0, v230
    v_max_f32 v231, 0, v231
    v_exp_f32_e64 v112, v112 clamp
    v_exp_f32_e64 v113, v113 clamp
    v_exp_f32_e64 v114, v114 clamp
    v_exp_f32_e64 v115, v115 clamp
    v_exp_f32_e64 v116, v116 clamp
    v_exp_f32_e64 v117, v117 clamp
    v_exp_f32_e64 v118, v118 clamp
    v_exp_f32_e64 v119, v119 clamp
    v_exp_f32_e64 v120, v120 clamp
    v_exp_f32_e64 v121, v121 clamp
    v_exp_f32_e64 v122, v122 clamp
    v_exp_f32_e64 v123, v123 clamp
    v_exp_f32_e64 v124, v124 clamp
    v_exp_f32_e64 v125, v125 clamp
    v_exp_f32_e64 v126, v126 clamp
    v_exp_f32_e64 v127, v127 clamp
    v_exp_f32_e64 v128, v128 clamp
    v_exp_f32_e64 v129, v129 clamp
    v_exp_f32_e64 v130, v130 clamp
    v_exp_f32_e64 v131, v131 clamp
    s_nop 0
    v_pk_add_f32 v[112:113], v[112:113], v[22:23] op_sel_hi:[1,0]
    v_pk_add_f32 v[114:115], v[114:115], v[22:23] op_sel_hi:[1,0]
    v_pk_add_f32 v[116:117], v[116:117], v[22:23] op_sel_hi:[1,0]
    v_pk_add_f32 v[118:119], v[118:119], v[22:23] op_sel_hi:[1,0]
    v_pk_add_f32 v[120:121], v[120:121], v[22:23] op_sel_hi:[1,0]
    v_pk_add_f32 v[122:123], v[122:123], v[22:23] op_sel_hi:[1,0]
    v_pk_add_f32 v[124:125], v[124:125], v[22:23] op_sel_hi:[1,0]
    v_pk_add_f32 v[126:127], v[126:127], v[22:23] op_sel_hi:[1,0]
    v_pk_add_f32 v[128:129], v[128:129], v[22:23] op_sel_hi:[1,0]
    v_pk_add_f32 v[130:131], v[130:131], v[22:23] op_sel_hi:[1,0]
    v_pk_fma_f32 v[164:165], v[164:165], v[38:39], v[112:113] op_sel_hi:[1,0,1]
    v_pk_fma_f32 v[166:167], v[166:167], v[38:39], v[114:115] op_sel_hi:[1,0,1]
    v_pk_fma_f32 v[180:181], v[180:181], v[38:39], v[116:117] op_sel_hi:[1,0,1]
    v_pk_fma_f32 v[182:183], v[182:183], v[38:39], v[118:119] op_sel_hi:[1,0,1]
    v_pk_fma_f32 v[196:197], v[196:197], v[38:39], v[120:121] op_sel_hi:[1,0,1]
    v_pk_fma_f32 v[198:199], v[198:199], v[38:39], v[122:123] op_sel_hi:[1,0,1]
    v_pk_fma_f32 v[212:213], v[212:213], v[38:39], v[124:125] op_sel_hi:[1,0,1]
    v_pk_fma_f32 v[214:215], v[214:215], v[38:39], v[126:127] op_sel_hi:[1,0,1]
    v_pk_fma_f32 v[228:229], v[228:229], v[38:39], v[128:129] op_sel_hi:[1,0,1]
    v_pk_fma_f32 v[230:231], v[230:231], v[38:39], v[130:131] op_sel_hi:[1,0,1]
    v_cvt_pk_bf16_f32 v142, v164, v165
    v_cvt_pk_bf16_f32 v143, v166, v167
    v_cvt_pk_bf16_f32 v144, v180, v181
    v_cvt_pk_bf16_f32 v145, v182, v183
    v_cvt_pk_bf16_f32 v146, v196, v197
    v_cvt_pk_bf16_f32 v147, v198, v199
    v_cvt_pk_bf16_f32 v148, v212, v213
    v_cvt_pk_bf16_f32 v149, v214, v215
    v_cvt_pk_bf16_f32 v150, v228, v229
    v_cvt_pk_bf16_f32 v151, v230, v231
    buffer_store_dwordx4 v[142:145], v15, s[16:19], s52 offen offset:1024 sc1
    buffer_store_dwordx4 v[146:149], v15, s[16:19], s54 offen offset:1024 sc1
    ds_write_b64 v58, v[150:151] offset:512
    v_mov_b32 v56, v150
    v_mov_b32 v57, v151
    v_pk_fma_f32 v[168:169], v[32:33], v[92:93], v[168:169] op_sel_hi:[0,1,1]
    v_pk_fma_f32 v[170:171], v[32:33], v[94:95], v[170:171] op_sel_hi:[0,1,1]
    v_pk_fma_f32 v[184:185], v[32:33], v[96:97], v[184:185] op_sel_hi:[0,1,1]
    v_pk_fma_f32 v[186:187], v[32:33], v[98:99], v[186:187] op_sel_hi:[0,1,1]
    v_pk_fma_f32 v[200:201], v[32:33], v[100:101], v[200:201] op_sel_hi:[0,1,1]
    v_pk_fma_f32 v[202:203], v[32:33], v[102:103], v[202:203] op_sel_hi:[0,1,1]
    v_pk_fma_f32 v[216:217], v[32:33], v[104:105], v[216:217] op_sel_hi:[0,1,1]
    v_pk_fma_f32 v[218:219], v[32:33], v[106:107], v[218:219] op_sel_hi:[0,1,1]
    v_pk_fma_f32 v[232:233], v[32:33], v[108:109], v[232:233] op_sel_hi:[0,1,1]
    v_pk_fma_f32 v[234:235], v[32:33], v[110:111], v[234:235] op_sel_hi:[0,1,1]
    v_pk_mul_f32 v[112:113], v[168:169], v[68:69] op_sel_hi:[1,0]
    v_pk_mul_f32 v[114:115], v[170:171], v[68:69] op_sel_hi:[1,0]
    v_pk_mul_f32 v[116:117], v[184:185], v[68:69] op_sel_hi:[1,0]
    v_pk_mul_f32 v[118:119], v[186:187], v[68:69] op_sel_hi:[1,0]
    v_pk_mul_f32 v[120:121], v[200:201], v[68:69] op_sel_hi:[1,0]
    v_pk_mul_f32 v[122:123], v[202:203], v[68:69] op_sel_hi:[1,0]
    v_pk_mul_f32 v[124:125], v[216:217], v[68:69] op_sel_hi:[1,0]
    v_pk_mul_f32 v[126:127], v[218:219], v[68:69] op_sel_hi:[1,0]
    v_pk_mul_f32 v[128:129], v[232:233], v[68:69] op_sel_hi:[1,0]
    v_pk_mul_f32 v[130:131], v[234:235], v[68:69] op_sel_hi:[1,0]
    v_max_f32 v168, 0, v168
    v_max_f32 v169, 0, v169
    v_max_f32 v170, 0, v170
    v_max_f32 v171, 0, v171
    v_max_f32 v184, 0, v184
    v_max_f32 v185, 0, v185
    v_max_f32 v186, 0, v186
    v_max_f32 v187, 0, v187
    v_max_f32 v200, 0, v200
    v_max_f32 v201, 0, v201
    v_max_f32 v202, 0, v202
    v_max_f32 v203, 0, v203
    v_max_f32 v216, 0, v216
    v_max_f32 v217, 0, v217
    v_max_f32 v218, 0, v218
    v_max_f32 v219, 0, v219
    v_max_f32 v232, 0, v232
    v_max_f32 v233, 0, v233
    v_max_f32 v234, 0, v234
    v_max_f32 v235, 0, v235
    v_exp_f32_e64 v112, v112 clamp
    v_exp_f32_e64 v113, v113 clamp
    v_exp_f32_e64 v114, v114 clamp
    v_exp_f32_e64 v115, v115 clamp
    v_exp_f32_e64 v116, v116 clamp
    v_exp_f32_e64 v117, v117 clamp
    v_exp_f32_e64 v118, v118 clamp
    v_exp_f32_e64 v119, v119 clamp
    v_exp_f32_e64 v120, v120 clamp
    v_exp_f32_e64 v121, v121 clamp
    v_exp_f32_e64 v122, v122 clamp
    v_exp_f32_e64 v123, v123 clamp
    v_exp_f32_e64 v124, v124 clamp
    v_exp_f32_e64 v125, v125 clamp
    v_exp_f32_e64 v126, v126 clamp
    v_exp_f32_e64 v127, v127 clamp
    v_exp_f32_e64 v128, v128 clamp
    v_exp_f32_e64 v129, v129 clamp
    v_exp_f32_e64 v130, v130 clamp
    v_exp_f32_e64 v131, v131 clamp
    s_nop 0
    v_pk_add_f32 v[112:113], v[112:113], v[22:23] op_sel_hi:[1,0]
    v_pk_add_f32 v[114:115], v[114:115], v[22:23] op_sel_hi:[1,0]
    v_pk_add_f32 v[116:117], v[116:117], v[22:23] op_sel_hi:[1,0]
    v_pk_add_f32 v[118:119], v[118:119], v[22:23] op_sel_hi:[1,0]
    v_pk_add_f32 v[120:121], v[120:121], v[22:23] op_sel_hi:[1,0]
    v_pk_add_f32 v[122:123], v[122:123], v[22:23] op_sel_hi:[1,0]
    v_pk_add_f32 v[124:125], v[124:125], v[22:23] op_sel_hi:[1,0]
    v_pk_add_f32 v[126:127], v[126:127], v[22:23] op_sel_hi:[1,0]
    v_pk_add_f32 v[128:129], v[128:129], v[22:23] op_sel_hi:[1,0]
    v_pk_add_f32 v[130:131], v[130:131], v[22:23] op_sel_hi:[1,0]
    v_pk_fma_f32 v[168:169], v[168:169], v[40:41], v[112:113] op_sel_hi:[1,0,1]
    v_pk_fma_f32 v[170:171], v[170:171], v[40:41], v[114:115] op_sel_hi:[1,0,1]
    v_pk_fma_f32 v[184:185], v[184:185], v[40:41], v[116:117] op_sel_hi:[1,0,1]
    v_pk_fma_f32 v[186:187], v[186:187], v[40:41], v[118:119] op_sel_hi:[1,0,1]
    v_pk_fma_f32 v[200:201], v[200:201], v[40:41], v[120:121] op_sel_hi:[1,0,1]
    v_pk_fma_f32 v[202:203], v[202:203], v[40:41], v[122:123] op_sel_hi:[1,0,1]
    v_pk_fma_f32 v[216:217], v[216:217], v[40:41], v[124:125] op_sel_hi:[1,0,1]
    v_pk_fma_f32 v[218:219], v[218:219], v[40:41], v[126:127] op_sel_hi:[1,0,1]
    v_pk_fma_f32 v[232:233], v[232:233], v[40:41], v[128:129] op_sel_hi:[1,0,1]
    v_pk_fma_f32 v[234:235], v[234:235], v[40:41], v[130:131] op_sel_hi:[1,0,1]
    v_cvt_pk_bf16_f32 v132, v168, v169
    v_cvt_pk_bf16_f32 v133, v170, v171
    v_cvt_pk_bf16_f32 v134, v184, v185
    v_cvt_pk_bf16_f32 v135, v186, v187
    v_cvt_pk_bf16_f32 v136, v200, v201
    v_cvt_pk_bf16_f32 v137, v202, v203
    v_cvt_pk_bf16_f32 v138, v216, v217
    v_cvt_pk_bf16_f32 v139, v218, v219
    v_cvt_pk_bf16_f32 v140, v232, v233
    v_cvt_pk_bf16_f32 v141, v234, v235
    buffer_store_dwordx4 v[132:135], v15, s[16:19], s52 offen offset:2048 sc1
    buffer_store_dwordx4 v[136:139], v15, s[16:19], s54 offen offset:2048 sc1
    ds_write_b64 v52, v[140:141] offset:0
    v_cndmask_b32 v54, v140, v54, s[56:57]
    v_cndmask_b32 v55, v141, v55, s[56:57]
    v_pk_fma_f32 v[172:173], v[34:35], v[92:93], v[172:173] op_sel_hi:[0,1,1]
    v_pk_fma_f32 v[174:175], v[34:35], v[94:95], v[174:175] op_sel_hi:[0,1,1]
    v_pk_fma_f32 v[188:189], v[34:35], v[96:97], v[188:189] op_sel_hi:[0,1,1]
    v_pk_fma_f32 v[190:191], v[34:35], v[98:99], v[190:191] op_sel_hi:[0,1,1]
    v_pk_fma_f32 v[204:205], v[34:35], v[100:101], v[204:205] op_sel_hi:[0,1,1]
    v_pk_fma_f32 v[206:207], v[34:35], v[102:103], v[206:207] op_sel_hi:[0,1,1]
    v_pk_fma_f32 v[220:221], v[34:35], v[104:105], v[220:221] op_sel_hi:[0,1,1]
    v_pk_fma_f32 v[222:223], v[34:35], v[106:107], v[222:223] op_sel_hi:[0,1,1]
    v_pk_fma_f32 v[236:237], v[34:35], v[108:109], v[236:237] op_sel_hi:[0,1,1]
    v_pk_fma_f32 v[238:239], v[34:35], v[110:111], v[238:239] op_sel_hi:[0,1,1]
    v_pk_mul_f32 v[112:113], v[172:173], v[70:71] op_sel_hi:[1,0]
    v_pk_mul_f32 v[114:115], v[174:175], v[70:71] op_sel_hi:[1,0]
    v_pk_mul_f32 v[116:117], v[188:189], v[70:71] op_sel_hi:[1,0]
    v_pk_mul_f32 v[118:119], v[190:191], v[70:71] op_sel_hi:[1,0]
    v_pk_mul_f32 v[120:121], v[204:205], v[70:71] op_sel_hi:[1,0]
    v_pk_mul_f32 v[122:123], v[206:207], v[70:71] op_sel_hi:[1,0]
    v_pk_mul_f32 v[124:125], v[220:221], v[70:71] op_sel_hi:[1,0]
    v_pk_mul_f32 v[126:127], v[222:223], v[70:71] op_sel_hi:[1,0]
    v_pk_mul_f32 v[128:129], v[236:237], v[70:71] op_sel_hi:[1,0]
    v_pk_mul_f32 v[130:131], v[238:239], v[70:71] op_sel_hi:[1,0]
    v_max_f32 v172, 0, v172
    v_max_f32 v173, 0, v173
    v_max_f32 v174, 0, v174
    v_max_f32 v175, 0, v175
    v_max_f32 v188, 0, v188
    v_max_f32 v189, 0, v189
    v_max_f32 v190, 0, v190
    v_max_f32 v191, 0, v191
    v_max_f32 v204, 0, v204
    v_max_f32 v205, 0, v205
    v_max_f32 v206, 0, v206
    v_max_f32 v207, 0, v207
    v_max_f32 v220, 0, v220
    v_max_f32 v221, 0, v221
    v_max_f32 v222, 0, v222
    v_max_f32 v223, 0, v223
    v_max_f32 v236, 0, v236
    v_max_f32 v237, 0, v237
    v_max_f32 v238, 0, v238
    v_max_f32 v239, 0, v239
    v_exp_f32_e64 v112, v112 clamp
    v_exp_f32_e64 v113, v113 clamp
    v_exp_f32_e64 v114, v114 clamp
    v_exp_f32_e64 v115, v115 clamp
    v_exp_f32_e64 v116, v116 clamp
    v_exp_f32_e64 v117, v117 clamp
    v_exp_f32_e64 v118, v118 clamp
    v_exp_f32_e64 v119, v119 clamp
    v_exp_f32_e64 v120, v120 clamp
    v_exp_f32_e64 v121, v121 clamp
    v_exp_f32_e64 v122, v122 clamp
    v_exp_f32_e64 v123, v123 clamp
    v_exp_f32_e64 v124, v124 clamp
    v_exp_f32_e64 v125, v125 clamp
    v_exp_f32_e64 v126, v126 clamp
    v_exp_f32_e64 v127, v127 clamp
    v_exp_f32_e64 v128, v128 clamp
    v_exp_f32_e64 v129, v129 clamp
    v_exp_f32_e64 v130, v130 clamp
    v_exp_f32_e64 v131, v131 clamp
    s_nop 0
    v_pk_add_f32 v[112:113], v[112:113], v[22:23] op_sel_hi:[1,0]
    v_pk_add_f32 v[114:115], v[114:115], v[22:23] op_sel_hi:[1,0]
    v_pk_add_f32 v[116:117], v[116:117], v[22:23] op_sel_hi:[1,0]
    v_pk_add_f32 v[118:119], v[118:119], v[22:23] op_sel_hi:[1,0]
    v_pk_add_f32 v[120:121], v[120:121], v[22:23] op_sel_hi:[1,0]
    v_pk_add_f32 v[122:123], v[122:123], v[22:23] op_sel_hi:[1,0]
    v_pk_add_f32 v[124:125], v[124:125], v[22:23] op_sel_hi:[1,0]
    v_pk_add_f32 v[126:127], v[126:127], v[22:23] op_sel_hi:[1,0]
    v_pk_add_f32 v[128:129], v[128:129], v[22:23] op_sel_hi:[1,0]
    v_pk_add_f32 v[130:131], v[130:131], v[22:23] op_sel_hi:[1,0]
    v_pk_fma_f32 v[172:173], v[172:173], v[42:43], v[112:113] op_sel_hi:[1,0,1]
    v_pk_fma_f32 v[174:175], v[174:175], v[42:43], v[114:115] op_sel_hi:[1,0,1]
    v_pk_fma_f32 v[188:189], v[188:189], v[42:43], v[116:117] op_sel_hi:[1,0,1]
    v_pk_fma_f32 v[190:191], v[190:191], v[42:43], v[118:119] op_sel_hi:[1,0,1]
    v_pk_fma_f32 v[204:205], v[204:205], v[42:43], v[120:121] op_sel_hi:[1,0,1]
    v_pk_fma_f32 v[206:207], v[206:207], v[42:43], v[122:123] op_sel_hi:[1,0,1]
    v_pk_fma_f32 v[220:221], v[220:221], v[42:43], v[124:125] op_sel_hi:[1,0,1]
    v_pk_fma_f32 v[222:223], v[222:223], v[42:43], v[126:127] op_sel_hi:[1,0,1]
    v_pk_fma_f32 v[236:237], v[236:237], v[42:43], v[128:129] op_sel_hi:[1,0,1]
    v_pk_fma_f32 v[238:239], v[238:239], v[42:43], v[130:131] op_sel_hi:[1,0,1]
    v_cvt_pk_bf16_f32 v142, v172, v173
    v_cvt_pk_bf16_f32 v143, v174, v175
    v_cvt_pk_bf16_f32 v144, v188, v189
    v_cvt_pk_bf16_f32 v145, v190, v191
    v_cvt_pk_bf16_f32 v146, v204, v205
    v_cvt_pk_bf16_f32 v147, v206, v207
    v_cvt_pk_bf16_f32 v148, v220, v221
    v_cvt_pk_bf16_f32 v149, v222, v223
    v_cvt_pk_bf16_f32 v150, v236, v237
    v_cvt_pk_bf16_f32 v151, v238, v239
    buffer_store_dwordx4 v[142:145], v15, s[16:19], s52 offen offset:3072 sc1
    buffer_store_dwordx4 v[146:149], v15, s[16:19], s54 offen offset:3072 sc1
    ds_write_b64 v52, v[150:151] offset:512
    v_cndmask_b32 v56, v150, v56, s[56:57]
    v_cndmask_b32 v57, v151, v57, s[56:57]
    s_waitcnt lgkmcnt(0)
    s_barrier
    ds_read_b64 v[44:45], v53
    ds_read_b64 v[48:49], v53 offset:512
    s_waitcnt lgkmcnt(0)
    v_cndmask_b32 v46, v54, v44, s[56:57]
    v_cndmask_b32 v47, v55, v45, s[56:57]
    v_cndmask_b32 v44, v44, v54, s[56:57]
    v_cndmask_b32 v45, v45, v55, s[56:57]
    buffer_store_dwordx4 v[44:47], v15, s[16:19], s53 offen offset:0 sc1
    v_cndmask_b32 v50, v56, v48, s[56:57]
    v_cndmask_b32 v51, v57, v49, s[56:57]
    v_cndmask_b32 v48, v48, v56, s[56:57]
    v_cndmask_b32 v49, v49, v57, s[56:57]
    buffer_store_dwordx4 v[48:51], v15, s[16:19], s53 offen offset:1024 sc1
L_k1_end_e:
L_k1_end:
    s_branch L_phase2
L_k1_exit:
    s_endpgm
L_k1_q_spin:
    s_mov_b32 s51, 0
L_k1_q_spin2:
    s_sleep 4
    buffer_load_dword v159, v158, s[44:47], 0 offen sc1
    s_add_u32 s51, s51, 1
    s_cmp_ge_u32 s51, 1000000
    s_waitcnt vmcnt(0)
    s_cbranch_scc1 L_k1_q_go
    v_cmp_eq_u32 vcc, 0, v159
    s_cbranch_vccnz L_k1_q_spin2
    s_branch L_k1_q_go
L_phase2:
    s_waitcnt vmcnt(0)
L_phase2_nw:
    v_mov_b32 v10, 163808
    v_mov_b32 v12, 0
    v_mov_b32 v13, 0
    v_mov_b32 v14, 0
    v_mov_b32 v15, 8
    v_lshlrev_b32 v17, s85, v0
    ds_write_b128 v10, v[12:15]
    ds_write_b32 v10, v12 offset:16
    v_mov_b32 v16, 1
    s_waitcnt lgkmcnt(0)
    s_barrier
    v_cmp_gt_u32 vcc, s69, v0
    s_and_saveexec_b64 s[34:35], vcc
    s_cbranch_execz L_p2_nofl
    buffer_store_dword v16, v17, s[16:19], s68 offen sc1
L_p2_nofl:
    s_mov_b64 exec, -1
L_p2_roles:
    s_setprio 0
    s_mov_b32 s36, s80
    s_mov_b32 s37, s81
    s_mov_b32 s21, s82
    s_mov_b32 s22, s83
    s_and_b32 s27, s20, 3
    v_lshlrev_b32 v2, 4, v1
    v_add_u32 v3, 4096, v2
    s_cmp_ge_u32 s20, 4
    s_cbranch_scc1 L_k2_s
    v_cmp_ne_u32 vcc, 1, v159
    s_cbranch_vccz L_k2_bok
    s_mov_b32 s30, s79
    v_lshlrev_b32 v13, 2, v1
    s_mov_b32 s40, 0x0
    s_mov_b32 s41, 0xffff0000
    s_mov_b32 s29, 0
L_gate_b:
    buffer_load_dword v15, v13, s[16:19], s30 offen offset:0 sc1
    s_add_u32 s29, s29, 1
    s_cmp_ge_u32 s29, 1000000
    s_waitcnt vmcnt(0)
    s_cbranch_scc1 L_gate_b_ok
    v_cmp_ne_u32 vcc, 1, v15
    s_nop 0
    s_and_b64 vcc, vcc, s[40:41]
    s_cbranch_scc0 L_gate_b_ok
    s_sleep 2
    s_branch L_gate_b
L_gate_b_ok:
L_k2_bok:
    s_mul_i32 s32, s27, 14
    s_cmp_eq_u32 s27, 3
    s_cselect_b32 s32, 41, s32
    s_mul_i32 s24, s83, 54
    s_add_u32 s24, s24, s32
    s_mul_i32 s24, s24, 5120
    s_add_u32 s24, s24, 9699328
    s_mul_i32 s43, s27, 10240
    s_add_u32 s43, s43, 51200
    s_cmp_ge_u32 s27, 2
    s_cselect_b32 s39, 40960, 0
    s_mul_i32 s42, s27, 25600
    s_add_u32 s42, s42, s39
    s_cmp_eq_u32 s89, 0
    s_cbranch_scc1 L_b_skip_h
    s_add_u32 m0, s43, 0
    s_add_u32 s39, s24, 0
    buffer_load_dwordx4 v2, s[16:19], s39 offen sc1 lds
    s_add_u32 m0, s43, 1024
    s_add_u32 s39, s24, 1024
    buffer_load_dwordx4 v2, s[16:19], s39 offen sc1 lds
    s_add_u32 m0, s43, 2048
    s_add_u32 s39, s24, 2048
    buffer_load_dwordx4 v2, s[16:19], s39 offen sc1 lds
    s_add_u32 m0, s43, 3072
    s_add_u32 s39, s24, 3072
    buffer_load_dwordx4 v2, s[16:19], s39 offen sc1 lds
    s_add_u32 m0, s43, 4096
    s_add_u32 s39, s24, 4096
    buffer_load_dwordx4 v2, s[16:19], s39 offen sc1 lds
    s_add_u32 m0, s43, 5120
    s_add_u32 s39, s24, 5120
    buffer_load_dwordx4 v2, s[16:19], s39 offen sc1 lds
    s_add_u32 m0, s43, 6144
    s_add_u32 s39, s24, 6144
    buffer_load_dwordx4 v2, s[16:19], s39 offen sc1 lds
    s_add_u32 m0, s43, 7168
    s_add_u32 s39, s24, 7168
    buffer_load_dwordx4 v2, s[16:19], s39 offen sc1 lds
    s_add_u32 m0, s43, 8192
    s_add_u32 s39, s24, 8192
    buffer_load_dwordx4 v2, s[16:19], s39 offen sc1 lds
    s_add_u32 m0, s43, 9216
    s_add_u32 s39, s24, 9216
    buffer_load_dwordx4 v2, s[16:19], s39 offen sc1 lds
L_b_skip_h:
    s_add_u32 m0, s42, 0
    s_add_u32 s39, s24, 10240
    buffer_load_dwordx4 v2, s[16:19], s39 offen sc1 lds
    s_add_u32 m0, s42, 1024
    s_add_u32 s39, s24, 11264
    buffer_load_dwordx4 v2, s[16:19], s39 offen sc1 lds
    s_add_u32 m0, s42, 2048
    s_add_u32 s39, s24, 12288
    buffer_load_dwordx4 v2, s[16:19], s39 offen sc1 lds
    s_add_u32 m0, s42, 3072
    s_add_u32 s39, s24, 13312
    buffer_load_dwordx4 v2, s[16:19], s39 offen sc1 lds
    s_add_u32 m0, s42, 4096
    s_add_u32 s39, s24, 14336
    buffer_load_dwordx4 v2, s[16:19], s39 offen sc1 lds
    s_add_u32 m0, s42, 5120
    s_add_u32 s39, s24, 15360
    buffer_load_dwordx4 v2, s[16:19], s39 offen sc1 lds
    s_add_u32 m0, s42, 6144
    s_add_u32 s39, s24, 16384
    buffer_load_dwordx4 v2, s[16:19], s39 offen sc1 lds
    s_add_u32 m0, s42, 7168
    s_add_u32 s39, s24, 17408
    buffer_load_dwordx4 v2, s[16:19], s39 offen sc1 lds
    s_add_u32 m0, s42, 8192
    s_add_u32 s39, s24, 18432
    buffer_load_dwordx4 v2, s[16:19], s39 offen sc1 lds
    s_add_u32 m0, s42, 9216
    s_add_u32 s39, s24, 19456
    buffer_load_dwordx4 v2, s[16:19], s39 offen sc1 lds
    s_add_u32 m0, s42, 10240
    s_add_u32 s39, s24, 20480
    buffer_load_dwordx4 v2, s[16:19], s39 offen sc1 lds
    s_add_u32 m0, s42, 11264
    s_add_u32 s39, s24, 21504
    buffer_load_dwordx4 v2, s[16:19], s39 offen sc1 lds
    s_add_u32 m0, s42, 12288
    s_add_u32 s39, s24, 22528
    buffer_load_dwordx4 v2, s[16:19], s39 offen sc1 lds
    s_add_u32 m0, s42, 13312
    s_add_u32 s39, s24, 23552
    buffer_load_dwordx4 v2, s[16:19], s39 offen sc1 lds
    s_add_u32 m0, s42, 14336
    s_add_u32 s39, s24, 24576
    buffer_load_dwordx4 v2, s[16:19], s39 offen sc1 lds
    s_add_u32 m0, s42, 15360
    s_add_u32 s39, s24, 25600
    buffer_load_dwordx4 v2, s[16:19], s39 offen sc1 lds
    s_add_u32 m0, s42, 16384
    s_add_u32 s39, s24, 26624
    buffer_load_dwordx4 v2, s[16:19], s39 offen sc1 lds
    s_add_u32 m0, s42, 17408
    s_add_u32 s39, s24, 27648
    buffer_load_dwordx4 v2, s[16:19], s39 offen sc1 lds
    s_add_u32 m0, s42, 18432
    s_add_u32 s39, s24, 28672
    buffer_load_dwordx4 v2, s[16:19], s39 offen sc1 lds
    s_add_u32 m0, s42, 19456
    s_add_u32 s39, s24, 29696
    buffer_load_dwordx4 v2, s[16:19], s39 offen sc1 lds
    s_add_u32 m0, s42, 20480
    s_add_u32 s39, s24, 30720
    buffer_load_dwordx4 v2, s[16:19], s39 offen sc1 lds
    s_add_u32 m0, s42, 21504
    s_add_u32 s39, s24, 31744
    buffer_load_dwordx4 v2, s[16:19], s39 offen sc1 lds
    s_add_u32 m0, s42, 22528
    s_add_u32 s39, s24, 32768
    buffer_load_dwordx4 v2, s[16:19], s39 offen sc1 lds
    s_add_u32 m0, s42, 23552
    s_add_u32 s39, s24, 33792
    buffer_load_dwordx4 v2, s[16:19], s39 offen sc1 lds
    s_add_u32 m0, s42, 24576
    s_add_u32 s39, s24, 34816
    buffer_load_dwordx4 v2, s[16:19], s39 offen sc1 lds
    s_branch L_k2_b2
L_p2_spare_h:
    s_waitcnt vmcnt(0)
    s_mov_b64 exec, 1
    ds_add_rtn_u32 v24, v30, v28 offset:12
    s_mov_b64 exec, -1
    s_waitcnt lgkmcnt(0)
    v_readfirstlane_b32 s33, v24
    s_nop 3
    s_cmp_lg_u32 s33, 7
    s_cbranch_scc1 L_sp_nolast_h
    buffer_store_dword v28, v29, s[16:19], s68 offen sc1
    s_add_u32 s68, s68, 32768
    buffer_store_dword v28, v29, s[16:19], s68 offen sc1
    s_add_u32 s68, s68, 32768
    buffer_store_dword v28, v29, s[16:19], s68 offen sc1
    s_add_u32 s68, s68, 32768
    buffer_store_dword v28, v29, s[16:19], s68 offen sc1
    s_add_u32 s68, s68, 32768
L_sp_nolast_h:
    s_setprio 0
    s_mov_b32 s36, s80
    s_mov_b32 s37, s81
    s_mov_b32 s21, s82
    s_mov_b32 s22, s83
    s_and_b32 s27, s20, 3
    v_lshlrev_b32 v2, 4, v1
    v_add_u32 v3, 4096, v2
    s_mul_i32 s32, s27, 14
    s_cmp_eq_u32 s27, 3
    s_cselect_b32 s32, 41, s32
    s_mul_i32 s24, s83, 54
    s_add_u32 s24, s24, s32
    s_mul_i32 s24, s24, 5120
    s_add_u32 s24, s24, 9699328
    s_mul_i32 s43, s27, 10240
    s_add_u32 s43, s43, 51200
    s_cmp_ge_u32 s27, 2
    s_cselect_b32 s39, 40960, 0
    s_mul_i32 s42, s27, 25600
    s_add_u32 s42, s42, s39
    s_add_u32 s24, s24, 51200
    s_cmp_lg_u32 s20, 0
    s_cbranch_scc1 L_k2_b3
    s_mov_b32 s30, s79
    v_lshlrev_b32 v13, 2, v1
    s_mov_b32 s40, 0x3fffff
    s_mov_b32 s41, 0x0
    s_mov_b32 s29, 0
L_gate_hs:
    buffer_load_dword v15, v13, s[16:19], s30 offen offset:0 sc1
    s_add_u32 s29, s29, 1
    s_cmp_ge_u32 s29, 1000000
    s_waitcnt vmcnt(0)
    s_cbranch_scc1 L_gate_hs_ok
    v_cmp_ne_u32 vcc, 1, v15
    s_nop 0
    s_and_b64 vcc, vcc, s[40:41]
    s_cbranch_scc0 L_gate_hs_ok
    s_sleep 1
    s_branch L_gate_hs
L_gate_hs_ok:
    v_mov_b32 v11, 163808
    v_mov_b32 v12, 1
    ds_write_b32 v11, v12
    s_branch L_k2_b3
L_k2_b2:
    s_add_u32 s24, s24, 35840
    buffer_load_dwordx4 v[116:119], v2, s[16:19], s24 offen offset:0 sc1
    buffer_load_dwordx4 v[120:123], v2, s[16:19], s24 offen offset:1024 sc1
    buffer_load_dwordx4 v[124:127], v2, s[16:19], s24 offen offset:2048 sc1
    buffer_load_dwordx4 v[128:131], v2, s[16:19], s24 offen offset:3072 sc1
    buffer_load_dwordx4 v[132:135], v3, s[16:19], s24 offen sc1
    s_add_u32 s24, s24, 5120
    buffer_load_dwordx4 v[136:139], v2, s[16:19], s24 offen offset:0 sc1
    buffer_load_dwordx4 v[140:143], v2, s[16:19], s24 offen offset:1024 sc1
    buffer_load_dwordx4 v[144:147], v2, s[16:19], s24 offen offset:2048 sc1
    buffer_load_dwordx4 v[148:151], v2, s[16:19], s24 offen offset:3072 sc1
    buffer_load_dwordx4 v[152:155], v3, s[16:19], s24 offen sc1
    s_add_u32 s24, s24, 5120
    buffer_load_dwordx4 v[156:159], v2, s[16:19], s24 offen offset:0 sc1
    buffer_load_dwordx4 v[160:163], v2, s[16:19], s24 offen offset:1024 sc1
    buffer_load_dwordx4 v[164:167], v2, s[16:19], s24 offen offset:2048 sc1
    buffer_load_dwordx4 v[168:171], v2, s[16:19], s24 offen offset:3072 sc1
    buffer_load_dwordx4 v[172:175], v3, s[16:19], s24 offen sc1
    s_add_u32 s24, s24, 5120
L_k2_b3:
    s_mul_i32 s23, s21, 54
    s_add_u32 s23, s23, s32
    s_lshl_b32 s23, s23, 12
    s_mov_b32 s8, s4
    s_and_b32 s9, s5, 0xffff
    s_mov_b32 s10, 2621440
    s_mov_b32 s11, 0x20000
    s_mov_b32 s12, s36
    s_and_b32 s13, s37, 0xffff
    s_mov_b32 s14, 2621440
    s_mov_b32 s15, 0x20000
    s_lshl_b32 s33, s21, 2
    s_add_u32 s33, s33, s27
    s_mul_i32 s33, s33, 20480
    s_mul_i32 s34, s22, 160
    s_add_u32 s33, s33, s34
    s_add_u32 s33, s33, 0
    v_lshrrev_b32 v7, 2, v1
    v_and_b32 v8, 3, v1
    v_mul_u32_u24 v4, 1280, v7
    v_lshl_add_u32 v4, v8, 3, v4
    v_add_u32 v4, s33, v4
    v_bfe_u32 v9, v7, 1, 2
    v_xor_b32 v9, v9, v8
    v_lshl_add_u32 v9, v7, 2, v9
    s_mul_i32 s33, s27, 5120
    s_add_u32 s33, s33, 0
    v_lshl_add_u32 v6, v9, 4, s33
    v_and_b32 v7, 15, v1
    v_lshrrev_b32 v8, 4, v1
    v_bfe_u32 v9, v7, 1, 2
    v_xor_b32 v9, v9, v8
    v_lshl_add_u32 v9, v7, 2, v9
    s_mul_i32 s33, s20, 20480
    v_lshl_add_u32 v5, v9, 4, s33
    v_add_u32 v10, s42, v2
    v_add_u32 v16, s43, v2
    v_mov_b32 v11, 163808
    s_waitcnt vmcnt(15)
    ds_read_b128 v[76:79], v16 offset:0
    ds_read_b128 v[80:83], v16 offset:1024
    ds_read_b128 v[84:87], v16 offset:2048
    ds_read_b128 v[88:91], v16 offset:3072
    ds_read_b128 v[92:95], v16 offset:4096
    ds_read_b128 v[96:99], v16 offset:5120
    ds_read_b128 v[100:103], v16 offset:6144
    ds_read_b128 v[104:107], v16 offset:7168
    ds_read_b128 v[108:111], v16 offset:8192
    ds_read_b128 v[112:115], v16 offset:9216
    s_mov_b32 s29, 0
L_lw_h:
    ds_read_b32 v12, v11 offset:0
    s_add_u32 s29, s29, 1
    s_cmp_ge_u32 s29, 40000000
    s_waitcnt lgkmcnt(0)
    s_cbranch_scc1 L_lw_h_ok
    v_cmp_gt_u32 vcc, 1, v12
    s_cbranch_vccz L_lw_h_ok
    s_sleep 1
    s_branch L_lw_h
L_lw_h_ok:
    buffer_load_dwordx4 v[28:31], v2, s[16:19], s23 offen offset:0 sc1
    buffer_load_dwordx4 v[32:35], v2, s[16:19], s23 offen offset:1024 sc1
    buffer_load_dwordx4 v[36:39], v2, s[16:19], s23 offen offset:2048 sc1
    buffer_load_dwordx4 v[40:43], v2, s[16:19], s23 offen offset:3072 sc1
    s_add_u32 s23, s23, 4096
    buffer_load_dwordx4 v[44:47], v2, s[16:19], s23 offen offset:0 sc1
    buffer_load_dwordx4 v[48:51], v2, s[16:19], s23 offen offset:1024 sc1
    buffer_load_dwordx4 v[52:55], v2, s[16:19], s23 offen offset:2048 sc1
    buffer_load_dwordx4 v[56:59], v2, s[16:19], s23 offen offset:3072 sc1
    s_add_u32 s23, s23, 4096
    buffer_load_dwordx4 v[60:63], v2, s[16:19], s23 offen offset:0 sc1
    buffer_load_dwordx4 v[64:67], v2, s[16:19], s23 offen offset:1024 sc1
    buffer_load_dwordx4 v[68:71], v2, s[16:19], s23 offen offset:2048 sc1
    buffer_load_dwordx4 v[72:75], v2, s[16:19], s23 offen offset:3072 sc1
    s_add_u32 s23, s23, 4096
    s_waitcnt vmcnt(8)
    v_mfma_f32_16x16x32_bf16 v[176:179], v[76:79], v[28:31], 0
    v_mfma_f32_16x16x32_bf16 v[180:183], v[80:83], v[28:31], 0
    v_mfma_f32_16x16x32_bf16 v[184:187], v[84:87], v[28:31], 0
    v_mfma_f32_16x16x32_bf16 v[188:191], v[88:91], v[28:31], 0
    v_mfma_f32_16x16x32_bf16 v[192:195], v[92:95], v[28:31], 0
    v_mfma_f32_16x16x32_bf16 v[196:199], v[76:79], v[32:35], 0
    v_mfma_f32_16x16x32_bf16 v[200:203], v[80:83], v[32:35], 0
    v_mfma_f32_16x16x32_bf16 v[204:207], v[84:87], v[32:35], 0
    v_mfma_f32_16x16x32_bf16 v[208:211], v[88:91], v[32:35], 0
    v_mfma_f32_16x16x32_bf16 v[212:215], v[92:95], v[32:35], 0
    v_mfma_f32_16x16x32_bf16 v[216:219], v[76:79], v[36:39], 0
    v_mfma_f32_16x16x32_bf16 v[220:223], v[80:83], v[36:39], 0
    v_mfma_f32_16x16x32_bf16 v[224:227], v[84:87], v[36:39], 0
    v_mfma_f32_16x16x32_bf16 v[228:231], v[88:91], v[36:39], 0
    v_mfma_f32_16x16x32_bf16 v[232:235], v[92:95], v[36:39], 0
    v_mfma_f32_16x16x32_bf16 v[236:239], v[76:79], v[40:43], 0
    v_mfma_f32_16x16x32_bf16 v[240:243], v[80:83], v[40:43], 0
    v_mfma_f32_16x16x32_bf16 v[244:247], v[84:87], v[40:43], 0
    v_mfma_f32_16x16x32_bf16 v[248:251], v[88:91], v[40:43], 0
    v_mfma_f32_16x16x32_bf16 v[252:255], v[92:95], v[40:43], 0
    buffer_load_dwordx4 v[28:31], v2, s[16:19], s23 offen offset:0 sc1
    buffer_load_dwordx4 v[32:35], v2, s[16:19], s23 offen offset:1024 sc1
    buffer_load_dwordx4 v[36:39], v2, s[16:19], s23 offen offset:2048 sc1
    buffer_load_dwordx4 v[40:43], v2, s[16:19], s23 offen offset:3072 sc1
    s_add_u32 s23, s23, 4096
    ds_read_b128 v[76:79], v10 offset:0
    ds_read_b128 v[80:83], v10 offset:1024
    ds_read_b128 v[84:87], v10 offset:2048
    ds_read_b128 v[88:91], v10 offset:3072
    ds_read_b128 v[92:95], v10 offset:4096
    s_waitcnt vmcnt(8)
    v_mfma_f32_16x16x32_bf16 v[176:179], v[96:99], v[44:47], v[176:179]
    v_mfma_f32_16x16x32_bf16 v[180:183], v[100:103], v[44:47], v[180:183]
    v_mfma_f32_16x16x32_bf16 v[184:187], v[104:107], v[44:47], v[184:187]
    v_mfma_f32_16x16x32_bf16 v[188:191], v[108:111], v[44:47], v[188:191]
    v_mfma_f32_16x16x32_bf16 v[192:195], v[112:115], v[44:47], v[192:195]
    v_mfma_f32_16x16x32_bf16 v[196:199], v[96:99], v[48:51], v[196:199]
    v_mfma_f32_16x16x32_bf16 v[200:203], v[100:103], v[48:51], v[200:203]
    v_mfma_f32_16x16x32_bf16 v[204:207], v[104:107], v[48:51], v[204:207]
    v_mfma_f32_16x16x32_bf16 v[208:211], v[108:111], v[48:51], v[208:211]
    v_mfma_f32_16x16x32_bf16 v[212:215], v[112:115], v[48:51], v[212:215]
    v_mfma_f32_16x16x32_bf16 v[216:219], v[96:99], v[52:55], v[216:219]
    v_mfma_f32_16x16x32_bf16 v[220:223], v[100:103], v[52:55], v[220:223]
    v_mfma_f32_16x16x32_bf16 v[224:227], v[104:107], v[52:55], v[224:227]
    v_mfma_f32_16x16x32_bf16 v[228:231], v[108:111], v[52:55], v[228:231]
    v_mfma_f32_16x16x32_bf16 v[232:235], v[112:115], v[52:55], v[232:235]
    v_mfma_f32_16x16x32_bf16 v[236:239], v[96:99], v[56:59], v[236:239]
    v_mfma_f32_16x16x32_bf16 v[240:243], v[100:103], v[56:59], v[240:243]
    v_mfma_f32_16x16x32_bf16 v[244:247], v[104:107], v[56:59], v[244:247]
    v_mfma_f32_16x16x32_bf16 v[248:251], v[108:111], v[56:59], v[248:251]
    v_mfma_f32_16x16x32_bf16 v[252:255], v[112:115], v[56:59], v[252:255]
    buffer_load_dwordx4 v[44:47], v2, s[16:19], s23 offen offset:0 sc1
    buffer_load_dwordx4 v[48:51], v2, s[16:19], s23 offen offset:1024 sc1
    buffer_load_dwordx4 v[52:55], v2, s[16:19], s23 offen offset:2048 sc1
    buffer_load_dwordx4 v[56:59], v2, s[16:19], s23 offen offset:3072 sc1
    s_add_u32 s23, s23, 4096
    ds_read_b128 v[96:99], v10 offset:5120
    ds_read_b128 v[100:103], v10 offset:6144
    ds_read_b128 v[104:107], v10 offset:7168
    ds_read_b128 v[108:111], v10 offset:8192
    ds_read_b128 v[112:115], v10 offset:9216
    s_waitcnt vmcnt(8)
    s_waitcnt lgkmcnt(5)
    v_mfma_f32_16x16x32_bf16 v[176:179], v[76:79], v[60:63], v[176:179]
    v_mfma_f32_16x16x32_bf16 v[180:183], v[80:83], v[60:63], v[180:183]
    v_mfma_f32_16x16x32_bf16 v[184:187], v[84:87], v[60:63], v[184:187]
    v_mfma_f32_16x16x32_bf16 v[188:191], v[88:91], v[60:63], v[188:191]
    v_mfma_f32_16x16x32_bf16 v[192:195], v[92:95], v[60:63], v[192:195]
    v_mfma_f32_16x16x32_bf16 v[196:199], v[76:79], v[64:67], v[196:199]
    v_mfma_f32_16x16x32_bf16 v[200:203], v[80:83], v[64:67], v[200:203]
    v_mfma_f32_16x16x32_bf16 v[204:207], v[84:87], v[64:67], v[204:207]
    v_mfma_f32_16x16x32_bf16 v[208:211], v[88:91], v[64:67], v[208:211]
    v_mfma_f32_16x16x32_bf16 v[212:215], v[92:95], v[64:67], v[212:215]
    v_mfma_f32_16x16x32_bf16 v[216:219], v[76:79], v[68:71], v[216:219]
    v_mfma_f32_16x16x32_bf16 v[220:223], v[80:83], v[68:71], v[220:223]
    v_mfma_f32_16x16x32_bf16 v[224:227], v[84:87], v[68:71], v[224:227]
    v_mfma_f32_16x16x32_bf16 v[228:231], v[88:91], v[68:71], v[228:231]
    v_mfma_f32_16x16x32_bf16 v[232:235], v[92:95], v[68:71], v[232:235]
    v_mfma_f32_16x16x32_bf16 v[236:239], v[76:79], v[72:75], v[236:239]
    v_mfma_f32_16x16x32_bf16 v[240:243], v[80:83], v[72:75], v[240:243]
    v_mfma_f32_16x16x32_bf16 v[244:247], v[84:87], v[72:75], v[244:247]
    v_mfma_f32_16x16x32_bf16 v[248:251], v[88:91], v[72:75], v[248:251]
    v_mfma_f32_16x16x32_bf16 v[252:255], v[92:95], v[72:75], v[252:255]
    buffer_load_dwordx4 v[60:63], v2, s[16:19], s23 offen offset:0 sc1
    buffer_load_dwordx4 v[64:67], v2, s[16:19], s23 offen offset:1024 sc1
    buffer_load_dwordx4 v[68:71], v2, s[16:19], s23 offen offset:2048 sc1
    buffer_load_dwordx4 v[72:75], v2, s[16:19], s23 offen offset:3072 sc1
    s_add_u32 s23, s23, 4096
    ds_read_b128 v[76:79], v10 offset:10240
    ds_read_b128 v[80:83], v10 offset:11264
    ds_read_b128 v[84:87], v10 offset:12288
    ds_read_b128 v[88:91], v10 offset:13312
    ds_read_b128 v[92:95], v10 offset:14336
    s_waitcnt vmcnt(8)
    s_waitcnt lgkmcnt(5)
    v_mfma_f32_16x16x32_bf16 v[176:179], v[96:99], v[28:31], v[176:179]
    v_mfma_f32_16x16x32_bf16 v[180:183], v[100:103], v[28:31], v[180:183]
    v_mfma_f32_16x16x32_bf16 v[184:187], v[104:107], v[28:31], v[184:187]
    v_mfma_f32_16x16x32_bf16 v[188:191], v[108:111], v[28:31], v[188:191]
    v_mfma_f32_16x16x32_bf16 v[192:195], v[112:115], v[28:31], v[192:195]
    v_mfma_f32_16x16x32_bf16 v[196:199], v[96:99], v[32:35], v[196:199]
    v_mfma_f32_16x16x32_bf16 v[200:203], v[100:103], v[32:35], v[200:203]
    v_mfma_f32_16x16x32_bf16 v[204:207], v[104:107], v[32:35], v[204:207]
    v_mfma_f32_16x16x32_bf16 v[208:211], v[108:111], v[32:35], v[208:211]
    v_mfma_f32_16x16x32_bf16 v[212:215], v[112:115], v[32:35], v[212:215]
    v_mfma_f32_16x16x32_bf16 v[216:219], v[96:99], v[36:39], v[216:219]
    v_mfma_f32_16x16x32_bf16 v[220:223], v[100:103], v[36:39], v[220:223]
    v_mfma_f32_16x16x32_bf16 v[224:227], v[104:107], v[36:39], v[224:227]
    v_mfma_f32_16x16x32_bf16 v[228:231], v[108:111], v[36:39], v[228:231]
    v_mfma_f32_16x16x32_bf16 v[232:235], v[112:115], v[36:39], v[232:235]
    v_mfma_f32_16x16x32_bf16 v[236:239], v[96:99], v[40:43], v[236:239]
    v_mfma_f32_16x16x32_bf16 v[240:243], v[100:103], v[40:43], v[240:243]
    v_mfma_f32_16x16x32_bf16 v[244:247], v[104:107], v[40:43], v[244:247]
    v_mfma_f32_16x16x32_bf16 v[248:251], v[108:111], v[40:43], v[248:251]
    v_mfma_f32_16x16x32_bf16 v[252:255], v[112:115], v[40:43], v[252:255]
    buffer_load_dwordx4 v[28:31], v2, s[16:19], s23 offen offset:0 sc1
    buffer_load_dwordx4 v[32:35], v2, s[16:19], s23 offen offset:1024 sc1
    buffer_load_dwordx4 v[36:39], v2, s[16:19], s23 offen offset:2048 sc1
    buffer_load_dwordx4 v[40:43], v2, s[16:19], s23 offen offset:3072 sc1
    s_add_u32 s23, s23, 4096
    ds_read_b128 v[96:99], v10 offset:15360
    ds_read_b128 v[100:103], v10 offset:16384
    ds_read_b128 v[104:107], v10 offset:17408
    ds_read_b128 v[108:111], v10 offset:18432
    ds_read_b128 v[112:115], v10 offset:19456
    s_waitcnt vmcnt(8)
    s_waitcnt lgkmcnt(5)
    v_mfma_f32_16x16x32_bf16 v[176:179], v[76:79], v[44:47], v[176:179]
    v_mfma_f32_16x16x32_bf16 v[180:183], v[80:83], v[44:47], v[180:183]
    v_mfma_f32_16x16x32_bf16 v[184:187], v[84:87], v[44:47], v[184:187]
    v_mfma_f32_16x16x32_bf16 v[188:191], v[88:91], v[44:47], v[188:191]
    v_mfma_f32_16x16x32_bf16 v[192:195], v[92:95], v[44:47], v[192:195]
    v_mfma_f32_16x16x32_bf16 v[196:199], v[76:79], v[48:51], v[196:199]
    v_mfma_f32_16x16x32_bf16 v[200:203], v[80:83], v[48:51], v[200:203]
    v_mfma_f32_16x16x32_bf16 v[204:207], v[84:87], v[48:51], v[204:207]
    v_mfma_f32_16x16x32_bf16 v[208:211], v[88:91], v[48:51], v[208:211]
    v_mfma_f32_16x16x32_bf16 v[212:215], v[92:95], v[48:51], v[212:215]
    v_mfma_f32_16x16x32_bf16 v[216:219], v[76:79], v[52:55], v[216:219]
    v_mfma_f32_16x16x32_bf16 v[220:223], v[80:83], v[52:55], v[220:223]
    v_mfma_f32_16x16x32_bf16 v[224:227], v[84:87], v[52:55], v[224:227]
    v_mfma_f32_16x16x32_bf16 v[228:231], v[88:91], v[52:55], v[228:231]
    v_mfma_f32_16x16x32_bf16 v[232:235], v[92:95], v[52:55], v[232:235]
    v_mfma_f32_16x16x32_bf16 v[236:239], v[76:79], v[56:59], v[236:239]
    v_mfma_f32_16x16x32_bf16 v[240:243], v[80:83], v[56:59], v[240:243]
    v_mfma_f32_16x16x32_bf16 v[244:247], v[84:87], v[56:59], v[244:247]
    v_mfma_f32_16x16x32_bf16 v[248:251], v[88:91], v[56:59], v[248:251]
    v_mfma_f32_16x16x32_bf16 v[252:255], v[92:95], v[56:59], v[252:255]
    buffer_load_dwordx4 v[44:47], v2, s[16:19], s23 offen offset:0 sc1
    buffer_load_dwordx4 v[48:51], v2, s[16:19], s23 offen offset:1024 sc1
    buffer_load_dwordx4 v[52:55], v2, s[16:19], s23 offen offset:2048 sc1
    buffer_load_dwordx4 v[56:59], v2, s[16:19], s23 offen offset:3072 sc1
    s_add_u32 s23, s23, 4096
    ds_read_b128 v[76:79], v10 offset:20480
    ds_read_b128 v[80:83], v10 offset:21504
    ds_read_b128 v[84:87], v10 offset:22528
    ds_read_b128 v[88:91], v10 offset:23552
    ds_read_b128 v[92:95], v10 offset:24576
    s_waitcnt vmcnt(8)
    s_waitcnt lgkmcnt(5)
    v_mfma_f32_16x16x32_bf16 v[176:179], v[96:99], v[60:63], v[176:179]
    v_mfma_f32_16x16x32_bf16 v[180:183], v[100:103], v[60:63], v[180:183]
    v_mfma_f32_16x16x32_bf16 v[184:187], v[104:107], v[60:63], v[184:187]
    v_mfma_f32_16x16x32_bf16 v[188:191], v[108:111], v[60:63], v[188:191]
    v_mfma_f32_16x16x32_bf16 v[192:195], v[112:115], v[60:63], v[192:195]
    v_mfma_f32_16x16x32_bf16 v[196:199], v[96:99], v[64:67], v[196:199]
    v_mfma_f32_16x16x32_bf16 v[200:203], v[100:103], v[64:67], v[200:203]
    v_mfma_f32_16x16x32_bf16 v[204:207], v[104:107], v[64:67], v[204:207]
    v_mfma_f32_16x16x32_bf16 v[208:211], v[108:111], v[64:67], v[208:211]
    v_mfma_f32_16x16x32_bf16 v[212:215], v[112:115], v[64:67], v[212:215]
    v_mfma_f32_16x16x32_bf16 v[216:219], v[96:99], v[68:71], v[216:219]
    v_mfma_f32_16x16x32_bf16 v[220:223], v[100:103], v[68:71], v[220:223]
    v_mfma_f32_16x16x32_bf16 v[224:227], v[104:107], v[68:71], v[224:227]
    v_mfma_f32_16x16x32_bf16 v[228:231], v[108:111], v[68:71], v[228:231]
    v_mfma_f32_16x16x32_bf16 v[232:235], v[112:115], v[68:71], v[232:235]
    v_mfma_f32_16x16x32_bf16 v[236:239], v[96:99], v[72:75], v[236:239]
    v_mfma_f32_16x16x32_bf16 v[240:243], v[100:103], v[72:75], v[240:243]
    v_mfma_f32_16x16x32_bf16 v[244:247], v[104:107], v[72:75], v[244:247]
    v_mfma_f32_16x16x32_bf16 v[248:251], v[108:111], v[72:75], v[248:251]
    v_mfma_f32_16x16x32_bf16 v[252:255], v[112:115], v[72:75], v[252:255]
    buffer_load_dwordx4 v[60:63], v2, s[16:19], s23 offen offset:0 sc1
    buffer_load_dwordx4 v[64:67], v2, s[16:19], s23 offen offset:1024 sc1
    buffer_load_dwordx4 v[68:71], v2, s[16:19], s23 offen offset:2048 sc1
    buffer_load_dwordx4 v[72:75], v2, s[16:19], s23 offen offset:3072 sc1
    s_add_u32 s23, s23, 4096
    buffer_load_dwordx4 v[96:99], v2, s[16:19], s24 offen offset:0 sc1
    buffer_load_dwordx4 v[100:103], v2, s[16:19], s24 offen offset:1024 sc1
    buffer_load_dwordx4 v[104:107], v2, s[16:19], s24 offen offset:2048 sc1
    buffer_load_dwordx4 v[108:111], v2, s[16:19], s24 offen offset:3072 sc1
    buffer_load_dwordx4 v[112:115], v3, s[16:19], s24 offen sc1
    s_add_u32 s24, s24, 5120
    s_waitcnt vmcnt(13)
    s_waitcnt lgkmcnt(0)
    v_mov_b32 v12, 1
    s_mov_b64 exec, 1
    ds_add_u32 v11, v12 offset:8
    s_mov_b64 exec, -1
    v_mfma_f32_16x16x32_bf16 v[176:179], v[76:79], v[28:31], v[176:179]
    v_mfma_f32_16x16x32_bf16 v[180:183], v[80:83], v[28:31], v[180:183]
    v_mfma_f32_16x16x32_bf16 v[184:187], v[84:87], v[28:31], v[184:187]
    v_mfma_f32_16x16x32_bf16 v[188:191], v[88:91], v[28:31], v[188:191]
    v_mfma_f32_16x16x32_bf16 v[192:195], v[92:95], v[28:31], v[192:195]
    v_mfma_f32_16x16x32_bf16 v[196:199], v[76:79], v[32:35], v[196:199]
    v_mfma_f32_16x16x32_bf16 v[200:203], v[80:83], v[32:35], v[200:203]
    v_mfma_f32_16x16x32_bf16 v[204:207], v[84:87], v[32:35], v[204:207]
    v_mfma_f32_16x16x32_bf16 v[208:211], v[88:91], v[32:35], v[208:211]
    v_mfma_f32_16x16x32_bf16 v[212:215], v[92:95], v[32:35], v[212:215]
    v_mfma_f32_16x16x32_bf16 v[216:219], v[76:79], v[36:39], v[216:219]
    v_mfma_f32_16x16x32_bf16 v[220:223], v[80:83], v[36:39], v[220:223]
    v_mfma_f32_16x16x32_bf16 v[224:227], v[84:87], v[36:39], v[224:227]
    v_mfma_f32_16x16x32_bf16 v[228:231], v[88:91], v[36:39], v[228:231]
    v_mfma_f32_16x16x32_bf16 v[232:235], v[92:95], v[36:39], v[232:235]
    v_mfma_f32_16x16x32_bf16 v[236:239], v[76:79], v[40:43], v[236:239]
    v_mfma_f32_16x16x32_bf16 v[240:243], v[80:83], v[40:43], v[240:243]
    v_mfma_f32_16x16x32_bf16 v[244:247], v[84:87], v[40:43], v[244:247]
    v_mfma_f32_16x16x32_bf16 v[248:251], v[88:91], v[40:43], v[248:251]
    v_mfma_f32_16x16x32_bf16 v[252:255], v[92:95], v[40:43], v[252:255]
    buffer_load_dwordx4 v[28:31], v2, s[16:19], s23 offen offset:0 sc1
    buffer_load_dwordx4 v[32:35], v2, s[16:19], s23 offen offset:1024 sc1
    buffer_load_dwordx4 v[36:39], v2, s[16:19], s23 offen offset:2048 sc1
    buffer_load_dwordx4 v[40:43], v2, s[16:19], s23 offen offset:3072 sc1
    s_add_u32 s23, s23, 4096
    buffer_load_dwordx4 v[76:79], v2, s[16:19], s24 offen offset:0 sc1
    buffer_load_dwordx4 v[80:83], v2, s[16:19], s24 offen offset:1024 sc1
    buffer_load_dwordx4 v[84:87], v2, s[16:19], s24 offen offset:2048 sc1
    buffer_load_dwordx4 v[88:91], v2, s[16:19], s24 offen offset:3072 sc1
    buffer_load_dwordx4 v[92:95], v3, s[16:19], s24 offen sc1
    s_add_u32 s24, s24, 5120
    s_waitcnt vmcnt(18)
    v_mfma_f32_16x16x32_bf16 v[176:179], v[116:119], v[44:47], v[176:179]
    v_mfma_f32_16x16x32_bf16 v[180:183], v[120:123], v[44:47], v[180:183]
    v_mfma_f32_16x16x32_bf16 v[184:187], v[124:127], v[44:47], v[184:187]
    v_mfma_f32_16x16x32_bf16 v[188:191], v[128:131], v[44:47], v[188:191]
    v_mfma_f32_16x16x32_bf16 v[192:195], v[132:135], v[44:47], v[192:195]
    v_mfma_f32_16x16x32_bf16 v[196:199], v[116:119], v[48:51], v[196:199]
    v_mfma_f32_16x16x32_bf16 v[200:203], v[120:123], v[48:51], v[200:203]
    v_mfma_f32_16x16x32_bf16 v[204:207], v[124:127], v[48:51], v[204:207]
    v_mfma_f32_16x16x32_bf16 v[208:211], v[128:131], v[48:51], v[208:211]
    v_mfma_f32_16x16x32_bf16 v[212:215], v[132:135], v[48:51], v[212:215]
    v_mfma_f32_16x16x32_bf16 v[216:219], v[116:119], v[52:55], v[216:219]
    v_mfma_f32_16x16x32_bf16 v[220:223], v[120:123], v[52:55], v[220:223]
    v_mfma_f32_16x16x32_bf16 v[224:227], v[124:127], v[52:55], v[224:227]
    v_mfma_f32_16x16x32_bf16 v[228:231], v[128:131], v[52:55], v[228:231]
    v_mfma_f32_16x16x32_bf16 v[232:235], v[132:135], v[52:55], v[232:235]
    v_mfma_f32_16x16x32_bf16 v[236:239], v[116:119], v[56:59], v[236:239]
    v_mfma_f32_16x16x32_bf16 v[240:243], v[120:123], v[56:59], v[240:243]
    v_mfma_f32_16x16x32_bf16 v[244:247], v[124:127], v[56:59], v[244:247]
    v_mfma_f32_16x16x32_bf16 v[248:251], v[128:131], v[56:59], v[248:251]
    v_mfma_f32_16x16x32_bf16 v[252:255], v[132:135], v[56:59], v[252:255]
    buffer_load_dwordx4 v[44:47], v2, s[16:19], s23 offen offset:0 sc1
    buffer_load_dwordx4 v[48:51], v2, s[16:19], s23 offen offset:1024 sc1
    buffer_load_dwordx4 v[52:55], v2, s[16:19], s23 offen offset:2048 sc1
    buffer_load_dwordx4 v[56:59], v2, s[16:19], s23 offen offset:3072 sc1
    s_add_u32 s23, s23, 4096
    buffer_load_dwordx4 v[116:119], v2, s[16:19], s24 offen offset:0 sc1
    buffer_load_dwordx4 v[120:123], v2, s[16:19], s24 offen offset:1024 sc1
    buffer_load_dwordx4 v[124:127], v2, s[16:19], s24 offen offset:2048 sc1
    buffer_load_dwordx4 v[128:131], v2, s[16:19], s24 offen offset:3072 sc1
    buffer_load_dwordx4 v[132:135], v3, s[16:19], s24 offen sc1
    s_add_u32 s24, s24, 5120
    s_waitcnt vmcnt(23)
    v_mfma_f32_16x16x32_bf16 v[176:179], v[136:139], v[60:63], v[176:179]
    v_mfma_f32_16x16x32_bf16 v[180:183], v[140:143], v[60:63], v[180:183]
    v_mfma_f32_16x16x32_bf16 v[184:187], v[144:147], v[60:63], v[184:187]
    v_mfma_f32_16x16x32_bf16 v[188:191], v[148:151], v[60:63], v[188:191]
    v_mfma_f32_16x16x32_bf16 v[192:195], v[152:155], v[60:63], v[192:195]
    v_mfma_f32_16x16x32_bf16 v[196:199], v[136:139], v[64:67], v[196:199]
    v_mfma_f32_16x16x32_bf16 v[200:203], v[140:143], v[64:67], v[200:203]
    v_mfma_f32_16x16x32_bf16 v[204:207], v[144:147], v[64:67], v[204:207]
    v_mfma_f32_16x16x32_bf16 v[208:211], v[148:151], v[64:67], v[208:211]
    v_mfma_f32_16x16x32_bf16 v[212:215], v[152:155], v[64:67], v[212:215]
    v_mfma_f32_16x16x32_bf16 v[216:219], v[136:139], v[68:71], v[216:219]
    v_mfma_f32_16x16x32_bf16 v[220:223], v[140:143], v[68:71], v[220:223]
    v_mfma_f32_16x16x32_bf16 v[224:227], v[144:147], v[68:71], v[224:227]
    v_mfma_f32_16x16x32_bf16 v[228:231], v[148:151], v[68:71], v[228:231]
    v_mfma_f32_16x16x32_bf16 v[232:235], v[152:155], v[68:71], v[232:235]
    v_mfma_f32_16x16x32_bf16 v[236:239], v[136:139], v[72:75], v[236:239]
    v_mfma_f32_16x16x32_bf16 v[240:243], v[140:143], v[72:75], v[240:243]
    v_mfma_f32_16x16x32_bf16 v[244:247], v[144:147], v[72:75], v[244:247]
    v_mfma_f32_16x16x32_bf16 v[248:251], v[148:151], v[72:75], v[248:251]
    v_mfma_f32_16x16x32_bf16 v[252:255], v[152:155], v[72:75], v[252:255]
    buffer_load_dwordx4 v[60:63], v2, s[16:19], s23 offen offset:0 sc1
    buffer_load_dwordx4 v[64:67], v2, s[16:19], s23 offen offset:1024 sc1
    buffer_load_dwordx4 v[68:71], v2, s[16:19], s23 offen offset:2048 sc1
    buffer_load_dwordx4 v[72:75], v2, s[16:19], s23 offen offset:3072 sc1
    s_add_u32 s23, s23, 4096
    s_cmp_ge_u32 s27, 2
    s_cselect_b32 s24, 1073741824, s24
    buffer_load_dwordx4 v[136:139], v2, s[16:19], s24 offen offset:0 sc1
    buffer_load_dwordx4 v[140:143], v2, s[16:19], s24 offen offset:1024 sc1
    buffer_load_dwordx4 v[144:147], v2, s[16:19], s24 offen offset:2048 sc1
    buffer_load_dwordx4 v[148:151], v2, s[16:19], s24 offen offset:3072 sc1
    buffer_load_dwordx4 v[152:155], v3, s[16:19], s24 offen sc1
    s_add_u32 s24, s24, 5120
    s_waitcnt vmcnt(23)
    v_mfma_f32_16x16x32_bf16 v[176:179], v[156:159], v[28:31], v[176:179]
    v_mfma_f32_16x16x32_bf16 v[180:183], v[160:163], v[28:31], v[180:183]
    v_mfma_f32_16x16x32_bf16 v[184:187], v[164:167], v[28:31], v[184:187]
    v_mfma_f32_16x16x32_bf16 v[188:191], v[168:171], v[28:31], v[188:191]
    v_mfma_f32_16x16x32_bf16 v[192:195], v[172:175], v[28:31], v[192:195]
    v_mfma_f32_16x16x32_bf16 v[196:199], v[156:159], v[32:35], v[196:199]
    v_mfma_f32_16x16x32_bf16 v[200:203], v[160:163], v[32:35], v[200:203]
    v_mfma_f32_16x16x32_bf16 v[204:207], v[164:167], v[32:35], v[204:207]
    v_mfma_f32_16x16x32_bf16 v[208:211], v[168:171], v[32:35], v[208:211]
    v_mfma_f32_16x16x32_bf16 v[212:215], v[172:175], v[32:35], v[212:215]
    v_mfma_f32_16x16x32_bf16 v[216:219], v[156:159], v[36:39], v[216:219]
    v_mfma_f32_16x16x32_bf16 v[220:223], v[160:163], v[36:39], v[220:223]
    v_mfma_f32_16x16x32_bf16 v[224:227], v[164:167], v[36:39], v[224:227]
    v_mfma_f32_16x16x32_bf16 v[228:231], v[168:171], v[36:39], v[228:231]
    v_mfma_f32_16x16x32_bf16 v[232:235], v[172:175], v[36:39], v[232:235]
    v_mfma_f32_16x16x32_bf16 v[236:239], v[156:159], v[40:43], v[236:239]
    v_mfma_f32_16x16x32_bf16 v[240:243], v[160:163], v[40:43], v[240:243]
    v_mfma_f32_16x16x32_bf16 v[244:247], v[164:167], v[40:43], v[244:247]
    v_mfma_f32_16x16x32_bf16 v[248:251], v[168:171], v[40:43], v[248:251]
    v_mfma_f32_16x16x32_bf16 v[252:255], v[172:175], v[40:43], v[252:255]
    buffer_load_dwordx4 v[28:31], v2, s[16:19], s23 offen offset:0 sc1
    buffer_load_dwordx4 v[32:35], v2, s[16:19], s23 offen offset:1024 sc1
    buffer_load_dwordx4 v[36:39], v2, s[16:19], s23 offen offset:2048 sc1
    buffer_load_dwordx4 v[40:43], v2, s[16:19], s23 offen offset:3072 sc1
    s_add_u32 s23, s23, 4096
    buffer_load_dwordx2 v[18:19], v4, s[8:11], 0 offen offset:0
    buffer_load_dwordx2 v[20:21], v4, s[8:11], 0 offen offset:32
    buffer_load_dwordx2 v[22:23], v4, s[8:11], 0 offen offset:64
    s_waitcnt vmcnt(21)
    v_mfma_f32_16x16x32_bf16 v[176:179], v[96:99], v[44:47], v[176:179]
    v_mfma_f32_16x16x32_bf16 v[180:183], v[100:103], v[44:47], v[180:183]
    v_mfma_f32_16x16x32_bf16 v[184:187], v[104:107], v[44:47], v[184:187]
    v_mfma_f32_16x16x32_bf16 v[188:191], v[108:111], v[44:47], v[188:191]
    v_mfma_f32_16x16x32_bf16 v[192:195], v[112:115], v[44:47], v[192:195]
    v_mfma_f32_16x16x32_bf16 v[196:199], v[96:99], v[48:51], v[196:199]
    v_mfma_f32_16x16x32_bf16 v[200:203], v[100:103], v[48:51], v[200:203]
    v_mfma_f32_16x16x32_bf16 v[204:207], v[104:107], v[48:51], v[204:207]
    v_mfma_f32_16x16x32_bf16 v[208:211], v[108:111], v[48:51], v[208:211]
    v_mfma_f32_16x16x32_bf16 v[212:215], v[112:115], v[48:51], v[212:215]
    v_mfma_f32_16x16x32_bf16 v[216:219], v[96:99], v[52:55], v[216:219]
    v_mfma_f32_16x16x32_bf16 v[220:223], v[100:103], v[52:55], v[220:223]
    v_mfma_f32_16x16x32_bf16 v[224:227], v[104:107], v[52:55], v[224:227]
    v_mfma_f32_16x16x32_bf16 v[228:231], v[108:111], v[52:55], v[228:231]
    v_mfma_f32_16x16x32_bf16 v[232:235], v[112:115], v[52:55], v[232:235]
    v_mfma_f32_16x16x32_bf16 v[236:239], v[96:99], v[56:59], v[236:239]
    v_mfma_f32_16x16x32_bf16 v[240:243], v[100:103], v[56:59], v[240:243]
    v_mfma_f32_16x16x32_bf16 v[244:247], v[104:107], v[56:59], v[244:247]
    v_mfma_f32_16x16x32_bf16 v[248:251], v[108:111], v[56:59], v[248:251]
    v_mfma_f32_16x16x32_bf16 v[252:255], v[112:115], v[56:59], v[252:255]
    s_cmp_ge_u32 s27, 2
    s_cselect_b32 s23, 1073741824, s23
    buffer_load_dwordx4 v[44:47], v2, s[16:19], s23 offen offset:0 sc1
    buffer_load_dwordx4 v[48:51], v2, s[16:19], s23 offen offset:1024 sc1
    buffer_load_dwordx4 v[52:55], v2, s[16:19], s23 offen offset:2048 sc1
    buffer_load_dwordx4 v[56:59], v2, s[16:19], s23 offen offset:3072 sc1
    s_add_u32 s23, s23, 4096
    s_waitcnt vmcnt(16)
    s_mov_b32 s29, 0
L_lw_hfree:
    ds_read_b32 v12, v11 offset:8
    s_add_u32 s29, s29, 1
    s_cmp_ge_u32 s29, 40000000
    s_waitcnt lgkmcnt(0)
    s_cbranch_scc1 L_lw_hfree_ok
    v_cmp_gt_u32 vcc, 4, v12
    s_cbranch_vccz L_lw_hfree_ok
    s_sleep 1
    s_branch L_lw_hfree
L_lw_hfree_ok:
    v_mov_b32 v12, 1
    s_mov_b64 exec, 1
    ds_add_u32 v11, v12 offset:12
    s_mov_b64 exec, -1
    v_mfma_f32_16x16x32_bf16 v[176:179], v[76:79], v[60:63], v[176:179]
    v_mfma_f32_16x16x32_bf16 v[180:183], v[80:83], v[60:63], v[180:183]
    v_mfma_f32_16x16x32_bf16 v[184:187], v[84:87], v[60:63], v[184:187]
    v_mfma_f32_16x16x32_bf16 v[188:191], v[88:91], v[60:63], v[188:191]
    v_mfma_f32_16x16x32_bf16 v[192:195], v[92:95], v[60:63], v[192:195]
    v_mfma_f32_16x16x32_bf16 v[196:199], v[76:79], v[64:67], v[196:199]
    v_mfma_f32_16x16x32_bf16 v[200:203], v[80:83], v[64:67], v[200:203]
    v_mfma_f32_16x16x32_bf16 v[204:207], v[84:87], v[64:67], v[204:207]
    v_mfma_f32_16x16x32_bf16 v[208:211], v[88:91], v[64:67], v[208:211]
    v_mfma_f32_16x16x32_bf16 v[212:215], v[92:95], v[64:67], v[212:215]
    v_mfma_f32_16x16x32_bf16 v[216:219], v[76:79], v[68:71], v[216:219]
    v_mfma_f32_16x16x32_bf16 v[220:223], v[80:83], v[68:71], v[220:223]
    v_mfma_f32_16x16x32_bf16 v[224:227], v[84:87], v[68:71], v[224:227]
    v_mfma_f32_16x16x32_bf16 v[228:231], v[88:91], v[68:71], v[228:231]
    v_mfma_f32_16x16x32_bf16 v[232:235], v[92:95], v[68:71], v[232:235]
    v_mfma_f32_16x16x32_bf16 v[236:239], v[76:79], v[72:75], v[236:239]
    v_mfma_f32_16x16x32_bf16 v[240:243], v[80:83], v[72:75], v[240:243]
    v_mfma_f32_16x16x32_bf16 v[244:247], v[84:87], v[72:75], v[244:247]
    v_mfma_f32_16x16x32_bf16 v[248:251], v[88:91], v[72:75], v[248:251]
    v_mfma_f32_16x16x32_bf16 v[252:255], v[92:95], v[72:75], v[252:255]
    s_waitcnt vmcnt(7)
    v_mfma_f32_16x16x32_bf16 v[176:179], v[116:119], v[28:31], v[176:179]
    v_mfma_f32_16x16x32_bf16 v[180:183], v[120:123], v[28:31], v[180:183]
    v_mfma_f32_16x16x32_bf16 v[184:187], v[124:127], v[28:31], v[184:187]
    v_mfma_f32_16x16x32_bf16 v[188:191], v[128:131], v[28:31], v[188:191]
    v_mfma_f32_16x16x32_bf16 v[192:195], v[132:135], v[28:31], v[192:195]
    v_mfma_f32_16x16x32_bf16 v[196:199], v[116:119], v[32:35], v[196:199]
    v_mfma_f32_16x16x32_bf16 v[200:203], v[120:123], v[32:35], v[200:203]
    v_mfma_f32_16x16x32_bf16 v[204:207], v[124:127], v[32:35], v[204:207]
    v_mfma_f32_16x16x32_bf16 v[208:211], v[128:131], v[32:35], v[208:211]
    v_mfma_f32_16x16x32_bf16 v[212:215], v[132:135], v[32:35], v[212:215]
    v_mfma_f32_16x16x32_bf16 v[216:219], v[116:119], v[36:39], v[216:219]
    v_mfma_f32_16x16x32_bf16 v[220:223], v[120:123], v[36:39], v[220:223]
    v_mfma_f32_16x16x32_bf16 v[224:227], v[124:127], v[36:39], v[224:227]
    v_mfma_f32_16x16x32_bf16 v[228:231], v[128:131], v[36:39], v[228:231]
    v_mfma_f32_16x16x32_bf16 v[232:235], v[132:135], v[36:39], v[232:235]
    v_mfma_f32_16x16x32_bf16 v[236:239], v[116:119], v[40:43], v[236:239]
    v_mfma_f32_16x16x32_bf16 v[240:243], v[120:123], v[40:43], v[240:243]
    v_mfma_f32_16x16x32_bf16 v[244:247], v[124:127], v[40:43], v[244:247]
    v_mfma_f32_16x16x32_bf16 v[248:251], v[128:131], v[40:43], v[248:251]
    v_mfma_f32_16x16x32_bf16 v[252:255], v[132:135], v[40:43], v[252:255]
    s_waitcnt vmcnt(0)
    v_mfma_f32_16x16x32_bf16 v[176:179], v[136:139], v[44:47], v[176:179]
    v_mfma_f32_16x16x32_bf16 v[180:183], v[140:143], v[44:47], v[180:183]
    v_mfma_f32_16x16x32_bf16 v[184:187], v[144:147], v[44:47], v[184:187]
    v_mfma_f32_16x16x32_bf16 v[188:191], v[148:151], v[44:47], v[188:191]
    v_mfma_f32_16x16x32_bf16 v[192:195], v[152:155], v[44:47], v[192:195]
    v_mfma_f32_16x16x32_bf16 v[196:199], v[136:139], v[48:51], v[196:199]
    v_mfma_f32_16x16x32_bf16 v[200:203], v[140:143], v[48:51], v[200:203]
    v_mfma_f32_16x16x32_bf16 v[204:207], v[144:147], v[48:51], v[204:207]
    v_mfma_f32_16x16x32_bf16 v[208:211], v[148:151], v[48:51], v[208:211]
    v_mfma_f32_16x16x32_bf16 v[212:215], v[152:155], v[48:51], v[212:215]
    ds_write_b128 v5, v[176:179] offset:0
    ds_write_b128 v5, v[180:183] offset:1024
    ds_write_b128 v5, v[184:187] offset:2048
    ds_write_b128 v5, v[188:191] offset:3072
    ds_write_b128 v5, v[192:195] offset:4096
    v_mfma_f32_16x16x32_bf16 v[216:219], v[136:139], v[52:55], v[216:219]
    v_mfma_f32_16x16x32_bf16 v[220:223], v[140:143], v[52:55], v[220:223]
    v_mfma_f32_16x16x32_bf16 v[224:227], v[144:147], v[52:55], v[224:227]
    v_mfma_f32_16x16x32_bf16 v[228:231], v[148:151], v[52:55], v[228:231]
    v_mfma_f32_16x16x32_bf16 v[232:235], v[152:155], v[52:55], v[232:235]
    ds_write_b128 v5, v[196:199] offset:5120
    ds_write_b128 v5, v[200:203] offset:6144
    ds_write_b128 v5, v[204:207] offset:7168
    ds_write_b128 v5, v[208:211] offset:8192
    ds_write_b128 v5, v[212:215] offset:9216
    v_mfma_f32_16x16x32_bf16 v[236:239], v[136:139], v[56:59], v[236:239]
    v_mfma_f32_16x16x32_bf16 v[240:243], v[140:143], v[56:59], v[240:243]
    v_mfma_f32_16x16x32_bf16 v[244:247], v[144:147], v[56:59], v[244:247]
    v_mfma_f32_16x16x32_bf16 v[248:251], v[148:151], v[56:59], v[248:251]
    v_mfma_f32_16x16x32_bf16 v[252:255], v[152:155], v[56:59], v[252:255]
    ds_write_b128 v5, v[216:219] offset:10240
    ds_write_b128 v5, v[220:223] offset:11264
    ds_write_b128 v5, v[224:227] offset:12288
    ds_write_b128 v5, v[228:231] offset:13312
    ds_write_b128 v5, v[232:235] offset:14336
    s_nop 3
    ds_write_b128 v5, v[236:239] offset:15360
    ds_write_b128 v5, v[240:243] offset:16384
    ds_write_b128 v5, v[244:247] offset:17408
    ds_write_b128 v5, v[248:251] offset:18432
    ds_write_b128 v5, v[252:255] offset:19456
    v_lshlrev_b32 v140, 16, v18
    v_and_b32 v141, 0xffff0000, v18
    v_lshlrev_b32 v142, 16, v19
    v_and_b32 v143, 0xffff0000, v19
    v_lshlrev_b32 v144, 16, v20
    v_and_b32 v145, 0xffff0000, v20
    v_lshlrev_b32 v146, 16, v21
    v_and_b32 v147, 0xffff0000, v21
    v_lshlrev_b32 v148, 16, v22
    v_and_b32 v149, 0xffff0000, v22
    v_lshlrev_b32 v150, 16, v23
    v_and_b32 v151, 0xffff0000, v23
    v_mov_b32 v14, 0xbfb8aa3b
    v_mov_b32 v16, 1.0
    v_add_u32 v7, 61440, v6
    v_add_u32 v8, 122880, v6
    s_waitcnt lgkmcnt(0)
    s_barrier
    ds_read_b128 v[32:35], v6 offset:0
    ds_read_b128 v[36:39], v6 offset:1024
    ds_read_b128 v[40:43], v6 offset:2048
    ds_read_b128 v[64:67], v6 offset:20480
    ds_read_b128 v[68:71], v6 offset:21504
    ds_read_b128 v[72:75], v6 offset:22528
    ds_read_b128 v[76:79], v6 offset:40960
    ds_read_b128 v[80:83], v6 offset:41984
    ds_read_b128 v[84:87], v6 offset:43008
    ds_read_b128 v[88:91], v7 offset:0
    ds_read_b128 v[92:95], v7 offset:1024
    ds_read_b128 v[96:99], v7 offset:2048
    ds_read_b128 v[44:47], v7 offset:20480
    ds_read_b128 v[48:51], v7 offset:21504
    ds_read_b128 v[52:55], v7 offset:22528
    s_waitcnt lgkmcnt(14)
    ds_read_b128 v[100:103], v7 offset:40960
    s_waitcnt lgkmcnt(14)
    ds_read_b128 v[104:107], v7 offset:41984
    s_waitcnt lgkmcnt(14)
    ds_read_b128 v[108:111], v7 offset:43008
    s_waitcnt lgkmcnt(14)
    ds_read_b128 v[112:115], v8 offset:0
    s_waitcnt lgkmcnt(14)
    ds_read_b128 v[116:119], v8 offset:1024
    s_waitcnt lgkmcnt(14)
    ds_read_b128 v[120:123], v8 offset:2048
    s_waitcnt lgkmcnt(14)
    ds_read_b128 v[124:127], v8 offset:20480
    s_waitcnt lgkmcnt(14)
    ds_read_b128 v[128:131], v8 offset:21504
    s_waitcnt lgkmcnt(14)
    ds_read_b128 v[132:135], v8 offset:22528
    v_pk_add_f32 v[32:33], v[32:33], v[64:65]
    v_pk_add_f32 v[34:35], v[34:35], v[66:67]
    v_pk_add_f32 v[36:37], v[36:37], v[68:69]
    v_pk_add_f32 v[38:39], v[38:39], v[70:71]
    v_pk_add_f32 v[40:41], v[40:41], v[72:73]
    v_pk_add_f32 v[42:43], v[42:43], v[74:75]
    v_pk_add_f32 v[32:33], v[32:33], v[76:77]
    v_pk_add_f32 v[34:35], v[34:35], v[78:79]
    v_pk_add_f32 v[36:37], v[36:37], v[80:81]
    v_pk_add_f32 v[38:39], v[38:39], v[82:83]
    v_pk_add_f32 v[40:41], v[40:41], v[84:85]
    v_pk_add_f32 v[42:43], v[42:43], v[86:87]
    s_waitcnt lgkmcnt(12)
    v_pk_add_f32 v[32:33], v[32:33], v[88:89]
    v_pk_add_f32 v[34:35], v[34:35], v[90:91]
    v_pk_add_f32 v[36:37], v[36:37], v[92:93]
    v_pk_add_f32 v[38:39], v[38:39], v[94:95]
    v_pk_add_f32 v[40:41], v[40:41], v[96:97]
    v_pk_add_f32 v[42:43], v[42:43], v[98:99]
    v_pk_mul_f32 v[176:177], v[32:33], v[14:15] op_sel_hi:[1,0]
    v_pk_mul_f32 v[178:179], v[34:35], v[14:15] op_sel_hi:[1,0]
    v_pk_mul_f32 v[180:181], v[36:37], v[14:15] op_sel_hi:[1,0]
    v_pk_mul_f32 v[182:183], v[38:39], v[14:15] op_sel_hi:[1,0]
    v_pk_mul_f32 v[184:185], v[40:41], v[14:15] op_sel_hi:[1,0]
    v_pk_mul_f32 v[186:187], v[42:43], v[14:15] op_sel_hi:[1,0]
    v_exp_f32 v176, v176
    v_exp_f32 v177, v177
    v_exp_f32 v178, v178
    v_exp_f32 v179, v179
    v_exp_f32 v180, v180
    v_exp_f32 v181, v181
    v_exp_f32 v182, v182
    v_exp_f32 v183, v183
    v_exp_f32 v184, v184
    v_exp_f32 v185, v185
    v_exp_f32 v186, v186
    v_exp_f32 v187, v187
    s_waitcnt lgkmcnt(6)
    v_pk_add_f32 v[44:45], v[44:45], v[100:101]
    v_pk_add_f32 v[46:47], v[46:47], v[102:103]
    v_pk_add_f32 v[48:49], v[48:49], v[104:105]
    v_pk_add_f32 v[50:51], v[50:51], v[106:107]
    v_pk_add_f32 v[52:53], v[52:53], v[108:109]
    v_pk_add_f32 v[54:55], v[54:55], v[110:111]
    s_waitcnt lgkmcnt(3)
    v_pk_add_f32 v[44:45], v[44:45], v[112:113]
    v_pk_add_f32 v[46:47], v[46:47], v[114:115]
    v_pk_add_f32 v[48:49], v[48:49], v[116:117]
    v_pk_add_f32 v[50:51], v[50:51], v[118:119]
    v_pk_add_f32 v[52:53], v[52:53], v[120:121]
    v_pk_add_f32 v[54:55], v[54:55], v[122:123]
    s_waitcnt lgkmcnt(0)
    v_pk_add_f32 v[44:45], v[44:45], v[124:125]
    v_pk_add_f32 v[46:47], v[46:47], v[126:127]
    v_pk_add_f32 v[48:49], v[48:49], v[128:129]
    v_pk_add_f32 v[50:51], v[50:51], v[130:131]
    v_pk_add_f32 v[52:53], v[52:53], v[132:133]
    v_pk_add_f32 v[54:55], v[54:55], v[134:135]
    v_pk_add_f32 v[176:177], v[176:177], v[16:17] op_sel_hi:[1,0]
    v_pk_mul_f32 v[32:33], v[32:33], v[44:45]
    v_pk_add_f32 v[178:179], v[178:179], v[16:17] op_sel_hi:[1,0]
    v_pk_mul_f32 v[34:35], v[34:35], v[46:47]
    v_pk_add_f32 v[180:181], v[180:181], v[16:17] op_sel_hi:[1,0]
    v_pk_mul_f32 v[36:37], v[36:37], v[48:49]
    v_pk_add_f32 v[182:183], v[182:183], v[16:17] op_sel_hi:[1,0]
    v_pk_mul_f32 v[38:39], v[38:39], v[50:51]
    v_pk_add_f32 v[184:185], v[184:185], v[16:17] op_sel_hi:[1,0]
    v_pk_mul_f32 v[40:41], v[40:41], v[52:53]
    v_pk_add_f32 v[186:187], v[186:187], v[16:17] op_sel_hi:[1,0]
    v_pk_mul_f32 v[42:43], v[42:43], v[54:55]
    v_rcp_f32 v176, v176
    v_rcp_f32 v177, v177
    v_rcp_f32 v178, v178
    v_rcp_f32 v179, v179
    v_rcp_f32 v180, v180
    v_rcp_f32 v181, v181
    v_rcp_f32 v182, v182
    v_rcp_f32 v183, v183
    v_rcp_f32 v184, v184
    v_rcp_f32 v185, v185
    v_rcp_f32 v186, v186
    v_rcp_f32 v187, v187
    s_nop 0
    v_pk_fma_f32 v[140:141], v[32:33], v[176:177], v[140:141]
    v_pk_fma_f32 v[142:143], v[34:35], v[178:179], v[142:143]
    v_pk_fma_f32 v[144:145], v[36:37], v[180:181], v[144:145]
    v_pk_fma_f32 v[146:147], v[38:39], v[182:183], v[146:147]
    v_pk_fma_f32 v[148:149], v[40:41], v[184:185], v[148:149]
    v_pk_fma_f32 v[150:151], v[42:43], v[186:187], v[150:151]
    v_cvt_pk_bf16_f32 v32, v140, v141
    v_cvt_pk_bf16_f32 v33, v142, v143
    buffer_store_dwordx2 v[32:33], v4, s[12:15], 0 offen offset:0
    v_cvt_pk_bf16_f32 v34, v144, v145
    v_cvt_pk_bf16_f32 v35, v146, v147
    buffer_store_dwordx2 v[34:35], v4, s[12:15], 0 offen offset:32
    v_cvt_pk_bf16_f32 v36, v148, v149
    v_cvt_pk_bf16_f32 v37, v150, v151
    buffer_store_dwordx2 v[36:37], v4, s[12:15], 0 offen offset:64
L_k2_end:
    s_endpgm
L_k2_s:
    s_setprio 2
    s_mul_i32 s33, s27, 5
    s_mul_i32 s25, s21, 20
    s_add_u32 s25, s25, s33
    s_lshl_b32 s25, s25, 12
    s_add_u32 s25, s25, 7077888
    s_mul_i32 s26, s22, 20
    s_add_u32 s26, s26, s33
    s_lshl_b32 s28, s26, 6
    s_add_u32 s28, s28, 14532608
    s_mul_i32 s26, s26, 5120
    s_add_u32 s26, s26, 13221888
    s_lshl_b32 s30, s21, 3
    s_add_u32 s30, s30, s22
    s_lshl_b32 s30, s30, 9
    s_add_u32 s30, s30, 14560256
    s_mov_b32 s8, s4
    s_and_b32 s9, s5, 0xffff
    s_mov_b32 s10, 2621440
    s_mov_b32 s11, 0x20000
    s_mov_b32 s12, s36
    s_and_b32 s13, s37, 0xffff
    s_mov_b32 s14, 2621440
    s_mov_b32 s15, 0x20000
    s_lshl_b32 s33, s21, 2
    s_add_u32 s33, s33, s27
    s_mul_i32 s33, s33, 20480
    s_mul_i32 s34, s22, 160
    s_add_u32 s33, s33, s34
    s_add_u32 s33, s33, 96
    v_lshrrev_b32 v7, 2, v1
    v_and_b32 v8, 3, v1
    v_mul_u32_u24 v4, 1280, v7
    v_lshl_add_u32 v4, v8, 3, v4
    v_add_u32 v4, s33, v4
    v_bfe_u32 v9, v7, 1, 2
    v_xor_b32 v9, v9, v8
    v_lshl_add_u32 v9, v7, 2, v9
    s_mul_i32 s33, s27, 5120
    s_add_u32 s33, s33, 3072
    v_lshl_add_u32 v6, v9, 4, s33
    v_and_b32 v7, 15, v1
    v_lshrrev_b32 v8, 4, v1
    v_bfe_u32 v9, v7, 1, 2
    v_xor_b32 v9, v9, v8
    v_lshl_add_u32 v9, v7, 2, v9
    s_mul_i32 s33, s20, 20480
    v_lshl_add_u32 v5, v9, 4, s33
    buffer_load_dwordx2 v[18:19], v4, s[8:11], 0 offen offset:0
    buffer_load_dwordx2 v[20:21], v4, s[8:11], 0 offen offset:32
    v_lshrrev_b32 v12, 4, v1
    v_lshlrev_b32 v12, 4, v12
    v_mov_b32 v10, 163808
    s_cmp_lg_u32 s20, 4
    s_cbranch_scc1 L_k2_shw
    ds_read_b32 v11, v10
    s_waitcnt lgkmcnt(0)
    v_cmp_eq_u32 vcc, 0, v11
    s_cbranch_vccz L_k2_shgo
    s_setprio 3
    v_lshlrev_b32 v13, 2, v1
    s_mov_b32 s40, 0x3fffff
    s_mov_b32 s41, 0x0
    s_mov_b32 s29, 0
L_gate_h:
    buffer_load_dword v15, v13, s[16:19], s30 offen offset:0 sc1
    s_add_u32 s29, s29, 1
    s_cmp_ge_u32 s29, 1000000
    s_waitcnt vmcnt(0)
    s_cbranch_scc1 L_gate_h_ok
    v_cmp_ne_u32 vcc, 1, v15
    s_nop 0
    s_and_b64 vcc, vcc, s[40:41]
    s_cbranch_scc0 L_gate_h_ok
    s_sleep 1
    s_branch L_gate_h
L_gate_h_ok:
    v_mov_b32 v11, 1
    ds_write_b32 v10, v11
    s_setprio 2
    s_branch L_k2_shgo
L_k2_shw:
    s_mov_b32 s29, 0
L_lw_sh:
    ds_read_b32 v11, v10 offset:0
    s_add_u32 s29, s29, 1
    s_cmp_ge_u32 s29, 40000000
    s_waitcnt lgkmcnt(0)
    s_cbranch_scc1 L_lw_sh_ok
    v_cmp_gt_u32 vcc, 1, v11
    s_cbranch_vccz L_lw_sh_ok
    s_sleep 1
    s_branch L_lw_sh
L_lw_sh_ok:
L_k2_shgo:
    v_lshlrev_b32 v13, 2, v1
    s_cmp_lg_u32 s20, 4
    s_cselect_b32 s29, 1073741824, s30
    buffer_load_dword v11, v13, s[16:19], s29 offen offset:256 sc1
    buffer_load_dwordx4 v[32:35], v2, s[16:19], s25 offen offset:0 sc1
    buffer_load_dwordx4 v[52:55], v2, s[16:19], s25 offen offset:1024 sc1
    buffer_load_dwordx4 v[72:75], v2, s[16:19], s25 offen offset:2048 sc1
    buffer_load_dwordx4 v[92:95], v2, s[16:19], s25 offen offset:3072 sc1
    s_add_u32 s25, s25, 4096
    buffer_load_dwordx4 v[36:39], v2, s[16:19], s25 offen offset:0 sc1
    buffer_load_dwordx4 v[56:59], v2, s[16:19], s25 offen offset:1024 sc1
    buffer_load_dwordx4 v[76:79], v2, s[16:19], s25 offen offset:2048 sc1
    buffer_load_dwordx4 v[96:99], v2, s[16:19], s25 offen offset:3072 sc1
    s_add_u32 s25, s25, 4096
    buffer_load_dwordx4 v[40:43], v2, s[16:19], s25 offen offset:0 sc1
    buffer_load_dwordx4 v[60:63], v2, s[16:19], s25 offen offset:1024 sc1
    buffer_load_dwordx4 v[80:83], v2, s[16:19], s25 offen offset:2048 sc1
    buffer_load_dwordx4 v[100:103], v2, s[16:19], s25 offen offset:3072 sc1
    s_add_u32 s25, s25, 4096
    buffer_load_dwordx4 v[44:47], v2, s[16:19], s25 offen offset:0 sc1
    buffer_load_dwordx4 v[64:67], v2, s[16:19], s25 offen offset:1024 sc1
    buffer_load_dwordx4 v[84:87], v2, s[16:19], s25 offen offset:2048 sc1
    buffer_load_dwordx4 v[104:107], v2, s[16:19], s25 offen offset:3072 sc1
    s_add_u32 s25, s25, 4096
    s_waitcnt vmcnt(12)
    buffer_load_dwordx4 v[48:51], v2, s[16:19], s25 offen offset:0 sc1
    buffer_load_dwordx4 v[68:71], v2, s[16:19], s25 offen offset:1024 sc1
    buffer_load_dwordx4 v[88:91], v2, s[16:19], s25 offen offset:2048 sc1
    buffer_load_dwordx4 v[108:111], v2, s[16:19], s25 offen offset:3072 sc1
    s_add_u32 s25, s25, 4096
    s_waitcnt vmcnt(12)
    v_and_b32 v14, 15, v1
    v_lshrrev_b32 v15, 2, v1
    v_and_b32 v15, 12, v15
    v_sub_u32 v14, v14, v15
    v_cmp_eq_u32 s[56:57], 0, v14
    v_cmp_eq_u32 s[58:59], 1, v14
    v_mov_b32 v14, 0x358637bd
    v_mov_b32 v15, 0x358637bd
    v_mov_b32 v16, 0x358637bd
    v_mov_b32 v17, 0x358637bd
    s_waitcnt vmcnt(20)
    s_cmp_lg_u32 s20, 4
    s_cbranch_scc1 L_k2_wl
    v_cmp_ne_u32 vcc, 1, v11
    s_nop 0
    s_and_b32 vcc_lo, vcc_lo, 0xffff
    s_cbranch_scc0 L_gate_m_ok
    v_lshlrev_b32 v13, 2, v1
    s_mov_b32 s40, 0xffff
    s_mov_b32 s41, 0x0
    s_mov_b32 s29, 0
L_gate_m:
    buffer_load_dword v11, v13, s[16:19], s30 offen offset:256 sc1
    s_add_u32 s29, s29, 1
    s_cmp_ge_u32 s29, 1000000
    s_waitcnt vmcnt(0)
    s_cbranch_scc1 L_gate_m_ok
    v_cmp_ne_u32 vcc, 1, v11
    s_nop 0
    s_and_b64 vcc, vcc, s[40:41]
    s_cbranch_scc0 L_gate_m_ok
    s_sleep 4
    s_branch L_gate_m
L_gate_m_ok:
    v_mov_b32 v11, 2
    ds_write_b32 v10, v11 offset:4
    s_branch L_k2_go
L_k2_wl:
    s_mov_b32 s29, 0
L_lw_m:
    ds_read_b32 v11, v10 offset:4
    s_add_u32 s29, s29, 1
    s_cmp_ge_u32 s29, 40000000
    s_waitcnt lgkmcnt(0)
    s_cbranch_scc1 L_lw_m_ok
    v_cmp_gt_u32 vcc, 2, v11
    s_cbranch_vccz L_lw_m_ok
    s_sleep 1
    s_branch L_lw_m
L_lw_m_ok:
L_k2_go:
    buffer_load_dwordx4 v[212:215], v12, s[16:19], s28 offen offset:0 sc1
    buffer_load_dwordx4 v[216:219], v12, s[16:19], s28 offen offset:64 sc1
    buffer_load_dwordx4 v[220:223], v12, s[16:19], s28 offen offset:128 sc1
    buffer_load_dwordx4 v[224:227], v12, s[16:19], s28 offen offset:192 sc1
    buffer_load_dwordx4 v[228:231], v12, s[16:19], s28 offen offset:256 sc1
    buffer_load_dwordx4 v[112:115], v2, s[16:19], s26 offen offset:0 sc1
    buffer_load_dwordx4 v[116:119], v2, s[16:19], s26 offen offset:1024 sc1
    buffer_load_dwordx4 v[120:123], v2, s[16:19], s26 offen offset:2048 sc1
    buffer_load_dwordx4 v[124:127], v2, s[16:19], s26 offen offset:3072 sc1
    buffer_load_dwordx4 v[128:131], v3, s[16:19], s26 offen sc1
    s_add_u32 s26, s26, 5120
    buffer_load_dwordx4 v[132:135], v2, s[16:19], s26 offen offset:0 sc1
    buffer_load_dwordx4 v[136:139], v2, s[16:19], s26 offen offset:1024 sc1
    buffer_load_dwordx4 v[140:143], v2, s[16:19], s26 offen offset:2048 sc1
    buffer_load_dwordx4 v[144:147], v2, s[16:19], s26 offen offset:3072 sc1
    buffer_load_dwordx4 v[148:151], v3, s[16:19], s26 offen sc1
    s_add_u32 s26, s26, 5120
    buffer_load_dwordx4 v[152:155], v2, s[16:19], s26 offen offset:0 sc1
    buffer_load_dwordx4 v[156:159], v2, s[16:19], s26 offen offset:1024 sc1
    buffer_load_dwordx4 v[160:163], v2, s[16:19], s26 offen offset:2048 sc1
    buffer_load_dwordx4 v[164:167], v2, s[16:19], s26 offen offset:3072 sc1
    buffer_load_dwordx4 v[168:171], v3, s[16:19], s26 offen sc1
    s_add_u32 s26, s26, 5120
    s_waitcnt vmcnt(15)
    v_cndmask_b32 v212, 0, v212, s[56:57]
    v_cndmask_b32 v213, 0, v213, s[56:57]
    v_cndmask_b32 v214, 0, v214, s[56:57]
    v_cndmask_b32 v215, 0, v215, s[56:57]
    v_cndmask_b32 v216, 0, v216, s[56:57]
    v_cndmask_b32 v217, 0, v217, s[56:57]
    v_cndmask_b32 v218, 0, v218, s[56:57]
    v_cndmask_b32 v219, 0, v219, s[56:57]
    v_cndmask_b32 v220, 0, v220, s[56:57]
    v_cndmask_b32 v221, 0, v221, s[56:57]
    v_cndmask_b32 v222, 0, v222, s[58:59]
    v_cndmask_b32 v223, 0, v223, s[58:59]
    v_cndmask_b32 v224, 0, v224, s[58:59]
    v_cndmask_b32 v225, 0, v225, s[58:59]
    v_cndmask_b32 v226, 0, v226, s[58:59]
    v_cndmask_b32 v227, 0, v227, s[58:59]
    v_cndmask_b32 v228, 0, v228, s[58:59]
    v_cndmask_b32 v229, 0, v229, s[58:59]
    v_cndmask_b32 v230, 0, v230, s[58:59]
    v_cndmask_b32 v231, 0, v231, s[58:59]
    v_mfma_f32_16x16x32_bf16 v[232:235], v[212:215], v[32:35], v[14:17]
    v_mfma_f32_16x16x32_bf16 v[236:239], v[212:215], v[52:55], v[14:17]
    v_mfma_f32_16x16x32_bf16 v[240:243], v[212:215], v[72:75], v[14:17]
    v_mfma_f32_16x16x32_bf16 v[244:247], v[212:215], v[92:95], v[14:17]
    v_mfma_f32_16x16x32_bf16 v[232:235], v[216:219], v[36:39], v[232:235]
    v_mfma_f32_16x16x32_bf16 v[236:239], v[216:219], v[56:59], v[236:239]
    v_mfma_f32_16x16x32_bf16 v[240:243], v[216:219], v[76:79], v[240:243]
    v_mfma_f32_16x16x32_bf16 v[244:247], v[216:219], v[96:99], v[244:247]
    v_mfma_f32_16x16x32_bf16 v[232:235], v[220:223], v[40:43], v[232:235]
    v_mfma_f32_16x16x32_bf16 v[236:239], v[220:223], v[60:63], v[236:239]
    v_mfma_f32_16x16x32_bf16 v[240:243], v[220:223], v[80:83], v[240:243]
    v_mfma_f32_16x16x32_bf16 v[244:247], v[220:223], v[100:103], v[244:247]
    v_mfma_f32_16x16x32_bf16 v[232:235], v[224:227], v[44:47], v[232:235]
    v_mfma_f32_16x16x32_bf16 v[236:239], v[224:227], v[64:67], v[236:239]
    v_mfma_f32_16x16x32_bf16 v[240:243], v[224:227], v[84:87], v[240:243]
    v_mfma_f32_16x16x32_bf16 v[244:247], v[224:227], v[104:107], v[244:247]
    v_mfma_f32_16x16x32_bf16 v[232:235], v[228:231], v[48:51], v[232:235]
    v_mfma_f32_16x16x32_bf16 v[236:239], v[228:231], v[68:71], v[236:239]
    v_mfma_f32_16x16x32_bf16 v[240:243], v[228:231], v[88:91], v[240:243]
    v_mfma_f32_16x16x32_bf16 v[244:247], v[228:231], v[108:111], v[244:247]
    buffer_load_dwordx4 v[172:175], v2, s[16:19], s26 offen offset:0 sc1
    buffer_load_dwordx4 v[176:179], v2, s[16:19], s26 offen offset:1024 sc1
    buffer_load_dwordx4 v[180:183], v2, s[16:19], s26 offen offset:2048 sc1
    buffer_load_dwordx4 v[184:187], v2, s[16:19], s26 offen offset:3072 sc1
    buffer_load_dwordx4 v[188:191], v3, s[16:19], s26 offen sc1
    s_add_u32 s26, s26, 5120
    buffer_load_dwordx4 v[192:195], v2, s[16:19], s26 offen offset:0 sc1
    buffer_load_dwordx4 v[196:199], v2, s[16:19], s26 offen offset:1024 sc1
    buffer_load_dwordx4 v[200:203], v2, s[16:19], s26 offen offset:2048 sc1
    buffer_load_dwordx4 v[204:207], v2, s[16:19], s26 offen offset:3072 sc1
    buffer_load_dwordx4 v[208:211], v3, s[16:19], s26 offen sc1
    s_add_u32 s26, s26, 5120
    s_nop 4
    v_rcp_f32 v232, v232
    v_rcp_f32 v233, v233
    v_rcp_f32 v236, v236
    v_rcp_f32 v237, v237
    v_rcp_f32 v240, v240
    v_rcp_f32 v241, v241
    v_rcp_f32 v244, v244
    v_rcp_f32 v245, v245
    v_lshlrev_b32 v248, 16, v32
    v_and_b32 v249, 0xffff0000, v32
    v_lshlrev_b32 v250, 16, v33
    v_and_b32 v251, 0xffff0000, v33
    v_lshlrev_b32 v252, 16, v34
    v_and_b32 v253, 0xffff0000, v34
    v_lshlrev_b32 v254, 16, v35
    v_and_b32 v255, 0xffff0000, v35
    v_mul_f32 v248, v232, v248
    v_mul_f32 v249, v232, v249
    v_mul_f32 v250, v232, v250
    v_mul_f32 v251, v232, v251
    v_mul_f32 v252, v232, v252
    v_mul_f32 v253, v232, v253
    v_mul_f32 v254, v232, v254
    v_mul_f32 v255, v232, v255
    v_cvt_pk_bf16_f32 v32, v248, v249
    v_cvt_pk_bf16_f32 v33, v250, v251
    v_cvt_pk_bf16_f32 v34, v252, v253
    v_cvt_pk_bf16_f32 v35, v254, v255
    v_lshlrev_b32 v248, 16, v36
    v_and_b32 v249, 0xffff0000, v36
    v_lshlrev_b32 v250, 16, v37
    v_and_b32 v251, 0xffff0000, v37
    v_lshlrev_b32 v252, 16, v38
    v_and_b32 v253, 0xffff0000, v38
    v_lshlrev_b32 v254, 16, v39
    v_and_b32 v255, 0xffff0000, v39
    v_mul_f32 v248, v232, v248
    v_mul_f32 v249, v232, v249
    v_mul_f32 v250, v232, v250
    v_mul_f32 v251, v232, v251
    v_mul_f32 v252, v232, v252
    v_mul_f32 v253, v232, v253
    v_mul_f32 v254, v232, v254
    v_mul_f32 v255, v232, v255
    v_cvt_pk_bf16_f32 v36, v248, v249
    v_cvt_pk_bf16_f32 v37, v250, v251
    v_cvt_pk_bf16_f32 v38, v252, v253
    v_cvt_pk_bf16_f32 v39, v254, v255
    v_lshlrev_b32 v248, 16, v40
    v_and_b32 v249, 0xffff0000, v40
    v_lshlrev_b32 v250, 16, v41
    v_and_b32 v251, 0xffff0000, v41
    v_lshlrev_b32 v252, 16, v42
    v_and_b32 v253, 0xffff0000, v42
    v_lshlrev_b32 v254, 16, v43
    v_and_b32 v255, 0xffff0000, v43
    v_mul_f32 v248, v232, v248
    v_mul_f32 v249, v232, v249
    v_mul_f32 v250, v232, v250
    v_mul_f32 v251, v232, v251
    v_mul_f32 v252, v233, v252
    v_mul_f32 v253, v233, v253
    v_mul_f32 v254, v233, v254
    v_mul_f32 v255, v233, v255
    v_cvt_pk_bf16_f32 v40, v248, v249
    v_cvt_pk_bf16_f32 v41, v250, v251
    v_cvt_pk_bf16_f32 v42, v252, v253
    v_cvt_pk_bf16_f32 v43, v254, v255
    v_lshlrev_b32 v248, 16, v44
    v_and_b32 v249, 0xffff0000, v44
    v_lshlrev_b32 v250, 16, v45
    v_and_b32 v251, 0xffff0000, v45
    v_lshlrev_b32 v252, 16, v46
    v_and_b32 v253, 0xffff0000, v46
    v_lshlrev_b32 v254, 16, v47
    v_and_b32 v255, 0xffff0000, v47
    v_mul_f32 v248, v233, v248
    v_mul_f32 v249, v233, v249
    v_mul_f32 v250, v233, v250
    v_mul_f32 v251, v233, v251
    v_mul_f32 v252, v233, v252
    v_mul_f32 v253, v233, v253
    v_mul_f32 v254, v233, v254
    v_mul_f32 v255, v233, v255
    v_cvt_pk_bf16_f32 v44, v248, v249
    v_cvt_pk_bf16_f32 v45, v250, v251
    v_cvt_pk_bf16_f32 v46, v252, v253
    v_cvt_pk_bf16_f32 v47, v254, v255
    v_lshlrev_b32 v248, 16, v48
    v_and_b32 v249, 0xffff0000, v48
    v_lshlrev_b32 v250, 16, v49
    v_and_b32 v251, 0xffff0000, v49
    v_lshlrev_b32 v252, 16, v50
    v_and_b32 v253, 0xffff0000, v50
    v_lshlrev_b32 v254, 16, v51
    v_and_b32 v255, 0xffff0000, v51
    v_mul_f32 v248, v233, v248
    v_mul_f32 v249, v233, v249
    v_mul_f32 v250, v233, v250
    v_mul_f32 v251, v233, v251
    v_mul_f32 v252, v233, v252
    v_mul_f32 v253, v233, v253
    v_mul_f32 v254, v233, v254
    v_mul_f32 v255, v233, v255
    v_cvt_pk_bf16_f32 v48, v248, v249
    v_cvt_pk_bf16_f32 v49, v250, v251
    v_cvt_pk_bf16_f32 v50, v252, v253
    v_cvt_pk_bf16_f32 v51, v254, v255
    v_lshlrev_b32 v248, 16, v52
    v_and_b32 v249, 0xffff0000, v52
    v_lshlrev_b32 v250, 16, v53
    v_and_b32 v251, 0xffff0000, v53
    v_lshlrev_b32 v252, 16, v54
    v_and_b32 v253, 0xffff0000, v54
    v_lshlrev_b32 v254, 16, v55
    v_and_b32 v255, 0xffff0000, v55
    v_mul_f32 v248, v236, v248
    v_mul_f32 v249, v236, v249
    v_mul_f32 v250, v236, v250
    v_mul_f32 v251, v236, v251
    v_mul_f32 v252, v236, v252
    v_mul_f32 v253, v236, v253
    v_mul_f32 v254, v236, v254
    v_mul_f32 v255, v236, v255
    v_cvt_pk_bf16_f32 v52, v248, v249
    v_cvt_pk_bf16_f32 v53, v250, v251
    v_cvt_pk_bf16_f32 v54, v252, v253
    v_cvt_pk_bf16_f32 v55, v254, v255
    v_lshlrev_b32 v248, 16, v56
    v_and_b32 v249, 0xffff0000, v56
    v_lshlrev_b32 v250, 16, v57
    v_and_b32 v251, 0xffff0000, v57
    v_lshlrev_b32 v252, 16, v58
    v_and_b32 v253, 0xffff0000, v58
    v_lshlrev_b32 v254, 16, v59
    v_and_b32 v255, 0xffff0000, v59
    v_mul_f32 v248, v236, v248
    v_mul_f32 v249, v236, v249
    v_mul_f32 v250, v236, v250
    v_mul_f32 v251, v236, v251
    v_mul_f32 v252, v236, v252
    v_mul_f32 v253, v236, v253
    v_mul_f32 v254, v236, v254
    v_mul_f32 v255, v236, v255
    v_cvt_pk_bf16_f32 v56, v248, v249
    v_cvt_pk_bf16_f32 v57, v250, v251
    v_cvt_pk_bf16_f32 v58, v252, v253
    v_cvt_pk_bf16_f32 v59, v254, v255
    v_lshlrev_b32 v248, 16, v60
    v_and_b32 v249, 0xffff0000, v60
    v_lshlrev_b32 v250, 16, v61
    v_and_b32 v251, 0xffff0000, v61
    v_lshlrev_b32 v252, 16, v62
    v_and_b32 v253, 0xffff0000, v62
    v_lshlrev_b32 v254, 16, v63
    v_and_b32 v255, 0xffff0000, v63
    v_mul_f32 v248, v236, v248
    v_mul_f32 v249, v236, v249
    v_mul_f32 v250, v236, v250
    v_mul_f32 v251, v236, v251
    v_mul_f32 v252, v237, v252
    v_mul_f32 v253, v237, v253
    v_mul_f32 v254, v237, v254
    v_mul_f32 v255, v237, v255
    v_cvt_pk_bf16_f32 v60, v248, v249
    v_cvt_pk_bf16_f32 v61, v250, v251
    v_cvt_pk_bf16_f32 v62, v252, v253
    v_cvt_pk_bf16_f32 v63, v254, v255
    v_lshlrev_b32 v248, 16, v64
    v_and_b32 v249, 0xffff0000, v64
    v_lshlrev_b32 v250, 16, v65
    v_and_b32 v251, 0xffff0000, v65
    v_lshlrev_b32 v252, 16, v66
    v_and_b32 v253, 0xffff0000, v66
    v_lshlrev_b32 v254, 16, v67
    v_and_b32 v255, 0xffff0000, v67
    v_mul_f32 v248, v237, v248
    v_mul_f32 v249, v237, v249
    v_mul_f32 v250, v237, v250
    v_mul_f32 v251, v237, v251
    v_mul_f32 v252, v237, v252
    v_mul_f32 v253, v237, v253
    v_mul_f32 v254, v237, v254
    v_mul_f32 v255, v237, v255
    v_cvt_pk_bf16_f32 v64, v248, v249
    v_cvt_pk_bf16_f32 v65, v250, v251
    v_cvt_pk_bf16_f32 v66, v252, v253
    v_cvt_pk_bf16_f32 v67, v254, v255
    v_lshlrev_b32 v248, 16, v68
    v_and_b32 v249, 0xffff0000, v68
    v_lshlrev_b32 v250, 16, v69
    v_and_b32 v251, 0xffff0000, v69
    v_lshlrev_b32 v252, 16, v70
    v_and_b32 v253, 0xffff0000, v70
    v_lshlrev_b32 v254, 16, v71
    v_and_b32 v255, 0xffff0000, v71
    v_mul_f32 v248, v237, v248
    v_mul_f32 v249, v237, v249
    v_mul_f32 v250, v237, v250
    v_mul_f32 v251, v237, v251
    v_mul_f32 v252, v237, v252
    v_mul_f32 v253, v237, v253
    v_mul_f32 v254, v237, v254
    v_mul_f32 v255, v237, v255
    v_cvt_pk_bf16_f32 v68, v248, v249
    v_cvt_pk_bf16_f32 v69, v250, v251
    v_cvt_pk_bf16_f32 v70, v252, v253
    v_cvt_pk_bf16_f32 v71, v254, v255
    s_waitcnt vmcnt(20)
    s_nop 1
    v_mfma_f32_16x16x32_bf16 v[212:215], v[112:115], v[32:35], 0
    v_lshlrev_b32 v248, 16, v72
    v_and_b32 v249, 0xffff0000, v72
    v_lshlrev_b32 v250, 16, v73
    v_and_b32 v251, 0xffff0000, v73
    v_mfma_f32_16x16x32_bf16 v[216:219], v[116:119], v[32:35], 0
    v_lshlrev_b32 v252, 16, v74
    v_and_b32 v253, 0xffff0000, v74
    v_lshlrev_b32 v254, 16, v75
    v_and_b32 v255, 0xffff0000, v75
    v_mfma_f32_16x16x32_bf16 v[220:223], v[120:123], v[32:35], 0
    v_mul_f32 v248, v240, v248
    v_mul_f32 v249, v240, v249
    v_mul_f32 v250, v240, v250
    v_mul_f32 v251, v240, v251
    v_mfma_f32_16x16x32_bf16 v[224:227], v[124:127], v[32:35], 0
    v_mul_f32 v252, v240, v252
    v_mul_f32 v253, v240, v253
    v_mul_f32 v254, v240, v254
    v_mul_f32 v255, v240, v255
    v_mfma_f32_16x16x32_bf16 v[228:231], v[128:131], v[32:35], 0
    v_cvt_pk_bf16_f32 v72, v248, v249
    v_cvt_pk_bf16_f32 v73, v250, v251
    v_cvt_pk_bf16_f32 v74, v252, v253
    v_cvt_pk_bf16_f32 v75, v254, v255
    s_waitcnt vmcnt(15)
    v_mfma_f32_16x16x32_bf16 v[212:215], v[132:135], v[36:39], v[212:215]
    v_lshlrev_b32 v248, 16, v76
    v_and_b32 v249, 0xffff0000, v76
    v_lshlrev_b32 v250, 16, v77
    v_and_b32 v251, 0xffff0000, v77
    v_mfma_f32_16x16x32_bf16 v[216:219], v[136:139], v[36:39], v[216:219]
    v_lshlrev_b32 v252, 16, v78
    v_and_b32 v253, 0xffff0000, v78
    v_lshlrev_b32 v254, 16, v79
    v_and_b32 v255, 0xffff0000, v79
    v_mfma_f32_16x16x32_bf16 v[220:223], v[140:143], v[36:39], v[220:223]
    v_mul_f32 v248, v240, v248
    v_mul_f32 v249, v240, v249
    v_mul_f32 v250, v240, v250
    v_mul_f32 v251, v240, v251
    v_mfma_f32_16x16x32_bf16 v[224:227], v[144:147], v[36:39], v[224:227]
    v_mul_f32 v252, v240, v252
    v_mul_f32 v253, v240, v253
    v_mul_f32 v254, v240, v254
    v_mul_f32 v255, v240, v255
    v_mfma_f32_16x16x32_bf16 v[228:231], v[148:151], v[36:39], v[228:231]
    v_cvt_pk_bf16_f32 v76, v248, v249
    v_cvt_pk_bf16_f32 v77, v250, v251
    v_cvt_pk_bf16_f32 v78, v252, v253
    v_cvt_pk_bf16_f32 v79, v254, v255
    s_waitcnt vmcnt(10)
    v_mfma_f32_16x16x32_bf16 v[212:215], v[152:155], v[40:43], v[212:215]
    v_lshlrev_b32 v248, 16, v80
    v_and_b32 v249, 0xffff0000, v80
    v_lshlrev_b32 v250, 16, v81
    v_and_b32 v251, 0xffff0000, v81
    v_mfma_f32_16x16x32_bf16 v[216:219], v[156:159], v[40:43], v[216:219]
    v_lshlrev_b32 v252, 16, v82
    v_and_b32 v253, 0xffff0000, v82
    v_lshlrev_b32 v254, 16, v83
    v_and_b32 v255, 0xffff0000, v83
    v_mfma_f32_16x16x32_bf16 v[220:223], v[160:163], v[40:43], v[220:223]
    v_mul_f32 v248, v240, v248
    v_mul_f32 v249, v240, v249
    v_mul_f32 v250, v240, v250
    v_mul_f32 v251, v240, v251
    v_mfma_f32_16x16x32_bf16 v[224:227], v[164:167], v[40:43], v[224:227]
    v_mul_f32 v252, v241, v252
    v_mul_f32 v253, v241, v253
    v_mul_f32 v254, v241, v254
    v_mul_f32 v255, v241, v255
    v_mfma_f32_16x16x32_bf16 v[228:231], v[168:171], v[40:43], v[228:231]
    v_cvt_pk_bf16_f32 v80, v248, v249
    v_cvt_pk_bf16_f32 v81, v250, v251
    v_cvt_pk_bf16_f32 v82, v252, v253
    v_cvt_pk_bf16_f32 v83, v254, v255
    s_waitcnt vmcnt(5)
    v_mfma_f32_16x16x32_bf16 v[212:215], v[172:175], v[44:47], v[212:215]
    v_lshlrev_b32 v248, 16, v84
    v_and_b32 v249, 0xffff0000, v84
    v_lshlrev_b32 v250, 16, v85
    v_and_b32 v251, 0xffff0000, v85
    v_mfma_f32_16x16x32_bf16 v[216:219], v[176:179], v[44:47], v[216:219]
    v_lshlrev_b32 v252, 16, v86
    v_and_b32 v253, 0xffff0000, v86
    v_lshlrev_b32 v254, 16, v87
    v_and_b32 v255, 0xffff0000, v87
    v_mfma_f32_16x16x32_bf16 v[220:223], v[180:183], v[44:47], v[220:223]
    v_mul_f32 v248, v241, v248
    v_mul_f32 v249, v241, v249
    v_mul_f32 v250, v241, v250
    v_mul_f32 v251, v241, v251
    v_mfma_f32_16x16x32_bf16 v[224:227], v[184:187], v[44:47], v[224:227]
    v_mul_f32 v252, v241, v252
    v_mul_f32 v253, v241, v253
    v_mul_f32 v254, v241, v254
    v_mul_f32 v255, v241, v255
    v_mfma_f32_16x16x32_bf16 v[228:231], v[188:191], v[44:47], v[228:231]
    v_cvt_pk_bf16_f32 v84, v248, v249
    v_cvt_pk_bf16_f32 v85, v250, v251
    v_cvt_pk_bf16_f32 v86, v252, v253
    v_cvt_pk_bf16_f32 v87, v254, v255
    s_waitcnt vmcnt(0)
    v_mfma_f32_16x16x32_bf16 v[212:215], v[192:195], v[48:51], v[212:215]
    v_lshlrev_b32 v248, 16, v88
    v_and_b32 v249, 0xffff0000, v88
    v_lshlrev_b32 v250, 16, v89
    v_and_b32 v251, 0xffff0000, v89
    v_mfma_f32_16x16x32_bf16 v[216:219], v[196:199], v[48:51], v[216:219]
    v_lshlrev_b32 v252, 16, v90
    v_and_b32 v253, 0xffff0000, v90
    v_lshlrev_b32 v254, 16, v91
    v_and_b32 v255, 0xffff0000, v91
    v_mfma_f32_16x16x32_bf16 v[220:223], v[200:203], v[48:51], v[220:223]
    v_mul_f32 v248, v241, v248
    v_mul_f32 v249, v241, v249
    v_mul_f32 v250, v241, v250
    v_mul_f32 v251, v241, v251
    v_mfma_f32_16x16x32_bf16 v[224:227], v[204:207], v[48:51], v[224:227]
    v_mul_f32 v252, v241, v252
    v_mul_f32 v253, v241, v253
    v_mul_f32 v254, v241, v254
    v_mul_f32 v255, v241, v255
    v_mfma_f32_16x16x32_bf16 v[228:231], v[208:211], v[48:51], v[228:231]
    v_cvt_pk_bf16_f32 v88, v248, v249
    v_cvt_pk_bf16_f32 v89, v250, v251
    v_cvt_pk_bf16_f32 v90, v252, v253
    v_cvt_pk_bf16_f32 v91, v254, v255
    s_nop 1
    v_mfma_f32_16x16x32_bf16 v[32:35], v[112:115], v[52:55], 0
    v_lshlrev_b32 v248, 16, v92
    v_and_b32 v249, 0xffff0000, v92
    v_lshlrev_b32 v250, 16, v93
    v_and_b32 v251, 0xffff0000, v93
    v_mfma_f32_16x16x32_bf16 v[36:39], v[116:119], v[52:55], 0
    v_lshlrev_b32 v252, 16, v94
    v_and_b32 v253, 0xffff0000, v94
    v_lshlrev_b32 v254, 16, v95
    v_and_b32 v255, 0xffff0000, v95
    v_mfma_f32_16x16x32_bf16 v[40:43], v[120:123], v[52:55], 0
    v_mul_f32 v248, v244, v248
    v_mul_f32 v249, v244, v249
    v_mul_f32 v250, v244, v250
    v_mul_f32 v251, v244, v251
    v_mfma_f32_16x16x32_bf16 v[44:47], v[124:127], v[52:55], 0
    v_mul_f32 v252, v244, v252
    v_mul_f32 v253, v244, v253
    v_mul_f32 v254, v244, v254
    v_mul_f32 v255, v244, v255
    v_mfma_f32_16x16x32_bf16 v[48:51], v[128:131], v[52:55], 0
    v_cvt_pk_bf16_f32 v92, v248, v249
    v_cvt_pk_bf16_f32 v93, v250, v251
    v_cvt_pk_bf16_f32 v94, v252, v253
    v_cvt_pk_bf16_f32 v95, v254, v255
    v_mfma_f32_16x16x32_bf16 v[32:35], v[132:135], v[56:59], v[32:35]
    v_lshlrev_b32 v248, 16, v96
    v_and_b32 v249, 0xffff0000, v96
    v_lshlrev_b32 v250, 16, v97
    v_and_b32 v251, 0xffff0000, v97
    v_mfma_f32_16x16x32_bf16 v[36:39], v[136:139], v[56:59], v[36:39]
    v_lshlrev_b32 v252, 16, v98
    v_and_b32 v253, 0xffff0000, v98
    v_lshlrev_b32 v254, 16, v99
    v_and_b32 v255, 0xffff0000, v99
    v_mfma_f32_16x16x32_bf16 v[40:43], v[140:143], v[56:59], v[40:43]
    v_mul_f32 v248, v244, v248
    v_mul_f32 v249, v244, v249
    v_mul_f32 v250, v244, v250
    v_mul_f32 v251, v244, v251
    v_mfma_f32_16x16x32_bf16 v[44:47], v[144:147], v[56:59], v[44:47]
    v_mul_f32 v252, v244, v252
    v_mul_f32 v253, v244, v253
    v_mul_f32 v254, v244, v254
    v_mul_f32 v255, v244, v255
    v_mfma_f32_16x16x32_bf16 v[48:51], v[148:151], v[56:59], v[48:51]
    v_cvt_pk_bf16_f32 v96, v248, v249
    v_cvt_pk_bf16_f32 v97, v250, v251
    v_cvt_pk_bf16_f32 v98, v252, v253
    v_cvt_pk_bf16_f32 v99, v254, v255
    v_mfma_f32_16x16x32_bf16 v[32:35], v[152:155], v[60:63], v[32:35]
    v_lshlrev_b32 v248, 16, v100
    v_and_b32 v249, 0xffff0000, v100
    v_lshlrev_b32 v250, 16, v101
    v_and_b32 v251, 0xffff0000, v101
    v_mfma_f32_16x16x32_bf16 v[36:39], v[156:159], v[60:63], v[36:39]
    v_lshlrev_b32 v252, 16, v102
    v_and_b32 v253, 0xffff0000, v102
    v_lshlrev_b32 v254, 16, v103
    v_and_b32 v255, 0xffff0000, v103
    v_mfma_f32_16x16x32_bf16 v[40:43], v[160:163], v[60:63], v[40:43]
    v_mul_f32 v248, v244, v248
    v_mul_f32 v249, v244, v249
    v_mul_f32 v250, v244, v250
    v_mul_f32 v251, v244, v251
    v_mfma_f32_16x16x32_bf16 v[44:47], v[164:167], v[60:63], v[44:47]
    v_mul_f32 v252, v245, v252
    v_mul_f32 v253, v245, v253
    v_mul_f32 v254, v245, v254
    v_mul_f32 v255, v245, v255
    v_mfma_f32_16x16x32_bf16 v[48:51], v[168:171], v[60:63], v[48:51]
    v_cvt_pk_bf16_f32 v100, v248, v249
    v_cvt_pk_bf16_f32 v101, v250, v251
    v_cvt_pk_bf16_f32 v102, v252, v253
    v_cvt_pk_bf16_f32 v103, v254, v255
    v_mfma_f32_16x16x32_bf16 v[32:35], v[172:175], v[64:67], v[32:35]
    v_lshlrev_b32 v248, 16, v104
    v_and_b32 v249, 0xffff0000, v104
    v_lshlrev_b32 v250, 16, v105
    v_and_b32 v251, 0xffff0000, v105
    v_mfma_f32_16x16x32_bf16 v[36:39], v[176:179], v[64:67], v[36:39]
    v_lshlrev_b32 v252, 16, v106
    v_and_b32 v253, 0xffff0000, v106
    v_lshlrev_b32 v254, 16, v107
    v_and_b32 v255, 0xffff0000, v107
    v_mfma_f32_16x16x32_bf16 v[40:43], v[180:183], v[64:67], v[40:43]
    v_mul_f32 v248, v245, v248
    v_mul_f32 v249, v245, v249
    v_mul_f32 v250, v245, v250
    v_mul_f32 v251, v245, v251
    v_mfma_f32_16x16x32_bf16 v[44:47], v[184:187], v[64:67], v[44:47]
    v_mul_f32 v252, v245, v252
    v_mul_f32 v253, v245, v253
    v_mul_f32 v254, v245, v254
    v_mul_f32 v255, v245, v255
    v_mfma_f32_16x16x32_bf16 v[48:51], v[188:191], v[64:67], v[48:51]
    v_cvt_pk_bf16_f32 v104, v248, v249
    v_cvt_pk_bf16_f32 v105, v250, v251
    v_cvt_pk_bf16_f32 v106, v252, v253
    v_cvt_pk_bf16_f32 v107, v254, v255
    v_mfma_f32_16x16x32_bf16 v[32:35], v[192:195], v[68:71], v[32:35]
    v_lshlrev_b32 v248, 16, v108
    v_and_b32 v249, 0xffff0000, v108
    v_lshlrev_b32 v250, 16, v109
    v_and_b32 v251, 0xffff0000, v109
    v_mfma_f32_16x16x32_bf16 v[36:39], v[196:199], v[68:71], v[36:39]
    v_lshlrev_b32 v252, 16, v110
    v_and_b32 v253, 0xffff0000, v110
    v_lshlrev_b32 v254, 16, v111
    v_and_b32 v255, 0xffff0000, v111
    v_mfma_f32_16x16x32_bf16 v[40:43], v[200:203], v[68:71], v[40:43]
    v_mul_f32 v248, v245, v248
    v_mul_f32 v249, v245, v249
    v_mul_f32 v250, v245, v250
    v_mul_f32 v251, v245, v251
    v_mfma_f32_16x16x32_bf16 v[44:47], v[204:207], v[68:71], v[44:47]
    v_mul_f32 v252, v245, v252
    v_mul_f32 v253, v245, v253
    v_mul_f32 v254, v245, v254
    v_mul_f32 v255, v245, v255
    v_mfma_f32_16x16x32_bf16 v[48:51], v[208:211], v[68:71], v[48:51]
    v_cvt_pk_bf16_f32 v108, v248, v249
    v_cvt_pk_bf16_f32 v109, v250, v251
    v_cvt_pk_bf16_f32 v110, v252, v253
    v_cvt_pk_bf16_f32 v111, v254, v255
    s_nop 1
    v_mfma_f32_16x16x32_bf16 v[52:55], v[112:115], v[72:75], 0
    v_mfma_f32_16x16x32_bf16 v[56:59], v[116:119], v[72:75], 0
    v_mfma_f32_16x16x32_bf16 v[60:63], v[120:123], v[72:75], 0
    v_mfma_f32_16x16x32_bf16 v[64:67], v[124:127], v[72:75], 0
    v_mfma_f32_16x16x32_bf16 v[68:71], v[128:131], v[72:75], 0
    v_mfma_f32_16x16x32_bf16 v[52:55], v[132:135], v[76:79], v[52:55]
    v_mfma_f32_16x16x32_bf16 v[56:59], v[136:139], v[76:79], v[56:59]
    v_mfma_f32_16x16x32_bf16 v[60:63], v[140:143], v[76:79], v[60:63]
    v_mfma_f32_16x16x32_bf16 v[64:67], v[144:147], v[76:79], v[64:67]
    v_mfma_f32_16x16x32_bf16 v[68:71], v[148:151], v[76:79], v[68:71]
    v_mfma_f32_16x16x32_bf16 v[52:55], v[152:155], v[80:83], v[52:55]
    v_mfma_f32_16x16x32_bf16 v[56:59], v[156:159], v[80:83], v[56:59]
    v_mfma_f32_16x16x32_bf16 v[60:63], v[160:163], v[80:83], v[60:63]
    v_mfma_f32_16x16x32_bf16 v[64:67], v[164:167], v[80:83], v[64:67]
    v_mfma_f32_16x16x32_bf16 v[68:71], v[168:171], v[80:83], v[68:71]
    v_mfma_f32_16x16x32_bf16 v[52:55], v[172:175], v[84:87], v[52:55]
    v_mfma_f32_16x16x32_bf16 v[56:59], v[176:179], v[84:87], v[56:59]
    v_mfma_f32_16x16x32_bf16 v[60:63], v[180:183], v[84:87], v[60:63]
    v_mfma_f32_16x16x32_bf16 v[64:67], v[184:187], v[84:87], v[64:67]
    v_mfma_f32_16x16x32_bf16 v[68:71], v[188:191], v[84:87], v[68:71]
    v_mfma_f32_16x16x32_bf16 v[52:55], v[192:195], v[88:91], v[52:55]
    v_mfma_f32_16x16x32_bf16 v[56:59], v[196:199], v[88:91], v[56:59]
    v_mfma_f32_16x16x32_bf16 v[60:63], v[200:203], v[88:91], v[60:63]
    v_mfma_f32_16x16x32_bf16 v[64:67], v[204:207], v[88:91], v[64:67]
    v_mfma_f32_16x16x32_bf16 v[68:71], v[208:211], v[88:91], v[68:71]
    s_mov_b32 s29, 0
L_lw_bfree:
    ds_read_b32 v11, v10 offset:8
    s_add_u32 s29, s29, 1
    s_cmp_ge_u32 s29, 40000000
    s_waitcnt lgkmcnt(0)
    s_cbranch_scc1 L_lw_bfree_ok
    v_cmp_gt_u32 vcc, 4, v11
    s_cbranch_vccz L_lw_bfree_ok
    s_sleep 1
    s_branch L_lw_bfree
L_lw_bfree_ok:
    v_mov_b32 v11, 1
    s_mov_b64 exec, 1
    ds_add_u32 v10, v11 offset:12
    s_mov_b64 exec, -1
    s_cmp_lg_u32 s20, 7
    s_cbranch_scc1 L_k2_gfree
    s_mov_b32 s29, 0
L_lw_gfree:
    ds_read_b32 v11, v10 offset:12
    s_add_u32 s29, s29, 1
    s_cmp_ge_u32 s29, 40000000
    s_waitcnt lgkmcnt(0)
    s_cbranch_scc1 L_lw_gfree_ok
    v_cmp_gt_u32 vcc, 16, v11
    s_cbranch_vccz L_lw_gfree_ok
    s_sleep 1
    s_branch L_lw_gfree
L_lw_gfree_ok:
L_k2_gfree:
    ds_write_b128 v5, v[212:215] offset:0
    ds_write_b128 v5, v[216:219] offset:1024
    ds_write_b128 v5, v[220:223] offset:2048
    ds_write_b128 v5, v[224:227] offset:3072
    ds_write_b128 v5, v[228:231] offset:4096
    ds_write_b128 v5, v[32:35] offset:5120
    ds_write_b128 v5, v[36:39] offset:6144
    ds_write_b128 v5, v[40:43] offset:7168
    ds_write_b128 v5, v[44:47] offset:8192
    ds_write_b128 v5, v[48:51] offset:9216
    s_nop 1
    v_mfma_f32_16x16x32_bf16 v[72:75], v[112:115], v[92:95], 0
    v_mfma_f32_16x16x32_bf16 v[76:79], v[116:119], v[92:95], 0
    v_mfma_f32_16x16x32_bf16 v[80:83], v[120:123], v[92:95], 0
    v_mfma_f32_16x16x32_bf16 v[84:87], v[124:127], v[92:95], 0
    v_mfma_f32_16x16x32_bf16 v[88:91], v[128:131], v[92:95], 0
    v_mfma_f32_16x16x32_bf16 v[72:75], v[132:135], v[96:99], v[72:75]
    v_mfma_f32_16x16x32_bf16 v[76:79], v[136:139], v[96:99], v[76:79]
    v_mfma_f32_16x16x32_bf16 v[80:83], v[140:143], v[96:99], v[80:83]
    v_mfma_f32_16x16x32_bf16 v[84:87], v[144:147], v[96:99], v[84:87]
    v_mfma_f32_16x16x32_bf16 v[88:91], v[148:151], v[96:99], v[88:91]
    v_mfma_f32_16x16x32_bf16 v[72:75], v[152:155], v[100:103], v[72:75]
    v_mfma_f32_16x16x32_bf16 v[76:79], v[156:159], v[100:103], v[76:79]
    v_mfma_f32_16x16x32_bf16 v[80:83], v[160:163], v[100:103], v[80:83]
    v_mfma_f32_16x16x32_bf16 v[84:87], v[164:167], v[100:103], v[84:87]
    v_mfma_f32_16x16x32_bf16 v[88:91], v[168:171], v[100:103], v[88:91]
    v_mfma_f32_16x16x32_bf16 v[72:75], v[172:175], v[104:107], v[72:75]
    v_mfma_f32_16x16x32_bf16 v[76:79], v[176:179], v[104:107], v[76:79]
    v_mfma_f32_16x16x32_bf16 v[80:83], v[180:183], v[104:107], v[80:83]
    v_mfma_f32_16x16x32_bf16 v[84:87], v[184:187], v[104:107], v[84:87]
    v_mfma_f32_16x16x32_bf16 v[88:91], v[188:191], v[104:107], v[88:91]
    v_mfma_f32_16x16x32_bf16 v[72:75], v[192:195], v[108:111], v[72:75]
    v_mfma_f32_16x16x32_bf16 v[76:79], v[196:199], v[108:111], v[76:79]
    v_mfma_f32_16x16x32_bf16 v[80:83], v[200:203], v[108:111], v[80:83]
    v_mfma_f32_16x16x32_bf16 v[84:87], v[204:207], v[108:111], v[84:87]
    v_mfma_f32_16x16x32_bf16 v[88:91], v[208:211], v[108:111], v[88:91]
    ds_write_b128 v5, v[52:55] offset:10240
    ds_write_b128 v5, v[56:59] offset:11264
    ds_write_b128 v5, v[60:63] offset:12288
    ds_write_b128 v5, v[64:67] offset:13312
    ds_write_b128 v5, v[68:71] offset:14336
    s_nop 3
    ds_write_b128 v5, v[72:75] offset:15360
    ds_write_b128 v5, v[76:79] offset:16384
    ds_write_b128 v5, v[80:83] offset:17408
    ds_write_b128 v5, v[84:87] offset:18432
    ds_write_b128 v5, v[88:91] offset:19456
    v_lshlrev_b32 v140, 16, v18
    v_and_b32 v141, 0xffff0000, v18
    v_lshlrev_b32 v142, 16, v19
    v_and_b32 v143, 0xffff0000, v19
    v_lshlrev_b32 v144, 16, v20
    v_and_b32 v145, 0xffff0000, v20
    v_lshlrev_b32 v146, 16, v21
    v_and_b32 v147, 0xffff0000, v21
    v_mov_b32 v14, 0xbfb8aa3b
    v_mov_b32 v16, 1.0
    v_add_u32 v7, 61440, v6
    v_add_u32 v8, 122880, v6
    s_waitcnt lgkmcnt(0)
    s_barrier
    ds_read_b128 v[32:35], v6 offset:0
    ds_read_b128 v[36:39], v6 offset:1024
    ds_read_b128 v[64:67], v6 offset:20480
    ds_read_b128 v[68:71], v6 offset:21504
    ds_read_b128 v[72:75], v6 offset:40960
    ds_read_b128 v[76:79], v6 offset:41984
    ds_read_b128 v[80:83], v7 offset:0
    ds_read_b128 v[84:87], v7 offset:1024
    ds_read_b128 v[40:43], v7 offset:20480
    ds_read_b128 v[44:47], v7 offset:21504
    ds_read_b128 v[88:91], v7 offset:40960
    ds_read_b128 v[92:95], v7 offset:41984
    ds_read_b128 v[96:99], v8 offset:0
    ds_read_b128 v[100:103], v8 offset:1024
    ds_read_b128 v[104:107], v8 offset:20480
    s_waitcnt lgkmcnt(14)
    ds_read_b128 v[108:111], v8 offset:21504
    s_waitcnt lgkmcnt(12)
    v_pk_add_f32 v[32:33], v[32:33], v[64:65]
    v_pk_add_f32 v[34:35], v[34:35], v[66:67]
    v_pk_add_f32 v[36:37], v[36:37], v[68:69]
    v_pk_add_f32 v[38:39], v[38:39], v[70:71]
    s_waitcnt lgkmcnt(10)
    v_pk_add_f32 v[32:33], v[32:33], v[72:73]
    v_pk_add_f32 v[34:35], v[34:35], v[74:75]
    v_pk_add_f32 v[36:37], v[36:37], v[76:77]
    v_pk_add_f32 v[38:39], v[38:39], v[78:79]
    s_waitcnt lgkmcnt(8)
    v_pk_add_f32 v[32:33], v[32:33], v[80:81]
    v_pk_add_f32 v[34:35], v[34:35], v[82:83]
    v_pk_add_f32 v[36:37], v[36:37], v[84:85]
    v_pk_add_f32 v[38:39], v[38:39], v[86:87]
    v_pk_mul_f32 v[176:177], v[32:33], v[14:15] op_sel_hi:[1,0]
    v_pk_mul_f32 v[178:179], v[34:35], v[14:15] op_sel_hi:[1,0]
    v_pk_mul_f32 v[180:181], v[36:37], v[14:15] op_sel_hi:[1,0]
    v_pk_mul_f32 v[182:183], v[38:39], v[14:15] op_sel_hi:[1,0]
    v_exp_f32 v176, v176
    v_exp_f32 v177, v177
    v_exp_f32 v178, v178
    v_exp_f32 v179, v179
    v_exp_f32 v180, v180
    v_exp_f32 v181, v181
    v_exp_f32 v182, v182
    v_exp_f32 v183, v183
    s_waitcnt lgkmcnt(4)
    v_pk_add_f32 v[40:41], v[40:41], v[88:89]
    v_pk_add_f32 v[42:43], v[42:43], v[90:91]
    v_pk_add_f32 v[44:45], v[44:45], v[92:93]
    v_pk_add_f32 v[46:47], v[46:47], v[94:95]
    s_waitcnt lgkmcnt(2)
    v_pk_add_f32 v[40:41], v[40:41], v[96:97]
    v_pk_add_f32 v[42:43], v[42:43], v[98:99]
    v_pk_add_f32 v[44:45], v[44:45], v[100:101]
    v_pk_add_f32 v[46:47], v[46:47], v[102:103]
    s_waitcnt lgkmcnt(0)
    v_pk_add_f32 v[40:41], v[40:41], v[104:105]
    v_pk_add_f32 v[42:43], v[42:43], v[106:107]
    v_pk_add_f32 v[44:45], v[44:45], v[108:109]
    v_pk_add_f32 v[46:47], v[46:47], v[110:111]
    v_pk_add_f32 v[176:177], v[176:177], v[16:17] op_sel_hi:[1,0]
    v_pk_mul_f32 v[32:33], v[32:33], v[40:41]
    v_pk_add_f32 v[178:179], v[178:179], v[16:17] op_sel_hi:[1,0]
    v_pk_mul_f32 v[34:35], v[34:35], v[42:43]
    v_pk_add_f32 v[180:181], v[180:181], v[16:17] op_sel_hi:[1,0]
    v_pk_mul_f32 v[36:37], v[36:37], v[44:45]
    v_pk_add_f32 v[182:183], v[182:183], v[16:17] op_sel_hi:[1,0]
    v_pk_mul_f32 v[38:39], v[38:39], v[46:47]
    v_rcp_f32 v176, v176
    v_rcp_f32 v177, v177
    v_rcp_f32 v178, v178
    v_rcp_f32 v179, v179
    v_rcp_f32 v180, v180
    v_rcp_f32 v181, v181
    v_rcp_f32 v182, v182
    v_rcp_f32 v183, v183
    s_nop 0
    v_pk_fma_f32 v[140:141], v[32:33], v[176:177], v[140:141]
    v_pk_fma_f32 v[142:143], v[34:35], v[178:179], v[142:143]
    v_pk_fma_f32 v[144:145], v[36:37], v[180:181], v[144:145]
    v_pk_fma_f32 v[146:147], v[38:39], v[182:183], v[146:147]
    v_cvt_pk_bf16_f32 v32, v140, v141
    v_cvt_pk_bf16_f32 v33, v142, v143
    buffer_store_dwordx2 v[32:33], v4, s[12:15], 0 offen offset:0
    v_cvt_pk_bf16_f32 v34, v144, v145
    v_cvt_pk_bf16_f32 v35, v146, v147
    buffer_store_dwordx2 v[34:35], v4, s[12:15], 0 offen offset:32
    s_endpgm
.section .rodata,"a"
.p2align 6
.amdhsa_kernel recurrent_scan__linear_attn_block__glu_gated_swiglu__prompt_kernel
  .amdhsa_next_free_vgpr 256
  .amdhsa_next_free_sgpr 102
  .amdhsa_accum_offset 256
  .amdhsa_group_segment_fixed_size 0
  .amdhsa_kernarg_size 80
  .amdhsa_user_sgpr_count 2
  .amdhsa_user_sgpr_kernarg_segment_ptr 1
  .amdhsa_system_sgpr_workgroup_id_x 1
.end_amdhsa_kernel
```
